```python
import torch

def _softmax(x, axis=-1):
    return torch.softmax(x, dim=axis)

def _gelu(x):
    return torch.nn.functional.gelu(x, approximate='tanh')

def _silu(x):
    return torch.nn.functional.silu(x)

def _sigmoid(x):
    return torch.sigmoid(x)

def _layernorm(x, axis=-1, eps=1e-05):
    m = x.mean(dim=axis, keepdim=True)
    v = x.var(dim=axis, keepdim=True, unbiased=False)
    return (x - m) / torch.sqrt(v + eps)

def _scatter_add(tgt, idx, src, axis=0):
    return tgt.clone().index_add_(axis, idx, src)

def _segment_sum(src, seg, n):
    out = torch.zeros((n,) + src.shape[1:], dtype=src.dtype)
    return out.index_add_(0, seg, src)

def _pad(x, pw):
    flat = tuple((v for pair in reversed(pw) for v in pair))
    return torch.nn.functional.pad(x, flat)
kernel_name = 'adaLN_cond__compressed_kv_cla__dense_activation_mish__prompt'

def setup_inputs():

    _w = lambda a: (lambda t: t.to(torch.bfloat16) if t.is_floating_point() else t)(torch.as_tensor(a))

    def _A_setup():
        B, H, Sq, Sk, D, M = (1, 32, 2048, 2048, 128, 512)
        Dc = 4 * D
        return {'x': _w((lambda *s: torch.randn(*s, dtype=torch.bfloat16) * 0.05)(B, Sq, M)), 'c_kv': _w((lambda *s: torch.randn(*s, dtype=torch.bfloat16) * 0.4)(B, Sk, Dc)), 'w_q': _w((lambda *s: torch.randn(*s, dtype=torch.bfloat16) * 3.2)(M, H, D) * M ** (-0.5)), 'w_uk': _w((lambda *s: torch.randn(*s, dtype=torch.bfloat16) * 3.2)(Dc, H, D) * Dc ** (-0.5)), 'w_uv': _w((lambda *s: torch.randn(*s, dtype=torch.bfloat16) * 0.4)(Dc, H, D) * Dc ** (-0.5)), 'w_o': _w((lambda *s: torch.randn(*s, dtype=torch.bfloat16) * 0.4)(H, D, M) * (H * D) ** (-0.5))}
    _A_in = _A_setup()

    def _B_setup():
        B, S, D, F = (1, 2048, 512, 1792)
        return {'x': _w((lambda *s: torch.randn(*s, dtype=torch.bfloat16) * 0.05)(B, S, D)), 'w1': _w((lambda *s: torch.randn(*s, dtype=torch.bfloat16) * 0.8)(D, F) * D ** (-0.5)), 'b1': _w((lambda *s: torch.randn(*s, dtype=torch.bfloat16) * 0.2)(F)), 'w2': _w((lambda *s: torch.randn(*s, dtype=torch.bfloat16) * 0.1)(F, D) * F ** (-0.5))}
    _B_in = _B_setup()
    return {'A_x': _A_in['x'], 'A_c_kv': _A_in['c_kv'], 'A_w_q': _A_in['w_q'], 'A_w_uk': _A_in['w_uk'], 'A_w_uv': _A_in['w_uv'], 'A_w_o': _A_in['w_o'], 'B_x': _B_in['x'], 'B_w1': _B_in['w1'], 'B_b1': _B_in['b1'], 'B_w2': _B_in['w2'], 'c': _w((lambda *s: torch.randn(*s, dtype=torch.bfloat16) * 0.1)(1, 512) * 8.0), 'w_mod': _w((lambda *s: torch.randn(*s, dtype=torch.bfloat16) * 0.1)(512, 6 * 512) * 512 ** (-0.5) * 8.0)}

def reference(A_x, A_c_kv, A_w_q, A_w_uk, A_w_uv, A_w_o, B_x, B_w1, B_b1, B_w2, c, w_mod):

    def _A_ref(x, c_kv, w_q, w_uk, w_uv, w_o):
        B, Sq, M = (x.shape[0], x.shape[1], x.shape[2])
        Sk = c_kv.shape[1]
        H, D = (w_q.shape[1], w_q.shape[2])
        q = torch.einsum('bqm,mhd->bhqd', x, w_q)
        k = torch.einsum('bkc,chd->bhkd', c_kv, w_uk)
        v = torch.einsum('bkc,chd->bhkd', c_kv, w_uv)
        scores = torch.einsum('bhqd,bhkd->bhqk', q, k) * D ** (-0.5)
        off = Sk - Sq
        qi = torch.arange(Sq)[:, None]
        kj = torch.arange(Sk)[None, :]
        cmask = kj <= qi + off
        scores = torch.where(cmask[None, None], scores, -1000000000.0)
        p = _softmax(scores, axis=-1)
        ctx = torch.einsum('bhqk,bhkd->bhqd', p, v)
        return torch.einsum('bhqd,hdm->bqm', ctx, w_o)

    def _B_ref(x, w1, b1, w2):
        h = torch.einsum('bsd,df->bsf', x, w1) + b1
        sp = torch.log1p(torch.exp(-torch.abs(h))) + torch.where(h > 0, h, torch.zeros_like(h))
        act = h * torch.tanh(sp)
        return torch.einsum('bsf,fd->bsd', act, w2)
    x = A_x
    mod = (_silu(c) @ w_mod).reshape(c.shape[0], 6, 1, -1)
    sa, ca, ga, sb, cb, gb = (mod[:, 0].clone(), mod[:, 1].clone(), mod[:, 2].clone(), mod[:, 3].clone(), mod[:, 4].clone(), mod[:, 5].clone())
    h = _layernorm(x, axis=-1) * (1 + ca) + sa
    x = x + ga * _A_ref(h, A_c_kv, A_w_q, A_w_uk, A_w_uv, A_w_o)
    h = _layernorm(x, axis=-1) * (1 + cb) + sb
    x = x + gb * _B_ref(h, B_w1, B_b1, B_w2)
    return x
```

```asm
; @launch grid=(256,1,1) block=(512,1,1) lds=163840
.amdgcn_target "amdgcn-amd-amdhsa--gfx950"
.text
.globl adaLN_cond__compressed_kv_cla__dense_activation_mish__prompt_kernel
.p2align 8
.type adaLN_cond__compressed_kv_cla__dense_activation_mish__prompt_kernel,@function
adaLN_cond__compressed_kv_cla__dense_activation_mish__prompt_kernel:
    s_cmp_ge_u32 s2, 256
    s_cbranch_scc1 Ldone
    s_getpc_b64 s[76:77]
    s_mov_b32 s78, CODE_END - adaLN_cond__compressed_kv_cla__dense_activation_mish__prompt_kernel - 64
    s_mov_b32 s79, 0x20000
    s_lshr_b32 s42, s2, 3
    s_lshl_b32 s42, s42, 12
    v_lshlrev_b32 v4, 7, v0
    v_subrev_u32 v4, 61440, v4
    v_cmp_le_u32 vcc, 480, v0
    s_nop 0
    s_and_saveexec_b64 s[80:81], vcc
    s_cbranch_execz Lnocpf
    buffer_load_dword v125, v4, s[76:79], s42 offen
Lnocpf:
    s_mov_b64 exec, s[80:81]
    s_load_dwordx2 s[8:9], s[0:1], 8
    s_load_dwordx2 s[12:13], s[0:1], 112
    s_load_dwordx2 s[16:17], s[0:1], 24
    s_load_dwordx2 s[20:21], s[0:1], 16
    s_load_dwordx2 s[48:49], s[0:1], 32
    s_load_dwordx2 s[52:53], s[0:1], 0
    s_load_dwordx2 s[56:57], s[0:1], 88
    s_load_dwordx2 s[60:61], s[0:1], 80
    s_mov_b32 s10, 2097152
    s_mov_b32 s11, 0x20000
    s_mov_b32 s14, 268435456
    s_mov_b32 s15, 0x20000
    s_mov_b32 s18, 4194304
    s_mov_b32 s19, 0x20000
    s_mov_b32 s22, 4194304
    s_mov_b32 s23, 0x20000
    s_mov_b32 s50, 4194304
    s_mov_b32 s51, 0x20000
    s_mov_b32 s54, 2097152
    s_mov_b32 s55, 0x20000
    s_mov_b32 s58, 3145728
    s_mov_b32 s59, 0x20000
    s_mov_b32 s62, 1024
    s_mov_b32 s63, 0x20000
    v_and_b32 v1, 63, v0
    v_lshrrev_b32 v3, 6, v0
    v_lshlrev_b32 v2, 4, v1
    v_readfirstlane_b32 s24, v3
    s_and_b32 s42, s2, 7
    s_bfe_u32 s43, s2, 0x20003
    s_lshl_b32 s25, s42, 2
    s_add_u32 s25, s25, s43
    s_lshr_b32 s26, s2, 5
    s_lshl_b32 s43, s43, 1
    s_add_u32 s70, s42, s43
    s_add_u32 s70, s70, s26
    s_and_b32 s70, s70, 0
    s_and_b32 s27, s24, 3
    s_lshr_b32 s28, s24, 2
    v_lshrrev_b32 v3, 3, v1
    v_and_b32 v12, 7, v1
    v_lshrrev_b32 v13, 4, v1
    v_add_u32 v14, 0, v13
    v_xor_b32 v14, v14, v12
    v_lshlrev_b32 v14, 4, v14
    v_lshl_add_u32 v14, v3, 10, v14
    v_add_u32 v4, 0, v14
    v_add_u32 v7, 21504, v14
    v_add_u32 v14, 4, v13
    v_xor_b32 v14, v14, v12
    v_lshlrev_b32 v14, 4, v14
    v_lshl_add_u32 v14, v3, 10, v14
    v_add_u32 v5, 7168, v14
    v_add_u32 v6, 14336, v14
    v_and_b32 v15, 15, v1
    v_lshlrev_b32 v14, 2, v13
    v_xor_b32 v14, v14, v15
    v_lshlrev_b32 v14, 4, v14
    v_lshl_add_u32 v8, v13, 13, v14
    v_add_u32 v9, 31744, v8
    v_add_u32 v10, 63488, v8
    v_add_u32 v11, 95232, v8
    v_xor_b32 v10, 16, v10
    v_xor_b32 v11, 16, v11
    s_lshl_b32 s68, s27, 1
    s_add_u32 s68, s68, s28
    s_lshl_b32 s68, s68, 3
    s_add_u32 s68, s68, s26
    s_lshl_b32 s68, s68, 15
    s_lshl_b32 s69, s27, 17
    s_lshl_b32 s42, s25, 8
    s_add_u32 s69, s69, s42
    s_lshl_b32 s73, s24, 17
    s_add_u32 s73, s73, s42
    s_lshl_b32 s72, s24, 12
    s_and_b32 s42, s2, 3
    s_lshl_b32 s42, s42, 7
    s_lshl_b32 s43, s24, 4
    s_add_u32 s42, s42, s43
    v_add_u32 v15, s42, v3
    v_mul_u32_u24 v14, 6144, v15
    v_lshl_add_u32 v14, v12, 4, v14
    v_lshlrev_b32 v15, 1, v15
    s_lshr_b32 s44, s2, 2
    s_min_u32 s44, s44, 47
    s_lshl_b32 s44, s44, 7
    s_cmp_ge_u32 s2, 999
    s_cselect_b32 s44, 0x40000000, s44
    s_add_u32 s45, s44, 49152
    s_lshl_b32 s42, s2, 3
    s_add_u32 s42, s42, s24
    s_lshl_b32 s43, s42, 10
    s_waitcnt lgkmcnt(0)
    s_load_dword s64, s[12:13], 131072
    s_mov_b32 s76, s16
    s_mov_b32 s77, s17
    s_cmp_ge_u32 s24, 4
    s_cselect_b32 s16, s48, s16
    s_cselect_b32 s17, s49, s17
    s_mov_b32 s46, s43
    s_bitcmp1_b32 s2, 0
    s_cselect_b32 s76, s48, s76
    s_cselect_b32 s77, s49, s77
    s_lshl_b32 s42, s24, 8
    s_add_u32 s42, s42, s2
    s_lshr_b32 s42, s42, 1
    s_mov_b32 s78, s22
    s_lshl_b32 s43, s2, 1
    s_and_b32 s47, s24, 1
    s_add_u32 s43, s43, s47
    s_cmp_ge_u32 s24, 4
    s_cselect_b32 s76, s20, s76
    s_cselect_b32 s77, s21, s77
    s_cselect_b32 s42, s43, s42
    s_cmp_ge_u32 s24, 6
    s_cselect_b32 s76, s8, s76
    s_cselect_b32 s77, s9, s77
    s_cselect_b32 s78, s10, s78
    s_cselect_b32 s42, s2, s42
    s_mov_b32 s79, 0x20000
    s_lshl_b32 s67, s42, 13
    s_cmp_eq_u32 s24, 6
    s_cselect_b32 s42, 0x1c80, -1
    v_lshlrev_b32 v95, 7, v1
    v_and_b32 v95, s42, v95
    buffer_load_dwordx4 v[84:87], v14, s[56:59], s44 offen nt
    buffer_load_dwordx4 v[88:91], v14, s[56:59], s45 offen nt
    buffer_load_dwordx4 v[80:83], v2, s[52:55], s46 offen
    buffer_load_ushort v92, v15, s[60:63], 0 offen
    buffer_load_ushort v93, v15, s[60:63], 0 offen offset:16
    s_add_u32 s74, s68, 0
    s_add_u32 m0, s72, 0
    s_nop 0
    buffer_load_dwordx4 v4, s[8:11], s74 offen offset:0 lds
    buffer_load_dwordx4 v5, s[8:11], s74 offen offset:1024 lds
    buffer_load_dwordx4 v6, s[8:11], s74 offen offset:2048 lds
    buffer_load_dwordx4 v7, s[8:11], s74 offen offset:3072 lds
    s_add_u32 s74, s69, 0
    s_add_u32 m0, s72, 32768
    s_nop 0
    buffer_load_dwordx4 v8, s[16:19], s74 offen offset:0 lds
    buffer_load_dwordx4 v9, s[16:19], s74 offen offset:1024 lds
    buffer_load_dwordx4 v10, s[16:19], s74 offen offset:2048 lds
    buffer_load_dwordx4 v11, s[16:19], s74 offen offset:3072 lds
    v_lshrrev_b32 v13, 5, v1
    v_bfe_u32 v12, v1, 2, 2
    v_and_b32 v14, 3, v1
    v_bfe_u32 v15, v1, 4, 1
    v_lshlrev_b32 v16, 3, v14
    v_lshl_add_u32 v16, v15, 5, v16
    v_lshl_add_u32 v17, v13, 3, v12
    v_lshl_add_u32 v30, v17, 8, v16
    v_mov_b32 v31, v12
    v_lshrrev_b32 v13, 4, v1
    v_and_b32 v18, 1, v14
    v_lshrrev_b32 v19, 1, v14
    v_and_b32 v16, 1, v12
    v_lshlrev_b32 v16, 4, v16
    v_lshrrev_b32 v17, 1, v12
    v_lshl_add_u32 v16, v17, 2, v16
    v_add_u32 v16, v16, v14
    v_lshl_add_u32 v17, v18, 1, v15
    v_lshlrev_b32 v17, 4, v17
    v_lshl_add_u32 v17, v19, 3, v17
    v_lshl_add_u32 v18, v13, 3, v12
    v_lshl_add_u32 v17, v18, 8, v17
    s_and_b32 s42, s24, 2
    v_xor_b32 v18, s42, v12
    v_lshl_add_u32 v17, v18, 6, v17
    s_lshl_b32 s43, s28, 14
    v_add_u32 v17, s43, v17
    v_bfe_u32 v18, v16, 1, 2
    v_lshrrev_b32 v19, 1, v16
    v_xor_b32 v19, v19, v16
    v_bfe_u32 v19, v19, 3, 1
    v_lshl_add_u32 v18, v19, 2, v18
    v_xor_b32 v18, v18, v13
    v_lshlrev_b32 v18, 4, v18
    v_lshl_add_u32 v16, v16, 7, v18
    s_and_b32 s42, s24, 1
    s_lshl_b32 s42, s42, 14
    v_add_u32 v16, s42, v16
    s_mov_b32 s63, 16
    s_add_u32 s62, s63, 64
    s_lshr_b32 s43, s2, 2
    s_lshl_b32 s43, s43, 15
    s_and_b32 s42, s2, 3
    s_lshl_b32 s42, s42, 7
    s_add_u32 s43, s43, s42
    s_add_u32 s43, s43, s72
    s_add_u32 s71, s43, 1048576
    v_and_b32 v14, 7, v1
    v_lshrrev_b32 v15, 3, v1
    v_lshlrev_b32 v28, 4, v14
    v_lshl_add_u32 v28, v15, 9, v28
    v_lshlrev_b32 v29, 3, v0
    v_lshlrev_b32 v12, 12, v15
    v_lshl_add_u32 v12, v14, 7, v12
    s_lshl_b32 s42, s24, 4
    s_add_u32 s42, s42, 131072
    v_add_u32 v12, s42, v12
    s_lshl_b32 s42, s24, 8
    s_add_u32 s42, s42, 132096
    v_lshlrev_b32 v13, 5, v14
    v_add_u32 v13, s42, v13
    s_add_u32 s42, s72, 131072
    v_add_u32 v14, s42, v2
    s_sub_u32 s37, 15, s26
    s_cmp_eq_u32 s28, 0
    s_cselect_b32 s36, s37, s26
    s_lshl_b32 s29, s36, 2
    s_add_u32 s29, s29, s27
    s_lshl_b32 s34, s27, 12
    s_mov_b32 s38, 0x40004000
    s_lshl_b32 s44, s29, 15
    s_add_u32 s44, s44, 1048576
    v_and_b32 v3, 15, v1
    v_lshlrev_b32 v3, 4, v3
    v_lshrrev_b32 v15, 5, v1
    v_lshl_add_u32 v3, v15, 9, v3
    v_bfe_u32 v15, v1, 4, 1
    v_lshl_add_u32 v3, v15, 10, v3
    s_waitcnt lgkmcnt(0)
    s_mul_i32 s64, s64, 0x9e3779b1
    s_add_u32 s64, s64, 0x7f4a7c15
    v_add_u32 v18, 0, v16
    v_add_u32 v20, 32768, v17
    v_xor_b32 v19, 64, v18
    v_xor_b32 v21, s63, v20
    v_xor_b32 v22, 64, v20
    v_xor_b32 v23, s62, v20
    s_waitcnt vmcnt(8)
    v_lshlrev_b32 v92, 16, v92
    v_lshlrev_b32 v112, 16, v80
    v_mul_f32 v94, 0xbfb8aa3b, v92
    v_and_b32 v113, 0xffff0000, v80
    v_exp_f32 v94, v94
    v_lshlrev_b32 v114, 16, v81
    v_add_f32 v94, 1.0, v94
    v_and_b32 v115, 0xffff0000, v81
    v_rcp_f32 v94, v94
    v_lshlrev_b32 v116, 16, v82
    v_mul_f32 v94, v94, v92
    v_and_b32 v117, 0xffff0000, v82
    v_cvt_pk_bf16_f32 v92, v94, v94
    v_lshlrev_b32 v118, 16, v83
    v_and_b32 v92, 0xffff0000, v92
    v_and_b32 v119, 0xffff0000, v83
    v_lshlrev_b32 v93, 16, v93
    v_readfirstlane_b32 s50, v112
    v_mul_f32 v94, 0xbfb8aa3b, v93
    s_mov_b32 s51, s50
    v_exp_f32 v94, v94
    v_pk_add_f32 v[32:33], v[112:113], s[50:51] neg_lo:[0,1] neg_hi:[0,1]
    v_add_f32 v94, 1.0, v94
    v_pk_add_f32 v[34:35], v[114:115], s[50:51] neg_lo:[0,1] neg_hi:[0,1]
    v_rcp_f32 v94, v94
    v_pk_add_f32 v[36:37], v[116:117], s[50:51] neg_lo:[0,1] neg_hi:[0,1]
    v_mul_f32 v94, v94, v93
    v_pk_add_f32 v[38:39], v[118:119], s[50:51] neg_lo:[0,1] neg_hi:[0,1]
    v_cvt_pk_bf16_f32 v93, v94, v94
    v_pk_mul_f32 v[122:123], v[32:33], v[32:33]
    v_and_b32 v93, 0xffff0000, v93
    v_pk_add_f32 v[120:121], v[32:33], v[34:35]
    v_lshlrev_b32 v96, 16, v84
    v_pk_fma_f32 v[122:123], v[34:35], v[34:35], v[122:123]
    v_and_b32 v97, 0xffff0000, v84
    v_pk_fma_f32 v[122:123], v[36:37], v[36:37], v[122:123]
    v_lshlrev_b32 v98, 16, v85
    v_pk_fma_f32 v[122:123], v[38:39], v[38:39], v[122:123]
    v_and_b32 v99, 0xffff0000, v85
    v_pk_add_f32 v[120:121], v[120:121], v[36:37]
    v_lshlrev_b32 v100, 16, v86
    v_pk_add_f32 v[120:121], v[120:121], v[38:39]
    v_and_b32 v101, 0xffff0000, v86
    v_add_f32 v120, v120, v121
    v_lshlrev_b32 v102, 16, v87
    v_add_f32 v121, v122, v123
    v_and_b32 v103, 0xffff0000, v87
    v_add_f32_dpp v120, v120, v120 quad_perm:[1,0,3,2] row_mask:0xf bank_mask:0xf
    v_lshlrev_b32 v104, 16, v88
    v_add_f32_dpp v121, v121, v121 quad_perm:[1,0,3,2] row_mask:0xf bank_mask:0xf
    v_and_b32 v105, 0xffff0000, v88
    v_add_f32_dpp v120, v120, v120 quad_perm:[2,3,0,1] row_mask:0xf bank_mask:0xf
    v_lshlrev_b32 v106, 16, v89
    v_add_f32_dpp v121, v121, v121 quad_perm:[2,3,0,1] row_mask:0xf bank_mask:0xf
    v_and_b32 v107, 0xffff0000, v89
    v_add_f32_dpp v120, v120, v120 row_half_mirror row_mask:0xf bank_mask:0xf
    v_lshlrev_b32 v108, 16, v90
    v_add_f32_dpp v121, v121, v121 row_half_mirror row_mask:0xf bank_mask:0xf
    v_and_b32 v109, 0xffff0000, v90
    v_add_f32_dpp v120, v120, v120 row_mirror row_mask:0xf bank_mask:0xf
    v_lshlrev_b32 v110, 16, v91
    v_add_f32_dpp v121, v121, v121 row_mirror row_mask:0xf bank_mask:0xf
    v_and_b32 v111, 0xffff0000, v91
    v_mov_b32 v122, v120
    v_pk_mul_f32 v[96:97], v[96:97], v[92:93] op_sel_hi:[1,0]
    v_mov_b32 v123, v121
    v_pk_mul_f32 v[98:99], v[98:99], v[92:93] op_sel_hi:[1,0]
    v_permlane16_swap_b32 v122, v120
    v_pk_mul_f32 v[100:101], v[100:101], v[92:93] op_sel_hi:[1,0]
    v_permlane16_swap_b32 v123, v121
    v_pk_mul_f32 v[102:103], v[102:103], v[92:93] op_sel_hi:[1,0]
    v_pk_add_f32 v[120:121], v[120:121], v[122:123]
    v_fmac_f32 v96, v93, v104
    v_mov_b32 v122, v120
    v_fmac_f32 v97, v93, v105
    v_mov_b32 v123, v121
    v_fmac_f32 v98, v93, v106
    v_permlane32_swap_b32 v122, v120
    v_fmac_f32 v99, v93, v107
    v_permlane32_swap_b32 v123, v121
    v_fmac_f32 v100, v93, v108
    v_pk_add_f32 v[120:121], v[120:121], v[122:123]
    v_fmac_f32 v101, v93, v109
    v_mul_f32 v120, 0x3b000000, v120
    v_fmac_f32 v102, v93, v110
    v_mul_f32 v121, 0x3b000000, v121
    s_add_u32 s74, s68, 128
    s_add_u32 m0, s72, 65536
    s_nop 0
    buffer_load_dwordx4 v4, s[8:11], s74 offen offset:0 lds
    buffer_load_dwordx4 v5, s[8:11], s74 offen offset:1024 lds
    buffer_load_dwordx4 v6, s[8:11], s74 offen offset:2048 lds
    buffer_load_dwordx4 v7, s[8:11], s74 offen offset:3072 lds
    v_fmac_f32 v103, v93, v111
    v_fma_f32 v121, -v120, v120, v121
    v_add_f32_dpp v96, v96, v96 row_ror:8 row_mask:0xf bank_mask:0xf
    v_add_f32 v120, s50, v120
    v_add_f32_dpp v97, v97, v97 row_ror:8 row_mask:0xf bank_mask:0xf
    v_max_f32 v121, 0, v121
    v_add_f32_dpp v98, v98, v98 row_ror:8 row_mask:0xf bank_mask:0xf
    v_cvt_pk_bf16_f32 v123, v120, v121
    v_add_f32_dpp v99, v99, v99 row_ror:8 row_mask:0xf bank_mask:0xf
    v_lshlrev_b32 v120, 16, v123
    v_add_f32_dpp v100, v100, v100 row_ror:8 row_mask:0xf bank_mask:0xf
    v_and_b32 v122, 0xffff0000, v123
    v_add_f32_dpp v101, v101, v101 row_ror:8 row_mask:0xf bank_mask:0xf
    v_add_f32 v122, 0x3727c5ac, v122
    v_add_f32_dpp v102, v102, v102 row_ror:8 row_mask:0xf bank_mask:0xf
    v_cvt_pk_bf16_f32 v122, v122, v122
    v_add_f32_dpp v103, v103, v103 row_ror:8 row_mask:0xf bank_mask:0xf
    v_and_b32 v122, 0xffff0000, v122
    v_mov_b32 v104, v96
    v_sqrt_f32 v122, v122
    v_mov_b32 v105, v97
    v_pk_add_f32 v[112:113], v[112:113], v[120:121] op_sel_hi:[1,0] neg_lo:[0,1] neg_hi:[0,1]
    v_mov_b32 v106, v98
    v_pk_add_f32 v[114:115], v[114:115], v[120:121] op_sel_hi:[1,0] neg_lo:[0,1] neg_hi:[0,1]
    v_mov_b32 v107, v99
    v_pk_add_f32 v[116:117], v[116:117], v[120:121] op_sel_hi:[1,0] neg_lo:[0,1] neg_hi:[0,1]
    v_mov_b32 v108, v100
    v_pk_add_f32 v[118:119], v[118:119], v[120:121] op_sel_hi:[1,0] neg_lo:[0,1] neg_hi:[0,1]
    v_mov_b32 v109, v101
    v_cvt_pk_bf16_f32 v122, v122, v122
    v_mov_b32 v110, v102
    v_and_b32 v122, 0xffff0000, v122
    v_mov_b32 v111, v103
    v_rcp_f32 v122, v122
    v_permlane16_swap_b32 v104, v96
    v_cvt_pk_bf16_f32 v80, v112, v113
    v_permlane16_swap_b32 v105, v97
    v_cvt_pk_bf16_f32 v81, v114, v115
    v_permlane16_swap_b32 v106, v98
    v_cvt_pk_bf16_f32 v82, v116, v117
    v_permlane16_swap_b32 v107, v99
    v_cvt_pk_bf16_f32 v83, v118, v119
    v_permlane16_swap_b32 v108, v100
    v_lshlrev_b32 v112, 16, v80
    v_permlane16_swap_b32 v109, v101
    v_and_b32 v113, 0xffff0000, v80
    v_permlane16_swap_b32 v110, v102
    v_lshlrev_b32 v114, 16, v81
    v_permlane16_swap_b32 v111, v103
    v_and_b32 v115, 0xffff0000, v81
    v_pk_add_f32 v[96:97], v[96:97], v[104:105]
    v_lshlrev_b32 v116, 16, v82
    v_pk_add_f32 v[98:99], v[98:99], v[106:107]
    v_and_b32 v117, 0xffff0000, v82
    v_pk_add_f32 v[100:101], v[100:101], v[108:109]
    v_lshlrev_b32 v118, 16, v83
    v_pk_add_f32 v[102:103], v[102:103], v[110:111]
    v_and_b32 v119, 0xffff0000, v83
    v_mov_b32 v104, v96
    v_pk_mul_f32 v[112:113], v[112:113], v[122:123] op_sel_hi:[1,0]
    v_mov_b32 v105, v97
    v_pk_mul_f32 v[114:115], v[114:115], v[122:123] op_sel_hi:[1,0]
    v_mov_b32 v106, v98
    v_pk_mul_f32 v[116:117], v[116:117], v[122:123] op_sel_hi:[1,0]
    v_mov_b32 v107, v99
    v_pk_mul_f32 v[118:119], v[118:119], v[122:123] op_sel_hi:[1,0]
    v_mov_b32 v108, v100
    v_cvt_pk_bf16_f32 v80, v112, v113
    v_mov_b32 v109, v101
    v_cvt_pk_bf16_f32 v81, v114, v115
    v_mov_b32 v110, v102
    v_cvt_pk_bf16_f32 v82, v116, v117
    v_mov_b32 v111, v103
    v_cvt_pk_bf16_f32 v83, v118, v119
    v_permlane32_swap_b32 v104, v96
    v_permlane32_swap_b32 v105, v97
    v_permlane32_swap_b32 v106, v98
    v_permlane32_swap_b32 v107, v99
    v_permlane32_swap_b32 v108, v100
    v_permlane32_swap_b32 v109, v101
    v_permlane32_swap_b32 v110, v102
    v_permlane32_swap_b32 v111, v103
    v_pk_add_f32 v[96:97], v[96:97], v[104:105]
    v_pk_add_f32 v[98:99], v[98:99], v[106:107]
    v_pk_add_f32 v[100:101], v[100:101], v[108:109]
    v_pk_add_f32 v[102:103], v[102:103], v[110:111]
    ds_write_b128 v13, v[96:99]
    ds_write_b128 v13, v[100:103] offset:16
    ds_write_b128 v12, v[80:83]
    s_waitcnt lgkmcnt(0)
    s_waitcnt vmcnt(4)
    s_barrier
    ds_read_b128 v[80:83], v14
    s_cmp_eq_u32 s24, 0
    s_cbranch_scc0 Lw0_1
    v_lshrrev_b32 v13, 1, v29
    v_add_u32 v13, 132096, v13
    ds_read_b32 v96, v13 offset:0
    ds_read_b32 v97, v13 offset:256
    ds_read_b32 v98, v13 offset:512
    ds_read_b32 v99, v13 offset:768
    ds_read_b32 v100, v13 offset:1024
    ds_read_b32 v101, v13 offset:1280
    ds_read_b32 v102, v13 offset:1536
    ds_read_b32 v103, v13 offset:1792
Lw0_1:
    s_cmp_ge_u32 s24, 4
    s_cbranch_scc1 Lvgemm
    ds_read_b64_tr_b16 v[32:33], v20 offset:0
    ds_read_b64_tr_b16 v[34:35], v20 offset:1024
    ds_read_b128 v[64:67], v18 offset:0
    ds_read_b64_tr_b16 v[36:37], v21 offset:0
    ds_read_b64_tr_b16 v[38:39], v21 offset:1024
    ds_read_b64_tr_b16 v[40:41], v22 offset:0
    ds_read_b64_tr_b16 v[42:43], v22 offset:1024
    ds_read_b64_tr_b16 v[44:45], v23 offset:0
    ds_read_b64_tr_b16 v[46:47], v23 offset:1024
    ds_read_b128 v[68:71], v19 offset:1024
    ds_read_b128 v[72:75], v18 offset:4096
    ds_read_b128 v[76:79], v19 offset:5120
    s_waitcnt lgkmcnt(9)
    v_mfma_f32_16x16x32_bf16 v[128:131], v[32:35], v[64:67], 0
    ds_read_b128 v[24:27], v18 offset:8192
    s_add_u32 s74, s69, 524288
    s_add_u32 m0, s72, 98304
    s_waitcnt lgkmcnt(8)
    v_mfma_f32_16x16x32_bf16 v[132:135], v[36:39], v[64:67], 0
    ds_read_b64_tr_b16 v[48:49], v20 offset:8192
    buffer_load_dwordx4 v8, s[16:19], s74 offen offset:0 lds
    s_waitcnt lgkmcnt(7)
    v_mfma_f32_16x16x32_bf16 v[144:147], v[40:43], v[64:67], 0
    ds_read_b64_tr_b16 v[50:51], v20 offset:9216
    buffer_load_dwordx4 v9, s[16:19], s74 offen offset:1024 lds
    s_waitcnt lgkmcnt(6)
    v_mfma_f32_16x16x32_bf16 v[148:151], v[44:47], v[64:67], 0
    ds_read_b64_tr_b16 v[52:53], v21 offset:8192
    s_waitcnt lgkmcnt(6)
    v_mfma_f32_16x16x32_bf16 v[156:159], v[44:47], v[68:71], 0
    ds_read_b128 v[64:67], v19 offset:9216
    buffer_load_dwordx4 v10, s[16:19], s74 offen offset:2048 lds
    v_mfma_f32_16x16x32_bf16 v[152:155], v[40:43], v[68:71], 0
    ds_read_b64_tr_b16 v[54:55], v21 offset:9216
    v_mfma_f32_16x16x32_bf16 v[140:143], v[36:39], v[68:71], 0
    ds_read_b64_tr_b16 v[56:57], v22 offset:8192
    buffer_load_dwordx4 v11, s[16:19], s74 offen offset:3072 lds
    v_mfma_f32_16x16x32_bf16 v[136:139], v[32:35], v[68:71], 0
    ds_read_b64_tr_b16 v[58:59], v22 offset:9216
    s_waitcnt lgkmcnt(9)
    v_mfma_f32_16x16x32_bf16 v[160:163], v[32:35], v[72:75], 0
    ds_read_b128 v[68:71], v18 offset:12288
    s_add_u32 s74, s68, 256
    s_add_u32 m0, s72, 131072
    v_mfma_f32_16x16x32_bf16 v[164:167], v[36:39], v[72:75], 0
    ds_read_b64_tr_b16 v[60:61], v23 offset:8192
    buffer_load_dwordx4 v4, s[8:11], s74 offen offset:0 lds
    v_mfma_f32_16x16x32_bf16 v[176:179], v[40:43], v[72:75], 0
    ds_read_b64_tr_b16 v[62:63], v23 offset:9216
    buffer_load_dwordx4 v5, s[8:11], s74 offen offset:1024 lds
    v_mfma_f32_16x16x32_bf16 v[180:183], v[44:47], v[72:75], 0
    s_waitcnt lgkmcnt(11)
    v_mfma_f32_16x16x32_bf16 v[188:191], v[44:47], v[76:79], 0
    ds_read_b128 v[72:75], v19 offset:13312
    buffer_load_dwordx4 v6, s[8:11], s74 offen offset:2048 lds
    v_mfma_f32_16x16x32_bf16 v[184:187], v[40:43], v[76:79], 0
    v_mfma_f32_16x16x32_bf16 v[172:175], v[36:39], v[76:79], 0
    buffer_load_dwordx4 v7, s[8:11], s74 offen offset:3072 lds
    v_mfma_f32_16x16x32_bf16 v[168:171], v[32:35], v[76:79], 0
    s_cmp_eq_u32 s24, 0
    s_cbranch_scc0 Lw0_2
    s_cmp_lt_u32 s2, 192
    s_cbranch_scc0 Lnm_3
    v_add_f32 v96, v96, v97
    v_add_f32 v96, v96, v98
    v_add_f32 v96, v96, v99
    v_add_f32 v96, v96, v100
    v_add_f32 v96, v96, v101
    v_add_f32 v96, v96, v102
    v_add_f32 v96, v96, v103
    s_and_b32 s42, s2, 3
    s_mul_i32 s42, s42, 24576
    s_lshr_b32 s43, s2, 2
    s_lshl_b32 s43, s43, 9
    s_add_u32 s42, s42, s43
    s_add_u32 s42, s42, 0
    v_mov_b32 v97, s64
    buffer_store_dwordx2 v[96:97], v29, s[12:15], s42 offen sc1
Lnm_3:
Lw0_2:
    s_cmp_eq_u32 s27, 1
    s_cbranch_scc0 Ltk_4
    v_bfe_u32 v126, v1, 1, 3
    v_lshlrev_b32 v126, 13, v126
    v_and_b32 v127, 1, v1
    v_lshl_add_u32 v126, v127, 7, v126
    s_lshl_b32 s42, s26, 16
    s_lshl_b32 s43, s25, 8
    s_add_u32 s42, s42, s43
    s_add_u32 s42, s42, 1048576
    buffer_load_dword v127, v126, s[16:19], s42 offen
Ltk_4:
    s_cmp_eq_u32 s27, 1
    s_cbranch_scc0 Ltk_5
    v_bfe_u32 v126, v1, 1, 3
    v_lshlrev_b32 v126, 13, v126
    v_and_b32 v127, 1, v1
    v_lshl_add_u32 v126, v127, 7, v126
    s_lshl_b32 s42, s26, 16
    s_lshl_b32 s43, s25, 8
    s_add_u32 s42, s42, s43
    s_add_u32 s42, s42, 1572864
    buffer_load_dword v127, v126, s[16:19], s42 offen
Ltk_5:
    s_cmp_eq_u32 s27, 1
    s_cbranch_scc0 Ltk_6
    v_bfe_u32 v126, v1, 1, 3
    v_lshlrev_b32 v126, 13, v126
    v_and_b32 v127, 1, v1
    v_lshl_add_u32 v126, v127, 7, v126
    s_lshl_b32 s42, s26, 16
    s_lshl_b32 s43, s25, 8
    s_add_u32 s42, s42, s43
    s_add_u32 s42, s42, 2097152
    buffer_load_dword v127, v126, s[16:19], s42 offen
Ltk_6:
    s_waitcnt lgkmcnt(11)
    v_mfma_f32_16x16x32_bf16 v[192:195], v[32:35], v[24:27], 0
    ds_read_b128 v[76:79], v19 offset:0
    v_mfma_f32_16x16x32_bf16 v[196:199], v[36:39], v[24:27], 0
    v_mfma_f32_16x16x32_bf16 v[208:211], v[40:43], v[24:27], 0
    v_mfma_f32_16x16x32_bf16 v[212:215], v[44:47], v[24:27], 0
    s_waitcnt lgkmcnt(8)
    v_mfma_f32_16x16x32_bf16 v[220:223], v[44:47], v[64:67], 0
    ds_read_b128 v[24:27], v18 offset:1024
    v_mfma_f32_16x16x32_bf16 v[216:219], v[40:43], v[64:67], 0
    v_mfma_f32_16x16x32_bf16 v[204:207], v[36:39], v[64:67], 0
    v_mfma_f32_16x16x32_bf16 v[200:203], v[32:35], v[64:67], 0
    s_waitcnt lgkmcnt(5)
    v_mfma_f32_16x16x32_bf16 v[224:227], v[32:35], v[68:71], 0
    ds_read_b128 v[64:67], v19 offset:4096
    v_mfma_f32_16x16x32_bf16 v[228:231], v[36:39], v[68:71], 0
    v_mfma_f32_16x16x32_bf16 v[240:243], v[40:43], v[68:71], 0
    v_mfma_f32_16x16x32_bf16 v[244:247], v[44:47], v[68:71], 0
    s_waitcnt lgkmcnt(3)
    v_mfma_f32_16x16x32_bf16 v[252:255], v[44:47], v[72:75], 0
    ds_read_b128 v[68:71], v18 offset:5120
    v_mfma_f32_16x16x32_bf16 v[248:251], v[40:43], v[72:75], 0
    v_mfma_f32_16x16x32_bf16 v[236:239], v[36:39], v[72:75], 0
    v_mfma_f32_16x16x32_bf16 v[232:235], v[32:35], v[72:75], 0
    s_waitcnt lgkmcnt(3)
    v_mfma_f32_16x16x32_bf16 v[128:131], v[48:51], v[76:79], v[128:131]
    ds_read_b128 v[72:75], v19 offset:8192
    v_mfma_f32_16x16x32_bf16 v[132:135], v[52:55], v[76:79], v[132:135]
    v_mfma_f32_16x16x32_bf16 v[144:147], v[56:59], v[76:79], v[144:147]
    v_mfma_f32_16x16x32_bf16 v[148:151], v[60:63], v[76:79], v[148:151]
    s_waitcnt lgkmcnt(3)
    v_mfma_f32_16x16x32_bf16 v[156:159], v[60:63], v[24:27], v[156:159]
    ds_read_b128 v[76:79], v18 offset:9216
    v_mfma_f32_16x16x32_bf16 v[152:155], v[56:59], v[24:27], v[152:155]
    v_mfma_f32_16x16x32_bf16 v[140:143], v[52:55], v[24:27], v[140:143]
    v_mfma_f32_16x16x32_bf16 v[136:139], v[48:51], v[24:27], v[136:139]
    s_waitcnt lgkmcnt(3)
    v_mfma_f32_16x16x32_bf16 v[160:163], v[48:51], v[64:67], v[160:163]
    ds_read_b128 v[24:27], v19 offset:12288
    v_mfma_f32_16x16x32_bf16 v[164:167], v[52:55], v[64:67], v[164:167]
    v_mfma_f32_16x16x32_bf16 v[176:179], v[56:59], v[64:67], v[176:179]
    v_mfma_f32_16x16x32_bf16 v[180:183], v[60:63], v[64:67], v[180:183]
    s_waitcnt lgkmcnt(3)
    v_mfma_f32_16x16x32_bf16 v[188:191], v[60:63], v[68:71], v[188:191]
    ds_read_b128 v[64:67], v18 offset:13312
    v_mfma_f32_16x16x32_bf16 v[184:187], v[56:59], v[68:71], v[184:187]
    v_mfma_f32_16x16x32_bf16 v[172:175], v[52:55], v[68:71], v[172:175]
    v_add_u32 v18, 65536, v16
    v_mfma_f32_16x16x32_bf16 v[168:171], v[48:51], v[68:71], v[168:171]
    v_add_u32 v20, 98304, v17
    s_waitcnt lgkmcnt(3)
    v_mfma_f32_16x16x32_bf16 v[192:195], v[48:51], v[72:75], v[192:195]
    v_xor_b32 v19, 64, v18
    v_mfma_f32_16x16x32_bf16 v[196:199], v[52:55], v[72:75], v[196:199]
    v_xor_b32 v21, s63, v20
    v_mfma_f32_16x16x32_bf16 v[208:211], v[56:59], v[72:75], v[208:211]
    v_xor_b32 v22, 64, v20
    v_mfma_f32_16x16x32_bf16 v[212:215], v[60:63], v[72:75], v[212:215]
    v_xor_b32 v23, s62, v20
    s_waitcnt lgkmcnt(0)
    s_waitcnt vmcnt(4)
    v_mfma_f32_16x16x32_bf16 v[220:223], v[60:63], v[76:79], v[220:223]
    s_barrier
    ds_read_b64_tr_b16 v[32:33], v20 offset:0
    v_mfma_f32_16x16x32_bf16 v[216:219], v[56:59], v[76:79], v[216:219]
    ds_read_b64_tr_b16 v[34:35], v20 offset:1024
    v_mfma_f32_16x16x32_bf16 v[204:207], v[52:55], v[76:79], v[204:207]
    ds_read_b128 v[68:71], v18 offset:0
    v_mfma_f32_16x16x32_bf16 v[200:203], v[48:51], v[76:79], v[200:203]
    ds_read_b64_tr_b16 v[36:37], v21 offset:0
    v_mfma_f32_16x16x32_bf16 v[224:227], v[48:51], v[24:27], v[224:227]
    ds_read_b64_tr_b16 v[38:39], v21 offset:1024
    s_add_u32 s74, s69, 1048576
    s_add_u32 m0, s72, 0
    v_mfma_f32_16x16x32_bf16 v[228:231], v[52:55], v[24:27], v[228:231]
    ds_read_b64_tr_b16 v[40:41], v22 offset:0
    buffer_load_dwordx4 v8, s[16:19], s74 offen offset:0 lds
    v_mfma_f32_16x16x32_bf16 v[240:243], v[56:59], v[24:27], v[240:243]
    ds_read_b64_tr_b16 v[42:43], v22 offset:1024
    buffer_load_dwordx4 v9, s[16:19], s74 offen offset:1024 lds
    v_mfma_f32_16x16x32_bf16 v[244:247], v[60:63], v[24:27], v[244:247]
    ds_read_b64_tr_b16 v[44:45], v23 offset:0
    v_mfma_f32_16x16x32_bf16 v[252:255], v[60:63], v[64:67], v[252:255]
    ds_read_b64_tr_b16 v[46:47], v23 offset:1024
    buffer_load_dwordx4 v10, s[16:19], s74 offen offset:2048 lds
    v_mfma_f32_16x16x32_bf16 v[248:251], v[56:59], v[64:67], v[248:251]
    ds_read_b128 v[72:75], v19 offset:1024
    v_mfma_f32_16x16x32_bf16 v[236:239], v[52:55], v[64:67], v[236:239]
    ds_read_b128 v[76:79], v18 offset:4096
    buffer_load_dwordx4 v11, s[16:19], s74 offen offset:3072 lds
    v_mfma_f32_16x16x32_bf16 v[232:235], v[48:51], v[64:67], v[232:235]
    ds_read_b128 v[24:27], v19 offset:5120
    s_waitcnt lgkmcnt(9)
    v_mfma_f32_16x16x32_bf16 v[128:131], v[32:35], v[68:71], v[128:131]
    ds_read_b128 v[64:67], v18 offset:8192
    s_waitcnt lgkmcnt(8)
    v_mfma_f32_16x16x32_bf16 v[132:135], v[36:39], v[68:71], v[132:135]
    ds_read_b64_tr_b16 v[48:49], v20 offset:8192
    s_waitcnt lgkmcnt(7)
    v_mfma_f32_16x16x32_bf16 v[144:147], v[40:43], v[68:71], v[144:147]
    ds_read_b64_tr_b16 v[50:51], v20 offset:9216
    s_waitcnt lgkmcnt(6)
    v_mfma_f32_16x16x32_bf16 v[148:151], v[44:47], v[68:71], v[148:151]
    ds_read_b64_tr_b16 v[52:53], v21 offset:8192
    s_waitcnt lgkmcnt(6)
    v_mfma_f32_16x16x32_bf16 v[156:159], v[44:47], v[72:75], v[156:159]
    ds_read_b128 v[68:71], v19 offset:9216
    s_add_u32 s74, s68, 384
    s_add_u32 m0, s72, 32768
    v_mfma_f32_16x16x32_bf16 v[152:155], v[40:43], v[72:75], v[152:155]
    ds_read_b64_tr_b16 v[54:55], v21 offset:9216
    buffer_load_dwordx4 v4, s[8:11], s74 offen offset:0 lds
    v_mfma_f32_16x16x32_bf16 v[140:143], v[36:39], v[72:75], v[140:143]
    ds_read_b64_tr_b16 v[56:57], v22 offset:8192
    buffer_load_dwordx4 v5, s[8:11], s74 offen offset:1024 lds
    v_mfma_f32_16x16x32_bf16 v[136:139], v[32:35], v[72:75], v[136:139]
    ds_read_b64_tr_b16 v[58:59], v22 offset:9216
    s_waitcnt lgkmcnt(9)
    v_mfma_f32_16x16x32_bf16 v[160:163], v[32:35], v[76:79], v[160:163]
    ds_read_b128 v[72:75], v18 offset:12288
    buffer_load_dwordx4 v6, s[8:11], s74 offen offset:2048 lds
    v_mfma_f32_16x16x32_bf16 v[164:167], v[36:39], v[76:79], v[164:167]
    ds_read_b64_tr_b16 v[60:61], v23 offset:8192
    v_mfma_f32_16x16x32_bf16 v[176:179], v[40:43], v[76:79], v[176:179]
    ds_read_b64_tr_b16 v[62:63], v23 offset:9216
    buffer_load_dwordx4 v7, s[8:11], s74 offen offset:3072 lds
    v_mfma_f32_16x16x32_bf16 v[180:183], v[44:47], v[76:79], v[180:183]
    s_waitcnt lgkmcnt(11)
    v_mfma_f32_16x16x32_bf16 v[188:191], v[44:47], v[24:27], v[188:191]
    ds_read_b128 v[76:79], v19 offset:13312
    v_mfma_f32_16x16x32_bf16 v[184:187], v[40:43], v[24:27], v[184:187]
    v_mfma_f32_16x16x32_bf16 v[172:175], v[36:39], v[24:27], v[172:175]
    v_mfma_f32_16x16x32_bf16 v[168:171], v[32:35], v[24:27], v[168:171]
    s_cmp_eq_u32 s27, 1
    s_cbranch_scc0 Ltk_7
    v_bfe_u32 v126, v1, 1, 3
    v_lshlrev_b32 v126, 13, v126
    v_and_b32 v127, 1, v1
    v_lshl_add_u32 v126, v127, 7, v126
    s_lshl_b32 s42, s26, 16
    s_lshl_b32 s43, s25, 8
    s_add_u32 s42, s42, s43
    s_add_u32 s42, s42, 2621440
    buffer_load_dword v127, v126, s[16:19], s42 offen
Ltk_7:
    s_waitcnt lgkmcnt(11)
    v_mfma_f32_16x16x32_bf16 v[192:195], v[32:35], v[64:67], v[192:195]
    ds_read_b128 v[24:27], v19 offset:0
    v_mfma_f32_16x16x32_bf16 v[196:199], v[36:39], v[64:67], v[196:199]
    v_mfma_f32_16x16x32_bf16 v[208:211], v[40:43], v[64:67], v[208:211]
    v_mfma_f32_16x16x32_bf16 v[212:215], v[44:47], v[64:67], v[212:215]
    s_waitcnt lgkmcnt(8)
    v_mfma_f32_16x16x32_bf16 v[220:223], v[44:47], v[68:71], v[220:223]
    ds_read_b128 v[64:67], v18 offset:1024
    v_mfma_f32_16x16x32_bf16 v[216:219], v[40:43], v[68:71], v[216:219]
    v_mfma_f32_16x16x32_bf16 v[204:207], v[36:39], v[68:71], v[204:207]
    v_mfma_f32_16x16x32_bf16 v[200:203], v[32:35], v[68:71], v[200:203]
    s_waitcnt lgkmcnt(5)
    v_mfma_f32_16x16x32_bf16 v[224:227], v[32:35], v[72:75], v[224:227]
    ds_read_b128 v[68:71], v19 offset:4096
    v_mfma_f32_16x16x32_bf16 v[228:231], v[36:39], v[72:75], v[228:231]
    v_mfma_f32_16x16x32_bf16 v[240:243], v[40:43], v[72:75], v[240:243]
    v_mfma_f32_16x16x32_bf16 v[244:247], v[44:47], v[72:75], v[244:247]
    s_waitcnt lgkmcnt(3)
    v_mfma_f32_16x16x32_bf16 v[252:255], v[44:47], v[76:79], v[252:255]
    ds_read_b128 v[72:75], v18 offset:5120
    v_mfma_f32_16x16x32_bf16 v[248:251], v[40:43], v[76:79], v[248:251]
    v_mfma_f32_16x16x32_bf16 v[236:239], v[36:39], v[76:79], v[236:239]
    v_mfma_f32_16x16x32_bf16 v[232:235], v[32:35], v[76:79], v[232:235]
    s_waitcnt lgkmcnt(3)
    v_mfma_f32_16x16x32_bf16 v[128:131], v[48:51], v[24:27], v[128:131]
    ds_read_b128 v[76:79], v19 offset:8192
    v_mfma_f32_16x16x32_bf16 v[132:135], v[52:55], v[24:27], v[132:135]
    v_mfma_f32_16x16x32_bf16 v[144:147], v[56:59], v[24:27], v[144:147]
    v_mfma_f32_16x16x32_bf16 v[148:151], v[60:63], v[24:27], v[148:151]
    s_waitcnt lgkmcnt(3)
    v_mfma_f32_16x16x32_bf16 v[156:159], v[60:63], v[64:67], v[156:159]
    ds_read_b128 v[24:27], v18 offset:9216
    s_mov_b32 s75, 0
    buffer_load_dwordx2 v[96:97], v29, s[12:15], s75 offen sc1
    v_mfma_f32_16x16x32_bf16 v[152:155], v[56:59], v[64:67], v[152:155]
    s_mov_b32 s75, 4096
    buffer_load_dwordx2 v[104:105], v29, s[12:15], s75 offen sc1
    v_mfma_f32_16x16x32_bf16 v[140:143], v[52:55], v[64:67], v[140:143]
    s_mov_b32 s75, 24576
    buffer_load_dwordx2 v[98:99], v29, s[12:15], s75 offen sc1
    v_mfma_f32_16x16x32_bf16 v[136:139], v[48:51], v[64:67], v[136:139]
    s_mov_b32 s75, 28672
    buffer_load_dwordx2 v[106:107], v29, s[12:15], s75 offen sc1
    s_waitcnt lgkmcnt(3)
    v_mfma_f32_16x16x32_bf16 v[160:163], v[48:51], v[68:71], v[160:163]
    ds_read_b128 v[64:67], v19 offset:12288
    s_mov_b32 s75, 49152
    buffer_load_dwordx2 v[100:101], v29, s[12:15], s75 offen sc1
    v_mfma_f32_16x16x32_bf16 v[164:167], v[52:55], v[68:71], v[164:167]
    s_mov_b32 s75, 53248
    buffer_load_dwordx2 v[108:109], v29, s[12:15], s75 offen sc1
    v_mfma_f32_16x16x32_bf16 v[176:179], v[56:59], v[68:71], v[176:179]
    s_mov_b32 s75, 73728
    buffer_load_dwordx2 v[102:103], v29, s[12:15], s75 offen sc1
    v_mfma_f32_16x16x32_bf16 v[180:183], v[60:63], v[68:71], v[180:183]
    s_mov_b32 s75, 77824
    buffer_load_dwordx2 v[110:111], v29, s[12:15], s75 offen sc1
    s_waitcnt lgkmcnt(3)
    v_mfma_f32_16x16x32_bf16 v[188:191], v[60:63], v[72:75], v[188:191]
    ds_read_b128 v[68:71], v18 offset:13312
    v_mfma_f32_16x16x32_bf16 v[184:187], v[56:59], v[72:75], v[184:187]
    v_mfma_f32_16x16x32_bf16 v[172:175], v[52:55], v[72:75], v[172:175]
    v_add_u32 v18, 131072, v16
    v_mfma_f32_16x16x32_bf16 v[168:171], v[48:51], v[72:75], v[168:171]
    v_add_u32 v20, 0, v17
    s_waitcnt lgkmcnt(3)
    v_mfma_f32_16x16x32_bf16 v[192:195], v[48:51], v[76:79], v[192:195]
    v_xor_b32 v19, 64, v18
    v_mfma_f32_16x16x32_bf16 v[196:199], v[52:55], v[76:79], v[196:199]
    v_xor_b32 v21, s63, v20
    v_mfma_f32_16x16x32_bf16 v[208:211], v[56:59], v[76:79], v[208:211]
    v_xor_b32 v22, 64, v20
    v_mfma_f32_16x16x32_bf16 v[212:215], v[60:63], v[76:79], v[212:215]
    v_xor_b32 v23, s62, v20
    s_waitcnt lgkmcnt(0)
    s_waitcnt vmcnt(12)
    v_mfma_f32_16x16x32_bf16 v[220:223], v[60:63], v[24:27], v[220:223]
    s_barrier
    ds_read_b64_tr_b16 v[32:33], v20 offset:0
    v_mfma_f32_16x16x32_bf16 v[216:219], v[56:59], v[24:27], v[216:219]
    ds_read_b64_tr_b16 v[34:35], v20 offset:1024
    v_mfma_f32_16x16x32_bf16 v[204:207], v[52:55], v[24:27], v[204:207]
    ds_read_b128 v[72:75], v18 offset:0
    v_mfma_f32_16x16x32_bf16 v[200:203], v[48:51], v[24:27], v[200:203]
    ds_read_b64_tr_b16 v[36:37], v21 offset:0
    v_mfma_f32_16x16x32_bf16 v[224:227], v[48:51], v[64:67], v[224:227]
    ds_read_b64_tr_b16 v[38:39], v21 offset:1024
    s_add_u32 s74, s69, 1572864
    s_add_u32 m0, s72, 65536
    v_mfma_f32_16x16x32_bf16 v[228:231], v[52:55], v[64:67], v[228:231]
    ds_read_b64_tr_b16 v[40:41], v22 offset:0
    buffer_load_dwordx4 v8, s[16:19], s74 offen offset:0 lds
    v_mfma_f32_16x16x32_bf16 v[240:243], v[56:59], v[64:67], v[240:243]
    ds_read_b64_tr_b16 v[42:43], v22 offset:1024
    buffer_load_dwordx4 v9, s[16:19], s74 offen offset:1024 lds
    v_mfma_f32_16x16x32_bf16 v[244:247], v[60:63], v[64:67], v[244:247]
    ds_read_b64_tr_b16 v[44:45], v23 offset:0
    v_mfma_f32_16x16x32_bf16 v[252:255], v[60:63], v[68:71], v[252:255]
    ds_read_b64_tr_b16 v[46:47], v23 offset:1024
    buffer_load_dwordx4 v10, s[16:19], s74 offen offset:2048 lds
    v_mfma_f32_16x16x32_bf16 v[248:251], v[56:59], v[68:71], v[248:251]
    ds_read_b128 v[76:79], v19 offset:1024
    v_mfma_f32_16x16x32_bf16 v[236:239], v[52:55], v[68:71], v[236:239]
    ds_read_b128 v[24:27], v18 offset:4096
    buffer_load_dwordx4 v11, s[16:19], s74 offen offset:3072 lds
    v_mfma_f32_16x16x32_bf16 v[232:235], v[48:51], v[68:71], v[232:235]
    ds_read_b128 v[64:67], v19 offset:5120
    s_waitcnt vmcnt(4)
    s_waitcnt lgkmcnt(9)
    v_mfma_f32_16x16x32_bf16 v[128:131], v[32:35], v[72:75], v[128:131]
    ds_read_b128 v[68:71], v18 offset:8192
    v_xor_b32 v97, s64, v97
    v_xor_b32 v99, s64, v99
    s_waitcnt lgkmcnt(8)
    v_mfma_f32_16x16x32_bf16 v[132:135], v[36:39], v[72:75], v[132:135]
    ds_read_b64_tr_b16 v[48:49], v20 offset:8192
    v_xor_b32 v101, s64, v101
    v_xor_b32 v103, s64, v103
    s_waitcnt lgkmcnt(7)
    v_mfma_f32_16x16x32_bf16 v[144:147], v[40:43], v[72:75], v[144:147]
    ds_read_b64_tr_b16 v[50:51], v20 offset:9216
    v_xor_b32 v105, s64, v105
    v_xor_b32 v107, s64, v107
    s_waitcnt lgkmcnt(6)
    v_mfma_f32_16x16x32_bf16 v[148:151], v[44:47], v[72:75], v[148:151]
    ds_read_b64_tr_b16 v[52:53], v21 offset:8192
    v_xor_b32 v109, s64, v109
    v_xor_b32 v111, s64, v111
    s_waitcnt lgkmcnt(6)
    v_mfma_f32_16x16x32_bf16 v[156:159], v[44:47], v[76:79], v[156:159]
    ds_read_b128 v[72:75], v19 offset:9216
    s_add_u32 s74, s68, 512
    s_add_u32 m0, s72, 98304
    s_nop 0
    buffer_load_dwordx4 v4, s[8:11], s74 offen offset:0 lds
    v_or3_b32 v97, v97, v99, v101
    v_mfma_f32_16x16x32_bf16 v[152:155], v[40:43], v[76:79], v[152:155]
    ds_read_b64_tr_b16 v[54:55], v21 offset:9216
    v_or3_b32 v103, v103, v105, v107
    v_or3_b32 v97, v97, v109, v111
    v_or_b32 v97, v97, v103
    v_mfma_f32_16x16x32_bf16 v[140:143], v[36:39], v[76:79], v[140:143]
    ds_read_b64_tr_b16 v[56:57], v22 offset:8192
    buffer_load_dwordx4 v5, s[8:11], s74 offen offset:1024 lds
    v_mfma_f32_16x16x32_bf16 v[136:139], v[32:35], v[76:79], v[136:139]
    ds_read_b64_tr_b16 v[58:59], v22 offset:9216
    v_cmp_ne_u32 vcc, 0, v97
    s_nop 0
    s_cbranch_vccnz Lml_8
Lmok_9:
    s_waitcnt lgkmcnt(9)
    v_mfma_f32_16x16x32_bf16 v[160:163], v[32:35], v[24:27], v[160:163]
    ds_read_b128 v[76:79], v18 offset:12288
    buffer_load_dwordx4 v6, s[8:11], s74 offen offset:2048 lds
    v_add_f32 v96, v96, v98
    v_add_f32 v100, v100, v102
    v_mfma_f32_16x16x32_bf16 v[164:167], v[36:39], v[24:27], v[164:167]
    ds_read_b64_tr_b16 v[60:61], v23 offset:8192
    v_add_f32 v104, v104, v106
    v_add_f32 v108, v108, v110
    v_mfma_f32_16x16x32_bf16 v[176:179], v[40:43], v[24:27], v[176:179]
    ds_read_b64_tr_b16 v[62:63], v23 offset:9216
    buffer_load_dwordx4 v7, s[8:11], s74 offen offset:3072 lds
    v_add_f32 v96, v96, v100
    v_add_f32 v104, v104, v108
    v_mfma_f32_16x16x32_bf16 v[180:183], v[44:47], v[24:27], v[180:183]
    v_cvt_pk_bf16_f32 v97, v96, v104
    v_lshlrev_b32 v96, 16, v97
    s_waitcnt lgkmcnt(11)
    v_mfma_f32_16x16x32_bf16 v[188:191], v[44:47], v[64:67], v[188:191]
    ds_read_b128 v[24:27], v19 offset:13312
    v_and_b32 v104, 0xffff0000, v97
    v_add_f32 v104, 1.0, v104
    v_mfma_f32_16x16x32_bf16 v[184:187], v[40:43], v[64:67], v[184:187]
    v_cvt_pk_bf16_f32 v96, v96, v104
    v_lshlrev_b32 v84, 16, v80
    v_mfma_f32_16x16x32_bf16 v[172:175], v[36:39], v[64:67], v[172:175]
    v_and_b32 v85, 0xffff0000, v80
    v_lshlrev_b32 v86, 16, v81
    v_mfma_f32_16x16x32_bf16 v[168:171], v[32:35], v[64:67], v[168:171]
    v_and_b32 v87, 0xffff0000, v81
    v_lshlrev_b32 v88, 16, v82
    s_cmp_eq_u32 s27, 1
    s_cbranch_scc0 Ltk_10
    v_bfe_u32 v126, v1, 1, 3
    v_lshlrev_b32 v126, 13, v126
    v_and_b32 v127, 1, v1
    v_lshl_add_u32 v126, v127, 7, v126
    s_lshl_b32 s42, s26, 16
    s_lshl_b32 s43, s25, 8
    s_add_u32 s42, s42, s43
    s_add_u32 s42, s42, 3145728
    buffer_load_dword v127, v126, s[16:19], s42 offen
Ltk_10:
    s_waitcnt lgkmcnt(11)
    v_mfma_f32_16x16x32_bf16 v[192:195], v[32:35], v[68:71], v[192:195]
    ds_read_b128 v[64:67], v19 offset:0
    v_and_b32 v89, 0xffff0000, v82
    v_lshlrev_b32 v90, 16, v83
    v_mfma_f32_16x16x32_bf16 v[196:199], v[36:39], v[68:71], v[196:199]
    v_and_b32 v91, 0xffff0000, v83
    v_mfma_f32_16x16x32_bf16 v[208:211], v[40:43], v[68:71], v[208:211]
    v_mfma_f32_16x16x32_bf16 v[212:215], v[44:47], v[68:71], v[212:215]
    ds_swizzle_b32 v104, v96 offset:24
    s_waitcnt lgkmcnt(9)
    v_mfma_f32_16x16x32_bf16 v[220:223], v[44:47], v[72:75], v[220:223]
    ds_read_b128 v[68:71], v18 offset:1024
    ds_swizzle_b32 v105, v96 offset:56
    v_mfma_f32_16x16x32_bf16 v[216:219], v[40:43], v[72:75], v[216:219]
    ds_swizzle_b32 v106, v96 offset:88
    v_mfma_f32_16x16x32_bf16 v[204:207], v[36:39], v[72:75], v[204:207]
    ds_swizzle_b32 v107, v96 offset:120
    v_mfma_f32_16x16x32_bf16 v[200:203], v[32:35], v[72:75], v[200:203]
    ds_swizzle_b32 v108, v96 offset:152
    s_waitcnt lgkmcnt(10)
    v_mfma_f32_16x16x32_bf16 v[224:227], v[32:35], v[76:79], v[224:227]
    ds_read_b128 v[72:75], v19 offset:4096
    ds_swizzle_b32 v109, v96 offset:184
    v_mfma_f32_16x16x32_bf16 v[228:231], v[36:39], v[76:79], v[228:231]
    ds_swizzle_b32 v110, v96 offset:216
    v_mfma_f32_16x16x32_bf16 v[240:243], v[40:43], v[76:79], v[240:243]
    ds_swizzle_b32 v111, v96 offset:248
    v_mfma_f32_16x16x32_bf16 v[244:247], v[44:47], v[76:79], v[244:247]
    s_waitcnt lgkmcnt(11)
    v_mfma_f32_16x16x32_bf16 v[252:255], v[44:47], v[24:27], v[252:255]
    ds_read_b128 v[76:79], v18 offset:5120
    v_mfma_f32_16x16x32_bf16 v[248:251], v[40:43], v[24:27], v[248:251]
    s_waitcnt lgkmcnt(1)
    v_mfma_f32_16x16x32_bf16 v[236:239], v[36:39], v[24:27], v[236:239]
    v_and_b32 v112, 0xffff0000, v104
    v_and_b32 v113, 0xffff0000, v105
    v_mfma_f32_16x16x32_bf16 v[232:235], v[32:35], v[24:27], v[232:235]
    v_and_b32 v114, 0xffff0000, v106
    v_and_b32 v115, 0xffff0000, v107
    v_mfma_f32_16x16x32_bf16 v[128:131], v[48:51], v[64:67], v[128:131]
    ds_read_b128 v[24:27], v19 offset:8192
    v_and_b32 v116, 0xffff0000, v108
    v_and_b32 v117, 0xffff0000, v109
    v_mfma_f32_16x16x32_bf16 v[132:135], v[52:55], v[64:67], v[132:135]
    v_and_b32 v118, 0xffff0000, v110
    v_and_b32 v119, 0xffff0000, v111
    v_mfma_f32_16x16x32_bf16 v[144:147], v[56:59], v[64:67], v[144:147]
    v_mul_f32 v84, v84, v112
    v_mul_f32 v85, v85, v113
    v_mfma_f32_16x16x32_bf16 v[148:151], v[60:63], v[64:67], v[148:151]
    v_mul_f32 v86, v86, v114
    v_mul_f32 v87, v87, v115
    v_mfma_f32_16x16x32_bf16 v[156:159], v[60:63], v[68:71], v[156:159]
    ds_read_b128 v[64:67], v18 offset:9216
    v_mul_f32 v88, v88, v116
    v_mul_f32 v89, v89, v117
    v_mfma_f32_16x16x32_bf16 v[152:155], v[56:59], v[68:71], v[152:155]
    v_mul_f32 v90, v90, v118
    v_mul_f32 v91, v91, v119
    v_mfma_f32_16x16x32_bf16 v[140:143], v[52:55], v[68:71], v[140:143]
    v_cvt_pk_bf16_f32 v96, v84, v85
    v_lshlrev_b32 v84, 16, v96
    v_mfma_f32_16x16x32_bf16 v[136:139], v[48:51], v[68:71], v[136:139]
    v_and_b32 v85, 0xffff0000, v96
    v_cvt_pk_bf16_f32 v96, v86, v87
    v_mfma_f32_16x16x32_bf16 v[160:163], v[48:51], v[72:75], v[160:163]
    ds_read_b128 v[68:71], v19 offset:12288
    v_lshlrev_b32 v86, 16, v96
    v_and_b32 v87, 0xffff0000, v96
    v_mfma_f32_16x16x32_bf16 v[164:167], v[52:55], v[72:75], v[164:167]
    v_cvt_pk_bf16_f32 v96, v88, v89
    v_lshlrev_b32 v88, 16, v96
    v_mfma_f32_16x16x32_bf16 v[176:179], v[56:59], v[72:75], v[176:179]
    v_and_b32 v89, 0xffff0000, v96
    v_cvt_pk_bf16_f32 v96, v90, v91
    v_mfma_f32_16x16x32_bf16 v[180:183], v[60:63], v[72:75], v[180:183]
    v_lshlrev_b32 v90, 16, v96
    v_and_b32 v91, 0xffff0000, v96
    s_waitcnt lgkmcnt(3)
    v_mfma_f32_16x16x32_bf16 v[188:191], v[60:63], v[76:79], v[188:191]
    ds_read_b128 v[72:75], v18 offset:13312
    v_lshlrev_b32 v104, 16, v104
    v_lshlrev_b32 v105, 16, v105
    v_mfma_f32_16x16x32_bf16 v[184:187], v[56:59], v[76:79], v[184:187]
    v_lshlrev_b32 v106, 16, v106
    v_lshlrev_b32 v107, 16, v107
    v_mfma_f32_16x16x32_bf16 v[172:175], v[52:55], v[76:79], v[172:175]
    v_add_u32 v18, 32768, v16
    v_add_u32 v20, 65536, v17
    v_lshlrev_b32 v108, 16, v108
    v_mfma_f32_16x16x32_bf16 v[168:171], v[48:51], v[76:79], v[168:171]
    v_lshlrev_b32 v109, 16, v109
    v_lshlrev_b32 v110, 16, v110
    v_lshlrev_b32 v111, 16, v111
    s_waitcnt lgkmcnt(3)
    v_mfma_f32_16x16x32_bf16 v[192:195], v[48:51], v[24:27], v[192:195]
    v_xor_b32 v19, 64, v18
    v_xor_b32 v21, s63, v20
    v_add_f32 v84, v84, v104
    v_mfma_f32_16x16x32_bf16 v[196:199], v[52:55], v[24:27], v[196:199]
    v_add_f32 v85, v85, v105
    v_add_f32 v86, v86, v106
    v_add_f32 v87, v87, v107
    v_mfma_f32_16x16x32_bf16 v[208:211], v[56:59], v[24:27], v[208:211]
    v_xor_b32 v22, 64, v20
    v_xor_b32 v23, s62, v20
    v_add_f32 v88, v88, v108
    v_mfma_f32_16x16x32_bf16 v[212:215], v[60:63], v[24:27], v[212:215]
    v_add_f32 v89, v89, v109
    v_add_f32 v90, v90, v110
    v_add_f32 v91, v91, v111
    s_waitcnt lgkmcnt(0)
    s_waitcnt vmcnt(4)
    v_mfma_f32_16x16x32_bf16 v[220:223], v[60:63], v[64:67], v[220:223]
    s_barrier
    ds_read_b64_tr_b16 v[32:33], v20 offset:0
    v_cvt_pk_bf16_f32 v80, v84, v85
    v_cvt_pk_bf16_f32 v81, v86, v87
    v_mfma_f32_16x16x32_bf16 v[216:219], v[56:59], v[64:67], v[216:219]
    ds_read_b64_tr_b16 v[34:35], v20 offset:1024
    v_cvt_pk_bf16_f32 v82, v88, v89
    v_cvt_pk_bf16_f32 v83, v90, v91
    v_mfma_f32_16x16x32_bf16 v[204:207], v[52:55], v[64:67], v[204:207]
    ds_read_b128 v[76:79], v18 offset:0
    buffer_store_dwordx4 v[80:83], v28, s[12:15], s71 offen sc1
    v_mfma_f32_16x16x32_bf16 v[200:203], v[48:51], v[64:67], v[200:203]
    ds_read_b64_tr_b16 v[36:37], v21 offset:0
    v_mfma_f32_16x16x32_bf16 v[224:227], v[48:51], v[68:71], v[224:227]
    ds_read_b64_tr_b16 v[38:39], v21 offset:1024
    s_add_u32 s74, s69, 2097152
    s_add_u32 m0, s72, 131072
    v_mfma_f32_16x16x32_bf16 v[228:231], v[52:55], v[68:71], v[228:231]
    ds_read_b64_tr_b16 v[40:41], v22 offset:0
    buffer_load_dwordx4 v8, s[16:19], s74 offen offset:0 lds
    v_mfma_f32_16x16x32_bf16 v[240:243], v[56:59], v[68:71], v[240:243]
    ds_read_b64_tr_b16 v[42:43], v22 offset:1024
    buffer_load_dwordx4 v9, s[16:19], s74 offen offset:1024 lds
    v_mfma_f32_16x16x32_bf16 v[244:247], v[60:63], v[68:71], v[244:247]
    ds_read_b64_tr_b16 v[44:45], v23 offset:0
    v_mfma_f32_16x16x32_bf16 v[252:255], v[60:63], v[72:75], v[252:255]
    ds_read_b64_tr_b16 v[46:47], v23 offset:1024
    buffer_load_dwordx4 v10, s[16:19], s74 offen offset:2048 lds
    v_mfma_f32_16x16x32_bf16 v[248:251], v[56:59], v[72:75], v[248:251]
    ds_read_b128 v[24:27], v19 offset:1024
    v_mfma_f32_16x16x32_bf16 v[236:239], v[52:55], v[72:75], v[236:239]
    ds_read_b128 v[64:67], v18 offset:4096
    buffer_load_dwordx4 v11, s[16:19], s74 offen offset:3072 lds
    v_mfma_f32_16x16x32_bf16 v[232:235], v[48:51], v[72:75], v[232:235]
    ds_read_b128 v[68:71], v19 offset:5120
    s_waitcnt lgkmcnt(9)
    v_mfma_f32_16x16x32_bf16 v[128:131], v[32:35], v[76:79], v[128:131]
    ds_read_b128 v[72:75], v18 offset:8192
    s_waitcnt lgkmcnt(8)
    v_mfma_f32_16x16x32_bf16 v[132:135], v[36:39], v[76:79], v[132:135]
    ds_read_b64_tr_b16 v[48:49], v20 offset:8192
    s_waitcnt lgkmcnt(7)
    v_mfma_f32_16x16x32_bf16 v[144:147], v[40:43], v[76:79], v[144:147]
    ds_read_b64_tr_b16 v[50:51], v20 offset:9216
    s_waitcnt lgkmcnt(6)
    v_mfma_f32_16x16x32_bf16 v[148:151], v[44:47], v[76:79], v[148:151]
    ds_read_b64_tr_b16 v[52:53], v21 offset:8192
    s_waitcnt lgkmcnt(6)
    v_mfma_f32_16x16x32_bf16 v[156:159], v[44:47], v[24:27], v[156:159]
    ds_read_b128 v[76:79], v19 offset:9216
    s_add_u32 s74, s68, 640
    s_add_u32 m0, s72, 0
    v_mfma_f32_16x16x32_bf16 v[152:155], v[40:43], v[24:27], v[152:155]
    ds_read_b64_tr_b16 v[54:55], v21 offset:9216
    buffer_load_dwordx4 v4, s[8:11], s74 offen offset:0 lds
    v_mfma_f32_16x16x32_bf16 v[140:143], v[36:39], v[24:27], v[140:143]
    ds_read_b64_tr_b16 v[56:57], v22 offset:8192
    buffer_load_dwordx4 v5, s[8:11], s74 offen offset:1024 lds
    v_mfma_f32_16x16x32_bf16 v[136:139], v[32:35], v[24:27], v[136:139]
    ds_read_b64_tr_b16 v[58:59], v22 offset:9216
    s_waitcnt lgkmcnt(9)
    v_mfma_f32_16x16x32_bf16 v[160:163], v[32:35], v[64:67], v[160:163]
    ds_read_b128 v[24:27], v18 offset:12288
    buffer_load_dwordx4 v6, s[8:11], s74 offen offset:2048 lds
    v_mfma_f32_16x16x32_bf16 v[164:167], v[36:39], v[64:67], v[164:167]
    ds_read_b64_tr_b16 v[60:61], v23 offset:8192
    v_mfma_f32_16x16x32_bf16 v[176:179], v[40:43], v[64:67], v[176:179]
    ds_read_b64_tr_b16 v[62:63], v23 offset:9216
    buffer_load_dwordx4 v7, s[8:11], s74 offen offset:3072 lds
    v_mfma_f32_16x16x32_bf16 v[180:183], v[44:47], v[64:67], v[180:183]
    s_waitcnt lgkmcnt(11)
    v_mfma_f32_16x16x32_bf16 v[188:191], v[44:47], v[68:71], v[188:191]
    ds_read_b128 v[64:67], v19 offset:13312
    v_mfma_f32_16x16x32_bf16 v[184:187], v[40:43], v[68:71], v[184:187]
    v_mfma_f32_16x16x32_bf16 v[172:175], v[36:39], v[68:71], v[172:175]
    v_mfma_f32_16x16x32_bf16 v[168:171], v[32:35], v[68:71], v[168:171]
    s_cmp_eq_u32 s27, 1
    s_cbranch_scc0 Ltk_11
    v_bfe_u32 v126, v1, 1, 3
    v_lshlrev_b32 v126, 13, v126
    v_and_b32 v127, 1, v1
    v_lshl_add_u32 v126, v127, 7, v126
    s_lshl_b32 s42, s26, 16
    s_lshl_b32 s43, s25, 8
    s_add_u32 s42, s42, s43
    s_add_u32 s42, s42, 3670016
    buffer_load_dword v127, v126, s[16:19], s42 offen
Ltk_11:
    s_waitcnt lgkmcnt(11)
    v_mfma_f32_16x16x32_bf16 v[192:195], v[32:35], v[72:75], v[192:195]
    ds_read_b128 v[68:71], v19 offset:0
    v_mfma_f32_16x16x32_bf16 v[196:199], v[36:39], v[72:75], v[196:199]
    v_mfma_f32_16x16x32_bf16 v[208:211], v[40:43], v[72:75], v[208:211]
    v_mfma_f32_16x16x32_bf16 v[212:215], v[44:47], v[72:75], v[212:215]
    s_waitcnt lgkmcnt(8)
    v_mfma_f32_16x16x32_bf16 v[220:223], v[44:47], v[76:79], v[220:223]
    ds_read_b128 v[72:75], v18 offset:1024
    v_mfma_f32_16x16x32_bf16 v[216:219], v[40:43], v[76:79], v[216:219]
    v_mfma_f32_16x16x32_bf16 v[204:207], v[36:39], v[76:79], v[204:207]
    v_mfma_f32_16x16x32_bf16 v[200:203], v[32:35], v[76:79], v[200:203]
    s_waitcnt lgkmcnt(5)
    v_mfma_f32_16x16x32_bf16 v[224:227], v[32:35], v[24:27], v[224:227]
    ds_read_b128 v[76:79], v19 offset:4096
    v_mfma_f32_16x16x32_bf16 v[228:231], v[36:39], v[24:27], v[228:231]
    v_mfma_f32_16x16x32_bf16 v[240:243], v[40:43], v[24:27], v[240:243]
    v_mfma_f32_16x16x32_bf16 v[244:247], v[44:47], v[24:27], v[244:247]
    s_waitcnt lgkmcnt(3)
    v_mfma_f32_16x16x32_bf16 v[252:255], v[44:47], v[64:67], v[252:255]
    ds_read_b128 v[24:27], v18 offset:5120
    v_mfma_f32_16x16x32_bf16 v[248:251], v[40:43], v[64:67], v[248:251]
    v_mfma_f32_16x16x32_bf16 v[236:239], v[36:39], v[64:67], v[236:239]
    v_mfma_f32_16x16x32_bf16 v[232:235], v[32:35], v[64:67], v[232:235]
    s_waitcnt lgkmcnt(3)
    v_mfma_f32_16x16x32_bf16 v[128:131], v[48:51], v[68:71], v[128:131]
    ds_read_b128 v[64:67], v19 offset:8192
    v_mfma_f32_16x16x32_bf16 v[132:135], v[52:55], v[68:71], v[132:135]
    v_mfma_f32_16x16x32_bf16 v[144:147], v[56:59], v[68:71], v[144:147]
    v_mfma_f32_16x16x32_bf16 v[148:151], v[60:63], v[68:71], v[148:151]
    s_waitcnt lgkmcnt(3)
    v_mfma_f32_16x16x32_bf16 v[156:159], v[60:63], v[72:75], v[156:159]
    ds_read_b128 v[68:71], v18 offset:9216
    v_mfma_f32_16x16x32_bf16 v[152:155], v[56:59], v[72:75], v[152:155]
    v_mfma_f32_16x16x32_bf16 v[140:143], v[52:55], v[72:75], v[140:143]
    v_mfma_f32_16x16x32_bf16 v[136:139], v[48:51], v[72:75], v[136:139]
    s_waitcnt lgkmcnt(3)
    v_mfma_f32_16x16x32_bf16 v[160:163], v[48:51], v[76:79], v[160:163]
    ds_read_b128 v[72:75], v19 offset:12288
    v_mfma_f32_16x16x32_bf16 v[164:167], v[52:55], v[76:79], v[164:167]
    v_mfma_f32_16x16x32_bf16 v[176:179], v[56:59], v[76:79], v[176:179]
    v_mfma_f32_16x16x32_bf16 v[180:183], v[60:63], v[76:79], v[180:183]
    s_waitcnt lgkmcnt(3)
    v_mfma_f32_16x16x32_bf16 v[188:191], v[60:63], v[24:27], v[188:191]
    ds_read_b128 v[76:79], v18 offset:13312
    v_mfma_f32_16x16x32_bf16 v[184:187], v[56:59], v[24:27], v[184:187]
    v_mfma_f32_16x16x32_bf16 v[172:175], v[52:55], v[24:27], v[172:175]
    v_add_u32 v18, 98304, v16
    v_mfma_f32_16x16x32_bf16 v[168:171], v[48:51], v[24:27], v[168:171]
    v_add_u32 v20, 131072, v17
    s_waitcnt lgkmcnt(3)
    v_mfma_f32_16x16x32_bf16 v[192:195], v[48:51], v[64:67], v[192:195]
    v_xor_b32 v19, 64, v18
    v_mfma_f32_16x16x32_bf16 v[196:199], v[52:55], v[64:67], v[196:199]
    v_xor_b32 v21, s63, v20
    v_mfma_f32_16x16x32_bf16 v[208:211], v[56:59], v[64:67], v[208:211]
    v_xor_b32 v22, 64, v20
    v_mfma_f32_16x16x32_bf16 v[212:215], v[60:63], v[64:67], v[212:215]
    v_xor_b32 v23, s62, v20
    s_waitcnt lgkmcnt(0)
    s_waitcnt vmcnt(4)
    v_mfma_f32_16x16x32_bf16 v[220:223], v[60:63], v[68:71], v[220:223]
    s_barrier
    ds_read_b64_tr_b16 v[32:33], v20 offset:0
    v_mfma_f32_16x16x32_bf16 v[216:219], v[56:59], v[68:71], v[216:219]
    ds_read_b64_tr_b16 v[34:35], v20 offset:1024
    s_cmp_eq_u32 s24, 0
    s_cbranch_scc0 Lw0_12
    s_lshr_b32 s42, s2, 4
    s_lshl_b32 s42, s42, 7
    s_and_b32 s43, s2, 15
    s_lshl_b32 s43, s43, 2
    s_add_u32 s42, s42, s43
    s_add_u32 s42, s42, 135168
    v_mov_b32 v94, s64
    v_mov_b32 v95, s42
    s_mov_b64 exec, 1
    buffer_store_dword v94, v95, s[12:15], 0 offen sc1
    s_mov_b64 exec, -1
Lw0_12:
    v_mfma_f32_16x16x32_bf16 v[204:207], v[52:55], v[68:71], v[204:207]
    ds_read_b128 v[24:27], v18 offset:0
    v_mfma_f32_16x16x32_bf16 v[200:203], v[48:51], v[68:71], v[200:203]
    ds_read_b64_tr_b16 v[36:37], v21 offset:0
    v_mfma_f32_16x16x32_bf16 v[224:227], v[48:51], v[72:75], v[224:227]
    ds_read_b64_tr_b16 v[38:39], v21 offset:1024
    s_add_u32 s74, s69, 2621440
    s_add_u32 m0, s72, 32768
    v_mfma_f32_16x16x32_bf16 v[228:231], v[52:55], v[72:75], v[228:231]
    ds_read_b64_tr_b16 v[40:41], v22 offset:0
    buffer_load_dwordx4 v8, s[16:19], s74 offen offset:0 lds
    v_mfma_f32_16x16x32_bf16 v[240:243], v[56:59], v[72:75], v[240:243]
    ds_read_b64_tr_b16 v[42:43], v22 offset:1024
    buffer_load_dwordx4 v9, s[16:19], s74 offen offset:1024 lds
    v_mfma_f32_16x16x32_bf16 v[244:247], v[60:63], v[72:75], v[244:247]
    ds_read_b64_tr_b16 v[44:45], v23 offset:0
    v_mfma_f32_16x16x32_bf16 v[252:255], v[60:63], v[76:79], v[252:255]
    ds_read_b64_tr_b16 v[46:47], v23 offset:1024
    buffer_load_dwordx4 v10, s[16:19], s74 offen offset:2048 lds
    v_mfma_f32_16x16x32_bf16 v[248:251], v[56:59], v[76:79], v[248:251]
    ds_read_b128 v[64:67], v19 offset:1024
    v_mfma_f32_16x16x32_bf16 v[236:239], v[52:55], v[76:79], v[236:239]
    ds_read_b128 v[68:71], v18 offset:4096
    buffer_load_dwordx4 v11, s[16:19], s74 offen offset:3072 lds
    v_mfma_f32_16x16x32_bf16 v[232:235], v[48:51], v[76:79], v[232:235]
    ds_read_b128 v[72:75], v19 offset:5120
    s_waitcnt lgkmcnt(9)
    v_mfma_f32_16x16x32_bf16 v[128:131], v[32:35], v[24:27], v[128:131]
    ds_read_b128 v[76:79], v18 offset:8192
    s_waitcnt lgkmcnt(8)
    v_mfma_f32_16x16x32_bf16 v[132:135], v[36:39], v[24:27], v[132:135]
    ds_read_b64_tr_b16 v[48:49], v20 offset:8192
    s_waitcnt lgkmcnt(7)
    v_mfma_f32_16x16x32_bf16 v[144:147], v[40:43], v[24:27], v[144:147]
    ds_read_b64_tr_b16 v[50:51], v20 offset:9216
    s_waitcnt lgkmcnt(6)
    v_mfma_f32_16x16x32_bf16 v[148:151], v[44:47], v[24:27], v[148:151]
    ds_read_b64_tr_b16 v[52:53], v21 offset:8192
    s_waitcnt lgkmcnt(6)
    v_mfma_f32_16x16x32_bf16 v[156:159], v[44:47], v[64:67], v[156:159]
    ds_read_b128 v[24:27], v19 offset:9216
    s_add_u32 s74, s68, 768
    s_add_u32 m0, s72, 65536
    v_mfma_f32_16x16x32_bf16 v[152:155], v[40:43], v[64:67], v[152:155]
    ds_read_b64_tr_b16 v[54:55], v21 offset:9216
    buffer_load_dwordx4 v4, s[8:11], s74 offen offset:0 lds
    v_mfma_f32_16x16x32_bf16 v[140:143], v[36:39], v[64:67], v[140:143]
    ds_read_b64_tr_b16 v[56:57], v22 offset:8192
    buffer_load_dwordx4 v5, s[8:11], s74 offen offset:1024 lds
    v_mfma_f32_16x16x32_bf16 v[136:139], v[32:35], v[64:67], v[136:139]
    ds_read_b64_tr_b16 v[58:59], v22 offset:9216
    s_waitcnt lgkmcnt(9)
    v_mfma_f32_16x16x32_bf16 v[160:163], v[32:35], v[68:71], v[160:163]
    ds_read_b128 v[64:67], v18 offset:12288
    buffer_load_dwordx4 v6, s[8:11], s74 offen offset:2048 lds
    v_mfma_f32_16x16x32_bf16 v[164:167], v[36:39], v[68:71], v[164:167]
    ds_read_b64_tr_b16 v[60:61], v23 offset:8192
    v_mfma_f32_16x16x32_bf16 v[176:179], v[40:43], v[68:71], v[176:179]
    ds_read_b64_tr_b16 v[62:63], v23 offset:9216
    buffer_load_dwordx4 v7, s[8:11], s74 offen offset:3072 lds
    v_mfma_f32_16x16x32_bf16 v[180:183], v[44:47], v[68:71], v[180:183]
    s_waitcnt lgkmcnt(11)
    v_mfma_f32_16x16x32_bf16 v[188:191], v[44:47], v[72:75], v[188:191]
    ds_read_b128 v[68:71], v19 offset:13312
    v_mfma_f32_16x16x32_bf16 v[184:187], v[40:43], v[72:75], v[184:187]
    v_mfma_f32_16x16x32_bf16 v[172:175], v[36:39], v[72:75], v[172:175]
    v_mfma_f32_16x16x32_bf16 v[168:171], v[32:35], v[72:75], v[168:171]
    s_waitcnt lgkmcnt(11)
    v_mfma_f32_16x16x32_bf16 v[192:195], v[32:35], v[76:79], v[192:195]
    ds_read_b128 v[72:75], v19 offset:0
    v_mfma_f32_16x16x32_bf16 v[196:199], v[36:39], v[76:79], v[196:199]
    v_mfma_f32_16x16x32_bf16 v[208:211], v[40:43], v[76:79], v[208:211]
    v_mfma_f32_16x16x32_bf16 v[212:215], v[44:47], v[76:79], v[212:215]
    s_waitcnt lgkmcnt(8)
    v_mfma_f32_16x16x32_bf16 v[220:223], v[44:47], v[24:27], v[220:223]
    ds_read_b128 v[76:79], v18 offset:1024
    v_mfma_f32_16x16x32_bf16 v[216:219], v[40:43], v[24:27], v[216:219]
    v_mfma_f32_16x16x32_bf16 v[204:207], v[36:39], v[24:27], v[204:207]
    v_mfma_f32_16x16x32_bf16 v[200:203], v[32:35], v[24:27], v[200:203]
    s_waitcnt lgkmcnt(5)
    v_mfma_f32_16x16x32_bf16 v[224:227], v[32:35], v[64:67], v[224:227]
    ds_read_b128 v[24:27], v19 offset:4096
    v_mfma_f32_16x16x32_bf16 v[228:231], v[36:39], v[64:67], v[228:231]
    v_mfma_f32_16x16x32_bf16 v[240:243], v[40:43], v[64:67], v[240:243]
    v_mfma_f32_16x16x32_bf16 v[244:247], v[44:47], v[64:67], v[244:247]
    s_waitcnt lgkmcnt(3)
    v_mfma_f32_16x16x32_bf16 v[252:255], v[44:47], v[68:71], v[252:255]
    ds_read_b128 v[64:67], v18 offset:5120
    v_mfma_f32_16x16x32_bf16 v[248:251], v[40:43], v[68:71], v[248:251]
    v_mfma_f32_16x16x32_bf16 v[236:239], v[36:39], v[68:71], v[236:239]
    v_mfma_f32_16x16x32_bf16 v[232:235], v[32:35], v[68:71], v[232:235]
    s_waitcnt lgkmcnt(3)
    v_mfma_f32_16x16x32_bf16 v[128:131], v[48:51], v[72:75], v[128:131]
    ds_read_b128 v[68:71], v19 offset:8192
    v_mfma_f32_16x16x32_bf16 v[132:135], v[52:55], v[72:75], v[132:135]
    v_mfma_f32_16x16x32_bf16 v[144:147], v[56:59], v[72:75], v[144:147]
    v_mfma_f32_16x16x32_bf16 v[148:151], v[60:63], v[72:75], v[148:151]
    s_waitcnt lgkmcnt(3)
    v_mfma_f32_16x16x32_bf16 v[156:159], v[60:63], v[76:79], v[156:159]
    ds_read_b128 v[72:75], v18 offset:9216
    v_mfma_f32_16x16x32_bf16 v[152:155], v[56:59], v[76:79], v[152:155]
    v_mfma_f32_16x16x32_bf16 v[140:143], v[52:55], v[76:79], v[140:143]
    v_mfma_f32_16x16x32_bf16 v[136:139], v[48:51], v[76:79], v[136:139]
    s_waitcnt lgkmcnt(3)
    v_mfma_f32_16x16x32_bf16 v[160:163], v[48:51], v[24:27], v[160:163]
    ds_read_b128 v[76:79], v19 offset:12288
    v_mfma_f32_16x16x32_bf16 v[164:167], v[52:55], v[24:27], v[164:167]
    v_mfma_f32_16x16x32_bf16 v[176:179], v[56:59], v[24:27], v[176:179]
    v_mfma_f32_16x16x32_bf16 v[180:183], v[60:63], v[24:27], v[180:183]
    s_waitcnt lgkmcnt(3)
    v_mfma_f32_16x16x32_bf16 v[188:191], v[60:63], v[64:67], v[188:191]
    ds_read_b128 v[24:27], v18 offset:13312
    v_mfma_f32_16x16x32_bf16 v[184:187], v[56:59], v[64:67], v[184:187]
    v_mfma_f32_16x16x32_bf16 v[172:175], v[52:55], v[64:67], v[172:175]
    v_add_u32 v18, 0, v16
    v_mfma_f32_16x16x32_bf16 v[168:171], v[48:51], v[64:67], v[168:171]
    v_add_u32 v20, 32768, v17
    s_waitcnt lgkmcnt(3)
    v_mfma_f32_16x16x32_bf16 v[192:195], v[48:51], v[68:71], v[192:195]
    v_xor_b32 v19, 64, v18
    v_mfma_f32_16x16x32_bf16 v[196:199], v[52:55], v[68:71], v[196:199]
    v_xor_b32 v21, s63, v20
    v_mfma_f32_16x16x32_bf16 v[208:211], v[56:59], v[68:71], v[208:211]
    v_xor_b32 v22, 64, v20
    v_mfma_f32_16x16x32_bf16 v[212:215], v[60:63], v[68:71], v[212:215]
    v_xor_b32 v23, s62, v20
    s_waitcnt lgkmcnt(0)
    s_waitcnt vmcnt(4)
    v_mfma_f32_16x16x32_bf16 v[220:223], v[60:63], v[72:75], v[220:223]
    s_barrier
    ds_read_b64_tr_b16 v[32:33], v20 offset:0
    v_mfma_f32_16x16x32_bf16 v[216:219], v[56:59], v[72:75], v[216:219]
    ds_read_b64_tr_b16 v[34:35], v20 offset:1024
    s_cmp_eq_u32 s24, 0
    s_cbranch_scc0 Lw0_13
    v_mov_b32 v95, s26
    v_mov_b32 v94, s37
    v_cmp_gt_u32 vcc, 32, v1
    s_nop 1
    v_cndmask_b32 v95, v94, v95, vcc
    v_and_b32 v94, 15, v1
    v_lshlrev_b32 v94, 2, v94
    v_lshl_add_u32 v95, v95, 7, v94
    v_add_u32 v95, 135168, v95
    buffer_load_dword v94, v95, s[12:15], 0 offen sc1
Lw0_13:
    v_mfma_f32_16x16x32_bf16 v[204:207], v[52:55], v[72:75], v[204:207]
    ds_read_b128 v[64:67], v18 offset:0
    v_mfma_f32_16x16x32_bf16 v[200:203], v[48:51], v[72:75], v[200:203]
    ds_read_b64_tr_b16 v[36:37], v21 offset:0
    v_mfma_f32_16x16x32_bf16 v[224:227], v[48:51], v[76:79], v[224:227]
    ds_read_b64_tr_b16 v[38:39], v21 offset:1024
    s_add_u32 s74, s69, 3145728
    s_add_u32 m0, s72, 98304
    v_mfma_f32_16x16x32_bf16 v[228:231], v[52:55], v[76:79], v[228:231]
    ds_read_b64_tr_b16 v[40:41], v22 offset:0
    buffer_load_dwordx4 v8, s[16:19], s74 offen offset:0 lds
    v_mfma_f32_16x16x32_bf16 v[240:243], v[56:59], v[76:79], v[240:243]
    ds_read_b64_tr_b16 v[42:43], v22 offset:1024
    buffer_load_dwordx4 v9, s[16:19], s74 offen offset:1024 lds
    v_mfma_f32_16x16x32_bf16 v[244:247], v[60:63], v[76:79], v[244:247]
    ds_read_b64_tr_b16 v[44:45], v23 offset:0
    v_mfma_f32_16x16x32_bf16 v[252:255], v[60:63], v[24:27], v[252:255]
    ds_read_b64_tr_b16 v[46:47], v23 offset:1024
    buffer_load_dwordx4 v10, s[16:19], s74 offen offset:2048 lds
    v_mfma_f32_16x16x32_bf16 v[248:251], v[56:59], v[24:27], v[248:251]
    ds_read_b128 v[68:71], v19 offset:1024
    v_mfma_f32_16x16x32_bf16 v[236:239], v[52:55], v[24:27], v[236:239]
    ds_read_b128 v[72:75], v18 offset:4096
    buffer_load_dwordx4 v11, s[16:19], s74 offen offset:3072 lds
    v_mfma_f32_16x16x32_bf16 v[232:235], v[48:51], v[24:27], v[232:235]
    ds_read_b128 v[76:79], v19 offset:5120
    s_waitcnt lgkmcnt(9)
    v_mfma_f32_16x16x32_bf16 v[128:131], v[32:35], v[64:67], v[128:131]
    ds_read_b128 v[24:27], v18 offset:8192
    s_waitcnt lgkmcnt(8)
    v_mfma_f32_16x16x32_bf16 v[132:135], v[36:39], v[64:67], v[132:135]
    ds_read_b64_tr_b16 v[48:49], v20 offset:8192
    s_waitcnt lgkmcnt(7)
    v_mfma_f32_16x16x32_bf16 v[144:147], v[40:43], v[64:67], v[144:147]
    ds_read_b64_tr_b16 v[50:51], v20 offset:9216
    s_waitcnt lgkmcnt(6)
    v_mfma_f32_16x16x32_bf16 v[148:151], v[44:47], v[64:67], v[148:151]
    ds_read_b64_tr_b16 v[52:53], v21 offset:8192
    s_waitcnt lgkmcnt(6)
    v_mfma_f32_16x16x32_bf16 v[156:159], v[44:47], v[68:71], v[156:159]
    ds_read_b128 v[64:67], v19 offset:9216
    s_add_u32 s74, s68, 896
    s_add_u32 m0, s72, 131072
    v_mfma_f32_16x16x32_bf16 v[152:155], v[40:43], v[68:71], v[152:155]
    ds_read_b64_tr_b16 v[54:55], v21 offset:9216
    buffer_load_dwordx4 v4, s[8:11], s74 offen offset:0 lds
    v_mfma_f32_16x16x32_bf16 v[140:143], v[36:39], v[68:71], v[140:143]
    ds_read_b64_tr_b16 v[56:57], v22 offset:8192
    buffer_load_dwordx4 v5, s[8:11], s74 offen offset:1024 lds
    v_mfma_f32_16x16x32_bf16 v[136:139], v[32:35], v[68:71], v[136:139]
    ds_read_b64_tr_b16 v[58:59], v22 offset:9216
    s_waitcnt lgkmcnt(9)
    v_mfma_f32_16x16x32_bf16 v[160:163], v[32:35], v[72:75], v[160:163]
    ds_read_b128 v[68:71], v18 offset:12288
    buffer_load_dwordx4 v6, s[8:11], s74 offen offset:2048 lds
    v_mfma_f32_16x16x32_bf16 v[164:167], v[36:39], v[72:75], v[164:167]
    ds_read_b64_tr_b16 v[60:61], v23 offset:8192
    v_mfma_f32_16x16x32_bf16 v[176:179], v[40:43], v[72:75], v[176:179]
    ds_read_b64_tr_b16 v[62:63], v23 offset:9216
    buffer_load_dwordx4 v7, s[8:11], s74 offen offset:3072 lds
    v_mfma_f32_16x16x32_bf16 v[180:183], v[44:47], v[72:75], v[180:183]
    s_waitcnt lgkmcnt(11)
    v_mfma_f32_16x16x32_bf16 v[188:191], v[44:47], v[76:79], v[188:191]
    ds_read_b128 v[72:75], v19 offset:13312
    v_mfma_f32_16x16x32_bf16 v[184:187], v[40:43], v[76:79], v[184:187]
    v_mfma_f32_16x16x32_bf16 v[172:175], v[36:39], v[76:79], v[172:175]
    v_mfma_f32_16x16x32_bf16 v[168:171], v[32:35], v[76:79], v[168:171]
    s_waitcnt lgkmcnt(11)
    v_mfma_f32_16x16x32_bf16 v[192:195], v[32:35], v[24:27], v[192:195]
    ds_read_b128 v[76:79], v19 offset:0
    v_mfma_f32_16x16x32_bf16 v[196:199], v[36:39], v[24:27], v[196:199]
    v_mfma_f32_16x16x32_bf16 v[208:211], v[40:43], v[24:27], v[208:211]
    v_mfma_f32_16x16x32_bf16 v[212:215], v[44:47], v[24:27], v[212:215]
    s_waitcnt lgkmcnt(8)
    v_mfma_f32_16x16x32_bf16 v[220:223], v[44:47], v[64:67], v[220:223]
    ds_read_b128 v[24:27], v18 offset:1024
    v_mfma_f32_16x16x32_bf16 v[216:219], v[40:43], v[64:67], v[216:219]
    v_mfma_f32_16x16x32_bf16 v[204:207], v[36:39], v[64:67], v[204:207]
    v_mfma_f32_16x16x32_bf16 v[200:203], v[32:35], v[64:67], v[200:203]
    s_waitcnt lgkmcnt(5)
    v_mfma_f32_16x16x32_bf16 v[224:227], v[32:35], v[68:71], v[224:227]
    ds_read_b128 v[64:67], v19 offset:4096
    v_mfma_f32_16x16x32_bf16 v[228:231], v[36:39], v[68:71], v[228:231]
    v_mfma_f32_16x16x32_bf16 v[240:243], v[40:43], v[68:71], v[240:243]
    v_mfma_f32_16x16x32_bf16 v[244:247], v[44:47], v[68:71], v[244:247]
    s_waitcnt lgkmcnt(3)
    v_mfma_f32_16x16x32_bf16 v[252:255], v[44:47], v[72:75], v[252:255]
    ds_read_b128 v[68:71], v18 offset:5120
    s_lshl_b32 s75, s25, 19
    s_and_b32 s43, s24, 1
    v_mfma_f32_16x16x32_bf16 v[248:251], v[40:43], v[72:75], v[248:251]
    s_lshl_b32 s43, s43, 3
    s_add_u32 s43, s43, s26
    v_mfma_f32_16x16x32_bf16 v[236:239], v[36:39], v[72:75], v[236:239]
    s_lshl_b32 s43, s43, 13
    s_add_u32 s75, s75, s43
    v_mfma_f32_16x16x32_bf16 v[232:235], v[32:35], v[72:75], v[232:235]
    s_bfe_u32 s43, s24, 0x10001
    s_lshl_b32 s43, s43, 12
    s_waitcnt lgkmcnt(3)
    v_mfma_f32_16x16x32_bf16 v[128:131], v[48:51], v[76:79], v[128:131]
    ds_read_b128 v[72:75], v19 offset:8192
    s_add_u32 s75, s75, s43
    s_lshl_b32 s43, s28, 24
    v_mfma_f32_16x16x32_bf16 v[132:135], v[52:55], v[76:79], v[132:135]
    s_add_u32 s75, s75, s43
    s_add_u32 s75, s75, 16777216
    v_mfma_f32_16x16x32_bf16 v[144:147], v[56:59], v[76:79], v[144:147]
    v_bfe_u32 v12, v1, 2, 2
    v_lshrrev_b32 v13, 5, v1
    v_mfma_f32_16x16x32_bf16 v[148:151], v[60:63], v[76:79], v[148:151]
    v_bfe_u32 v14, v1, 4, 1
    v_lshl_add_u32 v4, v13, 3, v12
    s_waitcnt lgkmcnt(3)
    v_mfma_f32_16x16x32_bf16 v[156:159], v[60:63], v[24:27], v[156:159]
    ds_read_b128 v[76:79], v18 offset:9216
    v_lshl_add_u32 v4, v14, 4, v4
    v_lshlrev_b32 v4, 8, v4
    v_mfma_f32_16x16x32_bf16 v[152:155], v[56:59], v[24:27], v[152:155]
    v_lshl_add_u32 v4, v12, 6, v4
    v_lshl_add_u32 v4, v14, 4, v4
    v_mfma_f32_16x16x32_bf16 v[140:143], v[52:55], v[24:27], v[140:143]
    v_and_b32 v13, 1, v1
    v_lshl_add_u32 v4, v13, 5, v4
    v_mfma_f32_16x16x32_bf16 v[136:139], v[48:51], v[24:27], v[136:139]
    v_bfe_u32 v13, v1, 1, 1
    v_lshl_add_u32 v4, v13, 3, v4
    s_waitcnt lgkmcnt(3)
    v_mfma_f32_16x16x32_bf16 v[160:163], v[48:51], v[64:67], v[160:163]
    ds_read_b128 v[24:27], v19 offset:12288
    v_add_u32 v4, 0x8000, v4
    v_xor_b32 v5, 64, v4
    v_mfma_f32_16x16x32_bf16 v[164:167], v[52:55], v[64:67], v[164:167]
    v_xor_b32 v6, 0x80, v4
    v_xor_b32 v7, 0xc0, v4
    v_mfma_f32_16x16x32_bf16 v[176:179], v[56:59], v[64:67], v[176:179]
    s_and_b32 s61, s24, 1
    s_lshl_b32 s61, s61, 4
    v_mfma_f32_16x16x32_bf16 v[180:183], v[60:63], v[64:67], v[180:183]
    s_xor_b32 s60, s61, s63
    s_waitcnt lgkmcnt(3)
    v_mfma_f32_16x16x32_bf16 v[188:191], v[60:63], v[68:71], v[188:191]
    ds_read_b128 v[64:67], v18 offset:13312
    v_mfma_f32_16x16x32_bf16 v[184:187], v[56:59], v[68:71], v[184:187]
    v_mfma_f32_16x16x32_bf16 v[172:175], v[52:55], v[68:71], v[172:175]
    v_add_u32 v18, 65536, v16
    v_mfma_f32_16x16x32_bf16 v[168:171], v[48:51], v[68:71], v[168:171]
    v_add_u32 v20, 98304, v17
    s_waitcnt lgkmcnt(3)
    v_mfma_f32_16x16x32_bf16 v[192:195], v[48:51], v[72:75], v[192:195]
    v_xor_b32 v19, 64, v18
    v_mfma_f32_16x16x32_bf16 v[196:199], v[52:55], v[72:75], v[196:199]
    v_xor_b32 v21, s63, v20
    v_mfma_f32_16x16x32_bf16 v[208:211], v[56:59], v[72:75], v[208:211]
    v_xor_b32 v22, 64, v20
    v_mfma_f32_16x16x32_bf16 v[212:215], v[60:63], v[72:75], v[212:215]
    v_xor_b32 v23, s62, v20
    s_waitcnt lgkmcnt(0)
    s_waitcnt vmcnt(4)
    s_cmp_eq_u32 s24, 0
    s_cbranch_scc0 Lw0_14
    s_mov_b32 s42, 200000
Lpl_15:
    v_cmp_ne_u32 vcc, s64, v94
    s_nop 0
    s_cbranch_vccz Lok_16
    s_sub_u32 s42, s42, 1
    s_cbranch_scc1 Lok_16
    s_sleep 4
    buffer_load_dword v94, v95, s[12:15], 0 offen sc1
    s_waitcnt vmcnt(0)
    s_branch Lpl_15
Lok_16:
Lw0_14:
    v_mfma_f32_16x16x32_bf16 v[220:223], v[60:63], v[76:79], v[220:223]
    s_barrier
    ds_read_b64_tr_b16 v[32:33], v20 offset:0
    v_mfma_f32_16x16x32_bf16 v[216:219], v[56:59], v[76:79], v[216:219]
    ds_read_b64_tr_b16 v[34:35], v20 offset:1024
    v_mfma_f32_16x16x32_bf16 v[204:207], v[52:55], v[76:79], v[204:207]
    ds_read_b128 v[68:71], v18 offset:0
    v_mfma_f32_16x16x32_bf16 v[200:203], v[48:51], v[76:79], v[200:203]
    ds_read_b64_tr_b16 v[36:37], v21 offset:0
    v_mfma_f32_16x16x32_bf16 v[224:227], v[48:51], v[24:27], v[224:227]
    ds_read_b64_tr_b16 v[38:39], v21 offset:1024
    s_add_u32 s74, s69, 3670016
    s_add_u32 m0, s72, 0
    v_mfma_f32_16x16x32_bf16 v[228:231], v[52:55], v[24:27], v[228:231]
    ds_read_b64_tr_b16 v[40:41], v22 offset:0
    buffer_load_dwordx4 v8, s[16:19], s74 offen offset:0 lds
    v_mfma_f32_16x16x32_bf16 v[240:243], v[56:59], v[24:27], v[240:243]
    ds_read_b64_tr_b16 v[42:43], v22 offset:1024
    buffer_load_dwordx4 v9, s[16:19], s74 offen offset:1024 lds
    v_mfma_f32_16x16x32_bf16 v[244:247], v[60:63], v[24:27], v[244:247]
    ds_read_b64_tr_b16 v[44:45], v23 offset:0
    v_mfma_f32_16x16x32_bf16 v[252:255], v[60:63], v[64:67], v[252:255]
    ds_read_b64_tr_b16 v[46:47], v23 offset:1024
    buffer_load_dwordx4 v10, s[16:19], s74 offen offset:2048 lds
    v_mfma_f32_16x16x32_bf16 v[248:251], v[56:59], v[64:67], v[248:251]
    ds_read_b128 v[72:75], v19 offset:1024
    v_mfma_f32_16x16x32_bf16 v[236:239], v[52:55], v[64:67], v[236:239]
    ds_read_b128 v[76:79], v18 offset:4096
    buffer_load_dwordx4 v11, s[16:19], s74 offen offset:3072 lds
    v_mfma_f32_16x16x32_bf16 v[232:235], v[48:51], v[64:67], v[232:235]
    ds_read_b128 v[24:27], v19 offset:5120
    s_waitcnt lgkmcnt(9)
    v_mfma_f32_16x16x32_bf16 v[128:131], v[32:35], v[68:71], v[128:131]
    ds_read_b128 v[64:67], v18 offset:8192
    v_xor_b32 v8, s61, v8
    v_xor_b32 v9, s61, v9
    s_waitcnt lgkmcnt(8)
    v_mfma_f32_16x16x32_bf16 v[132:135], v[36:39], v[68:71], v[132:135]
    ds_read_b64_tr_b16 v[48:49], v20 offset:8192
    v_xor_b32 v10, s60, v10
    v_xor_b32 v11, s60, v11
    s_waitcnt lgkmcnt(7)
    v_mfma_f32_16x16x32_bf16 v[144:147], v[40:43], v[68:71], v[144:147]
    ds_read_b64_tr_b16 v[50:51], v20 offset:9216
    s_waitcnt lgkmcnt(6)
    v_mfma_f32_16x16x32_bf16 v[148:151], v[44:47], v[68:71], v[148:151]
    ds_read_b64_tr_b16 v[52:53], v21 offset:8192
    s_waitcnt lgkmcnt(6)
    v_mfma_f32_16x16x32_bf16 v[156:159], v[44:47], v[72:75], v[156:159]
    ds_read_b128 v[68:71], v19 offset:9216
    s_add_u32 s74, s73, 0
    s_add_u32 m0, s72, 32768
    v_mfma_f32_16x16x32_bf16 v[152:155], v[40:43], v[72:75], v[152:155]
    ds_read_b64_tr_b16 v[54:55], v21 offset:9216
    buffer_load_dwordx4 v8, s[20:23], s74 offen offset:0 lds
    v_mfma_f32_16x16x32_bf16 v[140:143], v[36:39], v[72:75], v[140:143]
    ds_read_b64_tr_b16 v[56:57], v22 offset:8192
    buffer_load_dwordx4 v9, s[20:23], s74 offen offset:1024 lds
    v_mfma_f32_16x16x32_bf16 v[136:139], v[32:35], v[72:75], v[136:139]
    ds_read_b64_tr_b16 v[58:59], v22 offset:9216
    s_waitcnt lgkmcnt(9)
    v_mfma_f32_16x16x32_bf16 v[160:163], v[32:35], v[76:79], v[160:163]
    ds_read_b128 v[72:75], v18 offset:12288
    buffer_load_dwordx4 v10, s[20:23], s74 offen offset:2048 lds
    v_mfma_f32_16x16x32_bf16 v[164:167], v[36:39], v[76:79], v[164:167]
    ds_read_b64_tr_b16 v[60:61], v23 offset:8192
    v_mfma_f32_16x16x32_bf16 v[176:179], v[40:43], v[76:79], v[176:179]
    ds_read_b64_tr_b16 v[62:63], v23 offset:9216
    buffer_load_dwordx4 v11, s[20:23], s74 offen offset:3072 lds
    v_mfma_f32_16x16x32_bf16 v[180:183], v[44:47], v[76:79], v[180:183]
    s_waitcnt lgkmcnt(11)
    v_mfma_f32_16x16x32_bf16 v[188:191], v[44:47], v[24:27], v[188:191]
    ds_read_b128 v[76:79], v19 offset:13312
    v_mfma_f32_16x16x32_bf16 v[184:187], v[40:43], v[24:27], v[184:187]
    v_mfma_f32_16x16x32_bf16 v[172:175], v[36:39], v[24:27], v[172:175]
    v_mfma_f32_16x16x32_bf16 v[168:171], v[32:35], v[24:27], v[168:171]
    s_waitcnt lgkmcnt(11)
    v_mfma_f32_16x16x32_bf16 v[192:195], v[32:35], v[64:67], v[192:195]
    ds_read_b128 v[24:27], v19 offset:0
    v_mfma_f32_16x16x32_bf16 v[196:199], v[36:39], v[64:67], v[196:199]
    v_mfma_f32_16x16x32_bf16 v[208:211], v[40:43], v[64:67], v[208:211]
    v_mfma_f32_16x16x32_bf16 v[212:215], v[44:47], v[64:67], v[212:215]
    s_waitcnt lgkmcnt(8)
    v_mfma_f32_16x16x32_bf16 v[220:223], v[44:47], v[68:71], v[220:223]
    ds_read_b128 v[64:67], v18 offset:1024
    buffer_load_dwordx4 v[80:83], v3, s[12:15], s44 offen offset:0 sc1
    v_mfma_f32_16x16x32_bf16 v[216:219], v[40:43], v[68:71], v[216:219]
    v_mfma_f32_16x16x32_bf16 v[204:207], v[36:39], v[68:71], v[204:207]
    buffer_load_dwordx4 v[84:87], v3, s[12:15], s44 offen offset:256 sc1
    v_mfma_f32_16x16x32_bf16 v[200:203], v[32:35], v[68:71], v[200:203]
    s_waitcnt lgkmcnt(5)
    v_mfma_f32_16x16x32_bf16 v[224:227], v[32:35], v[72:75], v[224:227]
    ds_read_b128 v[68:71], v19 offset:4096
    buffer_load_dwordx4 v[88:91], v3, s[12:15], s44 offen offset:2048 sc1
    v_mfma_f32_16x16x32_bf16 v[228:231], v[36:39], v[72:75], v[228:231]
    v_mfma_f32_16x16x32_bf16 v[240:243], v[40:43], v[72:75], v[240:243]
    buffer_load_dwordx4 v[92:95], v3, s[12:15], s44 offen offset:2304 sc1
    v_mfma_f32_16x16x32_bf16 v[244:247], v[44:47], v[72:75], v[244:247]
    s_add_u32 s44, s44, 4096
    s_waitcnt lgkmcnt(3)
    v_mfma_f32_16x16x32_bf16 v[252:255], v[44:47], v[76:79], v[252:255]
    ds_read_b128 v[72:75], v18 offset:5120
    v_mfma_f32_16x16x32_bf16 v[248:251], v[40:43], v[76:79], v[248:251]
    v_mfma_f32_16x16x32_bf16 v[236:239], v[36:39], v[76:79], v[236:239]
    v_mfma_f32_16x16x32_bf16 v[232:235], v[32:35], v[76:79], v[232:235]
    s_waitcnt lgkmcnt(3)
    v_mfma_f32_16x16x32_bf16 v[128:131], v[48:51], v[24:27], v[128:131]
    ds_read_b128 v[76:79], v19 offset:8192
    v_mfma_f32_16x16x32_bf16 v[132:135], v[52:55], v[24:27], v[132:135]
    v_mfma_f32_16x16x32_bf16 v[144:147], v[56:59], v[24:27], v[144:147]
    v_mfma_f32_16x16x32_bf16 v[148:151], v[60:63], v[24:27], v[148:151]
    s_waitcnt lgkmcnt(3)
    v_mfma_f32_16x16x32_bf16 v[156:159], v[60:63], v[64:67], v[156:159]
    ds_read_b128 v[24:27], v18 offset:9216
    buffer_load_dwordx4 v[96:99], v3, s[12:15], s44 offen offset:0 sc1
    v_mfma_f32_16x16x32_bf16 v[152:155], v[56:59], v[64:67], v[152:155]
    v_mfma_f32_16x16x32_bf16 v[140:143], v[52:55], v[64:67], v[140:143]
    buffer_load_dwordx4 v[100:103], v3, s[12:15], s44 offen offset:256 sc1
    v_mfma_f32_16x16x32_bf16 v[136:139], v[48:51], v[64:67], v[136:139]
    s_waitcnt lgkmcnt(3)
    v_mfma_f32_16x16x32_bf16 v[160:163], v[48:51], v[68:71], v[160:163]
    ds_read_b128 v[64:67], v19 offset:12288
    buffer_load_dwordx4 v[104:107], v3, s[12:15], s44 offen offset:2048 sc1
    v_mfma_f32_16x16x32_bf16 v[164:167], v[52:55], v[68:71], v[164:167]
    v_mfma_f32_16x16x32_bf16 v[176:179], v[56:59], v[68:71], v[176:179]
    buffer_load_dwordx4 v[108:111], v3, s[12:15], s44 offen offset:2304 sc1
    v_mfma_f32_16x16x32_bf16 v[180:183], v[60:63], v[68:71], v[180:183]
    s_add_u32 s44, s44, 4096
    s_waitcnt lgkmcnt(3)
    v_mfma_f32_16x16x32_bf16 v[188:191], v[60:63], v[72:75], v[188:191]
    ds_read_b128 v[68:71], v18 offset:13312
    v_mfma_f32_16x16x32_bf16 v[184:187], v[56:59], v[72:75], v[184:187]
    v_mfma_f32_16x16x32_bf16 v[172:175], v[52:55], v[72:75], v[172:175]
    v_add_u32 v18, 131072, v16
    v_mfma_f32_16x16x32_bf16 v[168:171], v[48:51], v[72:75], v[168:171]
    v_add_u32 v20, 0, v17
    s_waitcnt lgkmcnt(3)
    v_mfma_f32_16x16x32_bf16 v[192:195], v[48:51], v[76:79], v[192:195]
    v_xor_b32 v19, 64, v18
    v_mfma_f32_16x16x32_bf16 v[196:199], v[52:55], v[76:79], v[196:199]
    v_xor_b32 v21, s63, v20
    v_mfma_f32_16x16x32_bf16 v[208:211], v[56:59], v[76:79], v[208:211]
    v_xor_b32 v22, 64, v20
    v_mfma_f32_16x16x32_bf16 v[212:215], v[60:63], v[76:79], v[212:215]
    v_xor_b32 v23, s62, v20
    s_waitcnt lgkmcnt(0)
    s_waitcnt vmcnt(12)
    v_mfma_f32_16x16x32_bf16 v[220:223], v[60:63], v[24:27], v[220:223]
    s_barrier
    ds_read_b64_tr_b16 v[32:33], v20 offset:0
    v_mfma_f32_16x16x32_bf16 v[216:219], v[56:59], v[24:27], v[216:219]
    ds_read_b64_tr_b16 v[34:35], v20 offset:1024
    v_mfma_f32_16x16x32_bf16 v[204:207], v[52:55], v[24:27], v[204:207]
    ds_read_b128 v[72:75], v18 offset:0
    v_mfma_f32_16x16x32_bf16 v[200:203], v[48:51], v[24:27], v[200:203]
    ds_read_b64_tr_b16 v[36:37], v21 offset:0
    v_mfma_f32_16x16x32_bf16 v[224:227], v[48:51], v[64:67], v[224:227]
    ds_read_b64_tr_b16 v[38:39], v21 offset:1024
    s_add_u32 s74, s73, 1048576
    s_add_u32 m0, s72, 65536
    v_mfma_f32_16x16x32_bf16 v[228:231], v[52:55], v[64:67], v[228:231]
    ds_read_b64_tr_b16 v[40:41], v22 offset:0
    buffer_load_dwordx4 v8, s[20:23], s74 offen offset:0 lds
    v_mfma_f32_16x16x32_bf16 v[240:243], v[56:59], v[64:67], v[240:243]
    ds_read_b64_tr_b16 v[42:43], v22 offset:1024
    buffer_load_dwordx4 v9, s[20:23], s74 offen offset:1024 lds
    v_mfma_f32_16x16x32_bf16 v[244:247], v[60:63], v[64:67], v[244:247]
    ds_read_b64_tr_b16 v[44:45], v23 offset:0
    v_mfma_f32_16x16x32_bf16 v[252:255], v[60:63], v[68:71], v[252:255]
    ds_read_b64_tr_b16 v[46:47], v23 offset:1024
    buffer_load_dwordx4 v10, s[20:23], s74 offen offset:2048 lds
    v_mfma_f32_16x16x32_bf16 v[248:251], v[56:59], v[68:71], v[248:251]
    ds_read_b128 v[76:79], v19 offset:1024
    v_mfma_f32_16x16x32_bf16 v[236:239], v[52:55], v[68:71], v[236:239]
    ds_read_b128 v[24:27], v19 offset:0
    buffer_load_dwordx4 v11, s[20:23], s74 offen offset:3072 lds
    v_mfma_f32_16x16x32_bf16 v[232:235], v[48:51], v[68:71], v[232:235]
    ds_read_b128 v[64:67], v18 offset:1024
    s_waitcnt lgkmcnt(9)
    v_mfma_f32_16x16x32_bf16 v[128:131], v[32:35], v[72:75], v[128:131]
    ds_read_b64_tr_b16 v[48:49], v20 offset:8192
    ds_read_b64_tr_b16 v[50:51], v20 offset:9216
    ds_read_b128 v[68:71], v18 offset:4096
    s_waitcnt lgkmcnt(10)
    v_mfma_f32_16x16x32_bf16 v[132:135], v[36:39], v[72:75], v[132:135]
    ds_read_b64_tr_b16 v[52:53], v21 offset:8192
    ds_read_b64_tr_b16 v[54:55], v21 offset:9216
    s_waitcnt lgkmcnt(10)
    v_mfma_f32_16x16x32_bf16 v[144:147], v[40:43], v[72:75], v[144:147]
    ds_read_b64_tr_b16 v[56:57], v22 offset:8192
    ds_read_b64_tr_b16 v[58:59], v22 offset:9216
    s_waitcnt lgkmcnt(10)
    v_mfma_f32_16x16x32_bf16 v[148:151], v[44:47], v[72:75], v[148:151]
    ds_read_b64_tr_b16 v[60:61], v23 offset:8192
    ds_read_b64_tr_b16 v[62:63], v23 offset:9216
    s_waitcnt lgkmcnt(11)
    v_mfma_f32_16x16x32_bf16 v[156:159], v[44:47], v[76:79], v[156:159]
    ds_read_b128 v[72:75], v19 offset:5120
    s_add_u32 s74, s73, 2097152
    s_add_u32 m0, s72, 98304
    v_mfma_f32_16x16x32_bf16 v[152:155], v[40:43], v[76:79], v[152:155]
    buffer_load_dwordx4 v8, s[20:23], s74 offen offset:0 lds
    v_mfma_f32_16x16x32_bf16 v[140:143], v[36:39], v[76:79], v[140:143]
    buffer_load_dwordx4 v9, s[20:23], s74 offen offset:1024 lds
    v_mfma_f32_16x16x32_bf16 v[136:139], v[32:35], v[76:79], v[136:139]
    s_waitcnt lgkmcnt(8)
    v_mfma_f32_16x16x32_bf16 v[128:131], v[48:51], v[24:27], v[128:131]
    ds_read_b128 v[76:79], v19 offset:4096
    buffer_load_dwordx4 v10, s[20:23], s74 offen offset:2048 lds
    s_waitcnt lgkmcnt(6)
    v_mfma_f32_16x16x32_bf16 v[132:135], v[52:55], v[24:27], v[132:135]
    s_waitcnt lgkmcnt(4)
    v_mfma_f32_16x16x32_bf16 v[144:147], v[56:59], v[24:27], v[144:147]
    buffer_load_dwordx4 v11, s[20:23], s74 offen offset:3072 lds
    s_waitcnt lgkmcnt(2)
    v_mfma_f32_16x16x32_bf16 v[148:151], v[60:63], v[24:27], v[148:151]
    v_mfma_f32_16x16x32_bf16 v[156:159], v[60:63], v[64:67], v[156:159]
    ds_read_b128 v[24:27], v18 offset:5120
    v_mfma_f32_16x16x32_bf16 v[152:155], v[56:59], v[64:67], v[152:155]
    v_mfma_f32_16x16x32_bf16 v[140:143], v[52:55], v[64:67], v[140:143]
    v_mfma_f32_16x16x32_bf16 v[136:139], v[48:51], v[64:67], v[136:139]
    v_mfma_f32_16x16x32_bf16 v[160:163], v[32:35], v[68:71], v[160:163]
    ds_read_b128 v[64:67], v18 offset:8192
    buffer_load_dwordx4 v[112:115], v3, s[12:15], s44 offen offset:0 sc1
    v_mfma_f32_16x16x32_bf16 v[164:167], v[36:39], v[68:71], v[164:167]
    v_mfma_f32_16x16x32_bf16 v[176:179], v[40:43], v[68:71], v[176:179]
    buffer_load_dwordx4 v[116:119], v3, s[12:15], s44 offen offset:256 sc1
    v_mfma_f32_16x16x32_bf16 v[180:183], v[44:47], v[68:71], v[180:183]
    s_waitcnt lgkmcnt(3)
    v_mfma_f32_16x16x32_bf16 v[188:191], v[44:47], v[72:75], v[188:191]
    ds_read_b128 v[68:71], v19 offset:9216
    buffer_load_dwordx4 v[120:123], v3, s[12:15], s44 offen offset:2048 sc1
    v_cvt_pk_bf16_f32 v128, v128, v129
    v_mfma_f32_16x16x32_bf16 v[184:187], v[40:43], v[72:75], v[184:187]
    v_cvt_pk_bf16_f32 v129, v130, v131
    v_cvt_pk_bf16_f32 v130, v132, v133
    v_mfma_f32_16x16x32_bf16 v[172:175], v[36:39], v[72:75], v[172:175]
    buffer_load_dwordx4 v[124:127], v3, s[12:15], s44 offen offset:2304 sc1
    s_add_u32 s44, s44, 4096
    v_cvt_pk_bf16_f32 v131, v134, v135
    v_mfma_f32_16x16x32_bf16 v[168:171], v[32:35], v[72:75], v[168:171]
    v_cvt_pk_bf16_f32 v132, v136, v137
    v_cvt_pk_bf16_f32 v133, v138, v139
    s_waitcnt lgkmcnt(3)
    v_mfma_f32_16x16x32_bf16 v[160:163], v[48:51], v[76:79], v[160:163]
    ds_read_b128 v[72:75], v19 offset:8192
    v_cvt_pk_bf16_f32 v134, v140, v141
    v_cvt_pk_bf16_f32 v135, v142, v143
    v_mfma_f32_16x16x32_bf16 v[164:167], v[52:55], v[76:79], v[164:167]
    v_cvt_pk_bf16_f32 v136, v144, v145
    v_mfma_f32_16x16x32_bf16 v[176:179], v[56:59], v[76:79], v[176:179]
    v_cvt_pk_bf16_f32 v137, v146, v147
    v_cvt_pk_bf16_f32 v138, v148, v149
    v_mfma_f32_16x16x32_bf16 v[180:183], v[60:63], v[76:79], v[180:183]
    v_cvt_pk_bf16_f32 v139, v150, v151
    s_waitcnt lgkmcnt(3)
    v_mfma_f32_16x16x32_bf16 v[188:191], v[60:63], v[24:27], v[188:191]
    ds_read_b128 v[76:79], v18 offset:9216
    v_cvt_pk_bf16_f32 v140, v152, v153
    v_cvt_pk_bf16_f32 v141, v154, v155
    v_mfma_f32_16x16x32_bf16 v[184:187], v[56:59], v[24:27], v[184:187]
    v_cvt_pk_bf16_f32 v142, v156, v157
    v_mfma_f32_16x16x32_bf16 v[172:175], v[52:55], v[24:27], v[172:175]
    v_cvt_pk_bf16_f32 v143, v158, v159
    v_mfma_f32_16x16x32_bf16 v[168:171], v[48:51], v[24:27], v[168:171]
    s_waitcnt lgkmcnt(3)
    v_mfma_f32_16x16x32_bf16 v[192:195], v[32:35], v[64:67], v[192:195]
    ds_read_b128 v[24:27], v18 offset:12288
    v_mfma_f32_16x16x32_bf16 v[196:199], v[36:39], v[64:67], v[196:199]
    v_mfma_f32_16x16x32_bf16 v[208:211], v[40:43], v[64:67], v[208:211]
    v_mfma_f32_16x16x32_bf16 v[212:215], v[44:47], v[64:67], v[212:215]
    s_waitcnt lgkmcnt(3)
    v_mfma_f32_16x16x32_bf16 v[220:223], v[44:47], v[68:71], v[220:223]
    ds_read_b128 v[64:67], v19 offset:13312
    v_cvt_pk_bf16_f32 v160, v160, v161
    v_cvt_pk_bf16_f32 v161, v162, v163
    v_mfma_f32_16x16x32_bf16 v[216:219], v[40:43], v[68:71], v[216:219]
    v_cvt_pk_bf16_f32 v162, v164, v165
    v_mfma_f32_16x16x32_bf16 v[204:207], v[36:39], v[68:71], v[204:207]
    v_cvt_pk_bf16_f32 v163, v166, v167
    v_cvt_pk_bf16_f32 v164, v168, v169
    v_mfma_f32_16x16x32_bf16 v[200:203], v[32:35], v[68:71], v[200:203]
    v_cvt_pk_bf16_f32 v165, v170, v171
    buffer_store_dwordx4 v[128:131], v3, s[12:15], s75 offen offset:0 sc1
    s_waitcnt lgkmcnt(3)
    v_mfma_f32_16x16x32_bf16 v[192:195], v[48:51], v[72:75], v[192:195]
    ds_read_b128 v[68:71], v19 offset:12288
    v_cvt_pk_bf16_f32 v166, v172, v173
    v_cvt_pk_bf16_f32 v167, v174, v175
    v_mfma_f32_16x16x32_bf16 v[196:199], v[52:55], v[72:75], v[196:199]
    v_cvt_pk_bf16_f32 v168, v176, v177
    v_mfma_f32_16x16x32_bf16 v[208:211], v[56:59], v[72:75], v[208:211]
    v_cvt_pk_bf16_f32 v169, v178, v179
    v_cvt_pk_bf16_f32 v170, v180, v181
    v_mfma_f32_16x16x32_bf16 v[212:215], v[60:63], v[72:75], v[212:215]
    v_cvt_pk_bf16_f32 v171, v182, v183
    s_waitcnt lgkmcnt(3)
    v_mfma_f32_16x16x32_bf16 v[220:223], v[60:63], v[76:79], v[220:223]
    ds_read_b128 v[72:75], v18 offset:13312
    v_cvt_pk_bf16_f32 v172, v184, v185
    v_cvt_pk_bf16_f32 v173, v186, v187
    v_mfma_f32_16x16x32_bf16 v[216:219], v[56:59], v[76:79], v[216:219]
    v_cvt_pk_bf16_f32 v174, v188, v189
    buffer_store_dwordx4 v[132:135], v3, s[12:15], s75 offen offset:256 sc1
    v_mfma_f32_16x16x32_bf16 v[204:207], v[52:55], v[76:79], v[204:207]
    v_cvt_pk_bf16_f32 v175, v190, v191
    v_mfma_f32_16x16x32_bf16 v[200:203], v[48:51], v[76:79], v[200:203]
    s_waitcnt lgkmcnt(3)
    v_mfma_f32_16x16x32_bf16 v[224:227], v[32:35], v[24:27], v[224:227]
    v_mfma_f32_16x16x32_bf16 v[228:231], v[36:39], v[24:27], v[228:231]
    v_mfma_f32_16x16x32_bf16 v[240:243], v[40:43], v[24:27], v[240:243]
    buffer_store_dwordx4 v[136:139], v3, s[12:15], s75 offen offset:2048 sc1
    v_mfma_f32_16x16x32_bf16 v[244:247], v[44:47], v[24:27], v[244:247]
    s_waitcnt lgkmcnt(0)
    s_waitcnt vmcnt(23)
    v_mfma_f32_16x16x32_bf16 v[252:255], v[44:47], v[64:67], v[252:255]
    s_barrier
    s_add_u32 s74, s73, 3145728
    s_add_u32 m0, s72, 131072
    s_nop 0
    buffer_load_dwordx4 v8, s[20:23], s74 offen offset:0 lds
    buffer_load_dwordx4 v9, s[20:23], s74 offen offset:1024 lds
    v_mfma_f32_16x16x32_bf16 v[248:251], v[40:43], v[64:67], v[248:251]
    v_cvt_pk_bf16_f32 v192, v192, v193
    v_cvt_pk_bf16_f32 v193, v194, v195
    v_cvt_pk_bf16_f32 v194, v196, v197
    v_mfma_f32_16x16x32_bf16 v[236:239], v[36:39], v[64:67], v[236:239]
    buffer_load_dwordx4 v10, s[20:23], s74 offen offset:2048 lds
    buffer_load_dwordx4 v11, s[20:23], s74 offen offset:3072 lds
    v_cvt_pk_bf16_f32 v195, v198, v199
    v_mfma_f32_16x16x32_bf16 v[232:235], v[32:35], v[64:67], v[232:235]
    v_cvt_pk_bf16_f32 v196, v200, v201
    v_cvt_pk_bf16_f32 v197, v202, v203
    v_mfma_f32_16x16x32_bf16 v[224:227], v[48:51], v[68:71], v[224:227]
    v_xor_b32 v8, 16, v4
    v_xor_b32 v9, 16, v5
    v_xor_b32 v10, 16, v6
    v_xor_b32 v11, 16, v7
    v_cvt_pk_bf16_f32 v198, v204, v205
    v_mfma_f32_16x16x32_bf16 v[228:231], v[52:55], v[68:71], v[228:231]
    v_cvt_pk_bf16_f32 v199, v206, v207
    v_cvt_pk_bf16_f32 v200, v208, v209
    buffer_store_dwordx4 v[140:143], v3, s[12:15], s75 offen offset:2304 sc1
    s_add_u32 s75, s75, 131072
    v_mfma_f32_16x16x32_bf16 v[240:243], v[56:59], v[68:71], v[240:243]
    ds_read_b64_tr_b16 v[144:145], v4 offset:0
    ds_read_b64_tr_b16 v[146:147], v4 offset:1024
    v_cvt_pk_bf16_f32 v201, v210, v211
    v_cvt_pk_bf16_f32 v202, v212, v213
    v_mfma_f32_16x16x32_bf16 v[244:247], v[60:63], v[68:71], v[244:247]
    ds_read_b64_tr_b16 v[148:149], v8 offset:0
    ds_read_b64_tr_b16 v[150:151], v8 offset:1024
    v_cvt_pk_bf16_f32 v203, v214, v215
    v_mfma_f32_16x16x32_bf16 v[252:255], v[60:63], v[72:75], v[252:255]
    ds_read_b64_tr_b16 v[152:153], v5 offset:0
    ds_read_b64_tr_b16 v[154:155], v5 offset:1024
    v_cvt_pk_bf16_f32 v204, v216, v217
    v_cvt_pk_bf16_f32 v205, v218, v219
    v_mfma_f32_16x16x32_bf16 v[248:251], v[56:59], v[72:75], v[248:251]
    ds_read_b64_tr_b16 v[156:157], v9 offset:0
    ds_read_b64_tr_b16 v[158:159], v9 offset:1024
    v_cvt_pk_bf16_f32 v206, v220, v221
    v_mfma_f32_16x16x32_bf16 v[236:239], v[52:55], v[72:75], v[236:239]
    ds_read_b64_tr_b16 v[176:177], v6 offset:0
    ds_read_b64_tr_b16 v[178:179], v6 offset:1024
    v_cvt_pk_bf16_f32 v207, v222, v223
    v_mfma_f32_16x16x32_bf16 v[232:235], v[48:51], v[72:75], v[232:235]
    s_branch Lkvepi
Lml_8:
    s_mov_b32 s42, 200000
Lml_8r:
    s_sleep 4
    s_mov_b32 s75, 0
    buffer_load_dwordx2 v[96:97], v29, s[12:15], s75 offen sc1
    s_mov_b32 s75, 4096
    buffer_load_dwordx2 v[104:105], v29, s[12:15], s75 offen sc1
    s_mov_b32 s75, 24576
    buffer_load_dwordx2 v[98:99], v29, s[12:15], s75 offen sc1
    s_mov_b32 s75, 28672
    buffer_load_dwordx2 v[106:107], v29, s[12:15], s75 offen sc1
    s_mov_b32 s75, 49152
    buffer_load_dwordx2 v[100:101], v29, s[12:15], s75 offen sc1
    s_mov_b32 s75, 53248
    buffer_load_dwordx2 v[108:109], v29, s[12:15], s75 offen sc1
    s_mov_b32 s75, 73728
    buffer_load_dwordx2 v[102:103], v29, s[12:15], s75 offen sc1
    s_mov_b32 s75, 77824
    buffer_load_dwordx2 v[110:111], v29, s[12:15], s75 offen sc1
    s_waitcnt vmcnt(0)
    v_xor_b32 v97, s64, v97
    v_xor_b32 v99, s64, v99
    v_xor_b32 v101, s64, v101
    v_xor_b32 v103, s64, v103
    v_xor_b32 v105, s64, v105
    v_xor_b32 v107, s64, v107
    v_xor_b32 v109, s64, v109
    v_xor_b32 v111, s64, v111
    v_or3_b32 v97, v97, v99, v101
    v_or3_b32 v103, v103, v105, v107
    v_or3_b32 v97, v97, v109, v111
    v_or_b32 v97, v97, v103
    v_cmp_ne_u32 vcc, 0, v97
    s_nop 0
    s_cbranch_vccz Lmok_9
    s_sub_u32 s42, s42, 1
    s_cbranch_scc0 Lml_8r
    s_branch Lmok_9
Lvgemm:
    ds_read_b64_tr_b16 v[32:33], v20 offset:0
    ds_read_b64_tr_b16 v[34:35], v20 offset:1024
    ds_read_b128 v[64:67], v18 offset:0
    ds_read_b64_tr_b16 v[36:37], v21 offset:0
    ds_read_b64_tr_b16 v[38:39], v21 offset:1024
    ds_read_b64_tr_b16 v[40:41], v22 offset:0
    ds_read_b64_tr_b16 v[42:43], v22 offset:1024
    ds_read_b64_tr_b16 v[44:45], v23 offset:0
    ds_read_b64_tr_b16 v[46:47], v23 offset:1024
    ds_read_b128 v[68:71], v19 offset:1024
    ds_read_b128 v[72:75], v18 offset:4096
    ds_read_b128 v[76:79], v19 offset:5120
    s_waitcnt lgkmcnt(9)
    v_mfma_f32_16x16x32_bf16 v[128:131], v[64:67], v[32:35], 0
    ds_read_b128 v[24:27], v18 offset:8192
    s_add_u32 s74, s69, 524288
    s_add_u32 m0, s72, 98304
    s_waitcnt lgkmcnt(8)
    v_mfma_f32_16x16x32_bf16 v[136:139], v[64:67], v[36:39], 0
    ds_read_b64_tr_b16 v[48:49], v20 offset:8192
    buffer_load_dwordx4 v8, s[16:19], s74 offen offset:0 lds
    s_waitcnt lgkmcnt(7)
    v_mfma_f32_16x16x32_bf16 v[144:147], v[64:67], v[40:43], 0
    ds_read_b64_tr_b16 v[50:51], v20 offset:9216
    buffer_load_dwordx4 v9, s[16:19], s74 offen offset:1024 lds
    s_waitcnt lgkmcnt(6)
    v_mfma_f32_16x16x32_bf16 v[152:155], v[64:67], v[44:47], 0
    ds_read_b64_tr_b16 v[52:53], v21 offset:8192
    s_waitcnt lgkmcnt(6)
    v_mfma_f32_16x16x32_bf16 v[156:159], v[68:71], v[44:47], 0
    ds_read_b128 v[64:67], v19 offset:9216
    buffer_load_dwordx4 v10, s[16:19], s74 offen offset:2048 lds
    v_mfma_f32_16x16x32_bf16 v[148:151], v[68:71], v[40:43], 0
    ds_read_b64_tr_b16 v[54:55], v21 offset:9216
    v_mfma_f32_16x16x32_bf16 v[140:143], v[68:71], v[36:39], 0
    ds_read_b64_tr_b16 v[56:57], v22 offset:8192
    buffer_load_dwordx4 v11, s[16:19], s74 offen offset:3072 lds
    v_mfma_f32_16x16x32_bf16 v[132:135], v[68:71], v[32:35], 0
    ds_read_b64_tr_b16 v[58:59], v22 offset:9216
    s_waitcnt lgkmcnt(9)
    v_mfma_f32_16x16x32_bf16 v[160:163], v[72:75], v[32:35], 0
    ds_read_b128 v[68:71], v18 offset:12288
    s_add_u32 s74, s68, 256
    s_add_u32 m0, s72, 131072
    v_mfma_f32_16x16x32_bf16 v[168:171], v[72:75], v[36:39], 0
    ds_read_b64_tr_b16 v[60:61], v23 offset:8192
    buffer_load_dwordx4 v4, s[8:11], s74 offen offset:0 lds
    v_mfma_f32_16x16x32_bf16 v[176:179], v[72:75], v[40:43], 0
    ds_read_b64_tr_b16 v[62:63], v23 offset:9216
    buffer_load_dwordx4 v5, s[8:11], s74 offen offset:1024 lds
    v_mfma_f32_16x16x32_bf16 v[184:187], v[72:75], v[44:47], 0
    s_waitcnt lgkmcnt(11)
    v_mfma_f32_16x16x32_bf16 v[188:191], v[76:79], v[44:47], 0
    ds_read_b128 v[72:75], v19 offset:13312
    buffer_load_dwordx4 v6, s[8:11], s74 offen offset:2048 lds
    v_mfma_f32_16x16x32_bf16 v[180:183], v[76:79], v[40:43], 0
    v_mfma_f32_16x16x32_bf16 v[172:175], v[76:79], v[36:39], 0
    buffer_load_dwordx4 v7, s[8:11], s74 offen offset:3072 lds
    v_mfma_f32_16x16x32_bf16 v[164:167], v[76:79], v[32:35], 0
    s_lshl_b32 s42, 1, s24
    s_and_b32 s42, s42, 128
    s_cbranch_scc0 Lpf_17
    buffer_load_dword v124, v95, s[76:79], s67 offen
Lpf_17:
    s_cmp_eq_u32 s27, 1
    s_cbranch_scc0 Ltk_18
    v_bfe_u32 v126, v1, 1, 3
    v_lshlrev_b32 v126, 13, v126
    v_and_b32 v127, 1, v1
    v_lshl_add_u32 v126, v127, 7, v126
    s_lshl_b32 s42, s26, 16
    s_lshl_b32 s43, s25, 8
    s_add_u32 s42, s42, s43
    s_add_u32 s42, s42, 1048576
    buffer_load_dword v127, v126, s[16:19], s42 offen
Ltk_18:
    s_cmp_eq_u32 s27, 1
    s_cbranch_scc0 Ltk_19
    v_bfe_u32 v126, v1, 1, 3
    v_lshlrev_b32 v126, 13, v126
    v_and_b32 v127, 1, v1
    v_lshl_add_u32 v126, v127, 7, v126
    s_lshl_b32 s42, s26, 16
    s_lshl_b32 s43, s25, 8
    s_add_u32 s42, s42, s43
    s_add_u32 s42, s42, 1572864
    buffer_load_dword v127, v126, s[16:19], s42 offen
Ltk_19:
    s_cmp_eq_u32 s27, 1
    s_cbranch_scc0 Ltk_20
    v_bfe_u32 v126, v1, 1, 3
    v_lshlrev_b32 v126, 13, v126
    v_and_b32 v127, 1, v1
    v_lshl_add_u32 v126, v127, 7, v126
    s_lshl_b32 s42, s26, 16
    s_lshl_b32 s43, s25, 8
    s_add_u32 s42, s42, s43
    s_add_u32 s42, s42, 2097152
    buffer_load_dword v127, v126, s[16:19], s42 offen
Ltk_20:
    s_waitcnt lgkmcnt(11)
    v_mfma_f32_16x16x32_bf16 v[192:195], v[24:27], v[32:35], 0
    ds_read_b128 v[76:79], v19 offset:0
    v_mfma_f32_16x16x32_bf16 v[200:203], v[24:27], v[36:39], 0
    v_mfma_f32_16x16x32_bf16 v[208:211], v[24:27], v[40:43], 0
    v_mfma_f32_16x16x32_bf16 v[216:219], v[24:27], v[44:47], 0
    s_waitcnt lgkmcnt(8)
    v_mfma_f32_16x16x32_bf16 v[220:223], v[64:67], v[44:47], 0
    ds_read_b128 v[24:27], v18 offset:1024
    v_mfma_f32_16x16x32_bf16 v[212:215], v[64:67], v[40:43], 0
    v_mfma_f32_16x16x32_bf16 v[204:207], v[64:67], v[36:39], 0
    v_mfma_f32_16x16x32_bf16 v[196:199], v[64:67], v[32:35], 0
    s_waitcnt lgkmcnt(5)
    v_mfma_f32_16x16x32_bf16 v[224:227], v[68:71], v[32:35], 0
    ds_read_b128 v[64:67], v19 offset:4096
    v_mfma_f32_16x16x32_bf16 v[232:235], v[68:71], v[36:39], 0
    v_mfma_f32_16x16x32_bf16 v[240:243], v[68:71], v[40:43], 0
    v_mfma_f32_16x16x32_bf16 v[248:251], v[68:71], v[44:47], 0
    s_waitcnt lgkmcnt(3)
    v_mfma_f32_16x16x32_bf16 v[252:255], v[72:75], v[44:47], 0
    ds_read_b128 v[68:71], v18 offset:5120
    v_mfma_f32_16x16x32_bf16 v[244:247], v[72:75], v[40:43], 0
    v_mfma_f32_16x16x32_bf16 v[236:239], v[72:75], v[36:39], 0
    v_mfma_f32_16x16x32_bf16 v[228:231], v[72:75], v[32:35], 0
    s_waitcnt lgkmcnt(3)
    v_mfma_f32_16x16x32_bf16 v[128:131], v[76:79], v[48:51], v[128:131]
    ds_read_b128 v[72:75], v19 offset:8192
    v_mfma_f32_16x16x32_bf16 v[136:139], v[76:79], v[52:55], v[136:139]
    v_mfma_f32_16x16x32_bf16 v[144:147], v[76:79], v[56:59], v[144:147]
    v_mfma_f32_16x16x32_bf16 v[152:155], v[76:79], v[60:63], v[152:155]
    s_waitcnt lgkmcnt(3)
    v_mfma_f32_16x16x32_bf16 v[156:159], v[24:27], v[60:63], v[156:159]
    ds_read_b128 v[76:79], v18 offset:9216
    v_mfma_f32_16x16x32_bf16 v[148:151], v[24:27], v[56:59], v[148:151]
    v_mfma_f32_16x16x32_bf16 v[140:143], v[24:27], v[52:55], v[140:143]
    v_mfma_f32_16x16x32_bf16 v[132:135], v[24:27], v[48:51], v[132:135]
    s_waitcnt lgkmcnt(3)
    v_mfma_f32_16x16x32_bf16 v[160:163], v[64:67], v[48:51], v[160:163]
    ds_read_b128 v[24:27], v19 offset:12288
    v_mfma_f32_16x16x32_bf16 v[168:171], v[64:67], v[52:55], v[168:171]
    v_mfma_f32_16x16x32_bf16 v[176:179], v[64:67], v[56:59], v[176:179]
    v_mfma_f32_16x16x32_bf16 v[184:187], v[64:67], v[60:63], v[184:187]
    s_waitcnt lgkmcnt(3)
    v_mfma_f32_16x16x32_bf16 v[188:191], v[68:71], v[60:63], v[188:191]
    ds_read_b128 v[64:67], v18 offset:13312
    v_mfma_f32_16x16x32_bf16 v[180:183], v[68:71], v[56:59], v[180:183]
    v_mfma_f32_16x16x32_bf16 v[172:175], v[68:71], v[52:55], v[172:175]
    v_add_u32 v18, 65536, v16
    v_mfma_f32_16x16x32_bf16 v[164:167], v[68:71], v[48:51], v[164:167]
    v_add_u32 v20, 98304, v17
    s_waitcnt lgkmcnt(3)
    v_mfma_f32_16x16x32_bf16 v[192:195], v[72:75], v[48:51], v[192:195]
    v_xor_b32 v19, 64, v18
    v_mfma_f32_16x16x32_bf16 v[200:203], v[72:75], v[52:55], v[200:203]
    v_xor_b32 v21, s63, v20
    v_mfma_f32_16x16x32_bf16 v[208:211], v[72:75], v[56:59], v[208:211]
    v_xor_b32 v22, 64, v20
    v_mfma_f32_16x16x32_bf16 v[216:219], v[72:75], v[60:63], v[216:219]
    v_xor_b32 v23, s62, v20
    s_waitcnt lgkmcnt(0)
    s_waitcnt vmcnt(4)
    v_mfma_f32_16x16x32_bf16 v[220:223], v[76:79], v[60:63], v[220:223]
    s_barrier
    ds_read_b64_tr_b16 v[32:33], v20 offset:0
    v_mfma_f32_16x16x32_bf16 v[212:215], v[76:79], v[56:59], v[212:215]
    ds_read_b64_tr_b16 v[34:35], v20 offset:1024
    v_mfma_f32_16x16x32_bf16 v[204:207], v[76:79], v[52:55], v[204:207]
    ds_read_b128 v[68:71], v18 offset:0
    v_mfma_f32_16x16x32_bf16 v[196:199], v[76:79], v[48:51], v[196:199]
    ds_read_b64_tr_b16 v[36:37], v21 offset:0
    v_mfma_f32_16x16x32_bf16 v[224:227], v[24:27], v[48:51], v[224:227]
    ds_read_b64_tr_b16 v[38:39], v21 offset:1024
    s_add_u32 s74, s69, 1048576
    s_add_u32 m0, s72, 0
    v_mfma_f32_16x16x32_bf16 v[232:235], v[24:27], v[52:55], v[232:235]
    ds_read_b64_tr_b16 v[40:41], v22 offset:0
    buffer_load_dwordx4 v8, s[16:19], s74 offen offset:0 lds
    v_mfma_f32_16x16x32_bf16 v[240:243], v[24:27], v[56:59], v[240:243]
    ds_read_b64_tr_b16 v[42:43], v22 offset:1024
    buffer_load_dwordx4 v9, s[16:19], s74 offen offset:1024 lds
    v_mfma_f32_16x16x32_bf16 v[248:251], v[24:27], v[60:63], v[248:251]
    ds_read_b64_tr_b16 v[44:45], v23 offset:0
    v_mfma_f32_16x16x32_bf16 v[252:255], v[64:67], v[60:63], v[252:255]
    ds_read_b64_tr_b16 v[46:47], v23 offset:1024
    buffer_load_dwordx4 v10, s[16:19], s74 offen offset:2048 lds
    v_mfma_f32_16x16x32_bf16 v[244:247], v[64:67], v[56:59], v[244:247]
    ds_read_b128 v[72:75], v19 offset:1024
    v_mfma_f32_16x16x32_bf16 v[236:239], v[64:67], v[52:55], v[236:239]
    ds_read_b128 v[76:79], v18 offset:4096
    buffer_load_dwordx4 v11, s[16:19], s74 offen offset:3072 lds
    v_mfma_f32_16x16x32_bf16 v[228:231], v[64:67], v[48:51], v[228:231]
    ds_read_b128 v[24:27], v19 offset:5120
    s_waitcnt lgkmcnt(9)
    v_mfma_f32_16x16x32_bf16 v[128:131], v[68:71], v[32:35], v[128:131]
    ds_read_b128 v[64:67], v18 offset:8192
    s_waitcnt lgkmcnt(8)
    v_mfma_f32_16x16x32_bf16 v[136:139], v[68:71], v[36:39], v[136:139]
    ds_read_b64_tr_b16 v[48:49], v20 offset:8192
    s_waitcnt lgkmcnt(7)
    v_mfma_f32_16x16x32_bf16 v[144:147], v[68:71], v[40:43], v[144:147]
    ds_read_b64_tr_b16 v[50:51], v20 offset:9216
    s_waitcnt lgkmcnt(6)
    v_mfma_f32_16x16x32_bf16 v[152:155], v[68:71], v[44:47], v[152:155]
    ds_read_b64_tr_b16 v[52:53], v21 offset:8192
    s_waitcnt lgkmcnt(6)
    v_mfma_f32_16x16x32_bf16 v[156:159], v[72:75], v[44:47], v[156:159]
    ds_read_b128 v[68:71], v19 offset:9216
    s_add_u32 s74, s68, 384
    s_add_u32 m0, s72, 32768
    v_mfma_f32_16x16x32_bf16 v[148:151], v[72:75], v[40:43], v[148:151]
    ds_read_b64_tr_b16 v[54:55], v21 offset:9216
    buffer_load_dwordx4 v4, s[8:11], s74 offen offset:0 lds
    v_mfma_f32_16x16x32_bf16 v[140:143], v[72:75], v[36:39], v[140:143]
    ds_read_b64_tr_b16 v[56:57], v22 offset:8192
    buffer_load_dwordx4 v5, s[8:11], s74 offen offset:1024 lds
    v_mfma_f32_16x16x32_bf16 v[132:135], v[72:75], v[32:35], v[132:135]
    ds_read_b64_tr_b16 v[58:59], v22 offset:9216
    s_waitcnt lgkmcnt(9)
    v_mfma_f32_16x16x32_bf16 v[160:163], v[76:79], v[32:35], v[160:163]
    ds_read_b128 v[72:75], v18 offset:12288
    buffer_load_dwordx4 v6, s[8:11], s74 offen offset:2048 lds
    v_mfma_f32_16x16x32_bf16 v[168:171], v[76:79], v[36:39], v[168:171]
    ds_read_b64_tr_b16 v[60:61], v23 offset:8192
    v_mfma_f32_16x16x32_bf16 v[176:179], v[76:79], v[40:43], v[176:179]
    ds_read_b64_tr_b16 v[62:63], v23 offset:9216
    buffer_load_dwordx4 v7, s[8:11], s74 offen offset:3072 lds
    v_mfma_f32_16x16x32_bf16 v[184:187], v[76:79], v[44:47], v[184:187]
    s_waitcnt lgkmcnt(11)
    v_mfma_f32_16x16x32_bf16 v[188:191], v[24:27], v[44:47], v[188:191]
    ds_read_b128 v[76:79], v19 offset:13312
    v_mfma_f32_16x16x32_bf16 v[180:183], v[24:27], v[40:43], v[180:183]
    v_mfma_f32_16x16x32_bf16 v[172:175], v[24:27], v[36:39], v[172:175]
    v_mfma_f32_16x16x32_bf16 v[164:167], v[24:27], v[32:35], v[164:167]
    s_cmp_eq_u32 s27, 1
    s_cbranch_scc0 Ltk_21
    v_bfe_u32 v126, v1, 1, 3
    v_lshlrev_b32 v126, 13, v126
    v_and_b32 v127, 1, v1
    v_lshl_add_u32 v126, v127, 7, v126
    s_lshl_b32 s42, s26, 16
    s_lshl_b32 s43, s25, 8
    s_add_u32 s42, s42, s43
    s_add_u32 s42, s42, 2621440
    buffer_load_dword v127, v126, s[16:19], s42 offen
Ltk_21:
    s_waitcnt lgkmcnt(11)
    v_mfma_f32_16x16x32_bf16 v[192:195], v[64:67], v[32:35], v[192:195]
    ds_read_b128 v[24:27], v19 offset:0
    v_mfma_f32_16x16x32_bf16 v[200:203], v[64:67], v[36:39], v[200:203]
    v_mfma_f32_16x16x32_bf16 v[208:211], v[64:67], v[40:43], v[208:211]
    v_mfma_f32_16x16x32_bf16 v[216:219], v[64:67], v[44:47], v[216:219]
    s_waitcnt lgkmcnt(8)
    v_mfma_f32_16x16x32_bf16 v[220:223], v[68:71], v[44:47], v[220:223]
    ds_read_b128 v[64:67], v18 offset:1024
    v_mfma_f32_16x16x32_bf16 v[212:215], v[68:71], v[40:43], v[212:215]
    v_mfma_f32_16x16x32_bf16 v[204:207], v[68:71], v[36:39], v[204:207]
    v_mfma_f32_16x16x32_bf16 v[196:199], v[68:71], v[32:35], v[196:199]
    s_waitcnt lgkmcnt(5)
    v_mfma_f32_16x16x32_bf16 v[224:227], v[72:75], v[32:35], v[224:227]
    ds_read_b128 v[68:71], v19 offset:4096
    v_mfma_f32_16x16x32_bf16 v[232:235], v[72:75], v[36:39], v[232:235]
    v_mfma_f32_16x16x32_bf16 v[240:243], v[72:75], v[40:43], v[240:243]
    v_mfma_f32_16x16x32_bf16 v[248:251], v[72:75], v[44:47], v[248:251]
    s_waitcnt lgkmcnt(3)
    v_mfma_f32_16x16x32_bf16 v[252:255], v[76:79], v[44:47], v[252:255]
    ds_read_b128 v[72:75], v18 offset:5120
    v_mfma_f32_16x16x32_bf16 v[244:247], v[76:79], v[40:43], v[244:247]
    v_mfma_f32_16x16x32_bf16 v[236:239], v[76:79], v[36:39], v[236:239]
    v_mfma_f32_16x16x32_bf16 v[228:231], v[76:79], v[32:35], v[228:231]
    s_waitcnt lgkmcnt(3)
    v_mfma_f32_16x16x32_bf16 v[128:131], v[24:27], v[48:51], v[128:131]
    ds_read_b128 v[76:79], v19 offset:8192
    v_mfma_f32_16x16x32_bf16 v[136:139], v[24:27], v[52:55], v[136:139]
    v_mfma_f32_16x16x32_bf16 v[144:147], v[24:27], v[56:59], v[144:147]
    v_mfma_f32_16x16x32_bf16 v[152:155], v[24:27], v[60:63], v[152:155]
    s_waitcnt lgkmcnt(3)
    v_mfma_f32_16x16x32_bf16 v[156:159], v[64:67], v[60:63], v[156:159]
    ds_read_b128 v[24:27], v18 offset:9216
    s_mov_b32 s75, 0
    buffer_load_dwordx2 v[96:97], v29, s[12:15], s75 offen sc1
    v_mfma_f32_16x16x32_bf16 v[148:151], v[64:67], v[56:59], v[148:151]
    s_mov_b32 s75, 4096
    buffer_load_dwordx2 v[104:105], v29, s[12:15], s75 offen sc1
    v_mfma_f32_16x16x32_bf16 v[140:143], v[64:67], v[52:55], v[140:143]
    s_mov_b32 s75, 24576
    buffer_load_dwordx2 v[98:99], v29, s[12:15], s75 offen sc1
    v_mfma_f32_16x16x32_bf16 v[132:135], v[64:67], v[48:51], v[132:135]
    s_mov_b32 s75, 28672
    buffer_load_dwordx2 v[106:107], v29, s[12:15], s75 offen sc1
    s_waitcnt lgkmcnt(3)
    v_mfma_f32_16x16x32_bf16 v[160:163], v[68:71], v[48:51], v[160:163]
    ds_read_b128 v[64:67], v19 offset:12288
    s_mov_b32 s75, 49152
    buffer_load_dwordx2 v[100:101], v29, s[12:15], s75 offen sc1
    v_mfma_f32_16x16x32_bf16 v[168:171], v[68:71], v[52:55], v[168:171]
    s_mov_b32 s75, 53248
    buffer_load_dwordx2 v[108:109], v29, s[12:15], s75 offen sc1
    v_mfma_f32_16x16x32_bf16 v[176:179], v[68:71], v[56:59], v[176:179]
    s_mov_b32 s75, 73728
    buffer_load_dwordx2 v[102:103], v29, s[12:15], s75 offen sc1
    v_mfma_f32_16x16x32_bf16 v[184:187], v[68:71], v[60:63], v[184:187]
    s_mov_b32 s75, 77824
    buffer_load_dwordx2 v[110:111], v29, s[12:15], s75 offen sc1
    s_waitcnt lgkmcnt(3)
    v_mfma_f32_16x16x32_bf16 v[188:191], v[72:75], v[60:63], v[188:191]
    ds_read_b128 v[68:71], v18 offset:13312
    v_mfma_f32_16x16x32_bf16 v[180:183], v[72:75], v[56:59], v[180:183]
    v_mfma_f32_16x16x32_bf16 v[172:175], v[72:75], v[52:55], v[172:175]
    v_add_u32 v18, 131072, v16
    v_mfma_f32_16x16x32_bf16 v[164:167], v[72:75], v[48:51], v[164:167]
    v_add_u32 v20, 0, v17
    s_waitcnt lgkmcnt(3)
    v_mfma_f32_16x16x32_bf16 v[192:195], v[76:79], v[48:51], v[192:195]
    v_xor_b32 v19, 64, v18
    v_mfma_f32_16x16x32_bf16 v[200:203], v[76:79], v[52:55], v[200:203]
    v_xor_b32 v21, s63, v20
    v_mfma_f32_16x16x32_bf16 v[208:211], v[76:79], v[56:59], v[208:211]
    v_xor_b32 v22, 64, v20
    v_mfma_f32_16x16x32_bf16 v[216:219], v[76:79], v[60:63], v[216:219]
    v_xor_b32 v23, s62, v20
    s_waitcnt lgkmcnt(0)
    s_waitcnt vmcnt(12)
    v_mfma_f32_16x16x32_bf16 v[220:223], v[24:27], v[60:63], v[220:223]
    s_barrier
    ds_read_b64_tr_b16 v[32:33], v20 offset:0
    v_mfma_f32_16x16x32_bf16 v[212:215], v[24:27], v[56:59], v[212:215]
    ds_read_b64_tr_b16 v[34:35], v20 offset:1024
    v_mfma_f32_16x16x32_bf16 v[204:207], v[24:27], v[52:55], v[204:207]
    ds_read_b128 v[72:75], v18 offset:0
    v_mfma_f32_16x16x32_bf16 v[196:199], v[24:27], v[48:51], v[196:199]
    ds_read_b64_tr_b16 v[36:37], v21 offset:0
    v_mfma_f32_16x16x32_bf16 v[224:227], v[64:67], v[48:51], v[224:227]
    ds_read_b64_tr_b16 v[38:39], v21 offset:1024
    s_add_u32 s74, s69, 1572864
    s_add_u32 m0, s72, 65536
    v_mfma_f32_16x16x32_bf16 v[232:235], v[64:67], v[52:55], v[232:235]
    ds_read_b64_tr_b16 v[40:41], v22 offset:0
    buffer_load_dwordx4 v8, s[16:19], s74 offen offset:0 lds
    v_mfma_f32_16x16x32_bf16 v[240:243], v[64:67], v[56:59], v[240:243]
    ds_read_b64_tr_b16 v[42:43], v22 offset:1024
    buffer_load_dwordx4 v9, s[16:19], s74 offen offset:1024 lds
    v_mfma_f32_16x16x32_bf16 v[248:251], v[64:67], v[60:63], v[248:251]
    ds_read_b64_tr_b16 v[44:45], v23 offset:0
    v_mfma_f32_16x16x32_bf16 v[252:255], v[68:71], v[60:63], v[252:255]
    ds_read_b64_tr_b16 v[46:47], v23 offset:1024
    buffer_load_dwordx4 v10, s[16:19], s74 offen offset:2048 lds
    v_mfma_f32_16x16x32_bf16 v[244:247], v[68:71], v[56:59], v[244:247]
    ds_read_b128 v[76:79], v19 offset:1024
    v_mfma_f32_16x16x32_bf16 v[236:239], v[68:71], v[52:55], v[236:239]
    ds_read_b128 v[24:27], v18 offset:4096
    buffer_load_dwordx4 v11, s[16:19], s74 offen offset:3072 lds
    v_mfma_f32_16x16x32_bf16 v[228:231], v[68:71], v[48:51], v[228:231]
    ds_read_b128 v[64:67], v19 offset:5120
    s_waitcnt vmcnt(4)
    s_waitcnt lgkmcnt(9)
    v_mfma_f32_16x16x32_bf16 v[128:131], v[72:75], v[32:35], v[128:131]
    ds_read_b128 v[68:71], v18 offset:8192
    v_xor_b32 v97, s64, v97
    v_xor_b32 v99, s64, v99
    s_waitcnt lgkmcnt(8)
    v_mfma_f32_16x16x32_bf16 v[136:139], v[72:75], v[36:39], v[136:139]
    ds_read_b64_tr_b16 v[48:49], v20 offset:8192
    v_xor_b32 v101, s64, v101
    v_xor_b32 v103, s64, v103
    s_waitcnt lgkmcnt(7)
    v_mfma_f32_16x16x32_bf16 v[144:147], v[72:75], v[40:43], v[144:147]
    ds_read_b64_tr_b16 v[50:51], v20 offset:9216
    v_xor_b32 v105, s64, v105
    v_xor_b32 v107, s64, v107
    s_waitcnt lgkmcnt(6)
    v_mfma_f32_16x16x32_bf16 v[152:155], v[72:75], v[44:47], v[152:155]
    ds_read_b64_tr_b16 v[52:53], v21 offset:8192
    v_xor_b32 v109, s64, v109
    v_xor_b32 v111, s64, v111
    s_waitcnt lgkmcnt(6)
    v_mfma_f32_16x16x32_bf16 v[156:159], v[76:79], v[44:47], v[156:159]
    ds_read_b128 v[72:75], v19 offset:9216
    s_add_u32 s74, s68, 512
    s_add_u32 m0, s72, 98304
    s_nop 0
    buffer_load_dwordx4 v4, s[8:11], s74 offen offset:0 lds
    v_or3_b32 v97, v97, v99, v101
    v_mfma_f32_16x16x32_bf16 v[148:151], v[76:79], v[40:43], v[148:151]
    ds_read_b64_tr_b16 v[54:55], v21 offset:9216
    v_or3_b32 v103, v103, v105, v107
    v_or3_b32 v97, v97, v109, v111
    v_or_b32 v97, v97, v103
    v_mfma_f32_16x16x32_bf16 v[140:143], v[76:79], v[36:39], v[140:143]
    ds_read_b64_tr_b16 v[56:57], v22 offset:8192
    buffer_load_dwordx4 v5, s[8:11], s74 offen offset:1024 lds
    v_mfma_f32_16x16x32_bf16 v[132:135], v[76:79], v[32:35], v[132:135]
    ds_read_b64_tr_b16 v[58:59], v22 offset:9216
    v_cmp_ne_u32 vcc, 0, v97
    s_nop 0
    s_cbranch_vccnz Lml_22
Lmok_23:
    s_waitcnt lgkmcnt(9)
    v_mfma_f32_16x16x32_bf16 v[160:163], v[24:27], v[32:35], v[160:163]
    ds_read_b128 v[76:79], v18 offset:12288
    buffer_load_dwordx4 v6, s[8:11], s74 offen offset:2048 lds
    v_add_f32 v96, v96, v98
    v_add_f32 v100, v100, v102
    v_mfma_f32_16x16x32_bf16 v[168:171], v[24:27], v[36:39], v[168:171]
    ds_read_b64_tr_b16 v[60:61], v23 offset:8192
    v_add_f32 v104, v104, v106
    v_add_f32 v108, v108, v110
    v_mfma_f32_16x16x32_bf16 v[176:179], v[24:27], v[40:43], v[176:179]
    ds_read_b64_tr_b16 v[62:63], v23 offset:9216
    buffer_load_dwordx4 v7, s[8:11], s74 offen offset:3072 lds
    v_add_f32 v96, v96, v100
    v_add_f32 v104, v104, v108
    v_mfma_f32_16x16x32_bf16 v[184:187], v[24:27], v[44:47], v[184:187]
    v_cvt_pk_bf16_f32 v97, v96, v104
    v_lshlrev_b32 v96, 16, v97
    s_waitcnt lgkmcnt(11)
    v_mfma_f32_16x16x32_bf16 v[188:191], v[64:67], v[44:47], v[188:191]
    ds_read_b128 v[24:27], v19 offset:13312
    v_and_b32 v104, 0xffff0000, v97
    v_add_f32 v104, 1.0, v104
    v_mfma_f32_16x16x32_bf16 v[180:183], v[64:67], v[40:43], v[180:183]
    v_cvt_pk_bf16_f32 v96, v96, v104
    v_lshlrev_b32 v84, 16, v80
    v_mfma_f32_16x16x32_bf16 v[172:175], v[64:67], v[36:39], v[172:175]
    v_and_b32 v85, 0xffff0000, v80
    v_lshlrev_b32 v86, 16, v81
    v_mfma_f32_16x16x32_bf16 v[164:167], v[64:67], v[32:35], v[164:167]
    v_and_b32 v87, 0xffff0000, v81
    v_lshlrev_b32 v88, 16, v82
    s_lshl_b32 s42, 1, s24
    s_and_b32 s42, s42, 16
    s_cbranch_scc0 Lpf_24
    buffer_load_dword v124, v95, s[76:79], s67 offen
Lpf_24:
    s_cmp_eq_u32 s27, 1
    s_cbranch_scc0 Ltk_25
    v_bfe_u32 v126, v1, 1, 3
    v_lshlrev_b32 v126, 13, v126
    v_and_b32 v127, 1, v1
    v_lshl_add_u32 v126, v127, 7, v126
    s_lshl_b32 s42, s26, 16
    s_lshl_b32 s43, s25, 8
    s_add_u32 s42, s42, s43
    s_add_u32 s42, s42, 3145728
    buffer_load_dword v127, v126, s[16:19], s42 offen
Ltk_25:
    s_waitcnt lgkmcnt(11)
    v_mfma_f32_16x16x32_bf16 v[192:195], v[68:71], v[32:35], v[192:195]
    ds_read_b128 v[64:67], v19 offset:0
    v_and_b32 v89, 0xffff0000, v82
    v_lshlrev_b32 v90, 16, v83
    v_mfma_f32_16x16x32_bf16 v[200:203], v[68:71], v[36:39], v[200:203]
    v_and_b32 v91, 0xffff0000, v83
    v_mfma_f32_16x16x32_bf16 v[208:211], v[68:71], v[40:43], v[208:211]
    v_mfma_f32_16x16x32_bf16 v[216:219], v[68:71], v[44:47], v[216:219]
    ds_swizzle_b32 v104, v96 offset:24
    s_waitcnt lgkmcnt(9)
    v_mfma_f32_16x16x32_bf16 v[220:223], v[72:75], v[44:47], v[220:223]
    ds_read_b128 v[68:71], v18 offset:1024
    ds_swizzle_b32 v105, v96 offset:56
    v_mfma_f32_16x16x32_bf16 v[212:215], v[72:75], v[40:43], v[212:215]
    ds_swizzle_b32 v106, v96 offset:88
    v_mfma_f32_16x16x32_bf16 v[204:207], v[72:75], v[36:39], v[204:207]
    ds_swizzle_b32 v107, v96 offset:120
    v_mfma_f32_16x16x32_bf16 v[196:199], v[72:75], v[32:35], v[196:199]
    ds_swizzle_b32 v108, v96 offset:152
    s_waitcnt lgkmcnt(10)
    v_mfma_f32_16x16x32_bf16 v[224:227], v[76:79], v[32:35], v[224:227]
    ds_read_b128 v[72:75], v19 offset:4096
    ds_swizzle_b32 v109, v96 offset:184
    v_mfma_f32_16x16x32_bf16 v[232:235], v[76:79], v[36:39], v[232:235]
    ds_swizzle_b32 v110, v96 offset:216
    v_mfma_f32_16x16x32_bf16 v[240:243], v[76:79], v[40:43], v[240:243]
    ds_swizzle_b32 v111, v96 offset:248
    v_mfma_f32_16x16x32_bf16 v[248:251], v[76:79], v[44:47], v[248:251]
    s_waitcnt lgkmcnt(11)
    v_mfma_f32_16x16x32_bf16 v[252:255], v[24:27], v[44:47], v[252:255]
    ds_read_b128 v[76:79], v18 offset:5120
    v_mfma_f32_16x16x32_bf16 v[244:247], v[24:27], v[40:43], v[244:247]
    s_waitcnt lgkmcnt(1)
    v_mfma_f32_16x16x32_bf16 v[236:239], v[24:27], v[36:39], v[236:239]
    v_and_b32 v112, 0xffff0000, v104
    v_and_b32 v113, 0xffff0000, v105
    v_mfma_f32_16x16x32_bf16 v[228:231], v[24:27], v[32:35], v[228:231]
    v_and_b32 v114, 0xffff0000, v106
    v_and_b32 v115, 0xffff0000, v107
    v_mfma_f32_16x16x32_bf16 v[128:131], v[64:67], v[48:51], v[128:131]
    ds_read_b128 v[24:27], v19 offset:8192
    v_and_b32 v116, 0xffff0000, v108
    v_and_b32 v117, 0xffff0000, v109
    v_mfma_f32_16x16x32_bf16 v[136:139], v[64:67], v[52:55], v[136:139]
    v_and_b32 v118, 0xffff0000, v110
    v_and_b32 v119, 0xffff0000, v111
    v_mfma_f32_16x16x32_bf16 v[144:147], v[64:67], v[56:59], v[144:147]
    v_mul_f32 v84, v84, v112
    v_mul_f32 v85, v85, v113
    v_mfma_f32_16x16x32_bf16 v[152:155], v[64:67], v[60:63], v[152:155]
    v_mul_f32 v86, v86, v114
    v_mul_f32 v87, v87, v115
    v_mfma_f32_16x16x32_bf16 v[156:159], v[68:71], v[60:63], v[156:159]
    ds_read_b128 v[64:67], v18 offset:9216
    v_mul_f32 v88, v88, v116
    v_mul_f32 v89, v89, v117
    v_mfma_f32_16x16x32_bf16 v[148:151], v[68:71], v[56:59], v[148:151]
    v_mul_f32 v90, v90, v118
    v_mul_f32 v91, v91, v119
    v_mfma_f32_16x16x32_bf16 v[140:143], v[68:71], v[52:55], v[140:143]
    v_cvt_pk_bf16_f32 v96, v84, v85
    v_lshlrev_b32 v84, 16, v96
    v_mfma_f32_16x16x32_bf16 v[132:135], v[68:71], v[48:51], v[132:135]
    v_and_b32 v85, 0xffff0000, v96
    v_cvt_pk_bf16_f32 v96, v86, v87
    v_mfma_f32_16x16x32_bf16 v[160:163], v[72:75], v[48:51], v[160:163]
    ds_read_b128 v[68:71], v19 offset:12288
    v_lshlrev_b32 v86, 16, v96
    v_and_b32 v87, 0xffff0000, v96
    v_mfma_f32_16x16x32_bf16 v[168:171], v[72:75], v[52:55], v[168:171]
    v_cvt_pk_bf16_f32 v96, v88, v89
    v_lshlrev_b32 v88, 16, v96
    v_mfma_f32_16x16x32_bf16 v[176:179], v[72:75], v[56:59], v[176:179]
    v_and_b32 v89, 0xffff0000, v96
    v_cvt_pk_bf16_f32 v96, v90, v91
    v_mfma_f32_16x16x32_bf16 v[184:187], v[72:75], v[60:63], v[184:187]
    v_lshlrev_b32 v90, 16, v96
    v_and_b32 v91, 0xffff0000, v96
    s_waitcnt lgkmcnt(3)
    v_mfma_f32_16x16x32_bf16 v[188:191], v[76:79], v[60:63], v[188:191]
    ds_read_b128 v[72:75], v18 offset:13312
    v_lshlrev_b32 v104, 16, v104
    v_lshlrev_b32 v105, 16, v105
    v_mfma_f32_16x16x32_bf16 v[180:183], v[76:79], v[56:59], v[180:183]
    v_lshlrev_b32 v106, 16, v106
    v_lshlrev_b32 v107, 16, v107
    v_mfma_f32_16x16x32_bf16 v[172:175], v[76:79], v[52:55], v[172:175]
    v_add_u32 v18, 32768, v16
    v_add_u32 v20, 65536, v17
    v_lshlrev_b32 v108, 16, v108
    v_mfma_f32_16x16x32_bf16 v[164:167], v[76:79], v[48:51], v[164:167]
    v_lshlrev_b32 v109, 16, v109
    v_lshlrev_b32 v110, 16, v110
    v_lshlrev_b32 v111, 16, v111
    s_waitcnt lgkmcnt(3)
    v_mfma_f32_16x16x32_bf16 v[192:195], v[24:27], v[48:51], v[192:195]
    v_xor_b32 v19, 64, v18
    v_xor_b32 v21, s63, v20
    v_add_f32 v84, v84, v104
    v_mfma_f32_16x16x32_bf16 v[200:203], v[24:27], v[52:55], v[200:203]
    v_add_f32 v85, v85, v105
    v_add_f32 v86, v86, v106
    v_add_f32 v87, v87, v107
    v_mfma_f32_16x16x32_bf16 v[208:211], v[24:27], v[56:59], v[208:211]
    v_xor_b32 v22, 64, v20
    v_xor_b32 v23, s62, v20
    v_add_f32 v88, v88, v108
    v_mfma_f32_16x16x32_bf16 v[216:219], v[24:27], v[60:63], v[216:219]
    v_add_f32 v89, v89, v109
    v_add_f32 v90, v90, v110
    v_add_f32 v91, v91, v111
    s_waitcnt lgkmcnt(0)
    s_waitcnt vmcnt(4)
    v_mfma_f32_16x16x32_bf16 v[220:223], v[64:67], v[60:63], v[220:223]
    s_barrier
    ds_read_b64_tr_b16 v[32:33], v20 offset:0
    v_cvt_pk_bf16_f32 v80, v84, v85
    v_cvt_pk_bf16_f32 v81, v86, v87
    v_mfma_f32_16x16x32_bf16 v[212:215], v[64:67], v[56:59], v[212:215]
    ds_read_b64_tr_b16 v[34:35], v20 offset:1024
    v_cvt_pk_bf16_f32 v82, v88, v89
    v_cvt_pk_bf16_f32 v83, v90, v91
    v_mfma_f32_16x16x32_bf16 v[204:207], v[64:67], v[52:55], v[204:207]
    ds_read_b128 v[76:79], v18 offset:0
    buffer_store_dwordx4 v[80:83], v28, s[12:15], s71 offen sc1
    v_mfma_f32_16x16x32_bf16 v[196:199], v[64:67], v[48:51], v[196:199]
    ds_read_b64_tr_b16 v[36:37], v21 offset:0
    v_mfma_f32_16x16x32_bf16 v[224:227], v[68:71], v[48:51], v[224:227]
    ds_read_b64_tr_b16 v[38:39], v21 offset:1024
    s_add_u32 s74, s69, 2097152
    s_add_u32 m0, s72, 131072
    v_mfma_f32_16x16x32_bf16 v[232:235], v[68:71], v[52:55], v[232:235]
    ds_read_b64_tr_b16 v[40:41], v22 offset:0
    buffer_load_dwordx4 v8, s[16:19], s74 offen offset:0 lds
    v_mfma_f32_16x16x32_bf16 v[240:243], v[68:71], v[56:59], v[240:243]
    ds_read_b64_tr_b16 v[42:43], v22 offset:1024
    buffer_load_dwordx4 v9, s[16:19], s74 offen offset:1024 lds
    v_mfma_f32_16x16x32_bf16 v[248:251], v[68:71], v[60:63], v[248:251]
    ds_read_b64_tr_b16 v[44:45], v23 offset:0
    v_mfma_f32_16x16x32_bf16 v[252:255], v[72:75], v[60:63], v[252:255]
    ds_read_b64_tr_b16 v[46:47], v23 offset:1024
    buffer_load_dwordx4 v10, s[16:19], s74 offen offset:2048 lds
    v_mfma_f32_16x16x32_bf16 v[244:247], v[72:75], v[56:59], v[244:247]
    ds_read_b128 v[24:27], v19 offset:1024
    v_mfma_f32_16x16x32_bf16 v[236:239], v[72:75], v[52:55], v[236:239]
    ds_read_b128 v[64:67], v18 offset:4096
    buffer_load_dwordx4 v11, s[16:19], s74 offen offset:3072 lds
    v_mfma_f32_16x16x32_bf16 v[228:231], v[72:75], v[48:51], v[228:231]
    ds_read_b128 v[68:71], v19 offset:5120
    s_waitcnt lgkmcnt(9)
    v_mfma_f32_16x16x32_bf16 v[128:131], v[76:79], v[32:35], v[128:131]
    ds_read_b128 v[72:75], v18 offset:8192
    s_waitcnt lgkmcnt(8)
    v_mfma_f32_16x16x32_bf16 v[136:139], v[76:79], v[36:39], v[136:139]
    ds_read_b64_tr_b16 v[48:49], v20 offset:8192
    s_waitcnt lgkmcnt(7)
    v_mfma_f32_16x16x32_bf16 v[144:147], v[76:79], v[40:43], v[144:147]
    ds_read_b64_tr_b16 v[50:51], v20 offset:9216
    s_waitcnt lgkmcnt(6)
    v_mfma_f32_16x16x32_bf16 v[152:155], v[76:79], v[44:47], v[152:155]
    ds_read_b64_tr_b16 v[52:53], v21 offset:8192
    s_waitcnt lgkmcnt(6)
    v_mfma_f32_16x16x32_bf16 v[156:159], v[24:27], v[44:47], v[156:159]
    ds_read_b128 v[76:79], v19 offset:9216
    s_add_u32 s74, s68, 640
    s_add_u32 m0, s72, 0
    v_mfma_f32_16x16x32_bf16 v[148:151], v[24:27], v[40:43], v[148:151]
    ds_read_b64_tr_b16 v[54:55], v21 offset:9216
    buffer_load_dwordx4 v4, s[8:11], s74 offen offset:0 lds
    v_mfma_f32_16x16x32_bf16 v[140:143], v[24:27], v[36:39], v[140:143]
    ds_read_b64_tr_b16 v[56:57], v22 offset:8192
    buffer_load_dwordx4 v5, s[8:11], s74 offen offset:1024 lds
    v_mfma_f32_16x16x32_bf16 v[132:135], v[24:27], v[32:35], v[132:135]
    ds_read_b64_tr_b16 v[58:59], v22 offset:9216
    s_waitcnt lgkmcnt(9)
    v_mfma_f32_16x16x32_bf16 v[160:163], v[64:67], v[32:35], v[160:163]
    ds_read_b128 v[24:27], v18 offset:12288
    buffer_load_dwordx4 v6, s[8:11], s74 offen offset:2048 lds
    v_mfma_f32_16x16x32_bf16 v[168:171], v[64:67], v[36:39], v[168:171]
    ds_read_b64_tr_b16 v[60:61], v23 offset:8192
    v_mfma_f32_16x16x32_bf16 v[176:179], v[64:67], v[40:43], v[176:179]
    ds_read_b64_tr_b16 v[62:63], v23 offset:9216
    buffer_load_dwordx4 v7, s[8:11], s74 offen offset:3072 lds
    v_mfma_f32_16x16x32_bf16 v[184:187], v[64:67], v[44:47], v[184:187]
    s_waitcnt lgkmcnt(11)
    v_mfma_f32_16x16x32_bf16 v[188:191], v[68:71], v[44:47], v[188:191]
    ds_read_b128 v[64:67], v19 offset:13312
    v_mfma_f32_16x16x32_bf16 v[180:183], v[68:71], v[40:43], v[180:183]
    v_mfma_f32_16x16x32_bf16 v[172:175], v[68:71], v[36:39], v[172:175]
    v_mfma_f32_16x16x32_bf16 v[164:167], v[68:71], v[32:35], v[164:167]
    s_lshl_b32 s42, 1, s24
    s_and_b32 s42, s42, 32
    s_cbranch_scc0 Lpf_26
    buffer_load_dword v124, v95, s[76:79], s67 offen
Lpf_26:
    s_cmp_eq_u32 s27, 1
    s_cbranch_scc0 Ltk_27
    v_bfe_u32 v126, v1, 1, 3
    v_lshlrev_b32 v126, 13, v126
    v_and_b32 v127, 1, v1
    v_lshl_add_u32 v126, v127, 7, v126
    s_lshl_b32 s42, s26, 16
    s_lshl_b32 s43, s25, 8
    s_add_u32 s42, s42, s43
    s_add_u32 s42, s42, 3670016
    buffer_load_dword v127, v126, s[16:19], s42 offen
Ltk_27:
    s_waitcnt lgkmcnt(11)
    v_mfma_f32_16x16x32_bf16 v[192:195], v[72:75], v[32:35], v[192:195]
    ds_read_b128 v[68:71], v19 offset:0
    v_mfma_f32_16x16x32_bf16 v[200:203], v[72:75], v[36:39], v[200:203]
    v_mfma_f32_16x16x32_bf16 v[208:211], v[72:75], v[40:43], v[208:211]
    v_mfma_f32_16x16x32_bf16 v[216:219], v[72:75], v[44:47], v[216:219]
    s_waitcnt lgkmcnt(8)
    v_mfma_f32_16x16x32_bf16 v[220:223], v[76:79], v[44:47], v[220:223]
    ds_read_b128 v[72:75], v18 offset:1024
    v_mfma_f32_16x16x32_bf16 v[212:215], v[76:79], v[40:43], v[212:215]
    v_mfma_f32_16x16x32_bf16 v[204:207], v[76:79], v[36:39], v[204:207]
    v_mfma_f32_16x16x32_bf16 v[196:199], v[76:79], v[32:35], v[196:199]
    s_waitcnt lgkmcnt(5)
    v_mfma_f32_16x16x32_bf16 v[224:227], v[24:27], v[32:35], v[224:227]
    ds_read_b128 v[76:79], v19 offset:4096
    v_mfma_f32_16x16x32_bf16 v[232:235], v[24:27], v[36:39], v[232:235]
    v_mfma_f32_16x16x32_bf16 v[240:243], v[24:27], v[40:43], v[240:243]
    v_mfma_f32_16x16x32_bf16 v[248:251], v[24:27], v[44:47], v[248:251]
    s_waitcnt lgkmcnt(3)
    v_mfma_f32_16x16x32_bf16 v[252:255], v[64:67], v[44:47], v[252:255]
    ds_read_b128 v[24:27], v18 offset:5120
    v_mfma_f32_16x16x32_bf16 v[244:247], v[64:67], v[40:43], v[244:247]
    v_mfma_f32_16x16x32_bf16 v[236:239], v[64:67], v[36:39], v[236:239]
    v_mfma_f32_16x16x32_bf16 v[228:231], v[64:67], v[32:35], v[228:231]
    s_waitcnt lgkmcnt(3)
    v_mfma_f32_16x16x32_bf16 v[128:131], v[68:71], v[48:51], v[128:131]
    ds_read_b128 v[64:67], v19 offset:8192
    v_mfma_f32_16x16x32_bf16 v[136:139], v[68:71], v[52:55], v[136:139]
    v_mfma_f32_16x16x32_bf16 v[144:147], v[68:71], v[56:59], v[144:147]
    v_mfma_f32_16x16x32_bf16 v[152:155], v[68:71], v[60:63], v[152:155]
    s_waitcnt lgkmcnt(3)
    v_mfma_f32_16x16x32_bf16 v[156:159], v[72:75], v[60:63], v[156:159]
    ds_read_b128 v[68:71], v18 offset:9216
    v_mfma_f32_16x16x32_bf16 v[148:151], v[72:75], v[56:59], v[148:151]
    v_mfma_f32_16x16x32_bf16 v[140:143], v[72:75], v[52:55], v[140:143]
    v_mfma_f32_16x16x32_bf16 v[132:135], v[72:75], v[48:51], v[132:135]
    s_waitcnt lgkmcnt(3)
    v_mfma_f32_16x16x32_bf16 v[160:163], v[76:79], v[48:51], v[160:163]
    ds_read_b128 v[72:75], v19 offset:12288
    v_mfma_f32_16x16x32_bf16 v[168:171], v[76:79], v[52:55], v[168:171]
    v_mfma_f32_16x16x32_bf16 v[176:179], v[76:79], v[56:59], v[176:179]
    v_mfma_f32_16x16x32_bf16 v[184:187], v[76:79], v[60:63], v[184:187]
    s_waitcnt lgkmcnt(3)
    v_mfma_f32_16x16x32_bf16 v[188:191], v[24:27], v[60:63], v[188:191]
    ds_read_b128 v[76:79], v18 offset:13312
    v_mfma_f32_16x16x32_bf16 v[180:183], v[24:27], v[56:59], v[180:183]
    v_mfma_f32_16x16x32_bf16 v[172:175], v[24:27], v[52:55], v[172:175]
    v_add_u32 v18, 98304, v16
    v_mfma_f32_16x16x32_bf16 v[164:167], v[24:27], v[48:51], v[164:167]
    v_add_u32 v20, 131072, v17
    s_waitcnt lgkmcnt(3)
    v_mfma_f32_16x16x32_bf16 v[192:195], v[64:67], v[48:51], v[192:195]
    v_xor_b32 v19, 64, v18
    v_mfma_f32_16x16x32_bf16 v[200:203], v[64:67], v[52:55], v[200:203]
    v_xor_b32 v21, s63, v20
    v_mfma_f32_16x16x32_bf16 v[208:211], v[64:67], v[56:59], v[208:211]
    v_xor_b32 v22, 64, v20
    v_mfma_f32_16x16x32_bf16 v[216:219], v[64:67], v[60:63], v[216:219]
    v_xor_b32 v23, s62, v20
    s_waitcnt lgkmcnt(0)
    s_waitcnt vmcnt(4)
    v_mfma_f32_16x16x32_bf16 v[220:223], v[68:71], v[60:63], v[220:223]
    s_barrier
    ds_read_b64_tr_b16 v[32:33], v20 offset:0
    v_mfma_f32_16x16x32_bf16 v[212:215], v[68:71], v[56:59], v[212:215]
    ds_read_b64_tr_b16 v[34:35], v20 offset:1024
    v_mfma_f32_16x16x32_bf16 v[204:207], v[68:71], v[52:55], v[204:207]
    ds_read_b128 v[24:27], v18 offset:0
    v_mfma_f32_16x16x32_bf16 v[196:199], v[68:71], v[48:51], v[196:199]
    ds_read_b64_tr_b16 v[36:37], v21 offset:0
    v_mfma_f32_16x16x32_bf16 v[224:227], v[72:75], v[48:51], v[224:227]
    ds_read_b64_tr_b16 v[38:39], v21 offset:1024
    s_add_u32 s74, s69, 2621440
    s_add_u32 m0, s72, 32768
    v_mfma_f32_16x16x32_bf16 v[232:235], v[72:75], v[52:55], v[232:235]
    ds_read_b64_tr_b16 v[40:41], v22 offset:0
    buffer_load_dwordx4 v8, s[16:19], s74 offen offset:0 lds
    v_mfma_f32_16x16x32_bf16 v[240:243], v[72:75], v[56:59], v[240:243]
    ds_read_b64_tr_b16 v[42:43], v22 offset:1024
    buffer_load_dwordx4 v9, s[16:19], s74 offen offset:1024 lds
    v_mfma_f32_16x16x32_bf16 v[248:251], v[72:75], v[60:63], v[248:251]
    ds_read_b64_tr_b16 v[44:45], v23 offset:0
    v_mfma_f32_16x16x32_bf16 v[252:255], v[76:79], v[60:63], v[252:255]
    ds_read_b64_tr_b16 v[46:47], v23 offset:1024
    buffer_load_dwordx4 v10, s[16:19], s74 offen offset:2048 lds
    v_mfma_f32_16x16x32_bf16 v[244:247], v[76:79], v[56:59], v[244:247]
    ds_read_b128 v[64:67], v19 offset:1024
    v_mfma_f32_16x16x32_bf16 v[236:239], v[76:79], v[52:55], v[236:239]
    ds_read_b128 v[68:71], v18 offset:4096
    buffer_load_dwordx4 v11, s[16:19], s74 offen offset:3072 lds
    v_mfma_f32_16x16x32_bf16 v[228:231], v[76:79], v[48:51], v[228:231]
    ds_read_b128 v[72:75], v19 offset:5120
    s_waitcnt lgkmcnt(9)
    v_mfma_f32_16x16x32_bf16 v[128:131], v[24:27], v[32:35], v[128:131]
    ds_read_b128 v[76:79], v18 offset:8192
    s_waitcnt lgkmcnt(8)
    v_mfma_f32_16x16x32_bf16 v[136:139], v[24:27], v[36:39], v[136:139]
    ds_read_b64_tr_b16 v[48:49], v20 offset:8192
    s_waitcnt lgkmcnt(7)
    v_mfma_f32_16x16x32_bf16 v[144:147], v[24:27], v[40:43], v[144:147]
    ds_read_b64_tr_b16 v[50:51], v20 offset:9216
    s_waitcnt lgkmcnt(6)
    v_mfma_f32_16x16x32_bf16 v[152:155], v[24:27], v[44:47], v[152:155]
    ds_read_b64_tr_b16 v[52:53], v21 offset:8192
    s_waitcnt lgkmcnt(6)
    v_mfma_f32_16x16x32_bf16 v[156:159], v[64:67], v[44:47], v[156:159]
    ds_read_b128 v[24:27], v19 offset:9216
    s_add_u32 s74, s68, 768
    s_add_u32 m0, s72, 65536
    v_mfma_f32_16x16x32_bf16 v[148:151], v[64:67], v[40:43], v[148:151]
    ds_read_b64_tr_b16 v[54:55], v21 offset:9216
    buffer_load_dwordx4 v4, s[8:11], s74 offen offset:0 lds
    v_mfma_f32_16x16x32_bf16 v[140:143], v[64:67], v[36:39], v[140:143]
    ds_read_b64_tr_b16 v[56:57], v22 offset:8192
    buffer_load_dwordx4 v5, s[8:11], s74 offen offset:1024 lds
    v_mfma_f32_16x16x32_bf16 v[132:135], v[64:67], v[32:35], v[132:135]
    ds_read_b64_tr_b16 v[58:59], v22 offset:9216
    s_waitcnt lgkmcnt(9)
    v_mfma_f32_16x16x32_bf16 v[160:163], v[68:71], v[32:35], v[160:163]
    ds_read_b128 v[64:67], v18 offset:12288
    buffer_load_dwordx4 v6, s[8:11], s74 offen offset:2048 lds
    v_mfma_f32_16x16x32_bf16 v[168:171], v[68:71], v[36:39], v[168:171]
    ds_read_b64_tr_b16 v[60:61], v23 offset:8192
    v_mfma_f32_16x16x32_bf16 v[176:179], v[68:71], v[40:43], v[176:179]
    ds_read_b64_tr_b16 v[62:63], v23 offset:9216
    buffer_load_dwordx4 v7, s[8:11], s74 offen offset:3072 lds
    v_mfma_f32_16x16x32_bf16 v[184:187], v[68:71], v[44:47], v[184:187]
    s_waitcnt lgkmcnt(11)
    v_mfma_f32_16x16x32_bf16 v[188:191], v[72:75], v[44:47], v[188:191]
    ds_read_b128 v[68:71], v19 offset:13312
    v_mfma_f32_16x16x32_bf16 v[180:183], v[72:75], v[40:43], v[180:183]
    v_mfma_f32_16x16x32_bf16 v[172:175], v[72:75], v[36:39], v[172:175]
    v_mfma_f32_16x16x32_bf16 v[164:167], v[72:75], v[32:35], v[164:167]
    s_waitcnt lgkmcnt(11)
    v_mfma_f32_16x16x32_bf16 v[192:195], v[76:79], v[32:35], v[192:195]
    ds_read_b128 v[72:75], v19 offset:0
    v_mfma_f32_16x16x32_bf16 v[200:203], v[76:79], v[36:39], v[200:203]
    v_mfma_f32_16x16x32_bf16 v[208:211], v[76:79], v[40:43], v[208:211]
    v_mfma_f32_16x16x32_bf16 v[216:219], v[76:79], v[44:47], v[216:219]
    s_waitcnt lgkmcnt(8)
    v_mfma_f32_16x16x32_bf16 v[220:223], v[24:27], v[44:47], v[220:223]
    ds_read_b128 v[76:79], v18 offset:1024
    v_mfma_f32_16x16x32_bf16 v[212:215], v[24:27], v[40:43], v[212:215]
    v_mfma_f32_16x16x32_bf16 v[204:207], v[24:27], v[36:39], v[204:207]
    v_mfma_f32_16x16x32_bf16 v[196:199], v[24:27], v[32:35], v[196:199]
    s_waitcnt lgkmcnt(5)
    v_mfma_f32_16x16x32_bf16 v[224:227], v[64:67], v[32:35], v[224:227]
    ds_read_b128 v[24:27], v19 offset:4096
    v_mfma_f32_16x16x32_bf16 v[232:235], v[64:67], v[36:39], v[232:235]
    v_mfma_f32_16x16x32_bf16 v[240:243], v[64:67], v[40:43], v[240:243]
    v_mfma_f32_16x16x32_bf16 v[248:251], v[64:67], v[44:47], v[248:251]
    s_waitcnt lgkmcnt(3)
    v_mfma_f32_16x16x32_bf16 v[252:255], v[68:71], v[44:47], v[252:255]
    ds_read_b128 v[64:67], v18 offset:5120
    v_mfma_f32_16x16x32_bf16 v[244:247], v[68:71], v[40:43], v[244:247]
    v_mfma_f32_16x16x32_bf16 v[236:239], v[68:71], v[36:39], v[236:239]
    v_mfma_f32_16x16x32_bf16 v[228:231], v[68:71], v[32:35], v[228:231]
    s_waitcnt lgkmcnt(3)
    v_mfma_f32_16x16x32_bf16 v[128:131], v[72:75], v[48:51], v[128:131]
    ds_read_b128 v[68:71], v19 offset:8192
    v_mfma_f32_16x16x32_bf16 v[136:139], v[72:75], v[52:55], v[136:139]
    v_mfma_f32_16x16x32_bf16 v[144:147], v[72:75], v[56:59], v[144:147]
    v_mfma_f32_16x16x32_bf16 v[152:155], v[72:75], v[60:63], v[152:155]
    s_waitcnt lgkmcnt(3)
    v_mfma_f32_16x16x32_bf16 v[156:159], v[76:79], v[60:63], v[156:159]
    ds_read_b128 v[72:75], v18 offset:9216
    v_mfma_f32_16x16x32_bf16 v[148:151], v[76:79], v[56:59], v[148:151]
    v_mfma_f32_16x16x32_bf16 v[140:143], v[76:79], v[52:55], v[140:143]
    v_mfma_f32_16x16x32_bf16 v[132:135], v[76:79], v[48:51], v[132:135]
    s_waitcnt lgkmcnt(3)
    v_mfma_f32_16x16x32_bf16 v[160:163], v[24:27], v[48:51], v[160:163]
    ds_read_b128 v[76:79], v19 offset:12288
    v_mfma_f32_16x16x32_bf16 v[168:171], v[24:27], v[52:55], v[168:171]
    v_mfma_f32_16x16x32_bf16 v[176:179], v[24:27], v[56:59], v[176:179]
    v_mfma_f32_16x16x32_bf16 v[184:187], v[24:27], v[60:63], v[184:187]
    s_waitcnt lgkmcnt(3)
    v_mfma_f32_16x16x32_bf16 v[188:191], v[64:67], v[60:63], v[188:191]
    ds_read_b128 v[24:27], v18 offset:13312
    v_mfma_f32_16x16x32_bf16 v[180:183], v[64:67], v[56:59], v[180:183]
    v_mfma_f32_16x16x32_bf16 v[172:175], v[64:67], v[52:55], v[172:175]
    v_add_u32 v18, 0, v16
    v_mfma_f32_16x16x32_bf16 v[164:167], v[64:67], v[48:51], v[164:167]
    v_add_u32 v20, 32768, v17
    s_waitcnt lgkmcnt(3)
    v_mfma_f32_16x16x32_bf16 v[192:195], v[68:71], v[48:51], v[192:195]
    v_xor_b32 v19, 64, v18
    v_mfma_f32_16x16x32_bf16 v[200:203], v[68:71], v[52:55], v[200:203]
    v_xor_b32 v21, s63, v20
    v_mfma_f32_16x16x32_bf16 v[208:211], v[68:71], v[56:59], v[208:211]
    v_xor_b32 v22, 64, v20
    v_mfma_f32_16x16x32_bf16 v[216:219], v[68:71], v[60:63], v[216:219]
    v_xor_b32 v23, s62, v20
    s_waitcnt lgkmcnt(0)
    s_waitcnt vmcnt(4)
    v_mfma_f32_16x16x32_bf16 v[220:223], v[72:75], v[60:63], v[220:223]
    s_barrier
    ds_read_b64_tr_b16 v[32:33], v20 offset:0
    v_mfma_f32_16x16x32_bf16 v[212:215], v[72:75], v[56:59], v[212:215]
    ds_read_b64_tr_b16 v[34:35], v20 offset:1024
    v_mfma_f32_16x16x32_bf16 v[204:207], v[72:75], v[52:55], v[204:207]
    ds_read_b128 v[64:67], v18 offset:0
    v_mfma_f32_16x16x32_bf16 v[196:199], v[72:75], v[48:51], v[196:199]
    ds_read_b64_tr_b16 v[36:37], v21 offset:0
    v_mfma_f32_16x16x32_bf16 v[224:227], v[76:79], v[48:51], v[224:227]
    ds_read_b64_tr_b16 v[38:39], v21 offset:1024
    s_add_u32 s74, s69, 3145728
    s_add_u32 m0, s72, 98304
    v_mfma_f32_16x16x32_bf16 v[232:235], v[76:79], v[52:55], v[232:235]
    ds_read_b64_tr_b16 v[40:41], v22 offset:0
    buffer_load_dwordx4 v8, s[16:19], s74 offen offset:0 lds
    v_mfma_f32_16x16x32_bf16 v[240:243], v[76:79], v[56:59], v[240:243]
    ds_read_b64_tr_b16 v[42:43], v22 offset:1024
    buffer_load_dwordx4 v9, s[16:19], s74 offen offset:1024 lds
    v_mfma_f32_16x16x32_bf16 v[248:251], v[76:79], v[60:63], v[248:251]
    ds_read_b64_tr_b16 v[44:45], v23 offset:0
    v_mfma_f32_16x16x32_bf16 v[252:255], v[24:27], v[60:63], v[252:255]
    ds_read_b64_tr_b16 v[46:47], v23 offset:1024
    buffer_load_dwordx4 v10, s[16:19], s74 offen offset:2048 lds
    v_mfma_f32_16x16x32_bf16 v[244:247], v[24:27], v[56:59], v[244:247]
    ds_read_b128 v[68:71], v19 offset:1024
    v_mfma_f32_16x16x32_bf16 v[236:239], v[24:27], v[52:55], v[236:239]
    ds_read_b128 v[72:75], v18 offset:4096
    buffer_load_dwordx4 v11, s[16:19], s74 offen offset:3072 lds
    v_mfma_f32_16x16x32_bf16 v[228:231], v[24:27], v[48:51], v[228:231]
    ds_read_b128 v[76:79], v19 offset:5120
    s_waitcnt lgkmcnt(9)
    v_mfma_f32_16x16x32_bf16 v[128:131], v[64:67], v[32:35], v[128:131]
    ds_read_b128 v[24:27], v18 offset:8192
    s_waitcnt lgkmcnt(8)
    v_mfma_f32_16x16x32_bf16 v[136:139], v[64:67], v[36:39], v[136:139]
    ds_read_b64_tr_b16 v[48:49], v20 offset:8192
    s_waitcnt lgkmcnt(7)
    v_mfma_f32_16x16x32_bf16 v[144:147], v[64:67], v[40:43], v[144:147]
    ds_read_b64_tr_b16 v[50:51], v20 offset:9216
    s_waitcnt lgkmcnt(6)
    v_mfma_f32_16x16x32_bf16 v[152:155], v[64:67], v[44:47], v[152:155]
    ds_read_b64_tr_b16 v[52:53], v21 offset:8192
    s_waitcnt lgkmcnt(6)
    v_mfma_f32_16x16x32_bf16 v[156:159], v[68:71], v[44:47], v[156:159]
    ds_read_b128 v[64:67], v19 offset:9216
    s_add_u32 s74, s68, 896
    s_add_u32 m0, s72, 131072
    v_mfma_f32_16x16x32_bf16 v[148:151], v[68:71], v[40:43], v[148:151]
    ds_read_b64_tr_b16 v[54:55], v21 offset:9216
    buffer_load_dwordx4 v4, s[8:11], s74 offen offset:0 lds
    v_mfma_f32_16x16x32_bf16 v[140:143], v[68:71], v[36:39], v[140:143]
    ds_read_b64_tr_b16 v[56:57], v22 offset:8192
    buffer_load_dwordx4 v5, s[8:11], s74 offen offset:1024 lds
    v_mfma_f32_16x16x32_bf16 v[132:135], v[68:71], v[32:35], v[132:135]
    ds_read_b64_tr_b16 v[58:59], v22 offset:9216
    s_waitcnt lgkmcnt(9)
    v_mfma_f32_16x16x32_bf16 v[160:163], v[72:75], v[32:35], v[160:163]
    ds_read_b128 v[68:71], v18 offset:12288
    buffer_load_dwordx4 v6, s[8:11], s74 offen offset:2048 lds
    v_mfma_f32_16x16x32_bf16 v[168:171], v[72:75], v[36:39], v[168:171]
    ds_read_b64_tr_b16 v[60:61], v23 offset:8192
    v_mfma_f32_16x16x32_bf16 v[176:179], v[72:75], v[40:43], v[176:179]
    ds_read_b64_tr_b16 v[62:63], v23 offset:9216
    buffer_load_dwordx4 v7, s[8:11], s74 offen offset:3072 lds
    v_mfma_f32_16x16x32_bf16 v[184:187], v[72:75], v[44:47], v[184:187]
    s_waitcnt lgkmcnt(11)
    v_mfma_f32_16x16x32_bf16 v[188:191], v[76:79], v[44:47], v[188:191]
    ds_read_b128 v[72:75], v19 offset:13312
    v_mfma_f32_16x16x32_bf16 v[180:183], v[76:79], v[40:43], v[180:183]
    v_mfma_f32_16x16x32_bf16 v[172:175], v[76:79], v[36:39], v[172:175]
    v_mfma_f32_16x16x32_bf16 v[164:167], v[76:79], v[32:35], v[164:167]
    s_waitcnt lgkmcnt(11)
    v_mfma_f32_16x16x32_bf16 v[192:195], v[24:27], v[32:35], v[192:195]
    ds_read_b128 v[76:79], v19 offset:0
    v_mfma_f32_16x16x32_bf16 v[200:203], v[24:27], v[36:39], v[200:203]
    v_mfma_f32_16x16x32_bf16 v[208:211], v[24:27], v[40:43], v[208:211]
    v_mfma_f32_16x16x32_bf16 v[216:219], v[24:27], v[44:47], v[216:219]
    s_waitcnt lgkmcnt(8)
    v_mfma_f32_16x16x32_bf16 v[220:223], v[64:67], v[44:47], v[220:223]
    ds_read_b128 v[24:27], v18 offset:1024
    v_mfma_f32_16x16x32_bf16 v[212:215], v[64:67], v[40:43], v[212:215]
    v_mfma_f32_16x16x32_bf16 v[204:207], v[64:67], v[36:39], v[204:207]
    v_mfma_f32_16x16x32_bf16 v[196:199], v[64:67], v[32:35], v[196:199]
    s_waitcnt lgkmcnt(5)
    v_mfma_f32_16x16x32_bf16 v[224:227], v[68:71], v[32:35], v[224:227]
    ds_read_b128 v[64:67], v19 offset:4096
    v_mfma_f32_16x16x32_bf16 v[232:235], v[68:71], v[36:39], v[232:235]
    v_mfma_f32_16x16x32_bf16 v[240:243], v[68:71], v[40:43], v[240:243]
    v_mfma_f32_16x16x32_bf16 v[248:251], v[68:71], v[44:47], v[248:251]
    s_waitcnt lgkmcnt(3)
    v_mfma_f32_16x16x32_bf16 v[252:255], v[72:75], v[44:47], v[252:255]
    ds_read_b128 v[68:71], v18 offset:5120
    s_lshl_b32 s75, s25, 19
    s_and_b32 s43, s24, 1
    v_mfma_f32_16x16x32_bf16 v[244:247], v[72:75], v[40:43], v[244:247]
    s_lshl_b32 s43, s43, 3
    s_add_u32 s43, s43, s26
    v_mfma_f32_16x16x32_bf16 v[236:239], v[72:75], v[36:39], v[236:239]
    s_lshl_b32 s43, s43, 13
    s_add_u32 s75, s75, s43
    v_mfma_f32_16x16x32_bf16 v[228:231], v[72:75], v[32:35], v[228:231]
    s_bfe_u32 s43, s24, 0x10001
    s_lshl_b32 s43, s43, 12
    s_waitcnt lgkmcnt(3)
    v_mfma_f32_16x16x32_bf16 v[128:131], v[76:79], v[48:51], v[128:131]
    ds_read_b128 v[72:75], v19 offset:8192
    s_add_u32 s75, s75, s43
    s_lshl_b32 s43, s28, 24
    v_mfma_f32_16x16x32_bf16 v[136:139], v[76:79], v[52:55], v[136:139]
    s_add_u32 s75, s75, s43
    s_add_u32 s75, s75, 16777216
    v_mfma_f32_16x16x32_bf16 v[144:147], v[76:79], v[56:59], v[144:147]
    v_bfe_u32 v12, v1, 2, 2
    v_lshrrev_b32 v13, 5, v1
    v_mfma_f32_16x16x32_bf16 v[152:155], v[76:79], v[60:63], v[152:155]
    v_bfe_u32 v14, v1, 4, 1
    v_lshl_add_u32 v4, v13, 3, v12
    s_waitcnt lgkmcnt(3)
    v_mfma_f32_16x16x32_bf16 v[156:159], v[24:27], v[60:63], v[156:159]
    ds_read_b128 v[76:79], v18 offset:9216
    v_lshl_add_u32 v4, v14, 4, v4
    v_lshlrev_b32 v4, 8, v4
    v_mfma_f32_16x16x32_bf16 v[148:151], v[24:27], v[56:59], v[148:151]
    v_lshl_add_u32 v4, v12, 6, v4
    v_lshl_add_u32 v4, v14, 4, v4
    v_mfma_f32_16x16x32_bf16 v[140:143], v[24:27], v[52:55], v[140:143]
    v_and_b32 v13, 1, v1
    v_lshl_add_u32 v4, v13, 5, v4
    v_mfma_f32_16x16x32_bf16 v[132:135], v[24:27], v[48:51], v[132:135]
    v_bfe_u32 v13, v1, 1, 1
    v_lshl_add_u32 v4, v13, 3, v4
    s_waitcnt lgkmcnt(3)
    v_mfma_f32_16x16x32_bf16 v[160:163], v[64:67], v[48:51], v[160:163]
    ds_read_b128 v[24:27], v19 offset:12288
    v_add_u32 v4, 0x8000, v4
    v_xor_b32 v5, 64, v4
    v_mfma_f32_16x16x32_bf16 v[168:171], v[64:67], v[52:55], v[168:171]
    v_xor_b32 v6, 0x80, v4
    v_xor_b32 v7, 0xc0, v4
    v_mfma_f32_16x16x32_bf16 v[176:179], v[64:67], v[56:59], v[176:179]
    s_and_b32 s61, s24, 1
    s_lshl_b32 s61, s61, 4
    v_mfma_f32_16x16x32_bf16 v[184:187], v[64:67], v[60:63], v[184:187]
    s_xor_b32 s60, s61, s63
    s_waitcnt lgkmcnt(3)
    v_mfma_f32_16x16x32_bf16 v[188:191], v[68:71], v[60:63], v[188:191]
    ds_read_b128 v[64:67], v18 offset:13312
    v_mfma_f32_16x16x32_bf16 v[180:183], v[68:71], v[56:59], v[180:183]
    v_mfma_f32_16x16x32_bf16 v[172:175], v[68:71], v[52:55], v[172:175]
    v_add_u32 v18, 65536, v16
    v_mfma_f32_16x16x32_bf16 v[164:167], v[68:71], v[48:51], v[164:167]
    v_add_u32 v20, 98304, v17
    s_waitcnt lgkmcnt(3)
    v_mfma_f32_16x16x32_bf16 v[192:195], v[72:75], v[48:51], v[192:195]
    v_xor_b32 v19, 64, v18
    v_mfma_f32_16x16x32_bf16 v[200:203], v[72:75], v[52:55], v[200:203]
    v_xor_b32 v21, s63, v20
    v_mfma_f32_16x16x32_bf16 v[208:211], v[72:75], v[56:59], v[208:211]
    v_xor_b32 v22, 64, v20
    v_mfma_f32_16x16x32_bf16 v[216:219], v[72:75], v[60:63], v[216:219]
    v_xor_b32 v23, s62, v20
    s_waitcnt lgkmcnt(0)
    s_waitcnt vmcnt(4)
    v_mfma_f32_16x16x32_bf16 v[220:223], v[76:79], v[60:63], v[220:223]
    s_barrier
    ds_read_b64_tr_b16 v[32:33], v20 offset:0
    v_mfma_f32_16x16x32_bf16 v[212:215], v[76:79], v[56:59], v[212:215]
    ds_read_b64_tr_b16 v[34:35], v20 offset:1024
    v_mfma_f32_16x16x32_bf16 v[204:207], v[76:79], v[52:55], v[204:207]
    ds_read_b128 v[68:71], v18 offset:0
    v_mfma_f32_16x16x32_bf16 v[196:199], v[76:79], v[48:51], v[196:199]
    ds_read_b64_tr_b16 v[36:37], v21 offset:0
    v_mfma_f32_16x16x32_bf16 v[224:227], v[24:27], v[48:51], v[224:227]
    ds_read_b64_tr_b16 v[38:39], v21 offset:1024
    s_add_u32 s74, s69, 3670016
    s_add_u32 m0, s72, 0
    v_mfma_f32_16x16x32_bf16 v[232:235], v[24:27], v[52:55], v[232:235]
    ds_read_b64_tr_b16 v[40:41], v22 offset:0
    buffer_load_dwordx4 v8, s[16:19], s74 offen offset:0 lds
    v_mfma_f32_16x16x32_bf16 v[240:243], v[24:27], v[56:59], v[240:243]
    ds_read_b64_tr_b16 v[42:43], v22 offset:1024
    buffer_load_dwordx4 v9, s[16:19], s74 offen offset:1024 lds
    v_mfma_f32_16x16x32_bf16 v[248:251], v[24:27], v[60:63], v[248:251]
    ds_read_b64_tr_b16 v[44:45], v23 offset:0
    v_mfma_f32_16x16x32_bf16 v[252:255], v[64:67], v[60:63], v[252:255]
    ds_read_b64_tr_b16 v[46:47], v23 offset:1024
    buffer_load_dwordx4 v10, s[16:19], s74 offen offset:2048 lds
    v_mfma_f32_16x16x32_bf16 v[244:247], v[64:67], v[56:59], v[244:247]
    ds_read_b128 v[72:75], v19 offset:1024
    v_mfma_f32_16x16x32_bf16 v[236:239], v[64:67], v[52:55], v[236:239]
    ds_read_b128 v[76:79], v18 offset:4096
    buffer_load_dwordx4 v11, s[16:19], s74 offen offset:3072 lds
    v_mfma_f32_16x16x32_bf16 v[228:231], v[64:67], v[48:51], v[228:231]
    ds_read_b128 v[24:27], v19 offset:5120
    s_waitcnt lgkmcnt(9)
    v_mfma_f32_16x16x32_bf16 v[128:131], v[68:71], v[32:35], v[128:131]
    ds_read_b128 v[64:67], v18 offset:8192
    v_xor_b32 v8, s61, v8
    v_xor_b32 v9, s61, v9
    s_waitcnt lgkmcnt(8)
    v_mfma_f32_16x16x32_bf16 v[136:139], v[68:71], v[36:39], v[136:139]
    ds_read_b64_tr_b16 v[48:49], v20 offset:8192
    v_xor_b32 v10, s60, v10
    v_xor_b32 v11, s60, v11
    s_waitcnt lgkmcnt(7)
    v_mfma_f32_16x16x32_bf16 v[144:147], v[68:71], v[40:43], v[144:147]
    ds_read_b64_tr_b16 v[50:51], v20 offset:9216
    s_waitcnt lgkmcnt(6)
    v_mfma_f32_16x16x32_bf16 v[152:155], v[68:71], v[44:47], v[152:155]
    ds_read_b64_tr_b16 v[52:53], v21 offset:8192
    s_waitcnt lgkmcnt(6)
    v_mfma_f32_16x16x32_bf16 v[156:159], v[72:75], v[44:47], v[156:159]
    ds_read_b128 v[68:71], v19 offset:9216
    s_add_u32 s74, s73, 0
    s_add_u32 m0, s72, 32768
    v_mfma_f32_16x16x32_bf16 v[148:151], v[72:75], v[40:43], v[148:151]
    ds_read_b64_tr_b16 v[54:55], v21 offset:9216
    buffer_load_dwordx4 v8, s[20:23], s74 offen offset:0 lds
    v_mfma_f32_16x16x32_bf16 v[140:143], v[72:75], v[36:39], v[140:143]
    ds_read_b64_tr_b16 v[56:57], v22 offset:8192
    buffer_load_dwordx4 v9, s[20:23], s74 offen offset:1024 lds
    v_mfma_f32_16x16x32_bf16 v[132:135], v[72:75], v[32:35], v[132:135]
    ds_read_b64_tr_b16 v[58:59], v22 offset:9216
    s_waitcnt lgkmcnt(9)
    v_mfma_f32_16x16x32_bf16 v[160:163], v[76:79], v[32:35], v[160:163]
    ds_read_b128 v[72:75], v18 offset:12288
    buffer_load_dwordx4 v10, s[20:23], s74 offen offset:2048 lds
    v_mfma_f32_16x16x32_bf16 v[168:171], v[76:79], v[36:39], v[168:171]
    ds_read_b64_tr_b16 v[60:61], v23 offset:8192
    v_mfma_f32_16x16x32_bf16 v[176:179], v[76:79], v[40:43], v[176:179]
    ds_read_b64_tr_b16 v[62:63], v23 offset:9216
    buffer_load_dwordx4 v11, s[20:23], s74 offen offset:3072 lds
    v_mfma_f32_16x16x32_bf16 v[184:187], v[76:79], v[44:47], v[184:187]
    s_waitcnt lgkmcnt(11)
    v_mfma_f32_16x16x32_bf16 v[188:191], v[24:27], v[44:47], v[188:191]
    ds_read_b128 v[76:79], v19 offset:13312
    v_mfma_f32_16x16x32_bf16 v[180:183], v[24:27], v[40:43], v[180:183]
    v_mfma_f32_16x16x32_bf16 v[172:175], v[24:27], v[36:39], v[172:175]
    v_mfma_f32_16x16x32_bf16 v[164:167], v[24:27], v[32:35], v[164:167]
    s_waitcnt lgkmcnt(11)
    v_mfma_f32_16x16x32_bf16 v[192:195], v[64:67], v[32:35], v[192:195]
    ds_read_b128 v[24:27], v19 offset:0
    v_mfma_f32_16x16x32_bf16 v[200:203], v[64:67], v[36:39], v[200:203]
    v_mfma_f32_16x16x32_bf16 v[208:211], v[64:67], v[40:43], v[208:211]
    v_mfma_f32_16x16x32_bf16 v[216:219], v[64:67], v[44:47], v[216:219]
    s_waitcnt lgkmcnt(8)
    v_mfma_f32_16x16x32_bf16 v[220:223], v[68:71], v[44:47], v[220:223]
    ds_read_b128 v[64:67], v18 offset:1024
    buffer_load_dwordx4 v[80:83], v3, s[12:15], s44 offen offset:0 sc1
    v_mfma_f32_16x16x32_bf16 v[212:215], v[68:71], v[40:43], v[212:215]
    v_mfma_f32_16x16x32_bf16 v[204:207], v[68:71], v[36:39], v[204:207]
    buffer_load_dwordx4 v[84:87], v3, s[12:15], s44 offen offset:256 sc1
    v_mfma_f32_16x16x32_bf16 v[196:199], v[68:71], v[32:35], v[196:199]
    s_waitcnt lgkmcnt(5)
    v_mfma_f32_16x16x32_bf16 v[224:227], v[72:75], v[32:35], v[224:227]
    ds_read_b128 v[68:71], v19 offset:4096
    buffer_load_dwordx4 v[88:91], v3, s[12:15], s44 offen offset:2048 sc1
    v_mfma_f32_16x16x32_bf16 v[232:235], v[72:75], v[36:39], v[232:235]
    v_mfma_f32_16x16x32_bf16 v[240:243], v[72:75], v[40:43], v[240:243]
    buffer_load_dwordx4 v[92:95], v3, s[12:15], s44 offen offset:2304 sc1
    v_mfma_f32_16x16x32_bf16 v[248:251], v[72:75], v[44:47], v[248:251]
    s_add_u32 s44, s44, 4096
    s_waitcnt lgkmcnt(3)
    v_mfma_f32_16x16x32_bf16 v[252:255], v[76:79], v[44:47], v[252:255]
    ds_read_b128 v[72:75], v18 offset:5120
    v_mfma_f32_16x16x32_bf16 v[244:247], v[76:79], v[40:43], v[244:247]
    v_mfma_f32_16x16x32_bf16 v[236:239], v[76:79], v[36:39], v[236:239]
    v_mfma_f32_16x16x32_bf16 v[228:231], v[76:79], v[32:35], v[228:231]
    s_waitcnt lgkmcnt(3)
    v_mfma_f32_16x16x32_bf16 v[128:131], v[24:27], v[48:51], v[128:131]
    ds_read_b128 v[76:79], v19 offset:8192
    v_mfma_f32_16x16x32_bf16 v[136:139], v[24:27], v[52:55], v[136:139]
    v_mfma_f32_16x16x32_bf16 v[144:147], v[24:27], v[56:59], v[144:147]
    v_mfma_f32_16x16x32_bf16 v[152:155], v[24:27], v[60:63], v[152:155]
    s_waitcnt lgkmcnt(3)
    v_mfma_f32_16x16x32_bf16 v[156:159], v[64:67], v[60:63], v[156:159]
    ds_read_b128 v[24:27], v18 offset:9216
    buffer_load_dwordx4 v[96:99], v3, s[12:15], s44 offen offset:0 sc1
    v_mfma_f32_16x16x32_bf16 v[148:151], v[64:67], v[56:59], v[148:151]
    v_mfma_f32_16x16x32_bf16 v[140:143], v[64:67], v[52:55], v[140:143]
    buffer_load_dwordx4 v[100:103], v3, s[12:15], s44 offen offset:256 sc1
    v_mfma_f32_16x16x32_bf16 v[132:135], v[64:67], v[48:51], v[132:135]
    s_waitcnt lgkmcnt(3)
    v_mfma_f32_16x16x32_bf16 v[160:163], v[68:71], v[48:51], v[160:163]
    ds_read_b128 v[64:67], v19 offset:12288
    buffer_load_dwordx4 v[104:107], v3, s[12:15], s44 offen offset:2048 sc1
    v_mfma_f32_16x16x32_bf16 v[168:171], v[68:71], v[52:55], v[168:171]
    v_mfma_f32_16x16x32_bf16 v[176:179], v[68:71], v[56:59], v[176:179]
    buffer_load_dwordx4 v[108:111], v3, s[12:15], s44 offen offset:2304 sc1
    v_mfma_f32_16x16x32_bf16 v[184:187], v[68:71], v[60:63], v[184:187]
    s_add_u32 s44, s44, 4096
    s_waitcnt lgkmcnt(3)
    v_mfma_f32_16x16x32_bf16 v[188:191], v[72:75], v[60:63], v[188:191]
    ds_read_b128 v[68:71], v18 offset:13312
    v_mfma_f32_16x16x32_bf16 v[180:183], v[72:75], v[56:59], v[180:183]
    v_mfma_f32_16x16x32_bf16 v[172:175], v[72:75], v[52:55], v[172:175]
    v_add_u32 v18, 131072, v16
    v_mfma_f32_16x16x32_bf16 v[164:167], v[72:75], v[48:51], v[164:167]
    v_add_u32 v20, 0, v17
    s_waitcnt lgkmcnt(3)
    v_mfma_f32_16x16x32_bf16 v[192:195], v[76:79], v[48:51], v[192:195]
    v_xor_b32 v19, 64, v18
    v_mfma_f32_16x16x32_bf16 v[200:203], v[76:79], v[52:55], v[200:203]
    v_xor_b32 v21, s63, v20
    v_mfma_f32_16x16x32_bf16 v[208:211], v[76:79], v[56:59], v[208:211]
    v_xor_b32 v22, 64, v20
    v_mfma_f32_16x16x32_bf16 v[216:219], v[76:79], v[60:63], v[216:219]
    v_xor_b32 v23, s62, v20
    s_waitcnt lgkmcnt(0)
    s_waitcnt vmcnt(12)
    v_mfma_f32_16x16x32_bf16 v[220:223], v[24:27], v[60:63], v[220:223]
    s_barrier
    ds_read_b64_tr_b16 v[32:33], v20 offset:0
    v_mfma_f32_16x16x32_bf16 v[212:215], v[24:27], v[56:59], v[212:215]
    ds_read_b64_tr_b16 v[34:35], v20 offset:1024
    v_mfma_f32_16x16x32_bf16 v[204:207], v[24:27], v[52:55], v[204:207]
    ds_read_b128 v[72:75], v18 offset:0
    v_mfma_f32_16x16x32_bf16 v[196:199], v[24:27], v[48:51], v[196:199]
    ds_read_b64_tr_b16 v[36:37], v21 offset:0
    v_mfma_f32_16x16x32_bf16 v[224:227], v[64:67], v[48:51], v[224:227]
    ds_read_b64_tr_b16 v[38:39], v21 offset:1024
    s_add_u32 s74, s73, 1048576
    s_add_u32 m0, s72, 65536
    v_mfma_f32_16x16x32_bf16 v[232:235], v[64:67], v[52:55], v[232:235]
    ds_read_b64_tr_b16 v[40:41], v22 offset:0
    buffer_load_dwordx4 v8, s[20:23], s74 offen offset:0 lds
    v_mfma_f32_16x16x32_bf16 v[240:243], v[64:67], v[56:59], v[240:243]
    ds_read_b64_tr_b16 v[42:43], v22 offset:1024
    buffer_load_dwordx4 v9, s[20:23], s74 offen offset:1024 lds
    v_mfma_f32_16x16x32_bf16 v[248:251], v[64:67], v[60:63], v[248:251]
    ds_read_b64_tr_b16 v[44:45], v23 offset:0
    v_mfma_f32_16x16x32_bf16 v[252:255], v[68:71], v[60:63], v[252:255]
    ds_read_b64_tr_b16 v[46:47], v23 offset:1024
    buffer_load_dwordx4 v10, s[20:23], s74 offen offset:2048 lds
    v_mfma_f32_16x16x32_bf16 v[244:247], v[68:71], v[56:59], v[244:247]
    ds_read_b128 v[76:79], v19 offset:1024
    v_mfma_f32_16x16x32_bf16 v[236:239], v[68:71], v[52:55], v[236:239]
    ds_read_b128 v[24:27], v19 offset:0
    buffer_load_dwordx4 v11, s[20:23], s74 offen offset:3072 lds
    v_mfma_f32_16x16x32_bf16 v[228:231], v[68:71], v[48:51], v[228:231]
    ds_read_b128 v[64:67], v18 offset:1024
    s_waitcnt lgkmcnt(9)
    v_mfma_f32_16x16x32_bf16 v[128:131], v[72:75], v[32:35], v[128:131]
    ds_read_b64_tr_b16 v[48:49], v20 offset:8192
    ds_read_b64_tr_b16 v[50:51], v20 offset:9216
    ds_read_b128 v[68:71], v18 offset:4096
    s_waitcnt lgkmcnt(10)
    v_mfma_f32_16x16x32_bf16 v[136:139], v[72:75], v[36:39], v[136:139]
    ds_read_b64_tr_b16 v[52:53], v21 offset:8192
    ds_read_b64_tr_b16 v[54:55], v21 offset:9216
    s_waitcnt lgkmcnt(10)
    v_mfma_f32_16x16x32_bf16 v[144:147], v[72:75], v[40:43], v[144:147]
    ds_read_b64_tr_b16 v[56:57], v22 offset:8192
    ds_read_b64_tr_b16 v[58:59], v22 offset:9216
    s_waitcnt lgkmcnt(10)
    v_mfma_f32_16x16x32_bf16 v[152:155], v[72:75], v[44:47], v[152:155]
    ds_read_b64_tr_b16 v[60:61], v23 offset:8192
    ds_read_b64_tr_b16 v[62:63], v23 offset:9216
    s_waitcnt lgkmcnt(11)
    v_mfma_f32_16x16x32_bf16 v[156:159], v[76:79], v[44:47], v[156:159]
    ds_read_b128 v[72:75], v19 offset:5120
    s_add_u32 s74, s73, 2097152
    s_add_u32 m0, s72, 98304
    v_mfma_f32_16x16x32_bf16 v[148:151], v[76:79], v[40:43], v[148:151]
    buffer_load_dwordx4 v8, s[20:23], s74 offen offset:0 lds
    v_mfma_f32_16x16x32_bf16 v[140:143], v[76:79], v[36:39], v[140:143]
    buffer_load_dwordx4 v9, s[20:23], s74 offen offset:1024 lds
    v_mfma_f32_16x16x32_bf16 v[132:135], v[76:79], v[32:35], v[132:135]
    s_waitcnt lgkmcnt(8)
    v_mfma_f32_16x16x32_bf16 v[128:131], v[24:27], v[48:51], v[128:131]
    ds_read_b128 v[76:79], v19 offset:4096
    buffer_load_dwordx4 v10, s[20:23], s74 offen offset:2048 lds
    s_waitcnt lgkmcnt(6)
    v_mfma_f32_16x16x32_bf16 v[136:139], v[24:27], v[52:55], v[136:139]
    s_waitcnt lgkmcnt(4)
    v_mfma_f32_16x16x32_bf16 v[144:147], v[24:27], v[56:59], v[144:147]
    buffer_load_dwordx4 v11, s[20:23], s74 offen offset:3072 lds
    s_waitcnt lgkmcnt(2)
    v_mfma_f32_16x16x32_bf16 v[152:155], v[24:27], v[60:63], v[152:155]
    v_mfma_f32_16x16x32_bf16 v[156:159], v[64:67], v[60:63], v[156:159]
    ds_read_b128 v[24:27], v18 offset:5120
    v_mfma_f32_16x16x32_bf16 v[148:151], v[64:67], v[56:59], v[148:151]
    v_mfma_f32_16x16x32_bf16 v[140:143], v[64:67], v[52:55], v[140:143]
    v_mfma_f32_16x16x32_bf16 v[132:135], v[64:67], v[48:51], v[132:135]
    v_mfma_f32_16x16x32_bf16 v[160:163], v[68:71], v[32:35], v[160:163]
    ds_read_b128 v[64:67], v18 offset:8192
    buffer_load_dwordx4 v[112:115], v3, s[12:15], s44 offen offset:0 sc1
    v_mfma_f32_16x16x32_bf16 v[168:171], v[68:71], v[36:39], v[168:171]
    v_mfma_f32_16x16x32_bf16 v[176:179], v[68:71], v[40:43], v[176:179]
    buffer_load_dwordx4 v[116:119], v3, s[12:15], s44 offen offset:256 sc1
    v_mfma_f32_16x16x32_bf16 v[184:187], v[68:71], v[44:47], v[184:187]
    s_waitcnt lgkmcnt(3)
    v_mfma_f32_16x16x32_bf16 v[188:191], v[72:75], v[44:47], v[188:191]
    ds_read_b128 v[68:71], v19 offset:9216
    buffer_load_dwordx4 v[120:123], v3, s[12:15], s44 offen offset:2048 sc1
    v_cvt_pk_bf16_f32 v128, v128, v129
    v_mfma_f32_16x16x32_bf16 v[180:183], v[72:75], v[40:43], v[180:183]
    v_cvt_pk_bf16_f32 v129, v130, v131
    v_cvt_pk_bf16_f32 v130, v132, v133
    v_mfma_f32_16x16x32_bf16 v[172:175], v[72:75], v[36:39], v[172:175]
    buffer_load_dwordx4 v[124:127], v3, s[12:15], s44 offen offset:2304 sc1
    s_add_u32 s44, s44, 4096
    v_cvt_pk_bf16_f32 v131, v134, v135
    v_mfma_f32_16x16x32_bf16 v[164:167], v[72:75], v[32:35], v[164:167]
    v_cvt_pk_bf16_f32 v132, v136, v137
    v_cvt_pk_bf16_f32 v133, v138, v139
    s_waitcnt lgkmcnt(3)
    v_mfma_f32_16x16x32_bf16 v[160:163], v[76:79], v[48:51], v[160:163]
    ds_read_b128 v[72:75], v19 offset:8192
    v_cvt_pk_bf16_f32 v134, v140, v141
    v_cvt_pk_bf16_f32 v135, v142, v143
    v_mfma_f32_16x16x32_bf16 v[168:171], v[76:79], v[52:55], v[168:171]
    v_cvt_pk_bf16_f32 v136, v144, v145
    v_mfma_f32_16x16x32_bf16 v[176:179], v[76:79], v[56:59], v[176:179]
    v_cvt_pk_bf16_f32 v137, v146, v147
    v_cvt_pk_bf16_f32 v138, v148, v149
    v_mfma_f32_16x16x32_bf16 v[184:187], v[76:79], v[60:63], v[184:187]
    v_cvt_pk_bf16_f32 v139, v150, v151
    s_waitcnt lgkmcnt(3)
    v_mfma_f32_16x16x32_bf16 v[188:191], v[24:27], v[60:63], v[188:191]
    ds_read_b128 v[76:79], v18 offset:9216
    v_cvt_pk_bf16_f32 v140, v152, v153
    v_cvt_pk_bf16_f32 v141, v154, v155
    v_mfma_f32_16x16x32_bf16 v[180:183], v[24:27], v[56:59], v[180:183]
    v_cvt_pk_bf16_f32 v142, v156, v157
    v_mfma_f32_16x16x32_bf16 v[172:175], v[24:27], v[52:55], v[172:175]
    v_cvt_pk_bf16_f32 v143, v158, v159
    v_mfma_f32_16x16x32_bf16 v[164:167], v[24:27], v[48:51], v[164:167]
    s_waitcnt lgkmcnt(3)
    v_mfma_f32_16x16x32_bf16 v[192:195], v[64:67], v[32:35], v[192:195]
    ds_read_b128 v[24:27], v18 offset:12288
    v_mfma_f32_16x16x32_bf16 v[200:203], v[64:67], v[36:39], v[200:203]
    v_mfma_f32_16x16x32_bf16 v[208:211], v[64:67], v[40:43], v[208:211]
    v_mfma_f32_16x16x32_bf16 v[216:219], v[64:67], v[44:47], v[216:219]
    s_waitcnt lgkmcnt(3)
    v_mfma_f32_16x16x32_bf16 v[220:223], v[68:71], v[44:47], v[220:223]
    ds_read_b128 v[64:67], v19 offset:13312
    v_cvt_pk_bf16_f32 v160, v160, v161
    v_cvt_pk_bf16_f32 v161, v162, v163
    v_mfma_f32_16x16x32_bf16 v[212:215], v[68:71], v[40:43], v[212:215]
    v_cvt_pk_bf16_f32 v162, v164, v165
    v_mfma_f32_16x16x32_bf16 v[204:207], v[68:71], v[36:39], v[204:207]
    v_cvt_pk_bf16_f32 v163, v166, v167
    v_cvt_pk_bf16_f32 v164, v168, v169
    v_mfma_f32_16x16x32_bf16 v[196:199], v[68:71], v[32:35], v[196:199]
    v_cvt_pk_bf16_f32 v165, v170, v171
    buffer_store_dwordx4 v[128:131], v3, s[12:15], s75 offen offset:0 sc1
    s_waitcnt lgkmcnt(3)
    v_mfma_f32_16x16x32_bf16 v[192:195], v[72:75], v[48:51], v[192:195]
    ds_read_b128 v[68:71], v19 offset:12288
    v_cvt_pk_bf16_f32 v166, v172, v173
    v_cvt_pk_bf16_f32 v167, v174, v175
    v_mfma_f32_16x16x32_bf16 v[200:203], v[72:75], v[52:55], v[200:203]
    v_cvt_pk_bf16_f32 v168, v176, v177
    v_mfma_f32_16x16x32_bf16 v[208:211], v[72:75], v[56:59], v[208:211]
    v_cvt_pk_bf16_f32 v169, v178, v179
    v_cvt_pk_bf16_f32 v170, v180, v181
    v_mfma_f32_16x16x32_bf16 v[216:219], v[72:75], v[60:63], v[216:219]
    v_cvt_pk_bf16_f32 v171, v182, v183
    s_waitcnt lgkmcnt(3)
    v_mfma_f32_16x16x32_bf16 v[220:223], v[76:79], v[60:63], v[220:223]
    ds_read_b128 v[72:75], v18 offset:13312
    v_cvt_pk_bf16_f32 v172, v184, v185
    v_cvt_pk_bf16_f32 v173, v186, v187
    v_mfma_f32_16x16x32_bf16 v[212:215], v[76:79], v[56:59], v[212:215]
    v_cvt_pk_bf16_f32 v174, v188, v189
    buffer_store_dwordx4 v[132:135], v3, s[12:15], s75 offen offset:256 sc1
    v_mfma_f32_16x16x32_bf16 v[204:207], v[76:79], v[52:55], v[204:207]
    v_cvt_pk_bf16_f32 v175, v190, v191
    v_mfma_f32_16x16x32_bf16 v[196:199], v[76:79], v[48:51], v[196:199]
    s_waitcnt lgkmcnt(3)
    v_mfma_f32_16x16x32_bf16 v[224:227], v[24:27], v[32:35], v[224:227]
    v_mfma_f32_16x16x32_bf16 v[232:235], v[24:27], v[36:39], v[232:235]
    v_mfma_f32_16x16x32_bf16 v[240:243], v[24:27], v[40:43], v[240:243]
    buffer_store_dwordx4 v[136:139], v3, s[12:15], s75 offen offset:2048 sc1
    v_mfma_f32_16x16x32_bf16 v[248:251], v[24:27], v[44:47], v[248:251]
    s_waitcnt lgkmcnt(0)
    s_waitcnt vmcnt(23)
    v_mfma_f32_16x16x32_bf16 v[252:255], v[64:67], v[44:47], v[252:255]
    s_barrier
    s_add_u32 s74, s73, 3145728
    s_add_u32 m0, s72, 131072
    s_nop 0
    buffer_load_dwordx4 v8, s[20:23], s74 offen offset:0 lds
    buffer_load_dwordx4 v9, s[20:23], s74 offen offset:1024 lds
    v_mfma_f32_16x16x32_bf16 v[244:247], v[64:67], v[40:43], v[244:247]
    v_cvt_pk_bf16_f32 v192, v192, v193
    v_cvt_pk_bf16_f32 v193, v194, v195
    v_cvt_pk_bf16_f32 v194, v196, v197
    v_mfma_f32_16x16x32_bf16 v[236:239], v[64:67], v[36:39], v[236:239]
    buffer_load_dwordx4 v10, s[20:23], s74 offen offset:2048 lds
    buffer_load_dwordx4 v11, s[20:23], s74 offen offset:3072 lds
    v_cvt_pk_bf16_f32 v195, v198, v199
    v_mfma_f32_16x16x32_bf16 v[228:231], v[64:67], v[32:35], v[228:231]
    v_cvt_pk_bf16_f32 v196, v200, v201
    v_cvt_pk_bf16_f32 v197, v202, v203
    v_mfma_f32_16x16x32_bf16 v[224:227], v[68:71], v[48:51], v[224:227]
    v_xor_b32 v8, 16, v4
    v_xor_b32 v9, 16, v5
    v_xor_b32 v10, 16, v6
    v_xor_b32 v11, 16, v7
    v_cvt_pk_bf16_f32 v198, v204, v205
    v_mfma_f32_16x16x32_bf16 v[232:235], v[68:71], v[52:55], v[232:235]
    v_cvt_pk_bf16_f32 v199, v206, v207
    v_cvt_pk_bf16_f32 v200, v208, v209
    buffer_store_dwordx4 v[140:143], v3, s[12:15], s75 offen offset:2304 sc1
    s_add_u32 s75, s75, 131072
    v_mfma_f32_16x16x32_bf16 v[240:243], v[68:71], v[56:59], v[240:243]
    ds_read_b64_tr_b16 v[144:145], v4 offset:0
    ds_read_b64_tr_b16 v[146:147], v4 offset:1024
    v_cvt_pk_bf16_f32 v201, v210, v211
    v_cvt_pk_bf16_f32 v202, v212, v213
    v_mfma_f32_16x16x32_bf16 v[248:251], v[68:71], v[60:63], v[248:251]
    ds_read_b64_tr_b16 v[148:149], v8 offset:0
    ds_read_b64_tr_b16 v[150:151], v8 offset:1024
    v_cvt_pk_bf16_f32 v203, v214, v215
    v_mfma_f32_16x16x32_bf16 v[252:255], v[72:75], v[60:63], v[252:255]
    ds_read_b64_tr_b16 v[152:153], v5 offset:0
    ds_read_b64_tr_b16 v[154:155], v5 offset:1024
    v_cvt_pk_bf16_f32 v204, v216, v217
    v_cvt_pk_bf16_f32 v205, v218, v219
    v_mfma_f32_16x16x32_bf16 v[244:247], v[72:75], v[56:59], v[244:247]
    ds_read_b64_tr_b16 v[156:157], v9 offset:0
    ds_read_b64_tr_b16 v[158:159], v9 offset:1024
    v_cvt_pk_bf16_f32 v206, v220, v221
    v_mfma_f32_16x16x32_bf16 v[236:239], v[72:75], v[52:55], v[236:239]
    ds_read_b64_tr_b16 v[176:177], v6 offset:0
    ds_read_b64_tr_b16 v[178:179], v6 offset:1024
    v_cvt_pk_bf16_f32 v207, v222, v223
    v_mfma_f32_16x16x32_bf16 v[228:231], v[72:75], v[48:51], v[228:231]
    s_branch Lkvepi
Lml_22:
    s_mov_b32 s42, 200000
Lml_22r:
    s_sleep 4
    s_mov_b32 s75, 0
    buffer_load_dwordx2 v[96:97], v29, s[12:15], s75 offen sc1
    s_mov_b32 s75, 4096
    buffer_load_dwordx2 v[104:105], v29, s[12:15], s75 offen sc1
    s_mov_b32 s75, 24576
    buffer_load_dwordx2 v[98:99], v29, s[12:15], s75 offen sc1
    s_mov_b32 s75, 28672
    buffer_load_dwordx2 v[106:107], v29, s[12:15], s75 offen sc1
    s_mov_b32 s75, 49152
    buffer_load_dwordx2 v[100:101], v29, s[12:15], s75 offen sc1
    s_mov_b32 s75, 53248
    buffer_load_dwordx2 v[108:109], v29, s[12:15], s75 offen sc1
    s_mov_b32 s75, 73728
    buffer_load_dwordx2 v[102:103], v29, s[12:15], s75 offen sc1
    s_mov_b32 s75, 77824
    buffer_load_dwordx2 v[110:111], v29, s[12:15], s75 offen sc1
    s_waitcnt vmcnt(0)
    v_xor_b32 v97, s64, v97
    v_xor_b32 v99, s64, v99
    v_xor_b32 v101, s64, v101
    v_xor_b32 v103, s64, v103
    v_xor_b32 v105, s64, v105
    v_xor_b32 v107, s64, v107
    v_xor_b32 v109, s64, v109
    v_xor_b32 v111, s64, v111
    v_or3_b32 v97, v97, v99, v101
    v_or3_b32 v103, v103, v105, v107
    v_or3_b32 v97, v97, v109, v111
    v_or_b32 v97, v97, v103
    v_cmp_ne_u32 vcc, 0, v97
    s_nop 0
    s_cbranch_vccz Lmok_23
    s_sub_u32 s42, s42, 1
    s_cbranch_scc0 Lml_22r
    s_branch Lmok_23
Lkvepi:
    s_waitcnt vmcnt(24)
    s_waitcnt lgkmcnt(8)
    v_mfma_f32_16x16x32_bf16 v[16:19], v[144:147], v[80:83], 0
    ds_read_b64_tr_b16 v[180:181], v10 offset:0
    ds_read_b64_tr_b16 v[182:183], v10 offset:1024
    buffer_load_dwordx4 v[208:211], v3, s[12:15], s44 offen offset:0 sc1
    v_mfma_f32_16x16x32_bf16 v[24:27], v[144:147], v[84:87], 0
    s_waitcnt lgkmcnt(8)
    v_mfma_f32_16x16x32_bf16 v[28:31], v[148:151], v[84:87], 0
    ds_read_b64_tr_b16 v[184:185], v7 offset:0
    ds_read_b64_tr_b16 v[186:187], v7 offset:1024
    buffer_load_dwordx4 v[212:215], v3, s[12:15], s44 offen offset:256 sc1
    v_mfma_f32_16x16x32_bf16 v[20:23], v[148:151], v[80:83], 0
    s_waitcnt lgkmcnt(8)
    v_mfma_f32_16x16x32_bf16 v[32:35], v[152:155], v[80:83], 0
    ds_read_b64_tr_b16 v[188:189], v11 offset:0
    ds_read_b64_tr_b16 v[190:191], v11 offset:1024
    v_cvt_pk_bf16_f32 v224, v224, v225
    v_cvt_pk_bf16_f32 v225, v226, v227
    v_mfma_f32_16x16x32_bf16 v[40:43], v[152:155], v[84:87], 0
    buffer_load_dwordx4 v[216:219], v3, s[12:15], s44 offen offset:2048 sc1
    s_waitcnt lgkmcnt(8)
    v_mfma_f32_16x16x32_bf16 v[44:47], v[156:159], v[84:87], 0
    ds_read_b64_tr_b16 v[144:145], v4 offset:8192
    ds_read_b64_tr_b16 v[146:147], v4 offset:9216
    v_cvt_pk_bf16_f32 v226, v228, v229
    v_cvt_pk_bf16_f32 v227, v230, v231
    v_mfma_f32_16x16x32_bf16 v[36:39], v[156:159], v[80:83], 0
    buffer_load_dwordx4 v[220:223], v3, s[12:15], s44 offen offset:2304 sc1
    s_add_u32 s44, s44, 4096
    s_waitcnt lgkmcnt(8)
    v_mfma_f32_16x16x32_bf16 v[48:51], v[176:179], v[80:83], 0
    ds_read_b64_tr_b16 v[148:149], v8 offset:8192
    ds_read_b64_tr_b16 v[150:151], v8 offset:9216
    v_cvt_pk_bf16_f32 v228, v232, v233
    v_mfma_f32_16x16x32_bf16 v[56:59], v[176:179], v[84:87], 0
    v_cvt_pk_bf16_f32 v229, v234, v235
    s_waitcnt lgkmcnt(8)
    v_mfma_f32_16x16x32_bf16 v[60:63], v[180:183], v[84:87], 0
    ds_read_b64_tr_b16 v[152:153], v5 offset:8192
    ds_read_b64_tr_b16 v[154:155], v5 offset:9216
    v_cvt_pk_bf16_f32 v230, v236, v237
    v_mfma_f32_16x16x32_bf16 v[52:55], v[180:183], v[80:83], 0
    v_cvt_pk_bf16_f32 v231, v238, v239
    s_waitcnt lgkmcnt(8)
    v_mfma_f32_16x16x32_bf16 v[64:67], v[184:187], v[80:83], 0
    ds_read_b64_tr_b16 v[156:157], v9 offset:8192
    ds_read_b64_tr_b16 v[158:159], v9 offset:9216
    v_cvt_pk_bf16_f32 v232, v240, v241
    v_mfma_f32_16x16x32_bf16 v[72:75], v[184:187], v[84:87], 0
    v_cvt_pk_bf16_f32 v233, v242, v243
    s_waitcnt lgkmcnt(8)
    v_mfma_f32_16x16x32_bf16 v[76:79], v[188:191], v[84:87], 0
    ds_read_b64_tr_b16 v[176:177], v6 offset:8192
    ds_read_b64_tr_b16 v[178:179], v6 offset:9216
    v_cvt_pk_bf16_f32 v234, v244, v245
    v_mfma_f32_16x16x32_bf16 v[68:71], v[188:191], v[80:83], 0
    v_cvt_pk_bf16_f32 v235, v246, v247
    s_waitcnt lgkmcnt(8)
    v_mfma_f32_16x16x32_bf16 v[16:19], v[144:147], v[88:91], v[16:19]
    ds_read_b64_tr_b16 v[180:181], v10 offset:8192
    ds_read_b64_tr_b16 v[182:183], v10 offset:9216
    v_cvt_pk_bf16_f32 v236, v248, v249
    v_mfma_f32_16x16x32_bf16 v[24:27], v[144:147], v[92:95], v[24:27]
    v_cvt_pk_bf16_f32 v237, v250, v251
    s_waitcnt lgkmcnt(8)
    v_mfma_f32_16x16x32_bf16 v[28:31], v[148:151], v[92:95], v[28:31]
    ds_read_b64_tr_b16 v[184:185], v7 offset:8192
    ds_read_b64_tr_b16 v[186:187], v7 offset:9216
    v_cvt_pk_bf16_f32 v238, v252, v253
    v_mfma_f32_16x16x32_bf16 v[20:23], v[148:151], v[88:91], v[20:23]
    v_cvt_pk_bf16_f32 v239, v254, v255
    s_waitcnt lgkmcnt(8)
    v_mfma_f32_16x16x32_bf16 v[32:35], v[152:155], v[88:91], v[32:35]
    ds_read_b64_tr_b16 v[188:189], v11 offset:8192
    ds_read_b64_tr_b16 v[190:191], v11 offset:9216
    v_mfma_f32_16x16x32_bf16 v[40:43], v[152:155], v[92:95], v[40:43]
    s_waitcnt lgkmcnt(8)
    v_mfma_f32_16x16x32_bf16 v[44:47], v[156:159], v[92:95], v[44:47]
    ds_read_b64_tr_b16 v[144:145], v4 offset:16384
    ds_read_b64_tr_b16 v[146:147], v4 offset:17408
    v_mfma_f32_16x16x32_bf16 v[36:39], v[156:159], v[88:91], v[36:39]
    s_waitcnt lgkmcnt(8)
    v_mfma_f32_16x16x32_bf16 v[48:51], v[176:179], v[88:91], v[48:51]
    ds_read_b64_tr_b16 v[148:149], v8 offset:16384
    ds_read_b64_tr_b16 v[150:151], v8 offset:17408
    buffer_load_dwordx4 v[240:243], v3, s[12:15], s44 offen offset:0 sc1
    v_mfma_f32_16x16x32_bf16 v[56:59], v[176:179], v[92:95], v[56:59]
    s_waitcnt lgkmcnt(8)
    v_mfma_f32_16x16x32_bf16 v[60:63], v[180:183], v[92:95], v[60:63]
    ds_read_b64_tr_b16 v[152:153], v5 offset:16384
    ds_read_b64_tr_b16 v[154:155], v5 offset:17408
    buffer_load_dwordx4 v[244:247], v3, s[12:15], s44 offen offset:256 sc1
    v_mfma_f32_16x16x32_bf16 v[52:55], v[180:183], v[88:91], v[52:55]
    s_waitcnt lgkmcnt(8)
    v_mfma_f32_16x16x32_bf16 v[64:67], v[184:187], v[88:91], v[64:67]
    ds_read_b64_tr_b16 v[156:157], v9 offset:16384
    ds_read_b64_tr_b16 v[158:159], v9 offset:17408
    buffer_load_dwordx4 v[248:251], v3, s[12:15], s44 offen offset:2048 sc1
    v_mfma_f32_16x16x32_bf16 v[72:75], v[184:187], v[92:95], v[72:75]
    s_waitcnt lgkmcnt(8)
    v_mfma_f32_16x16x32_bf16 v[76:79], v[188:191], v[92:95], v[76:79]
    ds_read_b64_tr_b16 v[176:177], v6 offset:16384
    ds_read_b64_tr_b16 v[178:179], v6 offset:17408
    buffer_load_dwordx4 v[252:255], v3, s[12:15], s44 offen offset:2304 sc1
    v_mfma_f32_16x16x32_bf16 v[68:71], v[188:191], v[88:91], v[68:71]
    s_add_u32 s44, s44, 4096
    s_waitcnt vmcnt(28)
    s_waitcnt lgkmcnt(8)
    v_mfma_f32_16x16x32_bf16 v[16:19], v[144:147], v[96:99], v[16:19]
    ds_read_b64_tr_b16 v[180:181], v10 offset:16384
    ds_read_b64_tr_b16 v[182:183], v10 offset:17408
    buffer_load_dwordx4 v[80:83], v3, s[12:15], s44 offen offset:0 sc1
    v_mfma_f32_16x16x32_bf16 v[24:27], v[144:147], v[100:103], v[24:27]
    s_waitcnt lgkmcnt(8)
    v_mfma_f32_16x16x32_bf16 v[28:31], v[148:151], v[100:103], v[28:31]
    ds_read_b64_tr_b16 v[184:185], v7 offset:16384
    ds_read_b64_tr_b16 v[186:187], v7 offset:17408
    s_lshl_b32 s32, s25, 19
    s_add_u32 s32, s32, s34
    s_add_u32 s33, s32, 33546240
    s_add_u32 s45, s32, 16777216
    v_mfma_f32_16x16x32_bf16 v[20:23], v[148:151], v[96:99], v[20:23]
    s_add_u32 s32, s32, 16785408
    s_mov_b32 s30, 0
    buffer_load_dwordx4 v[84:87], v3, s[12:15], s44 offen offset:256 sc1
    s_waitcnt lgkmcnt(8)
    v_mfma_f32_16x16x32_bf16 v[32:35], v[152:155], v[96:99], v[32:35]
    ds_read_b64_tr_b16 v[188:189], v11 offset:16384
    ds_read_b64_tr_b16 v[190:191], v11 offset:17408
    s_cmp_lt_u32 s27, 2
    s_cselect_b32 s45, s45, s33
    s_cmp_eq_u32 s28, 0
    s_cselect_b32 s45, s32, s45
    s_cselect_b32 s46, s32, s33
    s_add_u32 s46, s46, 0x4000
    v_mfma_f32_16x16x32_bf16 v[40:43], v[152:155], v[100:103], v[40:43]
    s_lshl_b32 s48, s28, 14
    s_add_u32 s48, s48, s34
    s_add_u32 s32, s32, 0xc000
    s_add_u32 s33, s33, 0xc000
    s_mov_b32 s31, 98304
    buffer_load_dwordx4 v[88:91], v3, s[12:15], s44 offen offset:2048 sc1
    s_waitcnt lgkmcnt(8)
    v_mfma_f32_16x16x32_bf16 v[44:47], v[156:159], v[100:103], v[44:47]
    ds_read_b64_tr_b16 v[144:145], v4 offset:24576
    ds_read_b64_tr_b16 v[146:147], v4 offset:25600
    s_lshl_b32 s47, s25, 7
    s_add_u32 s47, s47, 139264
    s_lshl_b32 s65, s26, 2
    s_add_u32 s65, s65, s47
    s_add_u32 s50, s65, 32
    s_add_u32 s66, s65, 64
    v_and_b32 v13, 7, v1
    v_lshlrev_b32 v13, 2, v13
    v_mfma_f32_16x16x32_bf16 v[36:39], v[156:159], v[96:99], v[36:39]
    v_add_u32 v13, s47, v13
    v_add_u32 v14, 32, v13
    s_cmp_eq_u32 s24, 0
    s_cselect_b32 s39, 1, 0
    s_mov_b32 s49, 0x3e0293ee
    buffer_load_dwordx4 v[92:95], v3, s[12:15], s44 offen offset:2304 sc1
    s_add_u32 s44, s44, 4096
    s_waitcnt lgkmcnt(8)
    v_mfma_f32_16x16x32_bf16 v[48:51], v[176:179], v[96:99], v[48:51]
    ds_read_b64_tr_b16 v[148:149], v8 offset:24576
    ds_read_b64_tr_b16 v[150:151], v8 offset:25600
    v_mfma_f32_16x16x32_bf16 v[56:59], v[176:179], v[100:103], v[56:59]
    s_waitcnt lgkmcnt(8)
    v_mfma_f32_16x16x32_bf16 v[60:63], v[180:183], v[100:103], v[60:63]
    ds_read_b64_tr_b16 v[152:153], v5 offset:24576
    ds_read_b64_tr_b16 v[154:155], v5 offset:25600
    v_mfma_f32_16x16x32_bf16 v[52:55], v[180:183], v[96:99], v[52:55]
    s_waitcnt lgkmcnt(8)
    v_mfma_f32_16x16x32_bf16 v[64:67], v[184:187], v[96:99], v[64:67]
    ds_read_b64_tr_b16 v[156:157], v9 offset:24576
    ds_read_b64_tr_b16 v[158:159], v9 offset:25600
    v_mfma_f32_16x16x32_bf16 v[72:75], v[184:187], v[100:103], v[72:75]
    s_waitcnt lgkmcnt(8)
    v_mfma_f32_16x16x32_bf16 v[76:79], v[188:191], v[100:103], v[76:79]
    ds_read_b64_tr_b16 v[176:177], v6 offset:24576
    ds_read_b64_tr_b16 v[178:179], v6 offset:25600
    v_mfma_f32_16x16x32_bf16 v[68:71], v[188:191], v[96:99], v[68:71]
    s_waitcnt lgkmcnt(8)
    v_mfma_f32_16x16x32_bf16 v[16:19], v[144:147], v[104:107], v[16:19]
    ds_read_b64_tr_b16 v[180:181], v10 offset:24576
    ds_read_b64_tr_b16 v[182:183], v10 offset:25600
    v_mfma_f32_16x16x32_bf16 v[24:27], v[144:147], v[108:111], v[24:27]
    s_waitcnt lgkmcnt(8)
    v_mfma_f32_16x16x32_bf16 v[28:31], v[148:151], v[108:111], v[28:31]
    ds_read_b64_tr_b16 v[184:185], v7 offset:24576
    ds_read_b64_tr_b16 v[186:187], v7 offset:25600
    v_mfma_f32_16x16x32_bf16 v[20:23], v[148:151], v[104:107], v[20:23]
    s_waitcnt lgkmcnt(8)
    v_mfma_f32_16x16x32_bf16 v[32:35], v[152:155], v[104:107], v[32:35]
    ds_read_b64_tr_b16 v[188:189], v11 offset:24576
    ds_read_b64_tr_b16 v[190:191], v11 offset:25600
    buffer_store_dwordx4 v[160:163], v3, s[12:15], s75 offen offset:0 sc1
    v_mfma_f32_16x16x32_bf16 v[40:43], v[152:155], v[108:111], v[40:43]
    s_waitcnt lgkmcnt(8)
    v_mfma_f32_16x16x32_bf16 v[44:47], v[156:159], v[108:111], v[44:47]
    v_add_u32 v4, 0x8000, v4
    v_add_u32 v5, 0x8000, v5
    v_add_u32 v6, 0x8000, v6
    v_add_u32 v7, 0x8000, v7
    v_mfma_f32_16x16x32_bf16 v[36:39], v[156:159], v[104:107], v[36:39]
    v_add_u32 v8, 0x8000, v8
    v_add_u32 v9, 0x8000, v9
    v_add_u32 v10, 0x8000, v10
    v_add_u32 v11, 0x8000, v11
    s_waitcnt lgkmcnt(0)
    s_waitcnt vmcnt(13)
    v_mfma_f32_16x16x32_bf16 v[48:51], v[176:179], v[104:107], v[48:51]
    s_barrier
    ds_read_b64_tr_b16 v[144:145], v4 offset:0
    ds_read_b64_tr_b16 v[146:147], v4 offset:1024
    v_mfma_f32_16x16x32_bf16 v[56:59], v[176:179], v[108:111], v[56:59]
    ds_read_b64_tr_b16 v[148:149], v8 offset:0
    ds_read_b64_tr_b16 v[150:151], v8 offset:1024
    s_cmp_eq_u32 s24, 0
    s_cbranch_scc0 Lw0_28
    v_mov_b32 v12, s64
    v_mov_b32 v15, s65
    s_mov_b64 exec, 1
    buffer_store_dword v12, v15, s[12:15], 0 offen sc1
    s_mov_b64 exec, -1
Lw0_28:
    v_mfma_f32_16x16x32_bf16 v[60:63], v[180:183], v[108:111], v[60:63]
    v_mfma_f32_16x16x32_bf16 v[52:55], v[180:183], v[104:107], v[52:55]
    ds_read_b64_tr_b16 v[152:153], v5 offset:0
    ds_read_b64_tr_b16 v[154:155], v5 offset:1024
    v_mfma_f32_16x16x32_bf16 v[64:67], v[184:187], v[104:107], v[64:67]
    ds_read_b64_tr_b16 v[156:157], v9 offset:0
    ds_read_b64_tr_b16 v[158:159], v9 offset:1024
    v_mfma_f32_16x16x32_bf16 v[72:75], v[184:187], v[108:111], v[72:75]
    v_mfma_f32_16x16x32_bf16 v[76:79], v[188:191], v[108:111], v[76:79]
    ds_read_b64_tr_b16 v[176:177], v6 offset:0
    ds_read_b64_tr_b16 v[178:179], v6 offset:1024
    v_mfma_f32_16x16x32_bf16 v[68:71], v[188:191], v[104:107], v[68:71]
    s_waitcnt vmcnt(13)
    s_waitcnt lgkmcnt(8)
    v_mfma_f32_16x16x32_bf16 v[16:19], v[144:147], v[112:115], v[16:19]
    ds_read_b64_tr_b16 v[180:181], v10 offset:0
    ds_read_b64_tr_b16 v[182:183], v10 offset:1024
    buffer_load_dwordx4 v[96:99], v3, s[12:15], s44 offen offset:0 sc1
    v_mfma_f32_16x16x32_bf16 v[24:27], v[144:147], v[116:119], v[24:27]
    s_waitcnt lgkmcnt(8)
    v_mfma_f32_16x16x32_bf16 v[28:31], v[148:151], v[116:119], v[28:31]
    ds_read_b64_tr_b16 v[184:185], v7 offset:0
    ds_read_b64_tr_b16 v[186:187], v7 offset:1024
    buffer_load_dwordx4 v[100:103], v3, s[12:15], s44 offen offset:256 sc1
    v_mfma_f32_16x16x32_bf16 v[20:23], v[148:151], v[112:115], v[20:23]
    s_waitcnt lgkmcnt(8)
    v_mfma_f32_16x16x32_bf16 v[32:35], v[152:155], v[112:115], v[32:35]
    ds_read_b64_tr_b16 v[188:189], v11 offset:0
    ds_read_b64_tr_b16 v[190:191], v11 offset:1024
    buffer_load_dwordx4 v[104:107], v3, s[12:15], s44 offen offset:2048 sc1
    v_mfma_f32_16x16x32_bf16 v[40:43], v[152:155], v[116:119], v[40:43]
    s_waitcnt lgkmcnt(8)
    v_mfma_f32_16x16x32_bf16 v[44:47], v[156:159], v[116:119], v[44:47]
    ds_read_b64_tr_b16 v[144:145], v4 offset:8192
    ds_read_b64_tr_b16 v[146:147], v4 offset:9216
    buffer_load_dwordx4 v[108:111], v3, s[12:15], s44 offen offset:2304 sc1
    v_mfma_f32_16x16x32_bf16 v[36:39], v[156:159], v[112:115], v[36:39]
    s_add_u32 s44, s44, 4096
    s_waitcnt lgkmcnt(8)
    v_mfma_f32_16x16x32_bf16 v[48:51], v[176:179], v[112:115], v[48:51]
    ds_read_b64_tr_b16 v[148:149], v8 offset:8192
    ds_read_b64_tr_b16 v[150:151], v8 offset:9216
    v_mfma_f32_16x16x32_bf16 v[56:59], v[176:179], v[116:119], v[56:59]
    s_waitcnt lgkmcnt(8)
    v_mfma_f32_16x16x32_bf16 v[60:63], v[180:183], v[116:119], v[60:63]
    ds_read_b64_tr_b16 v[152:153], v5 offset:8192
    ds_read_b64_tr_b16 v[154:155], v5 offset:9216
    v_mfma_f32_16x16x32_bf16 v[52:55], v[180:183], v[112:115], v[52:55]
    s_waitcnt lgkmcnt(8)
    v_mfma_f32_16x16x32_bf16 v[64:67], v[184:187], v[112:115], v[64:67]
    ds_read_b64_tr_b16 v[156:157], v9 offset:8192
    ds_read_b64_tr_b16 v[158:159], v9 offset:9216
    v_mfma_f32_16x16x32_bf16 v[72:75], v[184:187], v[116:119], v[72:75]
    s_waitcnt lgkmcnt(8)
    v_mfma_f32_16x16x32_bf16 v[76:79], v[188:191], v[116:119], v[76:79]
    ds_read_b64_tr_b16 v[176:177], v6 offset:8192
    ds_read_b64_tr_b16 v[178:179], v6 offset:9216
    v_mfma_f32_16x16x32_bf16 v[68:71], v[188:191], v[112:115], v[68:71]
    s_waitcnt lgkmcnt(8)
    v_mfma_f32_16x16x32_bf16 v[16:19], v[144:147], v[120:123], v[16:19]
    ds_read_b64_tr_b16 v[180:181], v10 offset:8192
    ds_read_b64_tr_b16 v[182:183], v10 offset:9216
    v_mfma_f32_16x16x32_bf16 v[24:27], v[144:147], v[124:127], v[24:27]
    s_waitcnt lgkmcnt(8)
    v_mfma_f32_16x16x32_bf16 v[28:31], v[148:151], v[124:127], v[28:31]
    ds_read_b64_tr_b16 v[184:185], v7 offset:8192
    ds_read_b64_tr_b16 v[186:187], v7 offset:9216
    v_mfma_f32_16x16x32_bf16 v[20:23], v[148:151], v[120:123], v[20:23]
    s_waitcnt lgkmcnt(8)
    v_mfma_f32_16x16x32_bf16 v[32:35], v[152:155], v[120:123], v[32:35]
    ds_read_b64_tr_b16 v[188:189], v11 offset:8192
    ds_read_b64_tr_b16 v[190:191], v11 offset:9216
    buffer_store_dwordx4 v[164:167], v3, s[12:15], s75 offen offset:256 sc1
    v_mfma_f32_16x16x32_bf16 v[40:43], v[152:155], v[124:127], v[40:43]
    s_waitcnt lgkmcnt(8)
    v_mfma_f32_16x16x32_bf16 v[44:47], v[156:159], v[124:127], v[44:47]
    ds_read_b64_tr_b16 v[144:145], v4 offset:16384
    ds_read_b64_tr_b16 v[146:147], v4 offset:17408
    v_mfma_f32_16x16x32_bf16 v[36:39], v[156:159], v[120:123], v[36:39]
    s_waitcnt lgkmcnt(8)
    v_mfma_f32_16x16x32_bf16 v[48:51], v[176:179], v[120:123], v[48:51]
    ds_read_b64_tr_b16 v[148:149], v8 offset:16384
    ds_read_b64_tr_b16 v[150:151], v8 offset:17408
    v_mfma_f32_16x16x32_bf16 v[56:59], v[176:179], v[124:127], v[56:59]
    s_waitcnt lgkmcnt(8)
    v_mfma_f32_16x16x32_bf16 v[60:63], v[180:183], v[124:127], v[60:63]
    ds_read_b64_tr_b16 v[152:153], v5 offset:16384
    ds_read_b64_tr_b16 v[154:155], v5 offset:17408
    v_mfma_f32_16x16x32_bf16 v[52:55], v[180:183], v[120:123], v[52:55]
    s_waitcnt lgkmcnt(8)
    v_mfma_f32_16x16x32_bf16 v[64:67], v[184:187], v[120:123], v[64:67]
    ds_read_b64_tr_b16 v[156:157], v9 offset:16384
    ds_read_b64_tr_b16 v[158:159], v9 offset:17408
    v_mfma_f32_16x16x32_bf16 v[72:75], v[184:187], v[124:127], v[72:75]
    s_waitcnt lgkmcnt(8)
    v_mfma_f32_16x16x32_bf16 v[76:79], v[188:191], v[124:127], v[76:79]
    ds_read_b64_tr_b16 v[176:177], v6 offset:16384
    ds_read_b64_tr_b16 v[178:179], v6 offset:17408
    v_mfma_f32_16x16x32_bf16 v[68:71], v[188:191], v[120:123], v[68:71]
    s_waitcnt vmcnt(14)
    s_waitcnt lgkmcnt(8)
    v_mfma_f32_16x16x32_bf16 v[16:19], v[144:147], v[208:211], v[16:19]
    ds_read_b64_tr_b16 v[180:181], v10 offset:16384
    ds_read_b64_tr_b16 v[182:183], v10 offset:17408
    buffer_load_dwordx4 v[112:115], v3, s[12:15], s44 offen offset:0 sc1
    v_mfma_f32_16x16x32_bf16 v[24:27], v[144:147], v[212:215], v[24:27]
    s_waitcnt lgkmcnt(8)
    v_mfma_f32_16x16x32_bf16 v[28:31], v[148:151], v[212:215], v[28:31]
    ds_read_b64_tr_b16 v[184:185], v7 offset:16384
    ds_read_b64_tr_b16 v[186:187], v7 offset:17408
    buffer_load_dwordx4 v[116:119], v3, s[12:15], s44 offen offset:256 sc1
    v_mfma_f32_16x16x32_bf16 v[20:23], v[148:151], v[208:211], v[20:23]
    s_waitcnt lgkmcnt(8)
    v_mfma_f32_16x16x32_bf16 v[32:35], v[152:155], v[208:211], v[32:35]
    ds_read_b64_tr_b16 v[188:189], v11 offset:16384
    ds_read_b64_tr_b16 v[190:191], v11 offset:17408
    buffer_load_dwordx4 v[120:123], v3, s[12:15], s44 offen offset:2048 sc1
    v_mfma_f32_16x16x32_bf16 v[40:43], v[152:155], v[212:215], v[40:43]
    s_waitcnt lgkmcnt(8)
    v_mfma_f32_16x16x32_bf16 v[44:47], v[156:159], v[212:215], v[44:47]
    ds_read_b64_tr_b16 v[144:145], v4 offset:24576
    ds_read_b64_tr_b16 v[146:147], v4 offset:25600
    buffer_load_dwordx4 v[124:127], v3, s[12:15], s44 offen offset:2304 sc1
    v_mfma_f32_16x16x32_bf16 v[36:39], v[156:159], v[208:211], v[36:39]
    s_add_u32 s44, s44, 4096
    s_waitcnt lgkmcnt(8)
    v_mfma_f32_16x16x32_bf16 v[48:51], v[176:179], v[208:211], v[48:51]
    ds_read_b64_tr_b16 v[148:149], v8 offset:24576
    ds_read_b64_tr_b16 v[150:151], v8 offset:25600
    v_mfma_f32_16x16x32_bf16 v[56:59], v[176:179], v[212:215], v[56:59]
    s_waitcnt lgkmcnt(8)
    v_mfma_f32_16x16x32_bf16 v[60:63], v[180:183], v[212:215], v[60:63]
    ds_read_b64_tr_b16 v[152:153], v5 offset:24576
    ds_read_b64_tr_b16 v[154:155], v5 offset:25600
    v_mfma_f32_16x16x32_bf16 v[52:55], v[180:183], v[208:211], v[52:55]
    s_waitcnt lgkmcnt(8)
    v_mfma_f32_16x16x32_bf16 v[64:67], v[184:187], v[208:211], v[64:67]
    ds_read_b64_tr_b16 v[156:157], v9 offset:24576
    ds_read_b64_tr_b16 v[158:159], v9 offset:25600
    v_mfma_f32_16x16x32_bf16 v[72:75], v[184:187], v[212:215], v[72:75]
    s_waitcnt lgkmcnt(8)
    v_mfma_f32_16x16x32_bf16 v[76:79], v[188:191], v[212:215], v[76:79]
    ds_read_b64_tr_b16 v[176:177], v6 offset:24576
    ds_read_b64_tr_b16 v[178:179], v6 offset:25600
    v_mfma_f32_16x16x32_bf16 v[68:71], v[188:191], v[208:211], v[68:71]
    s_waitcnt lgkmcnt(8)
    v_mfma_f32_16x16x32_bf16 v[16:19], v[144:147], v[216:219], v[16:19]
    ds_read_b64_tr_b16 v[180:181], v10 offset:24576
    ds_read_b64_tr_b16 v[182:183], v10 offset:25600
    v_mfma_f32_16x16x32_bf16 v[24:27], v[144:147], v[220:223], v[24:27]
    s_waitcnt lgkmcnt(8)
    v_mfma_f32_16x16x32_bf16 v[28:31], v[148:151], v[220:223], v[28:31]
    ds_read_b64_tr_b16 v[184:185], v7 offset:24576
    ds_read_b64_tr_b16 v[186:187], v7 offset:25600
    v_mfma_f32_16x16x32_bf16 v[20:23], v[148:151], v[216:219], v[20:23]
    s_waitcnt lgkmcnt(8)
    v_mfma_f32_16x16x32_bf16 v[32:35], v[152:155], v[216:219], v[32:35]
    ds_read_b64_tr_b16 v[188:189], v11 offset:24576
    ds_read_b64_tr_b16 v[190:191], v11 offset:25600
    buffer_store_dwordx4 v[168:171], v3, s[12:15], s75 offen offset:2048 sc1
    v_mfma_f32_16x16x32_bf16 v[40:43], v[152:155], v[220:223], v[40:43]
    s_waitcnt lgkmcnt(8)
    v_mfma_f32_16x16x32_bf16 v[44:47], v[156:159], v[220:223], v[44:47]
    v_add_u32 v4, 0x8000, v4
    v_add_u32 v5, 0x8000, v5
    v_add_u32 v6, 0x8000, v6
    v_add_u32 v7, 0x8000, v7
    v_mfma_f32_16x16x32_bf16 v[36:39], v[156:159], v[216:219], v[36:39]
    v_add_u32 v8, 0x8000, v8
    v_add_u32 v9, 0x8000, v9
    v_add_u32 v10, 0x8000, v10
    v_add_u32 v11, 0x8000, v11
    s_waitcnt lgkmcnt(0)
    s_waitcnt vmcnt(11)
    v_mfma_f32_16x16x32_bf16 v[48:51], v[176:179], v[216:219], v[48:51]
    s_barrier
    ds_read_b64_tr_b16 v[144:145], v4 offset:0
    ds_read_b64_tr_b16 v[146:147], v4 offset:1024
    v_mfma_f32_16x16x32_bf16 v[56:59], v[176:179], v[220:223], v[56:59]
    ds_read_b64_tr_b16 v[148:149], v8 offset:0
    ds_read_b64_tr_b16 v[150:151], v8 offset:1024
    v_mfma_f32_16x16x32_bf16 v[60:63], v[180:183], v[220:223], v[60:63]
    buffer_load_dword v12, v13, s[12:15], 0 offen sc1
    v_mfma_f32_16x16x32_bf16 v[52:55], v[180:183], v[216:219], v[52:55]
    ds_read_b64_tr_b16 v[152:153], v5 offset:0
    ds_read_b64_tr_b16 v[154:155], v5 offset:1024
    v_mfma_f32_16x16x32_bf16 v[64:67], v[184:187], v[216:219], v[64:67]
    ds_read_b64_tr_b16 v[156:157], v9 offset:0
    ds_read_b64_tr_b16 v[158:159], v9 offset:1024
    buffer_store_dwordx4 v[172:175], v3, s[12:15], s75 offen offset:2304 sc1
    v_mfma_f32_16x16x32_bf16 v[72:75], v[184:187], v[220:223], v[72:75]
    s_add_u32 s75, s75, 131072
    v_mfma_f32_16x16x32_bf16 v[76:79], v[188:191], v[220:223], v[76:79]
    ds_read_b64_tr_b16 v[176:177], v6 offset:0
    ds_read_b64_tr_b16 v[178:179], v6 offset:1024
    v_mfma_f32_16x16x32_bf16 v[68:71], v[188:191], v[216:219], v[68:71]
    s_waitcnt vmcnt(13)
    s_cmp_eq_u32 s28, 0
    s_cbranch_scc1 Lys_29
    s_load_dwordx2 s[68:69], s[0:1], 40
    s_load_dwordx2 s[52:53], s[0:1], 56
    s_load_dwordx2 s[56:57], s[0:1], 72
    s_mov_b32 s70, 4194304
    s_mov_b32 s71, 0x20000
    s_mov_b32 s54, 1835008
    s_mov_b32 s55, 0x20000
    s_bfe_u32 s60, s2, 0x10001
    s_lshl_b32 s60, s60, 21
    s_and_b32 s61, s2, 1
    s_lshl_b32 s61, s61, 19
    s_add_u32 s60, s60, s61
    s_bfe_u32 s61, s2, 0x40003
    s_lshl_b32 s61, s61, 15
    s_add_u32 s60, s60, s61
    s_lshl_b32 s61, s27, 13
    s_add_u32 s60, s60, s61
    s_and_b32 s42, s2, 127
    s_lshl_b32 s62, s42, 15
    s_lshl_b32 s61, s61, 1
    s_add_u32 s62, s62, s61
    s_mul_i32 s61, s42, 14336
    s_waitcnt lgkmcnt(0)
    s_bitcmp1_b32 s27, 0
    s_cselect_b32 s52, s56, s52
    s_cselect_b32 s53, s57, s53
    s_cmp_lt_u32 s27, 2
    s_cselect_b32 s52, s68, s52
    s_cselect_b32 s53, s69, s53
    s_cselect_b32 s54, s70, s54
    s_cselect_b32 s61, s62, s61
    s_cmp_lt_u32 s2, 128
    s_cselect_b32 s61, 0x40000000, s61
    s_add_u32 s62, s61, 12288
    s_bfe_u32 s42, s2, 65538
    s_lshl_b32 s42, s42, 3
    s_bfe_u32 s43, s2, 196611
    s_add_u32 s42, s42, s43
    s_lshl_b32 s42, s42, 4
    s_lshr_b32 s43, s2, 6
    s_lshl_b32 s43, s43, 2
    s_add_u32 s42, s42, s43
    s_bfe_u32 s43, s2, 131072
    s_add_u32 s42, s42, s43
    s_lshl_b32 s42, s42, 7
    s_add_u32 s63, s42, 16252928
Lys_29:
    s_waitcnt lgkmcnt(8)
    v_mfma_f32_16x16x32_bf16 v[16:19], v[144:147], v[240:243], v[16:19]
    ds_read_b64_tr_b16 v[180:181], v10 offset:0
    ds_read_b64_tr_b16 v[182:183], v10 offset:1024
    v_mfma_f32_16x16x32_bf16 v[24:27], v[144:147], v[244:247], v[24:27]
    s_waitcnt lgkmcnt(8)
    v_mfma_f32_16x16x32_bf16 v[28:31], v[148:151], v[244:247], v[28:31]
    ds_read_b64_tr_b16 v[184:185], v7 offset:0
    ds_read_b64_tr_b16 v[186:187], v7 offset:1024
    v_mfma_f32_16x16x32_bf16 v[20:23], v[148:151], v[240:243], v[20:23]
    s_waitcnt lgkmcnt(8)
    v_mfma_f32_16x16x32_bf16 v[32:35], v[152:155], v[240:243], v[32:35]
    ds_read_b64_tr_b16 v[188:189], v11 offset:0
    ds_read_b64_tr_b16 v[190:191], v11 offset:1024
    v_mfma_f32_16x16x32_bf16 v[40:43], v[152:155], v[244:247], v[40:43]
    s_waitcnt lgkmcnt(8)
    v_mfma_f32_16x16x32_bf16 v[44:47], v[156:159], v[244:247], v[44:47]
    ds_read_b64_tr_b16 v[144:145], v4 offset:8192
    ds_read_b64_tr_b16 v[146:147], v4 offset:9216
    v_mfma_f32_16x16x32_bf16 v[36:39], v[156:159], v[240:243], v[36:39]
    s_waitcnt lgkmcnt(8)
    v_mfma_f32_16x16x32_bf16 v[48:51], v[176:179], v[240:243], v[48:51]
    ds_read_b64_tr_b16 v[148:149], v8 offset:8192
    ds_read_b64_tr_b16 v[150:151], v8 offset:9216
    v_mfma_f32_16x16x32_bf16 v[56:59], v[176:179], v[244:247], v[56:59]
    s_waitcnt lgkmcnt(8)
    v_mfma_f32_16x16x32_bf16 v[60:63], v[180:183], v[244:247], v[60:63]
    ds_read_b64_tr_b16 v[152:153], v5 offset:8192
    ds_read_b64_tr_b16 v[154:155], v5 offset:9216
    v_mfma_f32_16x16x32_bf16 v[52:55], v[180:183], v[240:243], v[52:55]
    s_waitcnt lgkmcnt(8)
    v_mfma_f32_16x16x32_bf16 v[64:67], v[184:187], v[240:243], v[64:67]
    ds_read_b64_tr_b16 v[156:157], v9 offset:8192
    ds_read_b64_tr_b16 v[158:159], v9 offset:9216
    buffer_store_dwordx4 v[192:195], v3, s[12:15], s75 offen offset:0 sc1
    v_mfma_f32_16x16x32_bf16 v[72:75], v[184:187], v[244:247], v[72:75]
    s_waitcnt lgkmcnt(8)
    v_mfma_f32_16x16x32_bf16 v[76:79], v[188:191], v[244:247], v[76:79]
    ds_read_b64_tr_b16 v[176:177], v6 offset:8192
    ds_read_b64_tr_b16 v[178:179], v6 offset:9216
    v_mfma_f32_16x16x32_bf16 v[68:71], v[188:191], v[240:243], v[68:71]
    s_cmp_eq_u32 s24, 3
    s_cbranch_scc0 Lc1_30
    s_getpc_b64 s[76:77]
Lct_31:
    s_sub_u32 s76, s76, Lct_31 - adaLN_cond__compressed_kv_cla__dense_activation_mish__prompt_kernel
    s_subb_u32 s77, s77, 0
    s_mov_b32 s78, CODE_END - adaLN_cond__compressed_kv_cla__dense_activation_mish__prompt_kernel
    s_mov_b32 s79, 0x20000
    s_lshr_b32 s42, s2, 3
    s_lshl_b32 s42, s42, 12
    v_and_b32 v15, 31, v1
    v_lshlrev_b32 v15, 7, v15
    buffer_load_dword v15, v15, s[76:79], s42 offen
Lc1_30:
    s_waitcnt lgkmcnt(8)
    v_mfma_f32_16x16x32_bf16 v[16:19], v[144:147], v[248:251], v[16:19]
    ds_read_b64_tr_b16 v[180:181], v10 offset:8192
    ds_read_b64_tr_b16 v[182:183], v10 offset:9216
    v_mfma_f32_16x16x32_bf16 v[24:27], v[144:147], v[252:255], v[24:27]
    s_waitcnt lgkmcnt(8)
    v_mfma_f32_16x16x32_bf16 v[28:31], v[148:151], v[252:255], v[28:31]
    ds_read_b64_tr_b16 v[184:185], v7 offset:8192
    ds_read_b64_tr_b16 v[186:187], v7 offset:9216
    v_mfma_f32_16x16x32_bf16 v[20:23], v[148:151], v[248:251], v[20:23]
    s_waitcnt lgkmcnt(8)
    v_mfma_f32_16x16x32_bf16 v[32:35], v[152:155], v[248:251], v[32:35]
    ds_read_b64_tr_b16 v[188:189], v11 offset:8192
    ds_read_b64_tr_b16 v[190:191], v11 offset:9216
    v_mfma_f32_16x16x32_bf16 v[40:43], v[152:155], v[252:255], v[40:43]
    s_waitcnt lgkmcnt(8)
    v_mfma_f32_16x16x32_bf16 v[44:47], v[156:159], v[252:255], v[44:47]
    ds_read_b64_tr_b16 v[144:145], v4 offset:16384
    ds_read_b64_tr_b16 v[146:147], v4 offset:17408
    v_mfma_f32_16x16x32_bf16 v[36:39], v[156:159], v[248:251], v[36:39]
    s_waitcnt lgkmcnt(8)
    v_mfma_f32_16x16x32_bf16 v[48:51], v[176:179], v[248:251], v[48:51]
    ds_read_b64_tr_b16 v[148:149], v8 offset:16384
    ds_read_b64_tr_b16 v[150:151], v8 offset:17408
    v_mfma_f32_16x16x32_bf16 v[56:59], v[176:179], v[252:255], v[56:59]
    s_waitcnt lgkmcnt(8)
    v_mfma_f32_16x16x32_bf16 v[60:63], v[180:183], v[252:255], v[60:63]
    ds_read_b64_tr_b16 v[152:153], v5 offset:16384
    ds_read_b64_tr_b16 v[154:155], v5 offset:17408
    v_mfma_f32_16x16x32_bf16 v[52:55], v[180:183], v[248:251], v[52:55]
    s_waitcnt lgkmcnt(8)
    v_mfma_f32_16x16x32_bf16 v[64:67], v[184:187], v[248:251], v[64:67]
    ds_read_b64_tr_b16 v[156:157], v9 offset:16384
    ds_read_b64_tr_b16 v[158:159], v9 offset:17408
    buffer_store_dwordx4 v[196:199], v3, s[12:15], s75 offen offset:256 sc1
    v_mfma_f32_16x16x32_bf16 v[72:75], v[184:187], v[252:255], v[72:75]
    s_waitcnt lgkmcnt(8)
    v_mfma_f32_16x16x32_bf16 v[76:79], v[188:191], v[252:255], v[76:79]
    ds_read_b64_tr_b16 v[176:177], v6 offset:16384
    ds_read_b64_tr_b16 v[178:179], v6 offset:17408
    v_mfma_f32_16x16x32_bf16 v[68:71], v[188:191], v[248:251], v[68:71]
    s_waitcnt lgkmcnt(8)
    v_mfma_f32_16x16x32_bf16 v[16:19], v[144:147], v[80:83], v[16:19]
    ds_read_b64_tr_b16 v[180:181], v10 offset:16384
    ds_read_b64_tr_b16 v[182:183], v10 offset:17408
    v_mfma_f32_16x16x32_bf16 v[24:27], v[144:147], v[84:87], v[24:27]
    s_waitcnt lgkmcnt(8)
    v_mfma_f32_16x16x32_bf16 v[28:31], v[148:151], v[84:87], v[28:31]
    ds_read_b64_tr_b16 v[184:185], v7 offset:16384
    ds_read_b64_tr_b16 v[186:187], v7 offset:17408
    v_mfma_f32_16x16x32_bf16 v[20:23], v[148:151], v[80:83], v[20:23]
    s_waitcnt lgkmcnt(8)
    v_mfma_f32_16x16x32_bf16 v[32:35], v[152:155], v[80:83], v[32:35]
    ds_read_b64_tr_b16 v[188:189], v11 offset:16384
    ds_read_b64_tr_b16 v[190:191], v11 offset:17408
    v_mfma_f32_16x16x32_bf16 v[40:43], v[152:155], v[84:87], v[40:43]
    s_waitcnt lgkmcnt(8)
    v_mfma_f32_16x16x32_bf16 v[44:47], v[156:159], v[84:87], v[44:47]
    ds_read_b64_tr_b16 v[144:145], v4 offset:24576
    ds_read_b64_tr_b16 v[146:147], v4 offset:25600
    v_mfma_f32_16x16x32_bf16 v[36:39], v[156:159], v[80:83], v[36:39]
    s_waitcnt lgkmcnt(8)
    v_mfma_f32_16x16x32_bf16 v[48:51], v[176:179], v[80:83], v[48:51]
    ds_read_b64_tr_b16 v[148:149], v8 offset:24576
    ds_read_b64_tr_b16 v[150:151], v8 offset:25600
    v_mfma_f32_16x16x32_bf16 v[56:59], v[176:179], v[84:87], v[56:59]
    s_waitcnt lgkmcnt(8)
    v_mfma_f32_16x16x32_bf16 v[60:63], v[180:183], v[84:87], v[60:63]
    ds_read_b64_tr_b16 v[152:153], v5 offset:24576
    ds_read_b64_tr_b16 v[154:155], v5 offset:25600
    v_mfma_f32_16x16x32_bf16 v[52:55], v[180:183], v[80:83], v[52:55]
    s_waitcnt lgkmcnt(8)
    v_mfma_f32_16x16x32_bf16 v[64:67], v[184:187], v[80:83], v[64:67]
    ds_read_b64_tr_b16 v[156:157], v9 offset:24576
    ds_read_b64_tr_b16 v[158:159], v9 offset:25600
    buffer_store_dwordx4 v[200:203], v3, s[12:15], s75 offen offset:2048 sc1
    v_mfma_f32_16x16x32_bf16 v[72:75], v[184:187], v[84:87], v[72:75]
    s_waitcnt lgkmcnt(8)
    v_mfma_f32_16x16x32_bf16 v[76:79], v[188:191], v[84:87], v[76:79]
    ds_read_b64_tr_b16 v[176:177], v6 offset:24576
    ds_read_b64_tr_b16 v[178:179], v6 offset:25600
    v_mfma_f32_16x16x32_bf16 v[68:71], v[188:191], v[80:83], v[68:71]
    s_waitcnt lgkmcnt(8)
    v_mfma_f32_16x16x32_bf16 v[16:19], v[144:147], v[88:91], v[16:19]
    ds_read_b64_tr_b16 v[180:181], v10 offset:24576
    ds_read_b64_tr_b16 v[182:183], v10 offset:25600
    v_mfma_f32_16x16x32_bf16 v[24:27], v[144:147], v[92:95], v[24:27]
    s_waitcnt lgkmcnt(8)
    v_mfma_f32_16x16x32_bf16 v[28:31], v[148:151], v[92:95], v[28:31]
    ds_read_b64_tr_b16 v[184:185], v7 offset:24576
    ds_read_b64_tr_b16 v[186:187], v7 offset:25600
    v_mfma_f32_16x16x32_bf16 v[20:23], v[148:151], v[88:91], v[20:23]
    s_waitcnt lgkmcnt(8)
    v_mfma_f32_16x16x32_bf16 v[32:35], v[152:155], v[88:91], v[32:35]
    ds_read_b64_tr_b16 v[188:189], v11 offset:24576
    ds_read_b64_tr_b16 v[190:191], v11 offset:25600
    buffer_store_dwordx4 v[204:207], v3, s[12:15], s75 offen offset:2304 sc1
    v_mfma_f32_16x16x32_bf16 v[40:43], v[152:155], v[92:95], v[40:43]
    s_add_u32 s75, s75, 131072
    s_waitcnt lgkmcnt(8)
    v_mfma_f32_16x16x32_bf16 v[44:47], v[156:159], v[92:95], v[44:47]
    v_add_u32 v4, 0x8000, v4
    v_add_u32 v5, 0x8000, v5
    v_add_u32 v6, 0x8000, v6
    v_add_u32 v7, 0x8000, v7
    v_mfma_f32_16x16x32_bf16 v[36:39], v[156:159], v[88:91], v[36:39]
    v_add_u32 v8, 0x8000, v8
    v_add_u32 v9, 0x8000, v9
    v_add_u32 v10, 0x8000, v10
    v_add_u32 v11, 0x8000, v11
    s_waitcnt lgkmcnt(0)
    s_waitcnt vmcnt(5)
    s_mov_b32 s42, 200000
Lpl_32:
    v_cmp_ne_u32 vcc, s64, v12
    s_nop 0
    s_cbranch_vccz Lok_33
    s_sub_u32 s42, s42, 1
    s_cbranch_scc1 Lok_33
    s_sleep 4
    buffer_load_dword v12, v13, s[12:15], 0 offen sc1
    s_waitcnt vmcnt(0)
    s_branch Lpl_32
Lok_33:
    v_mfma_f32_16x16x32_bf16 v[48:51], v[176:179], v[88:91], v[48:51]
    s_barrier
    ds_read_b64_tr_b16 v[144:145], v4 offset:0
    ds_read_b64_tr_b16 v[146:147], v4 offset:1024
    v_mfma_f32_16x16x32_bf16 v[56:59], v[176:179], v[92:95], v[56:59]
    ds_read_b64_tr_b16 v[148:149], v8 offset:0
    ds_read_b64_tr_b16 v[150:151], v8 offset:1024
    v_mfma_f32_16x16x32_bf16 v[60:63], v[180:183], v[92:95], v[60:63]
    v_mfma_f32_16x16x32_bf16 v[52:55], v[180:183], v[88:91], v[52:55]
    ds_read_b64_tr_b16 v[152:153], v4 offset:8192
    ds_read_b64_tr_b16 v[154:155], v4 offset:9216
    v_mfma_f32_16x16x32_bf16 v[64:67], v[184:187], v[88:91], v[64:67]
    ds_read_b64_tr_b16 v[156:157], v8 offset:8192
    ds_read_b64_tr_b16 v[158:159], v8 offset:9216
    v_mfma_f32_16x16x32_bf16 v[72:75], v[184:187], v[92:95], v[72:75]
    v_mfma_f32_16x16x32_bf16 v[76:79], v[188:191], v[92:95], v[76:79]
    ds_read_b64_tr_b16 v[176:177], v4 offset:16384
    ds_read_b64_tr_b16 v[178:179], v4 offset:17408
    v_mfma_f32_16x16x32_bf16 v[68:71], v[188:191], v[88:91], v[68:71]
    s_waitcnt lgkmcnt(8)
    v_mfma_f32_16x16x32_bf16 v[16:19], v[144:147], v[96:99], v[16:19]
    ds_read_b64_tr_b16 v[180:181], v8 offset:16384
    ds_read_b64_tr_b16 v[182:183], v8 offset:17408
    s_add_u32 m0, s48, 0
    v_mfma_f32_16x16x32_bf16 v[24:27], v[144:147], v[100:103], v[24:27]
    buffer_load_dwordx4 v2, s[12:15], s45 offen offset:0 sc1 lds
    s_waitcnt lgkmcnt(8)
    v_mfma_f32_16x16x32_bf16 v[28:31], v[148:151], v[100:103], v[28:31]
    ds_read_b64_tr_b16 v[184:185], v4 offset:24576
    ds_read_b64_tr_b16 v[186:187], v4 offset:25600
    buffer_load_dwordx4 v2, s[12:15], s45 offen offset:1024 sc1 lds
    v_mfma_f32_16x16x32_bf16 v[20:23], v[148:151], v[96:99], v[20:23]
    s_waitcnt lgkmcnt(8)
    v_mfma_f32_16x16x32_bf16 v[16:19], v[152:155], v[104:107], v[16:19]
    ds_read_b64_tr_b16 v[188:189], v8 offset:24576
    ds_read_b64_tr_b16 v[190:191], v8 offset:25600
    buffer_load_dwordx4 v2, s[12:15], s45 offen offset:2048 sc1 lds
    v_mfma_f32_16x16x32_bf16 v[24:27], v[152:155], v[108:111], v[24:27]
    s_waitcnt lgkmcnt(8)
    v_mfma_f32_16x16x32_bf16 v[28:31], v[156:159], v[108:111], v[28:31]
    ds_read_b64_tr_b16 v[144:145], v5 offset:0
    ds_read_b64_tr_b16 v[146:147], v5 offset:1024
    buffer_load_dwordx4 v2, s[12:15], s45 offen offset:3072 sc1 lds
    v_mfma_f32_16x16x32_bf16 v[20:23], v[156:159], v[104:107], v[20:23]
    s_waitcnt lgkmcnt(8)
    v_mfma_f32_16x16x32_bf16 v[16:19], v[176:179], v[112:115], v[16:19]
    ds_read_b64_tr_b16 v[148:149], v9 offset:0
    ds_read_b64_tr_b16 v[150:151], v9 offset:1024
    s_add_u32 m0, s48, 32768
    v_mfma_f32_16x16x32_bf16 v[24:27], v[176:179], v[116:119], v[24:27]
    buffer_load_dwordx4 v2, s[12:15], s46 offen offset:0 sc1 lds
    s_waitcnt lgkmcnt(8)
    v_mfma_f32_16x16x32_bf16 v[28:31], v[180:183], v[116:119], v[28:31]
    ds_read_b64_tr_b16 v[152:153], v5 offset:8192
    ds_read_b64_tr_b16 v[154:155], v5 offset:9216
    buffer_load_dwordx4 v2, s[12:15], s46 offen offset:1024 sc1 lds
    v_mfma_f32_16x16x32_bf16 v[20:23], v[180:183], v[112:115], v[20:23]
    s_waitcnt lgkmcnt(8)
    v_mfma_f32_16x16x32_bf16 v[16:19], v[184:187], v[120:123], v[16:19]
    ds_read_b64_tr_b16 v[156:157], v9 offset:8192
    ds_read_b64_tr_b16 v[158:159], v9 offset:9216
    buffer_load_dwordx4 v2, s[12:15], s46 offen offset:2048 sc1 lds
    v_mfma_f32_16x16x32_bf16 v[24:27], v[184:187], v[124:127], v[24:27]
    s_waitcnt lgkmcnt(8)
    v_mfma_f32_16x16x32_bf16 v[28:31], v[188:191], v[124:127], v[28:31]
    ds_read_b64_tr_b16 v[176:177], v5 offset:16384
    ds_read_b64_tr_b16 v[178:179], v5 offset:17408
    buffer_load_dwordx4 v2, s[12:15], s46 offen offset:3072 sc1 lds
    v_mfma_f32_16x16x32_bf16 v[20:23], v[188:191], v[120:123], v[20:23]
    s_waitcnt lgkmcnt(8)
    v_mfma_f32_16x16x32_bf16 v[32:35], v[144:147], v[96:99], v[32:35]
    ds_read_b64_tr_b16 v[180:181], v9 offset:16384
    ds_read_b64_tr_b16 v[182:183], v9 offset:17408
    v_mfma_f32_16x16x32_bf16 v[40:43], v[144:147], v[100:103], v[40:43]
    s_waitcnt lgkmcnt(8)
    v_mfma_f32_16x16x32_bf16 v[44:47], v[148:151], v[100:103], v[44:47]
    ds_read_b64_tr_b16 v[184:185], v5 offset:24576
    ds_read_b64_tr_b16 v[186:187], v5 offset:25600
    v_mul_f32 v16, s49, v16
    v_mul_f32 v17, s49, v17
    v_mfma_f32_16x16x32_bf16 v[36:39], v[148:151], v[96:99], v[36:39]
    v_mul_f32 v18, s49, v18
    s_waitcnt lgkmcnt(8)
    v_mfma_f32_16x16x32_bf16 v[32:35], v[152:155], v[104:107], v[32:35]
    ds_read_b64_tr_b16 v[188:189], v9 offset:24576
    ds_read_b64_tr_b16 v[190:191], v9 offset:25600
    s_add_u32 m0, s48, 65536
    s_add_u32 s46, s46, 0x4000
    buffer_load_dwordx4 v2, s[12:15], s46 offen offset:0 sc1 lds
    v_mfma_f32_16x16x32_bf16 v[40:43], v[152:155], v[108:111], v[40:43]
    v_mul_f32 v19, s49, v19
    v_mul_f32 v20, s49, v20
    v_mul_f32 v21, s49, v21
    s_waitcnt lgkmcnt(8)
    v_mfma_f32_16x16x32_bf16 v[44:47], v[156:159], v[108:111], v[44:47]
    ds_read_b64_tr_b16 v[144:145], v6 offset:0
    ds_read_b64_tr_b16 v[146:147], v6 offset:1024
    v_mul_f32 v22, s49, v22
    v_mul_f32 v23, s49, v23
    v_mfma_f32_16x16x32_bf16 v[36:39], v[156:159], v[104:107], v[36:39]
    v_mul_f32 v24, s49, v24
    v_mul_f32 v25, s49, v25
    s_waitcnt lgkmcnt(8)
    v_mfma_f32_16x16x32_bf16 v[32:35], v[176:179], v[112:115], v[32:35]
    ds_read_b64_tr_b16 v[148:149], v10 offset:0
    ds_read_b64_tr_b16 v[150:151], v10 offset:1024
    buffer_load_dwordx4 v2, s[12:15], s46 offen offset:1024 sc1 lds
    v_mul_f32 v26, s49, v26
    v_mfma_f32_16x16x32_bf16 v[40:43], v[176:179], v[116:119], v[40:43]
    v_mul_f32 v27, s49, v27
    v_mul_f32 v28, s49, v28
    s_waitcnt lgkmcnt(8)
    v_mfma_f32_16x16x32_bf16 v[44:47], v[180:183], v[116:119], v[44:47]
    ds_read_b64_tr_b16 v[152:153], v6 offset:8192
    ds_read_b64_tr_b16 v[154:155], v6 offset:9216
    v_mul_f32 v29, s49, v29
    v_mul_f32 v30, s49, v30
    v_mfma_f32_16x16x32_bf16 v[36:39], v[180:183], v[112:115], v[36:39]
    v_mul_f32 v31, s49, v31
    v_cvt_pk_bf16_f32 v192, v16, v17
    s_waitcnt lgkmcnt(8)
    v_mfma_f32_16x16x32_bf16 v[32:35], v[184:187], v[120:123], v[32:35]
    ds_read_b64_tr_b16 v[156:157], v10 offset:8192
    ds_read_b64_tr_b16 v[158:159], v10 offset:9216
    buffer_load_dwordx4 v2, s[12:15], s46 offen offset:2048 sc1 lds
    v_cvt_pk_bf16_f32 v193, v18, v19
    v_mfma_f32_16x16x32_bf16 v[40:43], v[184:187], v[124:127], v[40:43]
    v_cvt_pk_bf16_f32 v194, v20, v21
    v_cvt_pk_bf16_f32 v195, v22, v23
    s_waitcnt lgkmcnt(8)
    v_mfma_f32_16x16x32_bf16 v[44:47], v[188:191], v[124:127], v[44:47]
    ds_read_b64_tr_b16 v[176:177], v6 offset:16384
    ds_read_b64_tr_b16 v[178:179], v6 offset:17408
    v_cvt_pk_bf16_f32 v196, v24, v25
    v_cvt_pk_bf16_f32 v197, v26, v27
    v_mfma_f32_16x16x32_bf16 v[36:39], v[188:191], v[120:123], v[36:39]
    v_cvt_pk_bf16_f32 v198, v28, v29
    v_cvt_pk_bf16_f32 v199, v30, v31
    s_waitcnt lgkmcnt(8)
    v_mfma_f32_16x16x32_bf16 v[48:51], v[144:147], v[96:99], v[48:51]
    ds_read_b64_tr_b16 v[180:181], v10 offset:16384
    ds_read_b64_tr_b16 v[182:183], v10 offset:17408
    buffer_load_dwordx4 v2, s[12:15], s46 offen offset:3072 sc1 lds
    v_mfma_f32_16x16x32_bf16 v[56:59], v[144:147], v[100:103], v[56:59]
    s_waitcnt lgkmcnt(8)
    v_mfma_f32_16x16x32_bf16 v[60:63], v[148:151], v[100:103], v[60:63]
    ds_read_b64_tr_b16 v[184:185], v6 offset:24576
    ds_read_b64_tr_b16 v[186:187], v6 offset:25600
    v_mul_f32 v32, s49, v32
    v_mul_f32 v33, s49, v33
    v_mfma_f32_16x16x32_bf16 v[52:55], v[148:151], v[96:99], v[52:55]
    v_mul_f32 v34, s49, v34
    s_waitcnt lgkmcnt(8)
    v_mfma_f32_16x16x32_bf16 v[48:51], v[152:155], v[104:107], v[48:51]
    ds_read_b64_tr_b16 v[188:189], v10 offset:24576
    ds_read_b64_tr_b16 v[190:191], v10 offset:25600
    v_mul_f32 v35, s49, v35
    v_mul_f32 v36, s49, v36
    v_mfma_f32_16x16x32_bf16 v[56:59], v[152:155], v[108:111], v[56:59]
    v_mul_f32 v37, s49, v37
    s_waitcnt lgkmcnt(8)
    v_mfma_f32_16x16x32_bf16 v[60:63], v[156:159], v[108:111], v[60:63]
    ds_read_b64_tr_b16 v[144:145], v7 offset:0
    ds_read_b64_tr_b16 v[146:147], v7 offset:1024
    buffer_store_dwordx4 v[224:227], v3, s[12:15], s75 offen offset:0 sc1
    v_mul_f32 v38, s49, v38
    v_mul_f32 v39, s49, v39
    v_mfma_f32_16x16x32_bf16 v[52:55], v[156:159], v[104:107], v[52:55]
    v_mul_f32 v40, s49, v40
    v_mul_f32 v41, s49, v41
    s_waitcnt lgkmcnt(8)
    v_mfma_f32_16x16x32_bf16 v[48:51], v[176:179], v[112:115], v[48:51]
    ds_read_b64_tr_b16 v[148:149], v11 offset:0
    ds_read_b64_tr_b16 v[150:151], v11 offset:1024
    v_mul_f32 v42, s49, v42
    v_mul_f32 v43, s49, v43
    v_mfma_f32_16x16x32_bf16 v[56:59], v[176:179], v[116:119], v[56:59]
    v_mul_f32 v44, s49, v44
    s_waitcnt lgkmcnt(8)
    v_mfma_f32_16x16x32_bf16 v[60:63], v[180:183], v[116:119], v[60:63]
    ds_read_b64_tr_b16 v[152:153], v7 offset:8192
    ds_read_b64_tr_b16 v[154:155], v7 offset:9216
    v_mul_f32 v45, s49, v45
    v_mul_f32 v46, s49, v46
    v_mfma_f32_16x16x32_bf16 v[52:55], v[180:183], v[112:115], v[52:55]
    v_mul_f32 v47, s49, v47
    v_cvt_pk_bf16_f32 v200, v32, v33
    s_waitcnt lgkmcnt(8)
    v_mfma_f32_16x16x32_bf16 v[48:51], v[184:187], v[120:123], v[48:51]
    ds_read_b64_tr_b16 v[156:157], v11 offset:8192
    ds_read_b64_tr_b16 v[158:159], v11 offset:9216
    v_cvt_pk_bf16_f32 v201, v34, v35
    v_cvt_pk_bf16_f32 v202, v36, v37
    v_mfma_f32_16x16x32_bf16 v[56:59], v[184:187], v[124:127], v[56:59]
    v_cvt_pk_bf16_f32 v203, v38, v39
    s_waitcnt lgkmcnt(8)
    v_mfma_f32_16x16x32_bf16 v[60:63], v[188:191], v[124:127], v[60:63]
    ds_read_b64_tr_b16 v[176:177], v7 offset:16384
    ds_read_b64_tr_b16 v[178:179], v7 offset:17408
    buffer_store_dwordx4 v[228:231], v3, s[12:15], s75 offen offset:256 sc1
    v_cvt_pk_bf16_f32 v204, v40, v41
    v_cvt_pk_bf16_f32 v205, v42, v43
    v_mfma_f32_16x16x32_bf16 v[52:55], v[188:191], v[120:123], v[52:55]
    v_cvt_pk_bf16_f32 v206, v44, v45
    v_cvt_pk_bf16_f32 v207, v46, v47
    s_waitcnt lgkmcnt(8)
    v_mfma_f32_16x16x32_bf16 v[64:67], v[144:147], v[96:99], v[64:67]
    ds_read_b64_tr_b16 v[180:181], v11 offset:16384
    ds_read_b64_tr_b16 v[182:183], v11 offset:17408
    v_mfma_f32_16x16x32_bf16 v[72:75], v[144:147], v[100:103], v[72:75]
    s_waitcnt lgkmcnt(8)
    v_mfma_f32_16x16x32_bf16 v[76:79], v[148:151], v[100:103], v[76:79]
    ds_read_b64_tr_b16 v[184:185], v7 offset:24576
    ds_read_b64_tr_b16 v[186:187], v7 offset:25600
    v_mul_f32 v48, s49, v48
    v_mul_f32 v49, s49, v49
    v_mfma_f32_16x16x32_bf16 v[68:71], v[148:151], v[96:99], v[68:71]
    v_mul_f32 v50, s49, v50
    s_waitcnt lgkmcnt(8)
    v_mfma_f32_16x16x32_bf16 v[64:67], v[152:155], v[104:107], v[64:67]
    ds_read_b64_tr_b16 v[188:189], v11 offset:24576
    ds_read_b64_tr_b16 v[190:191], v11 offset:25600
    v_mul_f32 v51, s49, v51
    v_mul_f32 v52, s49, v52
    v_mfma_f32_16x16x32_bf16 v[72:75], v[152:155], v[108:111], v[72:75]
    v_mul_f32 v53, s49, v53
    s_waitcnt lgkmcnt(8)
    v_mfma_f32_16x16x32_bf16 v[76:79], v[156:159], v[108:111], v[76:79]
    buffer_store_dwordx4 v[232:235], v3, s[12:15], s75 offen offset:2048 sc1
    v_mul_f32 v54, s49, v54
    v_mul_f32 v55, s49, v55
    v_mfma_f32_16x16x32_bf16 v[68:71], v[156:159], v[104:107], v[68:71]
    v_mul_f32 v56, s49, v56
    v_mul_f32 v57, s49, v57
    s_waitcnt lgkmcnt(6)
    v_mfma_f32_16x16x32_bf16 v[64:67], v[176:179], v[112:115], v[64:67]
    v_mul_f32 v58, s49, v58
    v_mul_f32 v59, s49, v59
    v_mfma_f32_16x16x32_bf16 v[72:75], v[176:179], v[116:119], v[72:75]
    v_mul_f32 v60, s49, v60
    s_waitcnt lgkmcnt(4)
    v_mfma_f32_16x16x32_bf16 v[76:79], v[180:183], v[116:119], v[76:79]
    v_mul_f32 v61, s49, v61
    v_mul_f32 v62, s49, v62
    v_mfma_f32_16x16x32_bf16 v[68:71], v[180:183], v[112:115], v[68:71]
    v_mul_f32 v63, s49, v63
    v_cvt_pk_bf16_f32 v208, v48, v49
    s_waitcnt lgkmcnt(2)
    v_mfma_f32_16x16x32_bf16 v[64:67], v[184:187], v[120:123], v[64:67]
    v_cvt_pk_bf16_f32 v209, v50, v51
    v_cvt_pk_bf16_f32 v210, v52, v53
    v_mfma_f32_16x16x32_bf16 v[72:75], v[184:187], v[124:127], v[72:75]
    v_cvt_pk_bf16_f32 v211, v54, v55
    s_waitcnt lgkmcnt(0)
    v_mfma_f32_16x16x32_bf16 v[76:79], v[188:191], v[124:127], v[76:79]
    buffer_store_dwordx4 v[236:239], v3, s[12:15], s75 offen offset:2304 sc1
    s_add_u32 s75, s75, 131072
    v_cvt_pk_bf16_f32 v212, v56, v57
    v_mfma_f32_16x16x32_bf16 v[68:71], v[188:191], v[120:123], v[68:71]
    v_cvt_pk_bf16_f32 v213, v58, v59
    v_cvt_pk_bf16_f32 v214, v60, v61
    v_cvt_pk_bf16_f32 v215, v62, v63
    v_mov_b32 v93, v3
    s_cmp_eq_u32 s28, 0
    s_cbranch_scc1 Lyw_34
    s_setprio 1
Lyw_34:
    s_waitcnt vmcnt(8)
    s_barrier
    ds_read_b128 v[96:99], v3 offset:16384
    ds_read_b128 v[100:103], v3 offset:18432
    ds_read_b128 v[104:107], v3 offset:20480
    ds_read_b128 v[108:111], v3 offset:22528
    ds_read_b128 v[112:115], v3 offset:16640
    ds_read_b128 v[116:119], v3 offset:18688
    ds_read_b128 v[120:123], v3 offset:20736
    ds_read_b128 v[124:127], v3 offset:22784
    ds_read_b128 v[224:227], v3 offset:0
    ds_read_b128 v[228:231], v3 offset:2048
    ds_read_b128 v[232:235], v3 offset:4096
    ds_read_b128 v[236:239], v3 offset:6144
    ds_read_b128 v[240:243], v3 offset:256
    ds_read_b128 v[244:247], v3 offset:2304
    ds_read_b128 v[248:251], v3 offset:4352
    ds_read_b128 v[252:255], v3 offset:6400
    s_cmp_eq_u32 s24, 0
    s_cbranch_scc0 Lw0_35
    v_mov_b32 v12, s64
    v_mov_b32 v15, s50
    s_mov_b64 exec, 1
    buffer_store_dword v12, v15, s[12:15], 0 offen sc1
    s_mov_b64 exec, -1
Lw0_35:
    v_mul_f32 v64, s49, v64
    v_mul_f32 v65, s49, v65
    v_mul_f32 v66, s49, v66
    v_mul_f32 v67, s49, v67
    v_mul_f32 v68, s49, v68
    v_mul_f32 v69, s49, v69
    v_mul_f32 v70, s49, v70
    v_mul_f32 v71, s49, v71
    v_mul_f32 v72, s49, v72
    v_mul_f32 v73, s49, v73
    v_mul_f32 v74, s49, v74
    v_mul_f32 v75, s49, v75
    v_mul_f32 v76, s49, v76
    v_mul_f32 v77, s49, v77
    v_mul_f32 v78, s49, v78
    v_mul_f32 v79, s49, v79
    v_cvt_pk_bf16_f32 v216, v64, v65
    v_cvt_pk_bf16_f32 v217, v66, v67
    v_cvt_pk_bf16_f32 v218, v68, v69
    v_cvt_pk_bf16_f32 v219, v70, v71
    v_cvt_pk_bf16_f32 v220, v72, v73
    v_cvt_pk_bf16_f32 v221, v74, v75
    v_cvt_pk_bf16_f32 v222, v76, v77
    v_cvt_pk_bf16_f32 v223, v78, v79
    v_lshlrev_b32 v9, 7, v1
    v_and_b32 v9, 0xf80, v9
    v_mov_b32 v92, 0xff800000
    v_and_b32 v95, 15, v1
    v_lshrrev_b32 v4, 5, v1
    v_lshlrev_b32 v4, 2, v4
    v_sub_u32 v95, v95, v4
    v_and_b32 v4, 16, v1
    v_sub_u32 v95, v95, v4
    v_and_b32 v4, 3, v1
    v_cmp_eq_u32 vcc, 0, v4
    v_mov_b32 v4, 0x3f803f80
    s_nop 0
    v_cndmask_b32 v88, 0, v4, vcc
    v_cndmask_b32 v89, 0, v4, vcc
    v_cndmask_b32 v90, 0, v4, vcc
    v_cndmask_b32 v91, 0, v4, vcc
    s_waitcnt lgkmcnt(8)
    v_mfma_f32_16x16x32_bf16 v[16:19], v[96:99], v[192:195], 0
    v_mfma_f32_16x16x32_bf16 v[24:27], v[96:99], v[196:199], 0
    v_mfma_f32_16x16x32_bf16 v[16:19], v[100:103], v[200:203], v[16:19]
    v_mfma_f32_16x16x32_bf16 v[24:27], v[100:103], v[204:207], v[24:27]
    v_mfma_f32_16x16x32_bf16 v[16:19], v[104:107], v[208:211], v[16:19]
    v_mfma_f32_16x16x32_bf16 v[24:27], v[104:107], v[212:215], v[24:27]
    v_mfma_f32_16x16x32_bf16 v[16:19], v[108:111], v[216:219], v[16:19]
    v_mfma_f32_16x16x32_bf16 v[24:27], v[108:111], v[220:223], v[24:27]
    v_mfma_f32_16x16x32_bf16 v[20:23], v[112:115], v[192:195], 0
    v_mfma_f32_16x16x32_bf16 v[28:31], v[112:115], v[196:199], 0
    v_mfma_f32_16x16x32_bf16 v[20:23], v[116:119], v[200:203], v[20:23]
    v_mfma_f32_16x16x32_bf16 v[28:31], v[116:119], v[204:207], v[28:31]
    v_mfma_f32_16x16x32_bf16 v[20:23], v[120:123], v[208:211], v[20:23]
    v_mfma_f32_16x16x32_bf16 v[28:31], v[120:123], v[212:215], v[28:31]
    v_mfma_f32_16x16x32_bf16 v[20:23], v[124:127], v[216:219], v[20:23]
    v_mfma_f32_16x16x32_bf16 v[28:31], v[124:127], v[220:223], v[28:31]
    s_mov_b32 s35, 0
    s_cmp_eq_u32 s36, 0
    s_cbranch_scc1 Lslow0
    s_waitcnt lgkmcnt(0)
    v_mfma_f32_16x16x32_bf16 v[32:35], v[224:227], v[192:195], 0
    v_mfma_f32_16x16x32_bf16 v[32:35], v[228:231], v[200:203], v[32:35]
    v_mfma_f32_16x16x32_bf16 v[32:35], v[232:235], v[208:211], v[32:35]
    v_max3_f32 v80, v16, v17, v18
    v_max3_f32 v80, v80, v19, v20
    v_max3_f32 v80, v80, v21, v22
    v_mfma_f32_16x16x32_bf16 v[32:35], v[236:239], v[216:219], v[32:35]
    v_max_f32 v80, v80, v23
    v_max3_f32 v81, v24, v25, v26
    v_max3_f32 v81, v81, v27, v28
    v_mfma_f32_16x16x32_bf16 v[40:43], v[224:227], v[196:199], 0
    v_max3_f32 v81, v81, v29, v30
    v_max_f32 v81, v81, v31
    v_mov_b32 v82, v80
    v_mfma_f32_16x16x32_bf16 v[40:43], v[228:231], v[204:207], v[40:43]
    v_mov_b32 v83, v81
    v_permlane16_swap_b32 v82, v80
    s_nop 0
    v_permlane16_swap_b32 v83, v81
    v_max_f32 v80, v80, v82
    v_mfma_f32_16x16x32_bf16 v[40:43], v[232:235], v[212:215], v[40:43]
    v_max_f32 v81, v81, v83
    v_mov_b32 v82, v80
    v_mov_b32 v83, v81
    v_mfma_f32_16x16x32_bf16 v[40:43], v[236:239], v[220:223], v[40:43]
    v_permlane32_swap_b32 v82, v80
    v_permlane32_swap_b32 v83, v81
    v_max_f32 v80, v80, v82
    v_mfma_f32_16x16x32_bf16 v[36:39], v[240:243], v[192:195], 0
    ds_read_b128 v[224:227], v3 offset:8192
    v_max_f32 v81, v81, v83
    v_add_f32 v80, 0x42000000, v80
    v_add_f32 v81, 0x42000000, v81
    v_sub_f32 v48, 0, v80
    v_mfma_f32_16x16x32_bf16 v[36:39], v[244:247], v[200:203], v[36:39]
    ds_read_b128 v[228:231], v3 offset:10240
    v_sub_f32 v49, 0, v80
    v_sub_f32 v50, 0, v80
    v_sub_f32 v51, 0, v80
    v_mfma_f32_16x16x32_bf16 v[36:39], v[248:251], v[208:211], v[36:39]
    ds_read_b128 v[232:235], v3 offset:12288
    v_sub_f32 v52, 0, v81
    v_sub_f32 v53, 0, v81
    v_sub_f32 v54, 0, v81
    v_mfma_f32_16x16x32_bf16 v[36:39], v[252:255], v[216:219], v[36:39]
    ds_read_b128 v[236:239], v3 offset:14336
    v_sub_f32 v55, 0, v81
    v_add_f32 v16, v16, v48
    v_add_f32 v17, v17, v48
    v_mfma_f32_16x16x32_bf16 v[44:47], v[240:243], v[196:199], 0
    v_add_f32 v18, v18, v48
    v_add_f32 v19, v19, v48
    v_add_f32 v20, v20, v48
    v_add_f32 v21, v21, v48
    v_mfma_f32_16x16x32_bf16 v[44:47], v[244:247], v[204:207], v[44:47]
    v_add_f32 v22, v22, v48
    v_add_f32 v23, v23, v48
    v_add_f32 v24, v24, v52
    v_mfma_f32_16x16x32_bf16 v[44:47], v[248:251], v[212:215], v[44:47]
    v_add_f32 v25, v25, v52
    v_add_f32 v26, v26, v52
    v_add_f32 v27, v27, v52
    v_mfma_f32_16x16x32_bf16 v[44:47], v[252:255], v[220:223], v[44:47]
    v_add_f32 v28, v28, v52
    v_add_f32 v29, v29, v52
    v_add_f32 v30, v30, v52
    v_add_f32 v31, v31, v52
    s_add_u32 s30, s30, 0x8000
    s_cmp_eq_u32 s30, 163840
    s_cselect_b32 s30, 0, s30
    ds_read_b128 v[240:243], v3 offset:8448
    ds_read_b128 v[244:247], v3 offset:10496
    ds_read_b128 v[248:251], v3 offset:12544
    ds_read_b128 v[252:255], v3 offset:14592
    v_exp_f32 v80, v16
    v_exp_f32 v81, v17
    v_exp_f32 v82, v18
    v_cvt_pk_bf16_f32 v64, v80, v81
    v_exp_f32 v83, v19
    v_add_f32 v32, v32, v48
    v_exp_f32 v84, v20
    v_add_f32 v33, v33, v48
    v_cvt_pk_bf16_f32 v65, v82, v83
    v_add_f32 v34, v34, v48
    v_exp_f32 v85, v21
    v_add_f32 v35, v35, v48
    v_exp_f32 v86, v22
    v_add_f32 v36, v36, v48
    v_cvt_pk_bf16_f32 v66, v84, v85
    v_add_f32 v37, v37, v48
    v_exp_f32 v87, v23
    v_add_f32 v38, v38, v48
    v_exp_f32 v80, v24
    v_add_f32 v39, v39, v48
    v_cvt_pk_bf16_f32 v67, v86, v87
    v_add_f32 v40, v40, v52
    v_exp_f32 v81, v25
    v_add_f32 v41, v41, v52
    v_exp_f32 v82, v26
    v_add_f32 v42, v42, v52
    v_cvt_pk_bf16_f32 v68, v80, v81
    v_add_f32 v43, v43, v52
    v_exp_f32 v83, v27
    v_add_f32 v44, v44, v52
    v_exp_f32 v84, v28
    v_add_f32 v45, v45, v52
    v_cvt_pk_bf16_f32 v69, v82, v83
    v_add_f32 v46, v46, v52
    v_exp_f32 v85, v29
    v_add_f32 v47, v47, v52
    v_exp_f32 v86, v30
    v_cvt_pk_bf16_f32 v70, v84, v85
    v_exp_f32 v87, v31
    s_nop 0
    v_cvt_pk_bf16_f32 v71, v86, v87
    s_waitcnt lgkmcnt(0)
    s_cmp_eq_u32 s28, 0
    s_cbranch_scc0 Lystart
Lxloop:
    v_mfma_f32_16x16x32_bf16 v[16:19], v[224:227], v[192:195], v[48:51]
    v_exp_f32 v80, v32
    v_mfma_f32_16x16x32_bf16 v[16:19], v[228:231], v[200:203], v[16:19]
    s_waitcnt lgkmcnt(4)
    v_exp_f32 v81, v33
    v_mfma_f32_16x16x32_bf16 v[16:19], v[232:235], v[208:211], v[16:19]
    v_exp_f32 v82, v34
    v_mfma_f32_16x16x32_bf16 v[16:19], v[236:239], v[216:219], v[16:19]
    ds_read_b128 v[96:99], v3 offset:24576
    v_cvt_pk_bf16_f32 v72, v80, v81
    v_mfma_f32_16x16x32_bf16 v[24:27], v[236:239], v[220:223], v[52:55]
    v_exp_f32 v83, v35
    v_mfma_f32_16x16x32_bf16 v[24:27], v[232:235], v[212:215], v[24:27]
    ds_read_b128 v[100:103], v3 offset:24832
    v_mfma_f32_16x16x32_bf16 v[24:27], v[228:231], v[204:207], v[24:27]
    v_exp_f32 v84, v36
    v_mfma_f32_16x16x32_bf16 v[24:27], v[224:227], v[196:199], v[24:27]
    s_waitcnt lgkmcnt(4)
    ds_read_b128 v[104:107], v3 offset:26624
    v_cvt_pk_bf16_f32 v73, v82, v83
    v_mfma_f32_16x16x32_bf16 v[28:31], v[240:243], v[196:199], v[52:55]
    v_exp_f32 v85, v37
    v_mfma_f32_16x16x32_bf16 v[28:31], v[244:247], v[204:207], v[28:31]
    s_waitcnt lgkmcnt(3)
    ds_read_b128 v[108:111], v3 offset:26880
    v_mfma_f32_16x16x32_bf16 v[28:31], v[248:251], v[212:215], v[28:31]
    v_exp_f32 v86, v38
    v_mfma_f32_16x16x32_bf16 v[28:31], v[252:255], v[220:223], v[28:31]
    ds_read_b128 v[112:115], v3 offset:28672
    v_cvt_pk_bf16_f32 v74, v84, v85
    v_mfma_f32_16x16x32_bf16 v[20:23], v[252:255], v[216:219], v[48:51]
    v_exp_f32 v87, v39
    v_mfma_f32_16x16x32_bf16 v[20:23], v[248:251], v[208:211], v[20:23]
    ds_read_b128 v[116:119], v3 offset:28928
    v_or3_b32 v94, v72, v73, v74
    v_mfma_f32_16x16x32_bf16 v[20:23], v[244:247], v[200:203], v[20:23]
    v_exp_f32 v80, v40
    v_mfma_f32_16x16x32_bf16 v[20:23], v[240:243], v[192:195], v[20:23]
    ds_read_b128 v[120:123], v3 offset:30720
    v_cvt_pk_bf16_f32 v75, v86, v87
    v_mfma_f32_16x16x32_bf16 v[60:63], v[88:91], v[68:71], 0
    v_exp_f32 v81, v41
    v_mfma_f32_16x16x32_bf16 v[56:59], v[88:91], v[64:67], 0
    s_waitcnt lgkmcnt(5)
    ds_read_b128 v[124:127], v3 offset:30976
    v_add_u32 v3, s30, v93
    v_mfma_f32_16x16x32_bf16 v[128:131], v[96:99], v[64:67], 0
    v_exp_f32 v82, v42
    v_mfma_f32_16x16x32_bf16 v[136:139], v[96:99], v[68:71], 0
    ds_read_b128 v[224:227], v3 offset:0
    v_cvt_pk_bf16_f32 v76, v80, v81
    v_mfma_f32_16x16x32_bf16 v[140:143], v[100:103], v[68:71], 0
    v_exp_f32 v83, v43
    v_mfma_f32_16x16x32_bf16 v[132:135], v[100:103], v[64:67], 0
    s_waitcnt lgkmcnt(5)
    ds_read_b128 v[228:231], v3 offset:2048
    v_or3_b32 v94, v94, v75, v76
    v_mfma_f32_16x16x32_bf16 v[144:147], v[104:107], v[64:67], 0
    v_exp_f32 v84, v44
    v_mfma_f32_16x16x32_bf16 v[152:155], v[104:107], v[68:71], 0
    ds_read_b128 v[232:235], v3 offset:4096
    v_cvt_pk_bf16_f32 v77, v82, v83
    v_mfma_f32_16x16x32_bf16 v[156:159], v[108:111], v[68:71], 0
    v_exp_f32 v85, v45
    v_mfma_f32_16x16x32_bf16 v[148:151], v[108:111], v[64:67], 0
    s_waitcnt lgkmcnt(5)
    ds_read_b128 v[236:239], v3 offset:6144
    v_mfma_f32_16x16x32_bf16 v[160:163], v[112:115], v[64:67], 0
    v_exp_f32 v86, v46
    v_mfma_f32_16x16x32_bf16 v[168:171], v[112:115], v[68:71], 0
    ds_read_b128 v[240:243], v3 offset:256
    v_cvt_pk_bf16_f32 v78, v84, v85
    v_mfma_f32_16x16x32_bf16 v[172:175], v[116:119], v[68:71], 0
    v_exp_f32 v87, v47
    v_mfma_f32_16x16x32_bf16 v[164:167], v[116:119], v[64:67], 0
    s_waitcnt lgkmcnt(5)
    ds_read_b128 v[244:247], v3 offset:2304
    v_or3_b32 v94, v94, v77, v78
    v_mfma_f32_16x16x32_bf16 v[176:179], v[120:123], v[64:67], 0
    ds_read_b128 v[248:251], v3 offset:4352
    v_cvt_pk_bf16_f32 v79, v86, v87
    v_mfma_f32_16x16x32_bf16 v[184:187], v[120:123], v[68:71], 0
    v_bitop3_b32 v94, v94, v79, s38 bitop3:0xa8
    v_cmp_ne_u32 vcc, 0, v94
    v_mfma_f32_16x16x32_bf16 v[188:191], v[124:127], v[68:71], 0
    s_waitcnt lgkmcnt(5)
    v_mfma_f32_16x16x32_bf16 v[180:183], v[124:127], v[64:67], 0
    s_cbranch_vccnz Lfb_36
Lbk_37:
    ds_read_b128 v[252:255], v3 offset:6400
    v_mfma_f32_16x16x32_bf16 v[32:35], v[224:227], v[192:195], v[48:51]
    v_exp_f32 v80, v16
    v_mfma_f32_16x16x32_bf16 v[32:35], v[228:231], v[200:203], v[32:35]
    s_waitcnt lgkmcnt(4)
    v_exp_f32 v81, v17
    v_mfma_f32_16x16x32_bf16 v[32:35], v[232:235], v[208:211], v[32:35]
    v_exp_f32 v82, v18
    v_mfma_f32_16x16x32_bf16 v[32:35], v[236:239], v[216:219], v[32:35]
    ds_read_b128 v[96:99], v3 offset:16384
    v_cvt_pk_bf16_f32 v64, v80, v81
    v_mfma_f32_16x16x32_bf16 v[40:43], v[236:239], v[220:223], v[52:55]
    v_exp_f32 v83, v19
    v_mfma_f32_16x16x32_bf16 v[40:43], v[232:235], v[212:215], v[40:43]
    ds_read_b128 v[100:103], v3 offset:16640
    v_mfma_f32_16x16x32_bf16 v[40:43], v[228:231], v[204:207], v[40:43]
    s_add_u32 s35, s35, 1
    v_exp_f32 v84, v20
    v_mfma_f32_16x16x32_bf16 v[40:43], v[224:227], v[196:199], v[40:43]
    s_waitcnt lgkmcnt(4)
    ds_read_b128 v[104:107], v3 offset:18432
    v_cvt_pk_bf16_f32 v65, v82, v83
    v_mfma_f32_16x16x32_bf16 v[44:47], v[240:243], v[196:199], v[52:55]
    v_exp_f32 v85, v21
    v_mfma_f32_16x16x32_bf16 v[44:47], v[244:247], v[204:207], v[44:47]
    s_waitcnt lgkmcnt(3)
    ds_read_b128 v[108:111], v3 offset:18688
    v_mfma_f32_16x16x32_bf16 v[44:47], v[248:251], v[212:215], v[44:47]
    v_exp_f32 v86, v22
    v_mfma_f32_16x16x32_bf16 v[44:47], v[252:255], v[220:223], v[44:47]
    ds_read_b128 v[112:115], v3 offset:20480
    v_cvt_pk_bf16_f32 v66, v84, v85
    v_mfma_f32_16x16x32_bf16 v[36:39], v[252:255], v[216:219], v[48:51]
    v_exp_f32 v87, v23
    v_mfma_f32_16x16x32_bf16 v[36:39], v[248:251], v[208:211], v[36:39]
    ds_read_b128 v[116:119], v3 offset:20736
    v_or3_b32 v94, v64, v65, v66
    v_mfma_f32_16x16x32_bf16 v[36:39], v[244:247], v[200:203], v[36:39]
    v_exp_f32 v80, v24
    v_mfma_f32_16x16x32_bf16 v[36:39], v[240:243], v[192:195], v[36:39]
    ds_read_b128 v[120:123], v3 offset:22528
    v_cvt_pk_bf16_f32 v67, v86, v87
    v_mfma_f32_16x16x32_bf16 v[60:63], v[88:91], v[76:79], v[60:63]
    s_add_u32 s30, s30, 0x8000
    v_exp_f32 v81, v25
    v_mfma_f32_16x16x32_bf16 v[56:59], v[88:91], v[72:75], v[56:59]
    s_waitcnt lgkmcnt(5)
    ds_read_b128 v[124:127], v3 offset:22784
    v_mfma_f32_16x16x32_bf16 v[128:131], v[96:99], v[72:75], v[128:131]
    s_cmp_eq_u32 s30, 163840
    v_exp_f32 v82, v26
    s_cselect_b32 s30, 0, s30
    v_mfma_f32_16x16x32_bf16 v[136:139], v[96:99], v[76:79], v[136:139]
    ds_read_b128 v[224:227], v3 offset:8192
    v_cvt_pk_bf16_f32 v68, v80, v81
    v_mfma_f32_16x16x32_bf16 v[140:143], v[100:103], v[76:79], v[140:143]
    v_exp_f32 v83, v27
    v_mfma_f32_16x16x32_bf16 v[132:135], v[100:103], v[72:75], v[132:135]
    s_waitcnt lgkmcnt(5)
    ds_read_b128 v[228:231], v3 offset:10240
    v_or3_b32 v94, v94, v67, v68
    v_mfma_f32_16x16x32_bf16 v[144:147], v[104:107], v[72:75], v[144:147]
    v_exp_f32 v84, v28
    v_mfma_f32_16x16x32_bf16 v[152:155], v[104:107], v[76:79], v[152:155]
    ds_read_b128 v[232:235], v3 offset:12288
    v_cvt_pk_bf16_f32 v69, v82, v83
    v_mfma_f32_16x16x32_bf16 v[156:159], v[108:111], v[76:79], v[156:159]
    v_exp_f32 v85, v29
    v_mfma_f32_16x16x32_bf16 v[148:151], v[108:111], v[72:75], v[148:151]
    s_waitcnt lgkmcnt(5)
    ds_read_b128 v[236:239], v3 offset:14336
    v_mfma_f32_16x16x32_bf16 v[160:163], v[112:115], v[72:75], v[160:163]
    v_exp_f32 v86, v30
    v_mfma_f32_16x16x32_bf16 v[168:171], v[112:115], v[76:79], v[168:171]
    ds_read_b128 v[240:243], v3 offset:8448
    v_cvt_pk_bf16_f32 v70, v84, v85
    v_mfma_f32_16x16x32_bf16 v[172:175], v[116:119], v[76:79], v[172:175]
    v_exp_f32 v87, v31
    v_mfma_f32_16x16x32_bf16 v[164:167], v[116:119], v[72:75], v[164:167]
    s_waitcnt lgkmcnt(5)
    ds_read_b128 v[244:247], v3 offset:10496
    v_or3_b32 v94, v94, v69, v70
    v_mfma_f32_16x16x32_bf16 v[176:179], v[120:123], v[72:75], v[176:179]
    ds_read_b128 v[248:251], v3 offset:12544
    v_cvt_pk_bf16_f32 v71, v86, v87
    v_mfma_f32_16x16x32_bf16 v[184:187], v[120:123], v[76:79], v[184:187]
    v_bitop3_b32 v94, v94, v71, s38 bitop3:0xa8
    v_cmp_ne_u32 vcc, 0, v94
    v_mfma_f32_16x16x32_bf16 v[188:191], v[124:127], v[76:79], v[188:191]
    s_waitcnt lgkmcnt(5)
    v_mfma_f32_16x16x32_bf16 v[180:183], v[124:127], v[72:75], v[180:183]
    s_cbranch_vccnz Lfb_38
Lbk_39:
    ds_read_b128 v[252:255], v3 offset:14592
    v_mfma_f32_16x16x32_bf16 v[16:19], v[224:227], v[192:195], v[48:51]
    v_exp_f32 v80, v32
    v_mfma_f32_16x16x32_bf16 v[16:19], v[228:231], v[200:203], v[16:19]
    s_waitcnt lgkmcnt(4)
    v_exp_f32 v81, v33
    v_mfma_f32_16x16x32_bf16 v[16:19], v[232:235], v[208:211], v[16:19]
    v_exp_f32 v82, v34
    v_mfma_f32_16x16x32_bf16 v[16:19], v[236:239], v[216:219], v[16:19]
    ds_read_b128 v[96:99], v3 offset:24576
    v_cvt_pk_bf16_f32 v72, v80, v81
    v_mfma_f32_16x16x32_bf16 v[24:27], v[236:239], v[220:223], v[52:55]
    v_exp_f32 v83, v35
    v_mfma_f32_16x16x32_bf16 v[24:27], v[232:235], v[212:215], v[24:27]
    ds_read_b128 v[100:103], v3 offset:24832
    v_mfma_f32_16x16x32_bf16 v[24:27], v[228:231], v[204:207], v[24:27]
    v_exp_f32 v84, v36
    v_mfma_f32_16x16x32_bf16 v[24:27], v[224:227], v[196:199], v[24:27]
    s_waitcnt lgkmcnt(4)
    ds_read_b128 v[104:107], v3 offset:26624
    v_cvt_pk_bf16_f32 v73, v82, v83
    v_mfma_f32_16x16x32_bf16 v[28:31], v[240:243], v[196:199], v[52:55]
    v_exp_f32 v85, v37
    v_mfma_f32_16x16x32_bf16 v[28:31], v[244:247], v[204:207], v[28:31]
    s_waitcnt lgkmcnt(3)
    ds_read_b128 v[108:111], v3 offset:26880
    v_mfma_f32_16x16x32_bf16 v[28:31], v[248:251], v[212:215], v[28:31]
    v_exp_f32 v86, v38
    v_mfma_f32_16x16x32_bf16 v[28:31], v[252:255], v[220:223], v[28:31]
    ds_read_b128 v[112:115], v3 offset:28672
    ds_read_b128 v[116:119], v3 offset:28928
    v_cvt_pk_bf16_f32 v74, v84, v85
    v_mfma_f32_16x16x32_bf16 v[20:23], v[252:255], v[216:219], v[48:51]
    v_exp_f32 v87, v39
    v_mfma_f32_16x16x32_bf16 v[20:23], v[248:251], v[208:211], v[20:23]
    ds_read_b128 v[120:123], v3 offset:30720
    ds_read_b128 v[124:127], v3 offset:30976
    v_or3_b32 v94, v72, v73, v74
    v_mfma_f32_16x16x32_bf16 v[20:23], v[244:247], v[200:203], v[20:23]
    v_exp_f32 v80, v40
    v_mfma_f32_16x16x32_bf16 v[20:23], v[240:243], v[192:195], v[20:23]
    v_cvt_pk_bf16_f32 v75, v86, v87
    v_mfma_f32_16x16x32_bf16 v[60:63], v[88:91], v[68:71], v[60:63]
    v_exp_f32 v81, v41
    v_mfma_f32_16x16x32_bf16 v[56:59], v[88:91], v[64:67], v[56:59]
    s_waitcnt vmcnt(0) lgkmcnt(0)
    v_add_u32 v3, s30, v93
    v_mfma_f32_16x16x32_bf16 v[128:131], v[96:99], v[64:67], v[128:131]
    s_barrier
    v_exp_f32 v82, v42
    v_mfma_f32_16x16x32_bf16 v[136:139], v[96:99], v[68:71], v[136:139]
    ds_read_b128 v[224:227], v3 offset:0
    v_cvt_pk_bf16_f32 v76, v80, v81
    v_mfma_f32_16x16x32_bf16 v[140:143], v[100:103], v[68:71], v[140:143]
    v_exp_f32 v83, v43
    v_mfma_f32_16x16x32_bf16 v[132:135], v[100:103], v[64:67], v[132:135]
    ds_read_b128 v[228:231], v3 offset:2048
    v_or3_b32 v94, v94, v75, v76
    v_mfma_f32_16x16x32_bf16 v[144:147], v[104:107], v[64:67], v[144:147]
    s_cmp_lg_u32 s39, 0
    v_exp_f32 v84, v44
    s_cbranch_scc1 Llatesig
Llatesig_bk:
    v_mfma_f32_16x16x32_bf16 v[152:155], v[104:107], v[68:71], v[152:155]
    ds_read_b128 v[232:235], v3 offset:4096
    v_cvt_pk_bf16_f32 v77, v82, v83
    v_mfma_f32_16x16x32_bf16 v[156:159], v[108:111], v[68:71], v[156:159]
    v_exp_f32 v85, v45
    v_mfma_f32_16x16x32_bf16 v[148:151], v[108:111], v[64:67], v[148:151]
    ds_read_b128 v[236:239], v3 offset:6144
    v_mfma_f32_16x16x32_bf16 v[160:163], v[112:115], v[64:67], v[160:163]
    v_exp_f32 v86, v46
    v_mfma_f32_16x16x32_bf16 v[168:171], v[112:115], v[68:71], v[168:171]
    ds_read_b128 v[240:243], v3 offset:256
    v_cvt_pk_bf16_f32 v78, v84, v85
    v_mfma_f32_16x16x32_bf16 v[172:175], v[116:119], v[68:71], v[172:175]
    v_exp_f32 v87, v47
    v_mfma_f32_16x16x32_bf16 v[164:167], v[116:119], v[64:67], v[164:167]
    ds_read_b128 v[244:247], v3 offset:2304
    v_or3_b32 v94, v94, v77, v78
    v_mfma_f32_16x16x32_bf16 v[176:179], v[120:123], v[64:67], v[176:179]
    ds_read_b128 v[248:251], v3 offset:4352
    v_cvt_pk_bf16_f32 v79, v86, v87
    v_mfma_f32_16x16x32_bf16 v[184:187], v[120:123], v[68:71], v[184:187]
    v_bitop3_b32 v94, v94, v79, s38 bitop3:0xa8
    v_cmp_ne_u32 vcc, 0, v94
    v_mfma_f32_16x16x32_bf16 v[188:191], v[124:127], v[68:71], v[188:191]
    s_waitcnt lgkmcnt(5)
    v_mfma_f32_16x16x32_bf16 v[180:183], v[124:127], v[64:67], v[180:183]
    s_cbranch_vccnz Lfb_40
Lbk_41:
    ds_read_b128 v[252:255], v3 offset:6400
Lxloop2:
    v_mfma_f32_16x16x32_bf16 v[32:35], v[224:227], v[192:195], v[48:51]
    v_exp_f32 v80, v16
    v_mfma_f32_16x16x32_bf16 v[32:35], v[228:231], v[200:203], v[32:35]
    s_waitcnt lgkmcnt(4)
    v_exp_f32 v81, v17
    v_mfma_f32_16x16x32_bf16 v[32:35], v[232:235], v[208:211], v[32:35]
    v_exp_f32 v82, v18
    v_mfma_f32_16x16x32_bf16 v[32:35], v[236:239], v[216:219], v[32:35]
    ds_read_b128 v[96:99], v3 offset:16384
    v_cvt_pk_bf16_f32 v64, v80, v81
    v_mfma_f32_16x16x32_bf16 v[40:43], v[236:239], v[220:223], v[52:55]
    v_exp_f32 v83, v19
    v_mfma_f32_16x16x32_bf16 v[40:43], v[232:235], v[212:215], v[40:43]
    ds_read_b128 v[100:103], v3 offset:16640
    v_mfma_f32_16x16x32_bf16 v[40:43], v[228:231], v[204:207], v[40:43]
    v_exp_f32 v84, v20
    v_mfma_f32_16x16x32_bf16 v[40:43], v[224:227], v[196:199], v[40:43]
    s_waitcnt lgkmcnt(4)
    ds_read_b128 v[104:107], v3 offset:18432
    v_cvt_pk_bf16_f32 v65, v82, v83
    v_mfma_f32_16x16x32_bf16 v[44:47], v[240:243], v[196:199], v[52:55]
    v_exp_f32 v85, v21
    v_mfma_f32_16x16x32_bf16 v[44:47], v[244:247], v[204:207], v[44:47]
    s_waitcnt lgkmcnt(3)
    ds_read_b128 v[108:111], v3 offset:18688
    v_mfma_f32_16x16x32_bf16 v[44:47], v[248:251], v[212:215], v[44:47]
    v_exp_f32 v86, v22
    v_mfma_f32_16x16x32_bf16 v[44:47], v[252:255], v[220:223], v[44:47]
    ds_read_b128 v[112:115], v3 offset:20480
    v_cvt_pk_bf16_f32 v66, v84, v85
    v_mfma_f32_16x16x32_bf16 v[36:39], v[252:255], v[216:219], v[48:51]
    v_exp_f32 v87, v23
    v_mfma_f32_16x16x32_bf16 v[36:39], v[248:251], v[208:211], v[36:39]
    ds_read_b128 v[116:119], v3 offset:20736
    v_or3_b32 v94, v64, v65, v66
    v_mfma_f32_16x16x32_bf16 v[36:39], v[244:247], v[200:203], v[36:39]
    v_exp_f32 v80, v24
    v_mfma_f32_16x16x32_bf16 v[36:39], v[240:243], v[192:195], v[36:39]
    ds_read_b128 v[120:123], v3 offset:22528
    v_cvt_pk_bf16_f32 v67, v86, v87
    v_mfma_f32_16x16x32_bf16 v[60:63], v[88:91], v[76:79], v[60:63]
    s_add_u32 s30, s30, 0x8000
    v_exp_f32 v81, v25
    v_mfma_f32_16x16x32_bf16 v[56:59], v[88:91], v[72:75], v[56:59]
    s_waitcnt lgkmcnt(5)
    ds_read_b128 v[124:127], v3 offset:22784
    v_mfma_f32_16x16x32_bf16 v[128:131], v[96:99], v[72:75], v[128:131]
    s_cmp_eq_u32 s30, 163840
    v_exp_f32 v82, v26
    s_cselect_b32 s30, 0, s30
    v_mfma_f32_16x16x32_bf16 v[136:139], v[96:99], v[76:79], v[136:139]
    ds_read_b128 v[224:227], v3 offset:8192
    v_cvt_pk_bf16_f32 v68, v80, v81
    v_mfma_f32_16x16x32_bf16 v[140:143], v[100:103], v[76:79], v[140:143]
    v_exp_f32 v83, v27
    v_mfma_f32_16x16x32_bf16 v[132:135], v[100:103], v[72:75], v[132:135]
    s_waitcnt lgkmcnt(5)
    ds_read_b128 v[228:231], v3 offset:10240
    v_or3_b32 v94, v94, v67, v68
    v_mfma_f32_16x16x32_bf16 v[144:147], v[104:107], v[72:75], v[144:147]
    v_exp_f32 v84, v28
    v_mfma_f32_16x16x32_bf16 v[152:155], v[104:107], v[76:79], v[152:155]
    ds_read_b128 v[232:235], v3 offset:12288
    v_cvt_pk_bf16_f32 v69, v82, v83
    v_mfma_f32_16x16x32_bf16 v[156:159], v[108:111], v[76:79], v[156:159]
    v_exp_f32 v85, v29
    v_mfma_f32_16x16x32_bf16 v[148:151], v[108:111], v[72:75], v[148:151]
    s_waitcnt lgkmcnt(5)
    ds_read_b128 v[236:239], v3 offset:14336
    v_mfma_f32_16x16x32_bf16 v[160:163], v[112:115], v[72:75], v[160:163]
    v_exp_f32 v86, v30
    v_mfma_f32_16x16x32_bf16 v[168:171], v[112:115], v[76:79], v[168:171]
    ds_read_b128 v[240:243], v3 offset:8448
    v_cvt_pk_bf16_f32 v70, v84, v85
    v_mfma_f32_16x16x32_bf16 v[172:175], v[116:119], v[76:79], v[172:175]
    v_exp_f32 v87, v31
    v_mfma_f32_16x16x32_bf16 v[164:167], v[116:119], v[72:75], v[164:167]
    s_waitcnt lgkmcnt(5)
    ds_read_b128 v[244:247], v3 offset:10496
    v_or3_b32 v94, v94, v69, v70
    v_mfma_f32_16x16x32_bf16 v[176:179], v[120:123], v[72:75], v[176:179]
    ds_read_b128 v[248:251], v3 offset:12544
    v_cvt_pk_bf16_f32 v71, v86, v87
    v_mfma_f32_16x16x32_bf16 v[184:187], v[120:123], v[76:79], v[184:187]
    v_bitop3_b32 v94, v94, v71, s38 bitop3:0xa8
    v_cmp_ne_u32 vcc, 0, v94
    v_mfma_f32_16x16x32_bf16 v[188:191], v[124:127], v[76:79], v[188:191]
    s_waitcnt lgkmcnt(5)
    v_mfma_f32_16x16x32_bf16 v[180:183], v[124:127], v[72:75], v[180:183]
    s_cbranch_vccnz Lfb_42
Lbk_43:
    ds_read_b128 v[252:255], v3 offset:14592
    v_mfma_f32_16x16x32_bf16 v[16:19], v[224:227], v[192:195], v[48:51]
    v_exp_f32 v80, v32
    v_mfma_f32_16x16x32_bf16 v[16:19], v[228:231], v[200:203], v[16:19]
    s_waitcnt lgkmcnt(4)
    v_exp_f32 v81, v33
    v_mfma_f32_16x16x32_bf16 v[16:19], v[232:235], v[208:211], v[16:19]
    v_exp_f32 v82, v34
    v_mfma_f32_16x16x32_bf16 v[16:19], v[236:239], v[216:219], v[16:19]
    ds_read_b128 v[96:99], v3 offset:24576
    v_cvt_pk_bf16_f32 v72, v80, v81
    v_mfma_f32_16x16x32_bf16 v[24:27], v[236:239], v[220:223], v[52:55]
    v_exp_f32 v83, v35
    v_mfma_f32_16x16x32_bf16 v[24:27], v[232:235], v[212:215], v[24:27]
    ds_read_b128 v[100:103], v3 offset:24832
    v_mfma_f32_16x16x32_bf16 v[24:27], v[228:231], v[204:207], v[24:27]
    v_exp_f32 v84, v36
    v_mfma_f32_16x16x32_bf16 v[24:27], v[224:227], v[196:199], v[24:27]
    s_waitcnt lgkmcnt(4)
    ds_read_b128 v[104:107], v3 offset:26624
    v_cvt_pk_bf16_f32 v73, v82, v83
    v_mfma_f32_16x16x32_bf16 v[28:31], v[240:243], v[196:199], v[52:55]
    v_exp_f32 v85, v37
    v_mfma_f32_16x16x32_bf16 v[28:31], v[244:247], v[204:207], v[28:31]
    s_waitcnt lgkmcnt(3)
    ds_read_b128 v[108:111], v3 offset:26880
    v_mfma_f32_16x16x32_bf16 v[28:31], v[248:251], v[212:215], v[28:31]
    v_exp_f32 v86, v38
    v_mfma_f32_16x16x32_bf16 v[28:31], v[252:255], v[220:223], v[28:31]
    ds_read_b128 v[112:115], v3 offset:28672
    v_cvt_pk_bf16_f32 v74, v84, v85
    v_mfma_f32_16x16x32_bf16 v[20:23], v[252:255], v[216:219], v[48:51]
    v_exp_f32 v87, v39
    v_mfma_f32_16x16x32_bf16 v[20:23], v[248:251], v[208:211], v[20:23]
    ds_read_b128 v[116:119], v3 offset:28928
    v_or3_b32 v94, v72, v73, v74
    v_mfma_f32_16x16x32_bf16 v[20:23], v[244:247], v[200:203], v[20:23]
    v_exp_f32 v80, v40
    v_mfma_f32_16x16x32_bf16 v[20:23], v[240:243], v[192:195], v[20:23]
    ds_read_b128 v[120:123], v3 offset:30720
    v_cvt_pk_bf16_f32 v75, v86, v87
    v_mfma_f32_16x16x32_bf16 v[60:63], v[88:91], v[68:71], v[60:63]
    v_exp_f32 v81, v41
    v_mfma_f32_16x16x32_bf16 v[56:59], v[88:91], v[64:67], v[56:59]
    s_waitcnt lgkmcnt(5)
    ds_read_b128 v[124:127], v3 offset:30976
    v_add_u32 v3, s30, v93
    v_mfma_f32_16x16x32_bf16 v[128:131], v[96:99], v[64:67], v[128:131]
    v_exp_f32 v82, v42
    v_mfma_f32_16x16x32_bf16 v[136:139], v[96:99], v[68:71], v[136:139]
    ds_read_b128 v[224:227], v3 offset:0
    v_cvt_pk_bf16_f32 v76, v80, v81
    v_mfma_f32_16x16x32_bf16 v[140:143], v[100:103], v[68:71], v[140:143]
    v_exp_f32 v83, v43
    v_mfma_f32_16x16x32_bf16 v[132:135], v[100:103], v[64:67], v[132:135]
    s_waitcnt lgkmcnt(5)
    ds_read_b128 v[228:231], v3 offset:2048
    v_or3_b32 v94, v94, v75, v76
    v_mfma_f32_16x16x32_bf16 v[144:147], v[104:107], v[64:67], v[144:147]
    v_exp_f32 v84, v44
    v_mfma_f32_16x16x32_bf16 v[152:155], v[104:107], v[68:71], v[152:155]
    ds_read_b128 v[232:235], v3 offset:4096
    v_cvt_pk_bf16_f32 v77, v82, v83
    v_mfma_f32_16x16x32_bf16 v[156:159], v[108:111], v[68:71], v[156:159]
    v_exp_f32 v85, v45
    v_mfma_f32_16x16x32_bf16 v[148:151], v[108:111], v[64:67], v[148:151]
    s_waitcnt lgkmcnt(5)
    ds_read_b128 v[236:239], v3 offset:6144
    v_mfma_f32_16x16x32_bf16 v[160:163], v[112:115], v[64:67], v[160:163]
    v_exp_f32 v86, v46
    v_mfma_f32_16x16x32_bf16 v[168:171], v[112:115], v[68:71], v[168:171]
    ds_read_b128 v[240:243], v3 offset:256
    v_cvt_pk_bf16_f32 v78, v84, v85
    v_mfma_f32_16x16x32_bf16 v[172:175], v[116:119], v[68:71], v[172:175]
    v_exp_f32 v87, v47
    v_mfma_f32_16x16x32_bf16 v[164:167], v[116:119], v[64:67], v[164:167]
    s_waitcnt lgkmcnt(5)
    ds_read_b128 v[244:247], v3 offset:2304
    v_or3_b32 v94, v94, v77, v78
    v_mfma_f32_16x16x32_bf16 v[176:179], v[120:123], v[64:67], v[176:179]
    ds_read_b128 v[248:251], v3 offset:4352
    v_cvt_pk_bf16_f32 v79, v86, v87
    v_mfma_f32_16x16x32_bf16 v[184:187], v[120:123], v[68:71], v[184:187]
    v_bitop3_b32 v94, v94, v79, s38 bitop3:0xa8
    v_cmp_ne_u32 vcc, 0, v94
    v_mfma_f32_16x16x32_bf16 v[188:191], v[124:127], v[68:71], v[188:191]
    s_waitcnt lgkmcnt(5)
    v_mfma_f32_16x16x32_bf16 v[180:183], v[124:127], v[64:67], v[180:183]
    s_cbranch_vccnz Lfb_44
Lbk_45:
    ds_read_b128 v[252:255], v3 offset:6400
    v_mfma_f32_16x16x32_bf16 v[32:35], v[224:227], v[192:195], v[48:51]
    v_exp_f32 v80, v16
    v_mfma_f32_16x16x32_bf16 v[32:35], v[228:231], v[200:203], v[32:35]
    s_waitcnt lgkmcnt(4)
    v_exp_f32 v81, v17
    v_mfma_f32_16x16x32_bf16 v[32:35], v[232:235], v[208:211], v[32:35]
    v_exp_f32 v82, v18
    v_mfma_f32_16x16x32_bf16 v[32:35], v[236:239], v[216:219], v[32:35]
    ds_read_b128 v[96:99], v3 offset:16384
    v_cvt_pk_bf16_f32 v64, v80, v81
    v_mfma_f32_16x16x32_bf16 v[40:43], v[236:239], v[220:223], v[52:55]
    v_exp_f32 v83, v19
    v_mfma_f32_16x16x32_bf16 v[40:43], v[232:235], v[212:215], v[40:43]
    ds_read_b128 v[100:103], v3 offset:16640
    v_mfma_f32_16x16x32_bf16 v[40:43], v[228:231], v[204:207], v[40:43]
    s_add_u32 s35, s35, 1
    v_exp_f32 v84, v20
    v_mfma_f32_16x16x32_bf16 v[40:43], v[224:227], v[196:199], v[40:43]
    s_waitcnt lgkmcnt(4)
    ds_read_b128 v[104:107], v3 offset:18432
    v_cvt_pk_bf16_f32 v65, v82, v83
    v_mfma_f32_16x16x32_bf16 v[44:47], v[240:243], v[196:199], v[52:55]
    v_exp_f32 v85, v21
    v_mfma_f32_16x16x32_bf16 v[44:47], v[244:247], v[204:207], v[44:47]
    s_waitcnt lgkmcnt(3)
    ds_read_b128 v[108:111], v3 offset:18688
    v_mfma_f32_16x16x32_bf16 v[44:47], v[248:251], v[212:215], v[44:47]
    v_exp_f32 v86, v22
    v_mfma_f32_16x16x32_bf16 v[44:47], v[252:255], v[220:223], v[44:47]
    ds_read_b128 v[112:115], v3 offset:20480
    v_cvt_pk_bf16_f32 v66, v84, v85
    v_mfma_f32_16x16x32_bf16 v[36:39], v[252:255], v[216:219], v[48:51]
    v_exp_f32 v87, v23
    v_mfma_f32_16x16x32_bf16 v[36:39], v[248:251], v[208:211], v[36:39]
    ds_read_b128 v[116:119], v3 offset:20736
    v_or3_b32 v94, v64, v65, v66
    v_mfma_f32_16x16x32_bf16 v[36:39], v[244:247], v[200:203], v[36:39]
    v_exp_f32 v80, v24
    v_mfma_f32_16x16x32_bf16 v[36:39], v[240:243], v[192:195], v[36:39]
    ds_read_b128 v[120:123], v3 offset:22528
    v_cvt_pk_bf16_f32 v67, v86, v87
    v_mfma_f32_16x16x32_bf16 v[60:63], v[88:91], v[76:79], v[60:63]
    s_add_u32 s30, s30, 0x8000
    v_exp_f32 v81, v25
    v_mfma_f32_16x16x32_bf16 v[56:59], v[88:91], v[72:75], v[56:59]
    s_waitcnt lgkmcnt(5)
    ds_read_b128 v[124:127], v3 offset:22784
    v_mfma_f32_16x16x32_bf16 v[128:131], v[96:99], v[72:75], v[128:131]
    s_cmp_eq_u32 s30, 163840
    v_exp_f32 v82, v26
    s_cselect_b32 s30, 0, s30
    v_mfma_f32_16x16x32_bf16 v[136:139], v[96:99], v[76:79], v[136:139]
    ds_read_b128 v[224:227], v3 offset:8192
    v_cvt_pk_bf16_f32 v68, v80, v81
    v_mfma_f32_16x16x32_bf16 v[140:143], v[100:103], v[76:79], v[140:143]
    v_exp_f32 v83, v27
    v_mfma_f32_16x16x32_bf16 v[132:135], v[100:103], v[72:75], v[132:135]
    s_waitcnt lgkmcnt(5)
    ds_read_b128 v[228:231], v3 offset:10240
    v_or3_b32 v94, v94, v67, v68
    v_mfma_f32_16x16x32_bf16 v[144:147], v[104:107], v[72:75], v[144:147]
    v_exp_f32 v84, v28
    v_mfma_f32_16x16x32_bf16 v[152:155], v[104:107], v[76:79], v[152:155]
    ds_read_b128 v[232:235], v3 offset:12288
    v_cvt_pk_bf16_f32 v69, v82, v83
    v_mfma_f32_16x16x32_bf16 v[156:159], v[108:111], v[76:79], v[156:159]
    v_exp_f32 v85, v29
    v_mfma_f32_16x16x32_bf16 v[148:151], v[108:111], v[72:75], v[148:151]
    s_waitcnt lgkmcnt(5)
    ds_read_b128 v[236:239], v3 offset:14336
    v_mfma_f32_16x16x32_bf16 v[160:163], v[112:115], v[72:75], v[160:163]
    v_exp_f32 v86, v30
    v_mfma_f32_16x16x32_bf16 v[168:171], v[112:115], v[76:79], v[168:171]
    ds_read_b128 v[240:243], v3 offset:8448
    v_cvt_pk_bf16_f32 v70, v84, v85
    v_mfma_f32_16x16x32_bf16 v[172:175], v[116:119], v[76:79], v[172:175]
    v_exp_f32 v87, v31
    v_mfma_f32_16x16x32_bf16 v[164:167], v[116:119], v[72:75], v[164:167]
    s_waitcnt lgkmcnt(5)
    ds_read_b128 v[244:247], v3 offset:10496
    v_or3_b32 v94, v94, v69, v70
    v_mfma_f32_16x16x32_bf16 v[176:179], v[120:123], v[72:75], v[176:179]
    ds_read_b128 v[248:251], v3 offset:12544
    v_cvt_pk_bf16_f32 v71, v86, v87
    v_mfma_f32_16x16x32_bf16 v[184:187], v[120:123], v[76:79], v[184:187]
    v_bitop3_b32 v94, v94, v71, s38 bitop3:0xa8
    v_cmp_ne_u32 vcc, 0, v94
    v_mfma_f32_16x16x32_bf16 v[188:191], v[124:127], v[76:79], v[188:191]
    s_waitcnt lgkmcnt(5)
    v_mfma_f32_16x16x32_bf16 v[180:183], v[124:127], v[72:75], v[180:183]
    s_cbranch_vccnz Lfb_46
Lbk_47:
    ds_read_b128 v[252:255], v3 offset:14592
    v_mfma_f32_16x16x32_bf16 v[16:19], v[224:227], v[192:195], v[48:51]
    v_exp_f32 v80, v32
    v_mfma_f32_16x16x32_bf16 v[16:19], v[228:231], v[200:203], v[16:19]
    s_waitcnt lgkmcnt(4)
    v_exp_f32 v81, v33
    v_mfma_f32_16x16x32_bf16 v[16:19], v[232:235], v[208:211], v[16:19]
    v_exp_f32 v82, v34
    v_mfma_f32_16x16x32_bf16 v[16:19], v[236:239], v[216:219], v[16:19]
    ds_read_b128 v[96:99], v3 offset:24576
    v_cvt_pk_bf16_f32 v72, v80, v81
    v_mfma_f32_16x16x32_bf16 v[24:27], v[236:239], v[220:223], v[52:55]
    v_exp_f32 v83, v35
    v_mfma_f32_16x16x32_bf16 v[24:27], v[232:235], v[212:215], v[24:27]
    ds_read_b128 v[100:103], v3 offset:24832
    v_mfma_f32_16x16x32_bf16 v[24:27], v[228:231], v[204:207], v[24:27]
    v_exp_f32 v84, v36
    v_mfma_f32_16x16x32_bf16 v[24:27], v[224:227], v[196:199], v[24:27]
    s_waitcnt lgkmcnt(4)
    ds_read_b128 v[104:107], v3 offset:26624
    v_cvt_pk_bf16_f32 v73, v82, v83
    v_mfma_f32_16x16x32_bf16 v[28:31], v[240:243], v[196:199], v[52:55]
    v_exp_f32 v85, v37
    v_mfma_f32_16x16x32_bf16 v[28:31], v[244:247], v[204:207], v[28:31]
    s_waitcnt lgkmcnt(3)
    ds_read_b128 v[108:111], v3 offset:26880
    v_mfma_f32_16x16x32_bf16 v[28:31], v[248:251], v[212:215], v[28:31]
    v_exp_f32 v86, v38
    v_mfma_f32_16x16x32_bf16 v[28:31], v[252:255], v[220:223], v[28:31]
    ds_read_b128 v[112:115], v3 offset:28672
    ds_read_b128 v[116:119], v3 offset:28928
    v_cvt_pk_bf16_f32 v74, v84, v85
    v_mfma_f32_16x16x32_bf16 v[20:23], v[252:255], v[216:219], v[48:51]
    v_exp_f32 v87, v39
    v_mfma_f32_16x16x32_bf16 v[20:23], v[248:251], v[208:211], v[20:23]
    ds_read_b128 v[120:123], v3 offset:30720
    ds_read_b128 v[124:127], v3 offset:30976
    v_or3_b32 v94, v72, v73, v74
    v_mfma_f32_16x16x32_bf16 v[20:23], v[244:247], v[200:203], v[20:23]
    v_exp_f32 v80, v40
    v_mfma_f32_16x16x32_bf16 v[20:23], v[240:243], v[192:195], v[20:23]
    v_cvt_pk_bf16_f32 v75, v86, v87
    v_mfma_f32_16x16x32_bf16 v[60:63], v[88:91], v[68:71], v[60:63]
    v_exp_f32 v81, v41
    v_mfma_f32_16x16x32_bf16 v[56:59], v[88:91], v[64:67], v[56:59]
    s_waitcnt  lgkmcnt(0)
    v_add_u32 v3, s30, v93
    v_mfma_f32_16x16x32_bf16 v[128:131], v[96:99], v[64:67], v[128:131]
    s_barrier
    v_exp_f32 v82, v42
    v_mfma_f32_16x16x32_bf16 v[136:139], v[96:99], v[68:71], v[136:139]
    ds_read_b128 v[224:227], v3 offset:0
    v_cvt_pk_bf16_f32 v76, v80, v81
    v_mfma_f32_16x16x32_bf16 v[140:143], v[100:103], v[68:71], v[140:143]
    v_exp_f32 v83, v43
    v_mfma_f32_16x16x32_bf16 v[132:135], v[100:103], v[64:67], v[132:135]
    ds_read_b128 v[228:231], v3 offset:2048
    v_or3_b32 v94, v94, v75, v76
    v_mfma_f32_16x16x32_bf16 v[144:147], v[104:107], v[64:67], v[144:147]
    v_exp_f32 v84, v44
    v_mfma_f32_16x16x32_bf16 v[152:155], v[104:107], v[68:71], v[152:155]
    ds_read_b128 v[232:235], v3 offset:4096
    v_cvt_pk_bf16_f32 v77, v82, v83
    v_mfma_f32_16x16x32_bf16 v[156:159], v[108:111], v[68:71], v[156:159]
    v_exp_f32 v85, v45
    v_mfma_f32_16x16x32_bf16 v[148:151], v[108:111], v[64:67], v[148:151]
    ds_read_b128 v[236:239], v3 offset:6144
    v_mfma_f32_16x16x32_bf16 v[160:163], v[112:115], v[64:67], v[160:163]
    v_exp_f32 v86, v46
    v_mfma_f32_16x16x32_bf16 v[168:171], v[112:115], v[68:71], v[168:171]
    ds_read_b128 v[240:243], v3 offset:256
    v_cvt_pk_bf16_f32 v78, v84, v85
    v_mfma_f32_16x16x32_bf16 v[172:175], v[116:119], v[68:71], v[172:175]
    s_cmp_ge_u32 s35, s36
    v_exp_f32 v87, v47
    v_mfma_f32_16x16x32_bf16 v[164:167], v[116:119], v[64:67], v[164:167]
    ds_read_b128 v[244:247], v3 offset:2304
    v_or3_b32 v94, v94, v77, v78
    v_mfma_f32_16x16x32_bf16 v[176:179], v[120:123], v[64:67], v[176:179]
    ds_read_b128 v[248:251], v3 offset:4352
    v_cvt_pk_bf16_f32 v79, v86, v87
    v_mfma_f32_16x16x32_bf16 v[184:187], v[120:123], v[68:71], v[184:187]
    v_bitop3_b32 v94, v94, v79, s38 bitop3:0xa8
    v_cmp_ne_u32 vcc, 0, v94
    v_mfma_f32_16x16x32_bf16 v[188:191], v[124:127], v[68:71], v[188:191]
    s_waitcnt lgkmcnt(5)
    v_mfma_f32_16x16x32_bf16 v[180:183], v[124:127], v[64:67], v[180:183]
    s_cbranch_vccnz Lfb_48
Lbk_49:
    ds_read_b128 v[252:255], v3 offset:6400
    s_cbranch_scc1 Ltail
    v_mfma_f32_16x16x32_bf16 v[32:35], v[224:227], v[192:195], v[48:51]
    v_exp_f32 v80, v16
    v_mfma_f32_16x16x32_bf16 v[32:35], v[228:231], v[200:203], v[32:35]
    s_waitcnt lgkmcnt(4)
    v_exp_f32 v81, v17
    v_mfma_f32_16x16x32_bf16 v[32:35], v[232:235], v[208:211], v[32:35]
    v_exp_f32 v82, v18
    v_mfma_f32_16x16x32_bf16 v[32:35], v[236:239], v[216:219], v[32:35]
    ds_read_b128 v[96:99], v3 offset:16384
    v_cvt_pk_bf16_f32 v64, v80, v81
    v_mfma_f32_16x16x32_bf16 v[40:43], v[236:239], v[220:223], v[52:55]
    v_exp_f32 v83, v19
    v_mfma_f32_16x16x32_bf16 v[40:43], v[232:235], v[212:215], v[40:43]
    ds_read_b128 v[100:103], v3 offset:16640
    v_mfma_f32_16x16x32_bf16 v[40:43], v[228:231], v[204:207], v[40:43]
    v_exp_f32 v84, v20
    v_mfma_f32_16x16x32_bf16 v[40:43], v[224:227], v[196:199], v[40:43]
    s_waitcnt lgkmcnt(4)
    ds_read_b128 v[104:107], v3 offset:18432
    v_cvt_pk_bf16_f32 v65, v82, v83
    v_mfma_f32_16x16x32_bf16 v[44:47], v[240:243], v[196:199], v[52:55]
    v_exp_f32 v85, v21
    v_mfma_f32_16x16x32_bf16 v[44:47], v[244:247], v[204:207], v[44:47]
    s_waitcnt lgkmcnt(3)
    ds_read_b128 v[108:111], v3 offset:18688
    v_mfma_f32_16x16x32_bf16 v[44:47], v[248:251], v[212:215], v[44:47]
    v_exp_f32 v86, v22
    v_mfma_f32_16x16x32_bf16 v[44:47], v[252:255], v[220:223], v[44:47]
    ds_read_b128 v[112:115], v3 offset:20480
    v_cvt_pk_bf16_f32 v66, v84, v85
    v_mfma_f32_16x16x32_bf16 v[36:39], v[252:255], v[216:219], v[48:51]
    v_exp_f32 v87, v23
    v_mfma_f32_16x16x32_bf16 v[36:39], v[248:251], v[208:211], v[36:39]
    ds_read_b128 v[116:119], v3 offset:20736
    v_or3_b32 v94, v64, v65, v66
    v_mfma_f32_16x16x32_bf16 v[36:39], v[244:247], v[200:203], v[36:39]
    v_exp_f32 v80, v24
    v_mfma_f32_16x16x32_bf16 v[36:39], v[240:243], v[192:195], v[36:39]
    ds_read_b128 v[120:123], v3 offset:22528
    v_cvt_pk_bf16_f32 v67, v86, v87
    v_mfma_f32_16x16x32_bf16 v[60:63], v[88:91], v[76:79], v[60:63]
    s_add_u32 s30, s30, 0x8000
    v_exp_f32 v81, v25
    v_mfma_f32_16x16x32_bf16 v[56:59], v[88:91], v[72:75], v[56:59]
    s_waitcnt lgkmcnt(5)
    ds_read_b128 v[124:127], v3 offset:22784
    v_mfma_f32_16x16x32_bf16 v[128:131], v[96:99], v[72:75], v[128:131]
    s_cmp_eq_u32 s30, 163840
    v_exp_f32 v82, v26
    s_cselect_b32 s30, 0, s30
    v_mfma_f32_16x16x32_bf16 v[136:139], v[96:99], v[76:79], v[136:139]
    ds_read_b128 v[224:227], v3 offset:8192
    v_cvt_pk_bf16_f32 v68, v80, v81
    v_mfma_f32_16x16x32_bf16 v[140:143], v[100:103], v[76:79], v[140:143]
    v_exp_f32 v83, v27
    v_mfma_f32_16x16x32_bf16 v[132:135], v[100:103], v[72:75], v[132:135]
    s_waitcnt lgkmcnt(5)
    ds_read_b128 v[228:231], v3 offset:10240
    v_or3_b32 v94, v94, v67, v68
    v_mfma_f32_16x16x32_bf16 v[144:147], v[104:107], v[72:75], v[144:147]
    v_exp_f32 v84, v28
    v_mfma_f32_16x16x32_bf16 v[152:155], v[104:107], v[76:79], v[152:155]
    ds_read_b128 v[232:235], v3 offset:12288
    v_cvt_pk_bf16_f32 v69, v82, v83
    v_mfma_f32_16x16x32_bf16 v[156:159], v[108:111], v[76:79], v[156:159]
    v_exp_f32 v85, v29
    v_mfma_f32_16x16x32_bf16 v[148:151], v[108:111], v[72:75], v[148:151]
    s_waitcnt lgkmcnt(5)
    ds_read_b128 v[236:239], v3 offset:14336
    v_mfma_f32_16x16x32_bf16 v[160:163], v[112:115], v[72:75], v[160:163]
    v_exp_f32 v86, v30
    v_mfma_f32_16x16x32_bf16 v[168:171], v[112:115], v[76:79], v[168:171]
    ds_read_b128 v[240:243], v3 offset:8448
    v_cvt_pk_bf16_f32 v70, v84, v85
    v_mfma_f32_16x16x32_bf16 v[172:175], v[116:119], v[76:79], v[172:175]
    v_exp_f32 v87, v31
    v_mfma_f32_16x16x32_bf16 v[164:167], v[116:119], v[72:75], v[164:167]
    s_waitcnt lgkmcnt(5)
    ds_read_b128 v[244:247], v3 offset:10496
    v_or3_b32 v94, v94, v69, v70
    v_mfma_f32_16x16x32_bf16 v[176:179], v[120:123], v[72:75], v[176:179]
    ds_read_b128 v[248:251], v3 offset:12544
    v_cvt_pk_bf16_f32 v71, v86, v87
    v_mfma_f32_16x16x32_bf16 v[184:187], v[120:123], v[76:79], v[184:187]
    v_bitop3_b32 v94, v94, v71, s38 bitop3:0xa8
    v_cmp_ne_u32 vcc, 0, v94
    v_mfma_f32_16x16x32_bf16 v[188:191], v[124:127], v[76:79], v[188:191]
    s_waitcnt lgkmcnt(5)
    v_mfma_f32_16x16x32_bf16 v[180:183], v[124:127], v[72:75], v[180:183]
    s_cbranch_vccnz Lfb_50
Lbk_51:
    ds_read_b128 v[252:255], v3 offset:14592
    v_mfma_f32_16x16x32_bf16 v[16:19], v[224:227], v[192:195], v[48:51]
    v_exp_f32 v80, v32
    v_mfma_f32_16x16x32_bf16 v[16:19], v[228:231], v[200:203], v[16:19]
    s_waitcnt lgkmcnt(4)
    v_exp_f32 v81, v33
    v_mfma_f32_16x16x32_bf16 v[16:19], v[232:235], v[208:211], v[16:19]
    v_exp_f32 v82, v34
    v_mfma_f32_16x16x32_bf16 v[16:19], v[236:239], v[216:219], v[16:19]
    ds_read_b128 v[96:99], v3 offset:24576
    v_cvt_pk_bf16_f32 v72, v80, v81
    v_mfma_f32_16x16x32_bf16 v[24:27], v[236:239], v[220:223], v[52:55]
    v_exp_f32 v83, v35
    v_mfma_f32_16x16x32_bf16 v[24:27], v[232:235], v[212:215], v[24:27]
    ds_read_b128 v[100:103], v3 offset:24832
    v_mfma_f32_16x16x32_bf16 v[24:27], v[228:231], v[204:207], v[24:27]
    v_exp_f32 v84, v36
    v_mfma_f32_16x16x32_bf16 v[24:27], v[224:227], v[196:199], v[24:27]
    s_waitcnt lgkmcnt(4)
    ds_read_b128 v[104:107], v3 offset:26624
    v_cvt_pk_bf16_f32 v73, v82, v83
    v_mfma_f32_16x16x32_bf16 v[28:31], v[240:243], v[196:199], v[52:55]
    v_exp_f32 v85, v37
    v_mfma_f32_16x16x32_bf16 v[28:31], v[244:247], v[204:207], v[28:31]
    s_waitcnt lgkmcnt(3)
    ds_read_b128 v[108:111], v3 offset:26880
    v_mfma_f32_16x16x32_bf16 v[28:31], v[248:251], v[212:215], v[28:31]
    v_exp_f32 v86, v38
    v_mfma_f32_16x16x32_bf16 v[28:31], v[252:255], v[220:223], v[28:31]
    ds_read_b128 v[112:115], v3 offset:28672
    v_cvt_pk_bf16_f32 v74, v84, v85
    v_mfma_f32_16x16x32_bf16 v[20:23], v[252:255], v[216:219], v[48:51]
    v_exp_f32 v87, v39
    v_mfma_f32_16x16x32_bf16 v[20:23], v[248:251], v[208:211], v[20:23]
    ds_read_b128 v[116:119], v3 offset:28928
    v_or3_b32 v94, v72, v73, v74
    v_mfma_f32_16x16x32_bf16 v[20:23], v[244:247], v[200:203], v[20:23]
    v_exp_f32 v80, v40
    v_mfma_f32_16x16x32_bf16 v[20:23], v[240:243], v[192:195], v[20:23]
    ds_read_b128 v[120:123], v3 offset:30720
    v_cvt_pk_bf16_f32 v75, v86, v87
    v_mfma_f32_16x16x32_bf16 v[60:63], v[88:91], v[68:71], v[60:63]
    v_exp_f32 v81, v41
    v_mfma_f32_16x16x32_bf16 v[56:59], v[88:91], v[64:67], v[56:59]
    s_waitcnt lgkmcnt(5)
    ds_read_b128 v[124:127], v3 offset:30976
    v_add_u32 v3, s30, v93
    v_mfma_f32_16x16x32_bf16 v[128:131], v[96:99], v[64:67], v[128:131]
    v_exp_f32 v82, v42
    v_mfma_f32_16x16x32_bf16 v[136:139], v[96:99], v[68:71], v[136:139]
    ds_read_b128 v[224:227], v3 offset:0
    v_cvt_pk_bf16_f32 v76, v80, v81
    v_mfma_f32_16x16x32_bf16 v[140:143], v[100:103], v[68:71], v[140:143]
    v_exp_f32 v83, v43
    v_mfma_f32_16x16x32_bf16 v[132:135], v[100:103], v[64:67], v[132:135]
    s_waitcnt lgkmcnt(5)
    ds_read_b128 v[228:231], v3 offset:2048
    v_or3_b32 v94, v94, v75, v76
    v_mfma_f32_16x16x32_bf16 v[144:147], v[104:107], v[64:67], v[144:147]
    v_exp_f32 v84, v44
    v_mfma_f32_16x16x32_bf16 v[152:155], v[104:107], v[68:71], v[152:155]
    ds_read_b128 v[232:235], v3 offset:4096
    v_cvt_pk_bf16_f32 v77, v82, v83
    v_mfma_f32_16x16x32_bf16 v[156:159], v[108:111], v[68:71], v[156:159]
    v_exp_f32 v85, v45
    v_mfma_f32_16x16x32_bf16 v[148:151], v[108:111], v[64:67], v[148:151]
    s_waitcnt lgkmcnt(5)
    ds_read_b128 v[236:239], v3 offset:6144
    v_mfma_f32_16x16x32_bf16 v[160:163], v[112:115], v[64:67], v[160:163]
    v_exp_f32 v86, v46
    v_mfma_f32_16x16x32_bf16 v[168:171], v[112:115], v[68:71], v[168:171]
    ds_read_b128 v[240:243], v3 offset:256
    v_cvt_pk_bf16_f32 v78, v84, v85
    v_mfma_f32_16x16x32_bf16 v[172:175], v[116:119], v[68:71], v[172:175]
    v_exp_f32 v87, v47
    v_mfma_f32_16x16x32_bf16 v[164:167], v[116:119], v[64:67], v[164:167]
    s_waitcnt lgkmcnt(5)
    ds_read_b128 v[244:247], v3 offset:2304
    v_or3_b32 v94, v94, v77, v78
    v_mfma_f32_16x16x32_bf16 v[176:179], v[120:123], v[64:67], v[176:179]
    ds_read_b128 v[248:251], v3 offset:4352
    v_cvt_pk_bf16_f32 v79, v86, v87
    v_mfma_f32_16x16x32_bf16 v[184:187], v[120:123], v[68:71], v[184:187]
    v_bitop3_b32 v94, v94, v79, s38 bitop3:0xa8
    v_cmp_ne_u32 vcc, 0, v94
    v_mfma_f32_16x16x32_bf16 v[188:191], v[124:127], v[68:71], v[188:191]
    s_waitcnt lgkmcnt(5)
    v_mfma_f32_16x16x32_bf16 v[180:183], v[124:127], v[64:67], v[180:183]
    s_cbranch_vccnz Lfb_52
Lbk_53:
    ds_read_b128 v[252:255], v3 offset:6400
    v_mfma_f32_16x16x32_bf16 v[32:35], v[224:227], v[192:195], v[48:51]
    v_exp_f32 v80, v16
    v_mfma_f32_16x16x32_bf16 v[32:35], v[228:231], v[200:203], v[32:35]
    s_waitcnt lgkmcnt(4)
    v_exp_f32 v81, v17
    v_mfma_f32_16x16x32_bf16 v[32:35], v[232:235], v[208:211], v[32:35]
    v_exp_f32 v82, v18
    v_mfma_f32_16x16x32_bf16 v[32:35], v[236:239], v[216:219], v[32:35]
    ds_read_b128 v[96:99], v3 offset:16384
    v_cvt_pk_bf16_f32 v64, v80, v81
    v_mfma_f32_16x16x32_bf16 v[40:43], v[236:239], v[220:223], v[52:55]
    v_exp_f32 v83, v19
    v_mfma_f32_16x16x32_bf16 v[40:43], v[232:235], v[212:215], v[40:43]
    ds_read_b128 v[100:103], v3 offset:16640
    v_mfma_f32_16x16x32_bf16 v[40:43], v[228:231], v[204:207], v[40:43]
    s_add_u32 s35, s35, 1
    v_exp_f32 v84, v20
    v_mfma_f32_16x16x32_bf16 v[40:43], v[224:227], v[196:199], v[40:43]
    s_waitcnt lgkmcnt(4)
    ds_read_b128 v[104:107], v3 offset:18432
    v_cvt_pk_bf16_f32 v65, v82, v83
    v_mfma_f32_16x16x32_bf16 v[44:47], v[240:243], v[196:199], v[52:55]
    v_exp_f32 v85, v21
    v_mfma_f32_16x16x32_bf16 v[44:47], v[244:247], v[204:207], v[44:47]
    s_waitcnt lgkmcnt(3)
    ds_read_b128 v[108:111], v3 offset:18688
    v_mfma_f32_16x16x32_bf16 v[44:47], v[248:251], v[212:215], v[44:47]
    v_exp_f32 v86, v22
    v_mfma_f32_16x16x32_bf16 v[44:47], v[252:255], v[220:223], v[44:47]
    ds_read_b128 v[112:115], v3 offset:20480
    v_cvt_pk_bf16_f32 v66, v84, v85
    v_mfma_f32_16x16x32_bf16 v[36:39], v[252:255], v[216:219], v[48:51]
    v_exp_f32 v87, v23
    v_mfma_f32_16x16x32_bf16 v[36:39], v[248:251], v[208:211], v[36:39]
    ds_read_b128 v[116:119], v3 offset:20736
    v_or3_b32 v94, v64, v65, v66
    v_mfma_f32_16x16x32_bf16 v[36:39], v[244:247], v[200:203], v[36:39]
    v_exp_f32 v80, v24
    v_mfma_f32_16x16x32_bf16 v[36:39], v[240:243], v[192:195], v[36:39]
    ds_read_b128 v[120:123], v3 offset:22528
    v_cvt_pk_bf16_f32 v67, v86, v87
    v_mfma_f32_16x16x32_bf16 v[60:63], v[88:91], v[76:79], v[60:63]
    s_add_u32 s30, s30, 0x8000
    v_exp_f32 v81, v25
    v_mfma_f32_16x16x32_bf16 v[56:59], v[88:91], v[72:75], v[56:59]
    s_waitcnt lgkmcnt(5)
    ds_read_b128 v[124:127], v3 offset:22784
    v_mfma_f32_16x16x32_bf16 v[128:131], v[96:99], v[72:75], v[128:131]
    s_cmp_eq_u32 s30, 163840
    v_exp_f32 v82, v26
    s_cselect_b32 s30, 0, s30
    v_mfma_f32_16x16x32_bf16 v[136:139], v[96:99], v[76:79], v[136:139]
    ds_read_b128 v[224:227], v3 offset:8192
    v_cvt_pk_bf16_f32 v68, v80, v81
    v_mfma_f32_16x16x32_bf16 v[140:143], v[100:103], v[76:79], v[140:143]
    v_exp_f32 v83, v27
    v_mfma_f32_16x16x32_bf16 v[132:135], v[100:103], v[72:75], v[132:135]
    s_waitcnt lgkmcnt(5)
    ds_read_b128 v[228:231], v3 offset:10240
    v_or3_b32 v94, v94, v67, v68
    v_mfma_f32_16x16x32_bf16 v[144:147], v[104:107], v[72:75], v[144:147]
    v_exp_f32 v84, v28
    v_mfma_f32_16x16x32_bf16 v[152:155], v[104:107], v[76:79], v[152:155]
    ds_read_b128 v[232:235], v3 offset:12288
    v_cvt_pk_bf16_f32 v69, v82, v83
    v_mfma_f32_16x16x32_bf16 v[156:159], v[108:111], v[76:79], v[156:159]
    v_exp_f32 v85, v29
    v_mfma_f32_16x16x32_bf16 v[148:151], v[108:111], v[72:75], v[148:151]
    s_waitcnt lgkmcnt(5)
    ds_read_b128 v[236:239], v3 offset:14336
    v_mfma_f32_16x16x32_bf16 v[160:163], v[112:115], v[72:75], v[160:163]
    v_exp_f32 v86, v30
    v_mfma_f32_16x16x32_bf16 v[168:171], v[112:115], v[76:79], v[168:171]
    ds_read_b128 v[240:243], v3 offset:8448
    v_cvt_pk_bf16_f32 v70, v84, v85
    v_mfma_f32_16x16x32_bf16 v[172:175], v[116:119], v[76:79], v[172:175]
    v_exp_f32 v87, v31
    v_mfma_f32_16x16x32_bf16 v[164:167], v[116:119], v[72:75], v[164:167]
    s_waitcnt lgkmcnt(5)
    ds_read_b128 v[244:247], v3 offset:10496
    v_or3_b32 v94, v94, v69, v70
    v_mfma_f32_16x16x32_bf16 v[176:179], v[120:123], v[72:75], v[176:179]
    ds_read_b128 v[248:251], v3 offset:12544
    v_cvt_pk_bf16_f32 v71, v86, v87
    v_mfma_f32_16x16x32_bf16 v[184:187], v[120:123], v[76:79], v[184:187]
    v_bitop3_b32 v94, v94, v71, s38 bitop3:0xa8
    v_cmp_ne_u32 vcc, 0, v94
    v_mfma_f32_16x16x32_bf16 v[188:191], v[124:127], v[76:79], v[188:191]
    s_waitcnt lgkmcnt(5)
    v_mfma_f32_16x16x32_bf16 v[180:183], v[124:127], v[72:75], v[180:183]
    s_cbranch_vccnz Lfb_54
Lbk_55:
    ds_read_b128 v[252:255], v3 offset:14592
    v_mfma_f32_16x16x32_bf16 v[16:19], v[224:227], v[192:195], v[48:51]
    v_exp_f32 v80, v32
    v_mfma_f32_16x16x32_bf16 v[16:19], v[228:231], v[200:203], v[16:19]
    s_waitcnt lgkmcnt(4)
    v_exp_f32 v81, v33
    v_mfma_f32_16x16x32_bf16 v[16:19], v[232:235], v[208:211], v[16:19]
    v_exp_f32 v82, v34
    v_mfma_f32_16x16x32_bf16 v[16:19], v[236:239], v[216:219], v[16:19]
    ds_read_b128 v[96:99], v3 offset:24576
    v_cvt_pk_bf16_f32 v72, v80, v81
    v_mfma_f32_16x16x32_bf16 v[24:27], v[236:239], v[220:223], v[52:55]
    v_exp_f32 v83, v35
    v_mfma_f32_16x16x32_bf16 v[24:27], v[232:235], v[212:215], v[24:27]
    ds_read_b128 v[100:103], v3 offset:24832
    v_mfma_f32_16x16x32_bf16 v[24:27], v[228:231], v[204:207], v[24:27]
    v_exp_f32 v84, v36
    v_mfma_f32_16x16x32_bf16 v[24:27], v[224:227], v[196:199], v[24:27]
    s_waitcnt lgkmcnt(4)
    ds_read_b128 v[104:107], v3 offset:26624
    v_cvt_pk_bf16_f32 v73, v82, v83
    v_mfma_f32_16x16x32_bf16 v[28:31], v[240:243], v[196:199], v[52:55]
    v_exp_f32 v85, v37
    v_mfma_f32_16x16x32_bf16 v[28:31], v[244:247], v[204:207], v[28:31]
    s_waitcnt lgkmcnt(3)
    ds_read_b128 v[108:111], v3 offset:26880
    v_mfma_f32_16x16x32_bf16 v[28:31], v[248:251], v[212:215], v[28:31]
    v_exp_f32 v86, v38
    v_mfma_f32_16x16x32_bf16 v[28:31], v[252:255], v[220:223], v[28:31]
    ds_read_b128 v[112:115], v3 offset:28672
    ds_read_b128 v[116:119], v3 offset:28928
    v_cvt_pk_bf16_f32 v74, v84, v85
    v_mfma_f32_16x16x32_bf16 v[20:23], v[252:255], v[216:219], v[48:51]
    v_exp_f32 v87, v39
    v_mfma_f32_16x16x32_bf16 v[20:23], v[248:251], v[208:211], v[20:23]
    ds_read_b128 v[120:123], v3 offset:30720
    ds_read_b128 v[124:127], v3 offset:30976
    v_or3_b32 v94, v72, v73, v74
    v_mfma_f32_16x16x32_bf16 v[20:23], v[244:247], v[200:203], v[20:23]
    v_exp_f32 v80, v40
    v_mfma_f32_16x16x32_bf16 v[20:23], v[240:243], v[192:195], v[20:23]
    v_cvt_pk_bf16_f32 v75, v86, v87
    v_mfma_f32_16x16x32_bf16 v[60:63], v[88:91], v[68:71], v[60:63]
    v_exp_f32 v81, v41
    v_mfma_f32_16x16x32_bf16 v[56:59], v[88:91], v[64:67], v[56:59]
    s_waitcnt  lgkmcnt(0)
    v_add_u32 v3, s30, v93
    v_mfma_f32_16x16x32_bf16 v[128:131], v[96:99], v[64:67], v[128:131]
    s_barrier
    v_exp_f32 v82, v42
    v_mfma_f32_16x16x32_bf16 v[136:139], v[96:99], v[68:71], v[136:139]
    ds_read_b128 v[224:227], v3 offset:0
    v_cvt_pk_bf16_f32 v76, v80, v81
    v_mfma_f32_16x16x32_bf16 v[140:143], v[100:103], v[68:71], v[140:143]
    v_exp_f32 v83, v43
    v_mfma_f32_16x16x32_bf16 v[132:135], v[100:103], v[64:67], v[132:135]
    ds_read_b128 v[228:231], v3 offset:2048
    v_or3_b32 v94, v94, v75, v76
    v_mfma_f32_16x16x32_bf16 v[144:147], v[104:107], v[64:67], v[144:147]
    v_exp_f32 v84, v44
    v_mfma_f32_16x16x32_bf16 v[152:155], v[104:107], v[68:71], v[152:155]
    ds_read_b128 v[232:235], v3 offset:4096
    v_cvt_pk_bf16_f32 v77, v82, v83
    v_mfma_f32_16x16x32_bf16 v[156:159], v[108:111], v[68:71], v[156:159]
    v_exp_f32 v85, v45
    v_mfma_f32_16x16x32_bf16 v[148:151], v[108:111], v[64:67], v[148:151]
    ds_read_b128 v[236:239], v3 offset:6144
    v_mfma_f32_16x16x32_bf16 v[160:163], v[112:115], v[64:67], v[160:163]
    v_exp_f32 v86, v46
    v_mfma_f32_16x16x32_bf16 v[168:171], v[112:115], v[68:71], v[168:171]
    ds_read_b128 v[240:243], v3 offset:256
    v_cvt_pk_bf16_f32 v78, v84, v85
    v_mfma_f32_16x16x32_bf16 v[172:175], v[116:119], v[68:71], v[172:175]
    s_cmp_lt_u32 s35, s36
    v_exp_f32 v87, v47
    v_mfma_f32_16x16x32_bf16 v[164:167], v[116:119], v[64:67], v[164:167]
    ds_read_b128 v[244:247], v3 offset:2304
    v_or3_b32 v94, v94, v77, v78
    v_mfma_f32_16x16x32_bf16 v[176:179], v[120:123], v[64:67], v[176:179]
    ds_read_b128 v[248:251], v3 offset:4352
    v_cvt_pk_bf16_f32 v79, v86, v87
    v_mfma_f32_16x16x32_bf16 v[184:187], v[120:123], v[68:71], v[184:187]
    v_bitop3_b32 v94, v94, v79, s38 bitop3:0xa8
    v_cmp_ne_u32 vcc, 0, v94
    v_mfma_f32_16x16x32_bf16 v[188:191], v[124:127], v[68:71], v[188:191]
    s_waitcnt lgkmcnt(5)
    v_mfma_f32_16x16x32_bf16 v[180:183], v[124:127], v[64:67], v[180:183]
    s_cbranch_vccnz Lfb_56
Lbk_57:
    ds_read_b128 v[252:255], v3 offset:6400
    s_cbranch_scc1 Lxloop2
    s_branch Ltail
Lslow0:
    v_mov_b32 v72, 0
    v_mov_b32 v73, 0
    v_mov_b32 v74, 0
    v_mov_b32 v75, 0
    v_mov_b32 v76, 0
    v_mov_b32 v77, 0
    v_mov_b32 v78, 0
    v_mov_b32 v79, 0
    v_mov_b32 v56, 0
    v_mov_b32 v57, 0
    v_mov_b32 v58, 0
    v_mov_b32 v59, 0
    v_mov_b32 v60, 0
    v_mov_b32 v61, 0
    v_mov_b32 v62, 0
    v_mov_b32 v63, 0
    v_mfma_f32_32x32x16_bf16 v[128:143], v[72:75], v[72:75], 0
    v_mfma_f32_32x32x16_bf16 v[144:159], v[72:75], v[72:75], 0
    v_mfma_f32_32x32x16_bf16 v[160:175], v[72:75], v[72:75], 0
    v_mfma_f32_32x32x16_bf16 v[176:191], v[72:75], v[72:75], 0
    s_cmp_eq_u32 s29, 0
    s_cbranch_scc0 Lnomask0
    v_cmp_le_i32 s[44:45], 0, v95
    v_cmp_le_i32 s[46:47], 1, v95
    v_cmp_le_i32 s[48:49], 2, v95
    v_cmp_le_i32 s[50:51], 3, v95
    v_cndmask_b32 v16, v92, v16, s[44:45]
    v_cndmask_b32 v17, v92, v17, s[46:47]
    v_cndmask_b32 v18, v92, v18, s[48:49]
    v_cndmask_b32 v19, v92, v19, s[50:51]
    v_cmp_le_i32 s[44:45], 8, v95
    v_cmp_le_i32 s[46:47], 9, v95
    v_cmp_le_i32 s[48:49], 10, v95
    v_cmp_le_i32 s[50:51], 11, v95
    v_cndmask_b32 v20, v92, v20, s[44:45]
    v_cndmask_b32 v21, v92, v21, s[46:47]
    v_cndmask_b32 v22, v92, v22, s[48:49]
    v_cndmask_b32 v23, v92, v23, s[50:51]
    v_cmp_le_i32 s[44:45], -16, v95
    v_cmp_le_i32 s[46:47], -15, v95
    v_cmp_le_i32 s[48:49], -14, v95
    v_cmp_le_i32 s[50:51], -13, v95
    v_cndmask_b32 v24, v92, v24, s[44:45]
    v_cndmask_b32 v25, v92, v25, s[46:47]
    v_cndmask_b32 v26, v92, v26, s[48:49]
    v_cndmask_b32 v27, v92, v27, s[50:51]
    v_cmp_le_i32 s[44:45], -8, v95
    v_cmp_le_i32 s[46:47], -7, v95
    v_cmp_le_i32 s[48:49], -6, v95
    v_cmp_le_i32 s[50:51], -5, v95
    v_cndmask_b32 v28, v92, v28, s[44:45]
    v_cndmask_b32 v29, v92, v29, s[46:47]
    v_cndmask_b32 v30, v92, v30, s[48:49]
    v_cndmask_b32 v31, v92, v31, s[50:51]
Lnomask0:
    v_max3_f32 v80, v16, v17, v18
    v_max3_f32 v80, v80, v19, v20
    v_max3_f32 v80, v80, v21, v22
    v_max_f32 v80, v80, v23
    v_max3_f32 v81, v24, v25, v26
    v_max3_f32 v81, v81, v27, v28
    v_max3_f32 v81, v81, v29, v30
    v_max_f32 v81, v81, v31
    v_mov_b32 v82, v80
    v_mov_b32 v83, v81
    s_nop 0
    v_permlane16_swap_b32 v82, v80
    v_permlane16_swap_b32 v83, v81
    v_max_f32 v80, v80, v82
    v_max_f32 v81, v81, v83
    v_mov_b32 v82, v80
    v_mov_b32 v83, v81
    s_nop 0
    v_permlane32_swap_b32 v82, v80
    v_permlane32_swap_b32 v83, v81
    v_max_f32 v80, v80, v82
    v_max_f32 v81, v81, v83
    v_add_f32 v80, 0x42000000, v80
    v_add_f32 v81, 0x42000000, v81
    v_sub_f32 v48, 0, v80
    v_sub_f32 v49, 0, v80
    v_sub_f32 v50, 0, v80
    v_sub_f32 v51, 0, v80
    v_sub_f32 v52, 0, v81
    v_sub_f32 v53, 0, v81
    v_sub_f32 v54, 0, v81
    v_sub_f32 v55, 0, v81
    v_add_f32 v16, v16, v48
    v_add_f32 v17, v17, v48
    v_add_f32 v18, v18, v48
    v_add_f32 v19, v19, v48
    v_add_f32 v20, v20, v48
    v_add_f32 v21, v21, v48
    v_add_f32 v22, v22, v48
    v_add_f32 v23, v23, v48
    v_add_f32 v24, v24, v52
    v_add_f32 v25, v25, v52
    v_add_f32 v26, v26, v52
    v_add_f32 v27, v27, v52
    v_add_f32 v28, v28, v52
    v_add_f32 v29, v29, v52
    v_add_f32 v30, v30, v52
    v_add_f32 v31, v31, v52
    s_waitcnt lgkmcnt(0)
    s_branch Lytail
Lystart:
    s_and_b32 s42, s39, 0xfffffffb
    s_sub_u32 s42, s42, 1
    s_cmp_gt_u32 s42, 1
    s_cbranch_scc1 Lpc_58
    s_call_b64 s[40:41], Lpoll2
Lpc_58:
    s_add_u32 s39, s39, 1
    v_mfma_f32_16x16x32_bf16 v[16:19], v[224:227], v[192:195], v[48:51]
    s_add_u32 m0, s31, s34
    v_exp_f32 v80, v32
    buffer_load_dwordx4 v2, s[12:15], s32 offen offset:0 sc1 lds
    v_mfma_f32_16x16x32_bf16 v[16:19], v[228:231], v[200:203], v[16:19]
    s_waitcnt lgkmcnt(4)
    v_exp_f32 v81, v33
    v_mfma_f32_16x16x32_bf16 v[16:19], v[232:235], v[208:211], v[16:19]
    v_exp_f32 v82, v34
    buffer_load_dwordx4 v2, s[12:15], s32 offen offset:1024 sc1 lds
    v_mfma_f32_16x16x32_bf16 v[16:19], v[236:239], v[216:219], v[16:19]
    ds_read_b128 v[96:99], v3 offset:24576
    v_cvt_pk_bf16_f32 v72, v80, v81
    v_mfma_f32_16x16x32_bf16 v[24:27], v[236:239], v[220:223], v[52:55]
    v_exp_f32 v83, v35
    buffer_load_dwordx4 v2, s[12:15], s32 offen offset:2048 sc1 lds
    v_mfma_f32_16x16x32_bf16 v[24:27], v[232:235], v[212:215], v[24:27]
    ds_read_b128 v[100:103], v3 offset:24832
    v_mfma_f32_16x16x32_bf16 v[24:27], v[228:231], v[204:207], v[24:27]
    v_exp_f32 v84, v36
    buffer_load_dwordx4 v2, s[12:15], s32 offen offset:3072 sc1 lds
    v_mfma_f32_16x16x32_bf16 v[24:27], v[224:227], v[196:199], v[24:27]
    s_waitcnt lgkmcnt(4)
    ds_read_b128 v[104:107], v3 offset:26624
    v_cvt_pk_bf16_f32 v73, v82, v83
    v_mfma_f32_16x16x32_bf16 v[28:31], v[240:243], v[196:199], v[52:55]
    s_add_u32 m0, m0, 0x4000
    v_exp_f32 v85, v37
    buffer_load_dwordx4 v2, s[12:15], s33 offen offset:0 sc1 lds
    v_mfma_f32_16x16x32_bf16 v[28:31], v[244:247], v[204:207], v[28:31]
    s_waitcnt lgkmcnt(3)
    ds_read_b128 v[108:111], v3 offset:26880
    v_mfma_f32_16x16x32_bf16 v[28:31], v[248:251], v[212:215], v[28:31]
    v_exp_f32 v86, v38
    buffer_load_dwordx4 v2, s[12:15], s33 offen offset:1024 sc1 lds
    v_mfma_f32_16x16x32_bf16 v[28:31], v[252:255], v[220:223], v[28:31]
    ds_read_b128 v[112:115], v3 offset:28672
    v_cvt_pk_bf16_f32 v74, v84, v85
    v_mfma_f32_16x16x32_bf16 v[20:23], v[252:255], v[216:219], v[48:51]
    v_exp_f32 v87, v39
    buffer_load_dwordx4 v2, s[12:15], s33 offen offset:2048 sc1 lds
    v_mfma_f32_16x16x32_bf16 v[20:23], v[248:251], v[208:211], v[20:23]
    ds_read_b128 v[116:119], v3 offset:28928
    v_or3_b32 v94, v72, v73, v74
    v_mfma_f32_16x16x32_bf16 v[20:23], v[244:247], v[200:203], v[20:23]
    v_exp_f32 v80, v40
    buffer_load_dwordx4 v2, s[12:15], s33 offen offset:3072 sc1 lds
    v_mfma_f32_16x16x32_bf16 v[20:23], v[240:243], v[192:195], v[20:23]
    ds_read_b128 v[120:123], v3 offset:30720
    v_cvt_pk_bf16_f32 v75, v86, v87
    v_mfma_f32_16x16x32_bf16 v[60:63], v[88:91], v[68:71], 0
    v_exp_f32 v81, v41
    v_mfma_f32_16x16x32_bf16 v[56:59], v[88:91], v[64:67], 0
    s_waitcnt lgkmcnt(5)
    ds_read_b128 v[124:127], v3 offset:30976
    v_add_u32 v3, s30, v93
    v_mfma_f32_16x16x32_bf16 v[128:131], v[96:99], v[64:67], 0
    v_exp_f32 v82, v42
    v_mfma_f32_16x16x32_bf16 v[136:139], v[96:99], v[68:71], 0
    ds_read_b128 v[224:227], v3 offset:0
    v_cvt_pk_bf16_f32 v76, v80, v81
    v_mfma_f32_16x16x32_bf16 v[140:143], v[100:103], v[68:71], 0
    s_add_u32 s32, s32, 0x4000
    v_exp_f32 v83, v43
    s_add_u32 s33, s33, 0x4000
    v_mfma_f32_16x16x32_bf16 v[132:135], v[100:103], v[64:67], 0
    s_waitcnt lgkmcnt(5)
    ds_read_b128 v[228:231], v3 offset:2048
    v_or3_b32 v94, v94, v75, v76
    v_mfma_f32_16x16x32_bf16 v[144:147], v[104:107], v[64:67], 0
    v_exp_f32 v84, v44
    v_mfma_f32_16x16x32_bf16 v[152:155], v[104:107], v[68:71], 0
    ds_read_b128 v[232:235], v3 offset:4096
    v_cvt_pk_bf16_f32 v77, v82, v83
    v_mfma_f32_16x16x32_bf16 v[156:159], v[108:111], v[68:71], 0
    s_add_u32 s31, s31, 0x8000
    v_exp_f32 v85, v45
    s_cmp_eq_u32 s31, 163840
    s_cselect_b32 s31, 0, s31
    v_mfma_f32_16x16x32_bf16 v[148:151], v[108:111], v[64:67], 0
    s_waitcnt lgkmcnt(5)
    ds_read_b128 v[236:239], v3 offset:6144
    v_mfma_f32_16x16x32_bf16 v[160:163], v[112:115], v[64:67], 0
    v_exp_f32 v86, v46
    v_mfma_f32_16x16x32_bf16 v[168:171], v[112:115], v[68:71], 0
    ds_read_b128 v[240:243], v3 offset:256
    v_cvt_pk_bf16_f32 v78, v84, v85
    v_mfma_f32_16x16x32_bf16 v[172:175], v[116:119], v[68:71], 0
    v_exp_f32 v87, v47
    v_mfma_f32_16x16x32_bf16 v[164:167], v[116:119], v[64:67], 0
    s_waitcnt lgkmcnt(5)
    ds_read_b128 v[244:247], v3 offset:2304
    v_or3_b32 v94, v94, v77, v78
    v_mfma_f32_16x16x32_bf16 v[176:179], v[120:123], v[64:67], 0
    ds_read_b128 v[248:251], v3 offset:4352
    v_cvt_pk_bf16_f32 v79, v86, v87
    v_mfma_f32_16x16x32_bf16 v[184:187], v[120:123], v[68:71], 0
    v_bitop3_b32 v94, v94, v79, s38 bitop3:0xa8
    v_cmp_ne_u32 vcc, 0, v94
    v_mfma_f32_16x16x32_bf16 v[188:191], v[124:127], v[68:71], 0
    s_waitcnt lgkmcnt(5)
    v_mfma_f32_16x16x32_bf16 v[180:183], v[124:127], v[64:67], 0
    s_cbranch_vccnz Lfb_59
Lbk_60:
    ds_read_b128 v[252:255], v3 offset:6400
    v_mfma_f32_16x16x32_bf16 v[32:35], v[224:227], v[192:195], v[48:51]
    s_add_u32 m0, s31, s34
    v_exp_f32 v80, v16
    buffer_load_dwordx4 v2, s[12:15], s32 offen offset:0 sc1 lds
    v_mfma_f32_16x16x32_bf16 v[32:35], v[228:231], v[200:203], v[32:35]
    s_waitcnt lgkmcnt(4)
    v_exp_f32 v81, v17
    v_mfma_f32_16x16x32_bf16 v[32:35], v[232:235], v[208:211], v[32:35]
    v_exp_f32 v82, v18
    buffer_load_dwordx4 v2, s[12:15], s32 offen offset:1024 sc1 lds
    v_mfma_f32_16x16x32_bf16 v[32:35], v[236:239], v[216:219], v[32:35]
    ds_read_b128 v[96:99], v3 offset:16384
    v_cvt_pk_bf16_f32 v64, v80, v81
    v_mfma_f32_16x16x32_bf16 v[40:43], v[236:239], v[220:223], v[52:55]
    v_exp_f32 v83, v19
    buffer_load_dwordx4 v2, s[12:15], s32 offen offset:2048 sc1 lds
    v_mfma_f32_16x16x32_bf16 v[40:43], v[232:235], v[212:215], v[40:43]
    ds_read_b128 v[100:103], v3 offset:16640
    v_mfma_f32_16x16x32_bf16 v[40:43], v[228:231], v[204:207], v[40:43]
    v_exp_f32 v84, v20
    buffer_load_dwordx4 v2, s[12:15], s32 offen offset:3072 sc1 lds
    v_mfma_f32_16x16x32_bf16 v[40:43], v[224:227], v[196:199], v[40:43]
    s_waitcnt lgkmcnt(4)
    ds_read_b128 v[104:107], v3 offset:18432
    v_cvt_pk_bf16_f32 v65, v82, v83
    v_mfma_f32_16x16x32_bf16 v[44:47], v[240:243], v[196:199], v[52:55]
    s_add_u32 m0, m0, 0x4000
    v_exp_f32 v85, v21
    buffer_load_dwordx4 v2, s[12:15], s33 offen offset:0 sc1 lds
    v_mfma_f32_16x16x32_bf16 v[44:47], v[244:247], v[204:207], v[44:47]
    s_waitcnt lgkmcnt(3)
    ds_read_b128 v[108:111], v3 offset:18688
    v_mfma_f32_16x16x32_bf16 v[44:47], v[248:251], v[212:215], v[44:47]
    v_exp_f32 v86, v22
    buffer_load_dwordx4 v2, s[12:15], s33 offen offset:1024 sc1 lds
    v_mfma_f32_16x16x32_bf16 v[44:47], v[252:255], v[220:223], v[44:47]
    ds_read_b128 v[112:115], v3 offset:20480
    v_cvt_pk_bf16_f32 v66, v84, v85
    v_mfma_f32_16x16x32_bf16 v[36:39], v[252:255], v[216:219], v[48:51]
    v_exp_f32 v87, v23
    buffer_load_dwordx4 v2, s[12:15], s33 offen offset:2048 sc1 lds
    v_mfma_f32_16x16x32_bf16 v[36:39], v[248:251], v[208:211], v[36:39]
    ds_read_b128 v[116:119], v3 offset:20736
    v_or3_b32 v94, v64, v65, v66
    v_mfma_f32_16x16x32_bf16 v[36:39], v[244:247], v[200:203], v[36:39]
    v_exp_f32 v80, v24
    buffer_load_dwordx4 v2, s[12:15], s33 offen offset:3072 sc1 lds
    v_mfma_f32_16x16x32_bf16 v[36:39], v[240:243], v[192:195], v[36:39]
    ds_read_b128 v[120:123], v3 offset:22528
    v_cvt_pk_bf16_f32 v67, v86, v87
    v_mfma_f32_16x16x32_bf16 v[60:63], v[88:91], v[76:79], v[60:63]
    s_add_u32 s30, s30, 0x8000
    v_exp_f32 v81, v25
    v_mfma_f32_16x16x32_bf16 v[56:59], v[88:91], v[72:75], v[56:59]
    s_waitcnt lgkmcnt(5)
    ds_read_b128 v[124:127], v3 offset:22784
    v_mfma_f32_16x16x32_bf16 v[128:131], v[96:99], v[72:75], v[128:131]
    s_cmp_eq_u32 s30, 163840
    v_exp_f32 v82, v26
    s_cselect_b32 s30, 0, s30
    v_mfma_f32_16x16x32_bf16 v[136:139], v[96:99], v[76:79], v[136:139]
    ds_read_b128 v[224:227], v3 offset:8192
    v_cvt_pk_bf16_f32 v68, v80, v81
    v_mfma_f32_16x16x32_bf16 v[140:143], v[100:103], v[76:79], v[140:143]
    s_add_u32 s32, s32, 0x4000
    v_exp_f32 v83, v27
    s_add_u32 s33, s33, 0x4000
    v_mfma_f32_16x16x32_bf16 v[132:135], v[100:103], v[72:75], v[132:135]
    s_waitcnt lgkmcnt(5)
    ds_read_b128 v[228:231], v3 offset:10240
    v_or3_b32 v94, v94, v67, v68
    v_mfma_f32_16x16x32_bf16 v[144:147], v[104:107], v[72:75], v[144:147]
    v_exp_f32 v84, v28
    v_mfma_f32_16x16x32_bf16 v[152:155], v[104:107], v[76:79], v[152:155]
    ds_read_b128 v[232:235], v3 offset:12288
    v_cvt_pk_bf16_f32 v69, v82, v83
    v_mfma_f32_16x16x32_bf16 v[156:159], v[108:111], v[76:79], v[156:159]
    s_add_u32 s31, s31, 0x8000
    v_exp_f32 v85, v29
    s_cmp_eq_u32 s31, 163840
    s_cselect_b32 s31, 0, s31
    v_mfma_f32_16x16x32_bf16 v[148:151], v[108:111], v[72:75], v[148:151]
    s_waitcnt lgkmcnt(5)
    ds_read_b128 v[236:239], v3 offset:14336
    v_mfma_f32_16x16x32_bf16 v[160:163], v[112:115], v[72:75], v[160:163]
    v_exp_f32 v86, v30
    buffer_load_dword v7, v9, s[52:55], s61 offen
    s_add_u32 s61, s61, 4096
    s_min_u32 s61, s61, s62
    v_mfma_f32_16x16x32_bf16 v[168:171], v[112:115], v[76:79], v[168:171]
    ds_read_b128 v[240:243], v3 offset:8448
    v_cvt_pk_bf16_f32 v70, v84, v85
    v_mfma_f32_16x16x32_bf16 v[172:175], v[116:119], v[76:79], v[172:175]
    v_exp_f32 v87, v31
    v_mfma_f32_16x16x32_bf16 v[164:167], v[116:119], v[72:75], v[164:167]
    s_waitcnt lgkmcnt(5)
    ds_read_b128 v[244:247], v3 offset:10496
    v_or3_b32 v94, v94, v69, v70
    v_mfma_f32_16x16x32_bf16 v[176:179], v[120:123], v[72:75], v[176:179]
    ds_read_b128 v[248:251], v3 offset:12544
    v_cvt_pk_bf16_f32 v71, v86, v87
    v_mfma_f32_16x16x32_bf16 v[184:187], v[120:123], v[76:79], v[184:187]
    v_bitop3_b32 v94, v94, v71, s38 bitop3:0xa8
    v_cmp_ne_u32 vcc, 0, v94
    v_mfma_f32_16x16x32_bf16 v[188:191], v[124:127], v[76:79], v[188:191]
    s_waitcnt lgkmcnt(5)
    v_mfma_f32_16x16x32_bf16 v[180:183], v[124:127], v[72:75], v[180:183]
    s_cbranch_vccnz Lfb_61
Lbk_62:
    ds_read_b128 v[252:255], v3 offset:14592
    v_mfma_f32_16x16x32_bf16 v[16:19], v[224:227], v[192:195], v[48:51]
    v_exp_f32 v80, v32
    v_mfma_f32_16x16x32_bf16 v[16:19], v[228:231], v[200:203], v[16:19]
    s_waitcnt lgkmcnt(4)
    v_exp_f32 v81, v33
    v_mfma_f32_16x16x32_bf16 v[16:19], v[232:235], v[208:211], v[16:19]
    v_exp_f32 v82, v34
    v_mfma_f32_16x16x32_bf16 v[16:19], v[236:239], v[216:219], v[16:19]
    ds_read_b128 v[96:99], v3 offset:24576
    v_cvt_pk_bf16_f32 v72, v80, v81
    v_mfma_f32_16x16x32_bf16 v[24:27], v[236:239], v[220:223], v[52:55]
    v_exp_f32 v83, v35
    v_mfma_f32_16x16x32_bf16 v[24:27], v[232:235], v[212:215], v[24:27]
    ds_read_b128 v[100:103], v3 offset:24832
    v_mfma_f32_16x16x32_bf16 v[24:27], v[228:231], v[204:207], v[24:27]
    v_exp_f32 v84, v36
    v_mfma_f32_16x16x32_bf16 v[24:27], v[224:227], v[196:199], v[24:27]
    s_waitcnt lgkmcnt(4)
    ds_read_b128 v[104:107], v3 offset:26624
    v_cvt_pk_bf16_f32 v73, v82, v83
    v_mfma_f32_16x16x32_bf16 v[28:31], v[240:243], v[196:199], v[52:55]
    v_exp_f32 v85, v37
    v_mfma_f32_16x16x32_bf16 v[28:31], v[244:247], v[204:207], v[28:31]
    s_waitcnt lgkmcnt(3)
    ds_read_b128 v[108:111], v3 offset:26880
    v_mfma_f32_16x16x32_bf16 v[28:31], v[248:251], v[212:215], v[28:31]
    v_exp_f32 v86, v38
    v_mfma_f32_16x16x32_bf16 v[28:31], v[252:255], v[220:223], v[28:31]
    ds_read_b128 v[112:115], v3 offset:28672
    ds_read_b128 v[116:119], v3 offset:28928
    v_cvt_pk_bf16_f32 v74, v84, v85
    v_mfma_f32_16x16x32_bf16 v[20:23], v[252:255], v[216:219], v[48:51]
    v_exp_f32 v87, v39
    v_mfma_f32_16x16x32_bf16 v[20:23], v[248:251], v[208:211], v[20:23]
    ds_read_b128 v[120:123], v3 offset:30720
    ds_read_b128 v[124:127], v3 offset:30976
    v_or3_b32 v94, v72, v73, v74
    v_mfma_f32_16x16x32_bf16 v[20:23], v[244:247], v[200:203], v[20:23]
    v_exp_f32 v80, v40
    v_mfma_f32_16x16x32_bf16 v[20:23], v[240:243], v[192:195], v[20:23]
    v_cvt_pk_bf16_f32 v75, v86, v87
    v_mfma_f32_16x16x32_bf16 v[60:63], v[88:91], v[68:71], v[60:63]
    v_exp_f32 v81, v41
    v_mfma_f32_16x16x32_bf16 v[56:59], v[88:91], v[64:67], v[56:59]
    s_waitcnt vmcnt(9) lgkmcnt(0)
    v_add_u32 v3, s30, v93
    v_mfma_f32_16x16x32_bf16 v[128:131], v[96:99], v[64:67], v[128:131]
    s_barrier
    v_exp_f32 v82, v42
    v_mfma_f32_16x16x32_bf16 v[136:139], v[96:99], v[68:71], v[136:139]
    ds_read_b128 v[224:227], v3 offset:0
    v_cvt_pk_bf16_f32 v76, v80, v81
    v_mfma_f32_16x16x32_bf16 v[140:143], v[100:103], v[68:71], v[140:143]
    v_exp_f32 v83, v43
    v_mfma_f32_16x16x32_bf16 v[132:135], v[100:103], v[64:67], v[132:135]
    ds_read_b128 v[228:231], v3 offset:2048
    v_or3_b32 v94, v94, v75, v76
    v_mfma_f32_16x16x32_bf16 v[144:147], v[104:107], v[64:67], v[144:147]
    v_exp_f32 v84, v44
    v_mfma_f32_16x16x32_bf16 v[152:155], v[104:107], v[68:71], v[152:155]
    ds_read_b128 v[232:235], v3 offset:4096
    v_cvt_pk_bf16_f32 v77, v82, v83
    v_mfma_f32_16x16x32_bf16 v[156:159], v[108:111], v[68:71], v[156:159]
    v_exp_f32 v85, v45
    v_mfma_f32_16x16x32_bf16 v[148:151], v[108:111], v[64:67], v[148:151]
    ds_read_b128 v[236:239], v3 offset:6144
    v_mfma_f32_16x16x32_bf16 v[160:163], v[112:115], v[64:67], v[160:163]
    v_exp_f32 v86, v46
    v_mfma_f32_16x16x32_bf16 v[168:171], v[112:115], v[68:71], v[168:171]
    ds_read_b128 v[240:243], v3 offset:256
    v_cvt_pk_bf16_f32 v78, v84, v85
    v_mfma_f32_16x16x32_bf16 v[172:175], v[116:119], v[68:71], v[172:175]
    v_exp_f32 v87, v47
    v_mfma_f32_16x16x32_bf16 v[164:167], v[116:119], v[64:67], v[164:167]
    ds_read_b128 v[244:247], v3 offset:2304
    v_or3_b32 v94, v94, v77, v78
    v_mfma_f32_16x16x32_bf16 v[176:179], v[120:123], v[64:67], v[176:179]
    ds_read_b128 v[248:251], v3 offset:4352
    v_cvt_pk_bf16_f32 v79, v86, v87
    v_mfma_f32_16x16x32_bf16 v[184:187], v[120:123], v[68:71], v[184:187]
    v_bitop3_b32 v94, v94, v79, s38 bitop3:0xa8
    v_cmp_ne_u32 vcc, 0, v94
    v_mfma_f32_16x16x32_bf16 v[188:191], v[124:127], v[68:71], v[188:191]
    s_waitcnt lgkmcnt(5)
    v_mfma_f32_16x16x32_bf16 v[180:183], v[124:127], v[64:67], v[180:183]
    s_cbranch_vccnz Lfb_63
Lbk_64:
    ds_read_b128 v[252:255], v3 offset:6400
    s_branch Lylend
Lyloop:
    s_and_b32 s42, s39, 0xfffffffb
    s_sub_u32 s42, s42, 1
    s_cmp_gt_u32 s42, 1
    s_cbranch_scc1 Lpc_65
    s_call_b64 s[40:41], Lpoll2
Lpc_65:
    s_add_u32 s39, s39, 1
    v_mfma_f32_16x16x32_bf16 v[32:35], v[224:227], v[192:195], v[48:51]
    s_add_u32 m0, s31, s34
    v_exp_f32 v80, v16
    buffer_load_dwordx4 v2, s[12:15], s32 offen offset:0 sc1 lds
    v_mfma_f32_16x16x32_bf16 v[32:35], v[228:231], v[200:203], v[32:35]
    s_waitcnt lgkmcnt(4)
    v_exp_f32 v81, v17
    v_mfma_f32_16x16x32_bf16 v[32:35], v[232:235], v[208:211], v[32:35]
    v_exp_f32 v82, v18
    buffer_load_dwordx4 v2, s[12:15], s32 offen offset:1024 sc1 lds
    v_mfma_f32_16x16x32_bf16 v[32:35], v[236:239], v[216:219], v[32:35]
    ds_read_b128 v[96:99], v3 offset:16384
    v_cvt_pk_bf16_f32 v64, v80, v81
    v_mfma_f32_16x16x32_bf16 v[40:43], v[236:239], v[220:223], v[52:55]
    v_exp_f32 v83, v19
    buffer_load_dwordx4 v2, s[12:15], s32 offen offset:2048 sc1 lds
    v_mfma_f32_16x16x32_bf16 v[40:43], v[232:235], v[212:215], v[40:43]
    ds_read_b128 v[100:103], v3 offset:16640
    v_mfma_f32_16x16x32_bf16 v[40:43], v[228:231], v[204:207], v[40:43]
    v_exp_f32 v84, v20
    buffer_load_dwordx4 v2, s[12:15], s32 offen offset:3072 sc1 lds
    v_mfma_f32_16x16x32_bf16 v[40:43], v[224:227], v[196:199], v[40:43]
    s_waitcnt lgkmcnt(4)
    ds_read_b128 v[104:107], v3 offset:18432
    v_cvt_pk_bf16_f32 v65, v82, v83
    v_mfma_f32_16x16x32_bf16 v[44:47], v[240:243], v[196:199], v[52:55]
    s_add_u32 m0, m0, 0x4000
    v_exp_f32 v85, v21
    buffer_load_dwordx4 v2, s[12:15], s33 offen offset:0 sc1 lds
    v_mfma_f32_16x16x32_bf16 v[44:47], v[244:247], v[204:207], v[44:47]
    s_waitcnt lgkmcnt(3)
    ds_read_b128 v[108:111], v3 offset:18688
    v_mfma_f32_16x16x32_bf16 v[44:47], v[248:251], v[212:215], v[44:47]
    v_exp_f32 v86, v22
    buffer_load_dwordx4 v2, s[12:15], s33 offen offset:1024 sc1 lds
    v_mfma_f32_16x16x32_bf16 v[44:47], v[252:255], v[220:223], v[44:47]
    ds_read_b128 v[112:115], v3 offset:20480
    v_cvt_pk_bf16_f32 v66, v84, v85
    v_mfma_f32_16x16x32_bf16 v[36:39], v[252:255], v[216:219], v[48:51]
    v_exp_f32 v87, v23
    buffer_load_dwordx4 v2, s[12:15], s33 offen offset:2048 sc1 lds
    v_mfma_f32_16x16x32_bf16 v[36:39], v[248:251], v[208:211], v[36:39]
    ds_read_b128 v[116:119], v3 offset:20736
    v_or3_b32 v94, v64, v65, v66
    v_mfma_f32_16x16x32_bf16 v[36:39], v[244:247], v[200:203], v[36:39]
    v_exp_f32 v80, v24
    buffer_load_dwordx4 v2, s[12:15], s33 offen offset:3072 sc1 lds
    v_mfma_f32_16x16x32_bf16 v[36:39], v[240:243], v[192:195], v[36:39]
    ds_read_b128 v[120:123], v3 offset:22528
    v_cvt_pk_bf16_f32 v67, v86, v87
    v_mfma_f32_16x16x32_bf16 v[60:63], v[88:91], v[76:79], v[60:63]
    s_add_u32 s30, s30, 0x8000
    v_exp_f32 v81, v25
    v_mfma_f32_16x16x32_bf16 v[56:59], v[88:91], v[72:75], v[56:59]
    s_waitcnt lgkmcnt(5)
    ds_read_b128 v[124:127], v3 offset:22784
    v_mfma_f32_16x16x32_bf16 v[128:131], v[96:99], v[72:75], v[128:131]
    s_cmp_eq_u32 s30, 163840
    v_exp_f32 v82, v26
    s_cselect_b32 s30, 0, s30
    v_mfma_f32_16x16x32_bf16 v[136:139], v[96:99], v[76:79], v[136:139]
    ds_read_b128 v[224:227], v3 offset:8192
    v_cvt_pk_bf16_f32 v68, v80, v81
    v_mfma_f32_16x16x32_bf16 v[140:143], v[100:103], v[76:79], v[140:143]
    s_add_u32 s32, s32, 0x4000
    v_exp_f32 v83, v27
    s_add_u32 s33, s33, 0x4000
    v_mfma_f32_16x16x32_bf16 v[132:135], v[100:103], v[72:75], v[132:135]
    s_waitcnt lgkmcnt(5)
    ds_read_b128 v[228:231], v3 offset:10240
    v_or3_b32 v94, v94, v67, v68
    v_mfma_f32_16x16x32_bf16 v[144:147], v[104:107], v[72:75], v[144:147]
    v_exp_f32 v84, v28
    v_mfma_f32_16x16x32_bf16 v[152:155], v[104:107], v[76:79], v[152:155]
    ds_read_b128 v[232:235], v3 offset:12288
    v_cvt_pk_bf16_f32 v69, v82, v83
    v_mfma_f32_16x16x32_bf16 v[156:159], v[108:111], v[76:79], v[156:159]
    s_add_u32 s31, s31, 0x8000
    v_exp_f32 v85, v29
    s_cmp_eq_u32 s31, 163840
    s_cselect_b32 s31, 0, s31
    v_mfma_f32_16x16x32_bf16 v[148:151], v[108:111], v[72:75], v[148:151]
    s_waitcnt lgkmcnt(5)
    ds_read_b128 v[236:239], v3 offset:14336
    v_mfma_f32_16x16x32_bf16 v[160:163], v[112:115], v[72:75], v[160:163]
    v_exp_f32 v86, v30
    v_mfma_f32_16x16x32_bf16 v[168:171], v[112:115], v[76:79], v[168:171]
    ds_read_b128 v[240:243], v3 offset:8448
    v_cvt_pk_bf16_f32 v70, v84, v85
    v_mfma_f32_16x16x32_bf16 v[172:175], v[116:119], v[76:79], v[172:175]
    v_exp_f32 v87, v31
    v_mfma_f32_16x16x32_bf16 v[164:167], v[116:119], v[72:75], v[164:167]
    s_waitcnt lgkmcnt(5)
    ds_read_b128 v[244:247], v3 offset:10496
    v_or3_b32 v94, v94, v69, v70
    v_mfma_f32_16x16x32_bf16 v[176:179], v[120:123], v[72:75], v[176:179]
    ds_read_b128 v[248:251], v3 offset:12544
    v_cvt_pk_bf16_f32 v71, v86, v87
    v_mfma_f32_16x16x32_bf16 v[184:187], v[120:123], v[76:79], v[184:187]
    v_bitop3_b32 v94, v94, v71, s38 bitop3:0xa8
    v_cmp_ne_u32 vcc, 0, v94
    v_mfma_f32_16x16x32_bf16 v[188:191], v[124:127], v[76:79], v[188:191]
    s_waitcnt lgkmcnt(5)
    v_mfma_f32_16x16x32_bf16 v[180:183], v[124:127], v[72:75], v[180:183]
    s_cbranch_vccnz Lfb_66
Lbk_67:
    ds_read_b128 v[252:255], v3 offset:14592
    v_mfma_f32_16x16x32_bf16 v[16:19], v[224:227], v[192:195], v[48:51]
    s_add_u32 m0, s31, s34
    v_exp_f32 v80, v32
    buffer_load_dwordx4 v2, s[12:15], s32 offen offset:0 sc1 lds
    v_mfma_f32_16x16x32_bf16 v[16:19], v[228:231], v[200:203], v[16:19]
    s_waitcnt lgkmcnt(4)
    v_exp_f32 v81, v33
    v_mfma_f32_16x16x32_bf16 v[16:19], v[232:235], v[208:211], v[16:19]
    v_exp_f32 v82, v34
    buffer_load_dwordx4 v2, s[12:15], s32 offen offset:1024 sc1 lds
    v_mfma_f32_16x16x32_bf16 v[16:19], v[236:239], v[216:219], v[16:19]
    ds_read_b128 v[96:99], v3 offset:24576
    v_cvt_pk_bf16_f32 v72, v80, v81
    v_mfma_f32_16x16x32_bf16 v[24:27], v[236:239], v[220:223], v[52:55]
    v_exp_f32 v83, v35
    buffer_load_dwordx4 v2, s[12:15], s32 offen offset:2048 sc1 lds
    v_mfma_f32_16x16x32_bf16 v[24:27], v[232:235], v[212:215], v[24:27]
    ds_read_b128 v[100:103], v3 offset:24832
    v_mfma_f32_16x16x32_bf16 v[24:27], v[228:231], v[204:207], v[24:27]
    v_exp_f32 v84, v36
    buffer_load_dwordx4 v2, s[12:15], s32 offen offset:3072 sc1 lds
    v_mfma_f32_16x16x32_bf16 v[24:27], v[224:227], v[196:199], v[24:27]
    s_waitcnt lgkmcnt(4)
    ds_read_b128 v[104:107], v3 offset:26624
    v_cvt_pk_bf16_f32 v73, v82, v83
    v_mfma_f32_16x16x32_bf16 v[28:31], v[240:243], v[196:199], v[52:55]
    s_add_u32 m0, m0, 0x4000
    v_exp_f32 v85, v37
    buffer_load_dwordx4 v2, s[12:15], s33 offen offset:0 sc1 lds
    v_mfma_f32_16x16x32_bf16 v[28:31], v[244:247], v[204:207], v[28:31]
    s_waitcnt lgkmcnt(3)
    ds_read_b128 v[108:111], v3 offset:26880
    v_mfma_f32_16x16x32_bf16 v[28:31], v[248:251], v[212:215], v[28:31]
    v_exp_f32 v86, v38
    buffer_load_dwordx4 v2, s[12:15], s33 offen offset:1024 sc1 lds
    v_mfma_f32_16x16x32_bf16 v[28:31], v[252:255], v[220:223], v[28:31]
    ds_read_b128 v[112:115], v3 offset:28672
    v_cvt_pk_bf16_f32 v74, v84, v85
    v_mfma_f32_16x16x32_bf16 v[20:23], v[252:255], v[216:219], v[48:51]
    v_exp_f32 v87, v39
    buffer_load_dwordx4 v2, s[12:15], s33 offen offset:2048 sc1 lds
    v_mfma_f32_16x16x32_bf16 v[20:23], v[248:251], v[208:211], v[20:23]
    ds_read_b128 v[116:119], v3 offset:28928
    v_or3_b32 v94, v72, v73, v74
    v_mfma_f32_16x16x32_bf16 v[20:23], v[244:247], v[200:203], v[20:23]
    v_exp_f32 v80, v40
    buffer_load_dwordx4 v2, s[12:15], s33 offen offset:3072 sc1 lds
    v_mfma_f32_16x16x32_bf16 v[20:23], v[240:243], v[192:195], v[20:23]
    ds_read_b128 v[120:123], v3 offset:30720
    v_cvt_pk_bf16_f32 v75, v86, v87
    v_mfma_f32_16x16x32_bf16 v[60:63], v[88:91], v[68:71], v[60:63]
    v_exp_f32 v81, v41
    v_mfma_f32_16x16x32_bf16 v[56:59], v[88:91], v[64:67], v[56:59]
    s_waitcnt lgkmcnt(5)
    ds_read_b128 v[124:127], v3 offset:30976
    v_add_u32 v3, s30, v93
    v_mfma_f32_16x16x32_bf16 v[128:131], v[96:99], v[64:67], v[128:131]
    v_exp_f32 v82, v42
    v_mfma_f32_16x16x32_bf16 v[136:139], v[96:99], v[68:71], v[136:139]
    ds_read_b128 v[224:227], v3 offset:0
    v_cvt_pk_bf16_f32 v76, v80, v81
    v_mfma_f32_16x16x32_bf16 v[140:143], v[100:103], v[68:71], v[140:143]
    s_add_u32 s32, s32, 0x4000
    v_exp_f32 v83, v43
    s_add_u32 s33, s33, 0x4000
    v_mfma_f32_16x16x32_bf16 v[132:135], v[100:103], v[64:67], v[132:135]
    s_waitcnt lgkmcnt(5)
    ds_read_b128 v[228:231], v3 offset:2048
    v_or3_b32 v94, v94, v75, v76
    v_mfma_f32_16x16x32_bf16 v[144:147], v[104:107], v[64:67], v[144:147]
    v_exp_f32 v84, v44
    v_mfma_f32_16x16x32_bf16 v[152:155], v[104:107], v[68:71], v[152:155]
    ds_read_b128 v[232:235], v3 offset:4096
    v_cvt_pk_bf16_f32 v77, v82, v83
    v_mfma_f32_16x16x32_bf16 v[156:159], v[108:111], v[68:71], v[156:159]
    s_add_u32 s31, s31, 0x8000
    v_exp_f32 v85, v45
    s_cmp_eq_u32 s31, 163840
    s_cselect_b32 s31, 0, s31
    v_mfma_f32_16x16x32_bf16 v[148:151], v[108:111], v[64:67], v[148:151]
    s_waitcnt lgkmcnt(5)
    ds_read_b128 v[236:239], v3 offset:6144
    v_mfma_f32_16x16x32_bf16 v[160:163], v[112:115], v[64:67], v[160:163]
    v_exp_f32 v86, v46
    buffer_load_dword v7, v9, s[52:55], s61 offen
    s_add_u32 s61, s61, 4096
    s_min_u32 s61, s61, s62
    v_mfma_f32_16x16x32_bf16 v[168:171], v[112:115], v[68:71], v[168:171]
    ds_read_b128 v[240:243], v3 offset:256
    v_cvt_pk_bf16_f32 v78, v84, v85
    v_mfma_f32_16x16x32_bf16 v[172:175], v[116:119], v[68:71], v[172:175]
    v_exp_f32 v87, v47
    v_mfma_f32_16x16x32_bf16 v[164:167], v[116:119], v[64:67], v[164:167]
    s_waitcnt lgkmcnt(5)
    ds_read_b128 v[244:247], v3 offset:2304
    v_or3_b32 v94, v94, v77, v78
    v_mfma_f32_16x16x32_bf16 v[176:179], v[120:123], v[64:67], v[176:179]
    ds_read_b128 v[248:251], v3 offset:4352
    v_cvt_pk_bf16_f32 v79, v86, v87
    v_mfma_f32_16x16x32_bf16 v[184:187], v[120:123], v[68:71], v[184:187]
    v_bitop3_b32 v94, v94, v79, s38 bitop3:0xa8
    v_cmp_ne_u32 vcc, 0, v94
    v_mfma_f32_16x16x32_bf16 v[188:191], v[124:127], v[68:71], v[188:191]
    s_waitcnt lgkmcnt(5)
    v_mfma_f32_16x16x32_bf16 v[180:183], v[124:127], v[64:67], v[180:183]
    s_cbranch_vccnz Lfb_68
Lbk_69:
    ds_read_b128 v[252:255], v3 offset:6400
    v_mfma_f32_16x16x32_bf16 v[32:35], v[224:227], v[192:195], v[48:51]
    v_exp_f32 v80, v16
    v_mfma_f32_16x16x32_bf16 v[32:35], v[228:231], v[200:203], v[32:35]
    s_waitcnt lgkmcnt(4)
    v_exp_f32 v81, v17
    v_mfma_f32_16x16x32_bf16 v[32:35], v[232:235], v[208:211], v[32:35]
    v_exp_f32 v82, v18
    v_mfma_f32_16x16x32_bf16 v[32:35], v[236:239], v[216:219], v[32:35]
    ds_read_b128 v[96:99], v3 offset:16384
    v_cvt_pk_bf16_f32 v64, v80, v81
    v_mfma_f32_16x16x32_bf16 v[40:43], v[236:239], v[220:223], v[52:55]
    v_exp_f32 v83, v19
    v_mfma_f32_16x16x32_bf16 v[40:43], v[232:235], v[212:215], v[40:43]
    ds_read_b128 v[100:103], v3 offset:16640
    v_mfma_f32_16x16x32_bf16 v[40:43], v[228:231], v[204:207], v[40:43]
    v_exp_f32 v84, v20
    v_mfma_f32_16x16x32_bf16 v[40:43], v[224:227], v[196:199], v[40:43]
    s_waitcnt lgkmcnt(4)
    ds_read_b128 v[104:107], v3 offset:18432
    v_cvt_pk_bf16_f32 v65, v82, v83
    v_mfma_f32_16x16x32_bf16 v[44:47], v[240:243], v[196:199], v[52:55]
    v_exp_f32 v85, v21
    v_mfma_f32_16x16x32_bf16 v[44:47], v[244:247], v[204:207], v[44:47]
    s_waitcnt lgkmcnt(3)
    ds_read_b128 v[108:111], v3 offset:18688
    v_mfma_f32_16x16x32_bf16 v[44:47], v[248:251], v[212:215], v[44:47]
    v_exp_f32 v86, v22
    v_mfma_f32_16x16x32_bf16 v[44:47], v[252:255], v[220:223], v[44:47]
    ds_read_b128 v[112:115], v3 offset:20480
    v_cvt_pk_bf16_f32 v66, v84, v85
    v_mfma_f32_16x16x32_bf16 v[36:39], v[252:255], v[216:219], v[48:51]
    v_exp_f32 v87, v23
    v_mfma_f32_16x16x32_bf16 v[36:39], v[248:251], v[208:211], v[36:39]
    ds_read_b128 v[116:119], v3 offset:20736
    v_or3_b32 v94, v64, v65, v66
    v_mfma_f32_16x16x32_bf16 v[36:39], v[244:247], v[200:203], v[36:39]
    v_exp_f32 v80, v24
    v_mfma_f32_16x16x32_bf16 v[36:39], v[240:243], v[192:195], v[36:39]
    ds_read_b128 v[120:123], v3 offset:22528
    v_cvt_pk_bf16_f32 v67, v86, v87
    v_mfma_f32_16x16x32_bf16 v[60:63], v[88:91], v[76:79], v[60:63]
    s_add_u32 s30, s30, 0x8000
    v_exp_f32 v81, v25
    v_mfma_f32_16x16x32_bf16 v[56:59], v[88:91], v[72:75], v[56:59]
    s_waitcnt lgkmcnt(5)
    ds_read_b128 v[124:127], v3 offset:22784
    v_mfma_f32_16x16x32_bf16 v[128:131], v[96:99], v[72:75], v[128:131]
    s_cmp_eq_u32 s30, 163840
    v_exp_f32 v82, v26
    s_cselect_b32 s30, 0, s30
    v_mfma_f32_16x16x32_bf16 v[136:139], v[96:99], v[76:79], v[136:139]
    ds_read_b128 v[224:227], v3 offset:8192
    v_cvt_pk_bf16_f32 v68, v80, v81
    v_mfma_f32_16x16x32_bf16 v[140:143], v[100:103], v[76:79], v[140:143]
    v_exp_f32 v83, v27
    v_mfma_f32_16x16x32_bf16 v[132:135], v[100:103], v[72:75], v[132:135]
    s_waitcnt lgkmcnt(5)
    ds_read_b128 v[228:231], v3 offset:10240
    v_or3_b32 v94, v94, v67, v68
    v_mfma_f32_16x16x32_bf16 v[144:147], v[104:107], v[72:75], v[144:147]
    v_exp_f32 v84, v28
    v_mfma_f32_16x16x32_bf16 v[152:155], v[104:107], v[76:79], v[152:155]
    ds_read_b128 v[232:235], v3 offset:12288
    v_cvt_pk_bf16_f32 v69, v82, v83
    v_mfma_f32_16x16x32_bf16 v[156:159], v[108:111], v[76:79], v[156:159]
    v_exp_f32 v85, v29
    v_mfma_f32_16x16x32_bf16 v[148:151], v[108:111], v[72:75], v[148:151]
    s_waitcnt lgkmcnt(5)
    ds_read_b128 v[236:239], v3 offset:14336
    v_mfma_f32_16x16x32_bf16 v[160:163], v[112:115], v[72:75], v[160:163]
    v_exp_f32 v86, v30
    v_mfma_f32_16x16x32_bf16 v[168:171], v[112:115], v[76:79], v[168:171]
    ds_read_b128 v[240:243], v3 offset:8448
    v_cvt_pk_bf16_f32 v70, v84, v85
    v_mfma_f32_16x16x32_bf16 v[172:175], v[116:119], v[76:79], v[172:175]
    v_exp_f32 v87, v31
    v_mfma_f32_16x16x32_bf16 v[164:167], v[116:119], v[72:75], v[164:167]
    s_waitcnt lgkmcnt(5)
    ds_read_b128 v[244:247], v3 offset:10496
    v_or3_b32 v94, v94, v69, v70
    v_mfma_f32_16x16x32_bf16 v[176:179], v[120:123], v[72:75], v[176:179]
    ds_read_b128 v[248:251], v3 offset:12544
    v_cvt_pk_bf16_f32 v71, v86, v87
    v_mfma_f32_16x16x32_bf16 v[184:187], v[120:123], v[76:79], v[184:187]
    v_bitop3_b32 v94, v94, v71, s38 bitop3:0xa8
    v_cmp_ne_u32 vcc, 0, v94
    v_mfma_f32_16x16x32_bf16 v[188:191], v[124:127], v[76:79], v[188:191]
    s_waitcnt lgkmcnt(5)
    v_mfma_f32_16x16x32_bf16 v[180:183], v[124:127], v[72:75], v[180:183]
    s_cbranch_vccnz Lfb_70
Lbk_71:
    ds_read_b128 v[252:255], v3 offset:14592
    v_mfma_f32_16x16x32_bf16 v[16:19], v[224:227], v[192:195], v[48:51]
    v_exp_f32 v80, v32
    v_mfma_f32_16x16x32_bf16 v[16:19], v[228:231], v[200:203], v[16:19]
    s_waitcnt lgkmcnt(4)
    v_exp_f32 v81, v33
    v_mfma_f32_16x16x32_bf16 v[16:19], v[232:235], v[208:211], v[16:19]
    v_exp_f32 v82, v34
    v_mfma_f32_16x16x32_bf16 v[16:19], v[236:239], v[216:219], v[16:19]
    ds_read_b128 v[96:99], v3 offset:24576
    v_cvt_pk_bf16_f32 v72, v80, v81
    v_mfma_f32_16x16x32_bf16 v[24:27], v[236:239], v[220:223], v[52:55]
    v_exp_f32 v83, v35
    v_mfma_f32_16x16x32_bf16 v[24:27], v[232:235], v[212:215], v[24:27]
    ds_read_b128 v[100:103], v3 offset:24832
    v_mfma_f32_16x16x32_bf16 v[24:27], v[228:231], v[204:207], v[24:27]
    v_exp_f32 v84, v36
    v_mfma_f32_16x16x32_bf16 v[24:27], v[224:227], v[196:199], v[24:27]
    s_waitcnt lgkmcnt(4)
    ds_read_b128 v[104:107], v3 offset:26624
    v_cvt_pk_bf16_f32 v73, v82, v83
    v_mfma_f32_16x16x32_bf16 v[28:31], v[240:243], v[196:199], v[52:55]
    v_exp_f32 v85, v37
    v_mfma_f32_16x16x32_bf16 v[28:31], v[244:247], v[204:207], v[28:31]
    s_waitcnt lgkmcnt(3)
    ds_read_b128 v[108:111], v3 offset:26880
    v_mfma_f32_16x16x32_bf16 v[28:31], v[248:251], v[212:215], v[28:31]
    v_exp_f32 v86, v38
    v_mfma_f32_16x16x32_bf16 v[28:31], v[252:255], v[220:223], v[28:31]
    ds_read_b128 v[112:115], v3 offset:28672
    ds_read_b128 v[116:119], v3 offset:28928
    v_cvt_pk_bf16_f32 v74, v84, v85
    v_mfma_f32_16x16x32_bf16 v[20:23], v[252:255], v[216:219], v[48:51]
    v_exp_f32 v87, v39
    v_mfma_f32_16x16x32_bf16 v[20:23], v[248:251], v[208:211], v[20:23]
    ds_read_b128 v[120:123], v3 offset:30720
    ds_read_b128 v[124:127], v3 offset:30976
    v_or3_b32 v94, v72, v73, v74
    v_mfma_f32_16x16x32_bf16 v[20:23], v[244:247], v[200:203], v[20:23]
    v_exp_f32 v80, v40
    v_mfma_f32_16x16x32_bf16 v[20:23], v[240:243], v[192:195], v[20:23]
    v_cvt_pk_bf16_f32 v75, v86, v87
    v_mfma_f32_16x16x32_bf16 v[60:63], v[88:91], v[68:71], v[60:63]
    v_exp_f32 v81, v41
    v_mfma_f32_16x16x32_bf16 v[56:59], v[88:91], v[64:67], v[56:59]
    s_waitcnt vmcnt(1) lgkmcnt(0)
    v_add_u32 v3, s30, v93
    v_mfma_f32_16x16x32_bf16 v[128:131], v[96:99], v[64:67], v[128:131]
    s_barrier
    v_exp_f32 v82, v42
    v_mfma_f32_16x16x32_bf16 v[136:139], v[96:99], v[68:71], v[136:139]
    ds_read_b128 v[224:227], v3 offset:0
    v_cvt_pk_bf16_f32 v76, v80, v81
    v_mfma_f32_16x16x32_bf16 v[140:143], v[100:103], v[68:71], v[140:143]
    v_exp_f32 v83, v43
    v_mfma_f32_16x16x32_bf16 v[132:135], v[100:103], v[64:67], v[132:135]
    ds_read_b128 v[228:231], v3 offset:2048
    v_or3_b32 v94, v94, v75, v76
    v_mfma_f32_16x16x32_bf16 v[144:147], v[104:107], v[64:67], v[144:147]
    v_exp_f32 v84, v44
    v_mfma_f32_16x16x32_bf16 v[152:155], v[104:107], v[68:71], v[152:155]
    ds_read_b128 v[232:235], v3 offset:4096
    v_cvt_pk_bf16_f32 v77, v82, v83
    v_mfma_f32_16x16x32_bf16 v[156:159], v[108:111], v[68:71], v[156:159]
    v_exp_f32 v85, v45
    v_mfma_f32_16x16x32_bf16 v[148:151], v[108:111], v[64:67], v[148:151]
    ds_read_b128 v[236:239], v3 offset:6144
    v_mfma_f32_16x16x32_bf16 v[160:163], v[112:115], v[64:67], v[160:163]
    v_exp_f32 v86, v46
    v_mfma_f32_16x16x32_bf16 v[168:171], v[112:115], v[68:71], v[168:171]
    ds_read_b128 v[240:243], v3 offset:256
    v_cvt_pk_bf16_f32 v78, v84, v85
    v_mfma_f32_16x16x32_bf16 v[172:175], v[116:119], v[68:71], v[172:175]
    v_exp_f32 v87, v47
    v_mfma_f32_16x16x32_bf16 v[164:167], v[116:119], v[64:67], v[164:167]
    ds_read_b128 v[244:247], v3 offset:2304
    v_or3_b32 v94, v94, v77, v78
    v_mfma_f32_16x16x32_bf16 v[176:179], v[120:123], v[64:67], v[176:179]
    ds_read_b128 v[248:251], v3 offset:4352
    v_cvt_pk_bf16_f32 v79, v86, v87
    v_mfma_f32_16x16x32_bf16 v[184:187], v[120:123], v[68:71], v[184:187]
    v_bitop3_b32 v94, v94, v79, s38 bitop3:0xa8
    v_cmp_ne_u32 vcc, 0, v94
    v_mfma_f32_16x16x32_bf16 v[188:191], v[124:127], v[68:71], v[188:191]
    s_waitcnt lgkmcnt(5)
    v_mfma_f32_16x16x32_bf16 v[180:183], v[124:127], v[64:67], v[180:183]
    s_cbranch_vccnz Lfb_72
Lbk_73:
    ds_read_b128 v[252:255], v3 offset:6400
Lylend:
    s_add_u32 s35, s35, 1
    s_cmp_lt_u32 s35, s36
    s_cbranch_scc1 Lyloop
Lytail:
    s_and_b32 s42, s39, 0xfffffffb
    s_sub_u32 s42, s42, 1
    s_cmp_gt_u32 s42, 1
    s_cbranch_scc1 Lpc_74
    s_call_b64 s[40:41], Lpoll2
Lpc_74:
    s_add_u32 s39, s39, 1
    s_cmp_eq_u32 s27, 0
    s_cbranch_scc0 Lyt0
    s_add_u32 m0, s31, s34
    s_nop 0
    buffer_load_dwordx4 v2, s[12:15], s32 offen offset:0 sc1 lds
    buffer_load_dwordx4 v2, s[12:15], s32 offen offset:1024 sc1 lds
    buffer_load_dwordx4 v2, s[12:15], s32 offen offset:2048 sc1 lds
    buffer_load_dwordx4 v2, s[12:15], s32 offen offset:3072 sc1 lds
    s_add_u32 m0, m0, 0x4000
    s_nop 0
    buffer_load_dwordx4 v2, s[12:15], s33 offen offset:0 sc1 lds
    buffer_load_dwordx4 v2, s[12:15], s33 offen offset:1024 sc1 lds
    buffer_load_dwordx4 v2, s[12:15], s33 offen offset:2048 sc1 lds
    buffer_load_dwordx4 v2, s[12:15], s33 offen offset:3072 sc1 lds
    s_add_u32 s32, s32, 0x4000
    s_add_u32 s33, s33, 0x4000
    s_add_u32 s31, s31, 0x8000
    s_cmp_eq_u32 s31, 163840
    s_cselect_b32 s31, 0, s31
    s_add_u32 m0, s31, s34
    s_nop 0
    buffer_load_dwordx4 v2, s[12:15], s32 offen offset:0 sc1 lds
    buffer_load_dwordx4 v2, s[12:15], s32 offen offset:1024 sc1 lds
    buffer_load_dwordx4 v2, s[12:15], s32 offen offset:2048 sc1 lds
    buffer_load_dwordx4 v2, s[12:15], s32 offen offset:3072 sc1 lds
    s_add_u32 m0, m0, 0x4000
    s_nop 0
    buffer_load_dwordx4 v2, s[12:15], s33 offen offset:0 sc1 lds
    buffer_load_dwordx4 v2, s[12:15], s33 offen offset:1024 sc1 lds
    buffer_load_dwordx4 v2, s[12:15], s33 offen offset:2048 sc1 lds
    buffer_load_dwordx4 v2, s[12:15], s33 offen offset:3072 sc1 lds
    s_add_u32 s32, s32, 0x4000
    s_add_u32 s33, s33, 0x4000
    s_add_u32 s31, s31, 0x8000
    s_cmp_eq_u32 s31, 163840
    s_cselect_b32 s31, 0, s31
    buffer_load_dword v7, v9, s[52:55], s61 offen
    s_add_u32 s61, s61, 4096
    s_min_u32 s61, s61, s62
    s_branch Lfin0
Lyt0:
    v_mfma_f32_16x16x32_bf16 v[32:35], v[224:227], v[192:195], v[48:51]
    s_add_u32 m0, s31, s34
    v_exp_f32 v80, v16
    buffer_load_dwordx4 v2, s[12:15], s32 offen offset:0 sc1 lds
    v_mfma_f32_16x16x32_bf16 v[32:35], v[228:231], v[200:203], v[32:35]
    s_waitcnt lgkmcnt(4)
    v_exp_f32 v81, v17
    v_mfma_f32_16x16x32_bf16 v[32:35], v[232:235], v[208:211], v[32:35]
    v_exp_f32 v82, v18
    buffer_load_dwordx4 v2, s[12:15], s32 offen offset:1024 sc1 lds
    v_mfma_f32_16x16x32_bf16 v[32:35], v[236:239], v[216:219], v[32:35]
    ds_read_b128 v[96:99], v3 offset:16384
    v_cvt_pk_bf16_f32 v64, v80, v81
    v_mfma_f32_16x16x32_bf16 v[40:43], v[236:239], v[220:223], v[52:55]
    v_exp_f32 v83, v19
    buffer_load_dwordx4 v2, s[12:15], s32 offen offset:2048 sc1 lds
    v_mfma_f32_16x16x32_bf16 v[40:43], v[232:235], v[212:215], v[40:43]
    ds_read_b128 v[100:103], v3 offset:16640
    v_mfma_f32_16x16x32_bf16 v[40:43], v[228:231], v[204:207], v[40:43]
    v_exp_f32 v84, v20
    buffer_load_dwordx4 v2, s[12:15], s32 offen offset:3072 sc1 lds
    v_mfma_f32_16x16x32_bf16 v[40:43], v[224:227], v[196:199], v[40:43]
    s_waitcnt lgkmcnt(4)
    ds_read_b128 v[104:107], v3 offset:18432
    v_cvt_pk_bf16_f32 v65, v82, v83
    v_mfma_f32_16x16x32_bf16 v[44:47], v[240:243], v[196:199], v[52:55]
    s_add_u32 m0, m0, 0x4000
    v_exp_f32 v85, v21
    buffer_load_dwordx4 v2, s[12:15], s33 offen offset:0 sc1 lds
    v_mfma_f32_16x16x32_bf16 v[44:47], v[244:247], v[204:207], v[44:47]
    s_waitcnt lgkmcnt(3)
    ds_read_b128 v[108:111], v3 offset:18688
    v_mfma_f32_16x16x32_bf16 v[44:47], v[248:251], v[212:215], v[44:47]
    v_exp_f32 v86, v22
    buffer_load_dwordx4 v2, s[12:15], s33 offen offset:1024 sc1 lds
    v_mfma_f32_16x16x32_bf16 v[44:47], v[252:255], v[220:223], v[44:47]
    ds_read_b128 v[112:115], v3 offset:20480
    v_cvt_pk_bf16_f32 v66, v84, v85
    v_mfma_f32_16x16x32_bf16 v[36:39], v[252:255], v[216:219], v[48:51]
    v_exp_f32 v87, v23
    buffer_load_dwordx4 v2, s[12:15], s33 offen offset:2048 sc1 lds
    v_mfma_f32_16x16x32_bf16 v[36:39], v[248:251], v[208:211], v[36:39]
    ds_read_b128 v[116:119], v3 offset:20736
    v_or3_b32 v94, v64, v65, v66
    v_mfma_f32_16x16x32_bf16 v[36:39], v[244:247], v[200:203], v[36:39]
    v_exp_f32 v80, v24
    buffer_load_dwordx4 v2, s[12:15], s33 offen offset:3072 sc1 lds
    v_mfma_f32_16x16x32_bf16 v[36:39], v[240:243], v[192:195], v[36:39]
    ds_read_b128 v[120:123], v3 offset:22528
    v_cvt_pk_bf16_f32 v67, v86, v87
    v_mfma_f32_16x16x32_bf16 v[60:63], v[88:91], v[76:79], v[60:63]
    s_add_u32 s30, s30, 0x8000
    v_exp_f32 v81, v25
    v_mfma_f32_16x16x32_bf16 v[56:59], v[88:91], v[72:75], v[56:59]
    s_waitcnt lgkmcnt(5)
    ds_read_b128 v[124:127], v3 offset:22784
    v_mfma_f32_16x16x32_bf16 v[128:131], v[96:99], v[72:75], v[128:131]
    s_cmp_eq_u32 s30, 163840
    v_exp_f32 v82, v26
    s_cselect_b32 s30, 0, s30
    v_mfma_f32_16x16x32_bf16 v[136:139], v[96:99], v[76:79], v[136:139]
    ds_read_b128 v[224:227], v3 offset:8192
    v_cvt_pk_bf16_f32 v68, v80, v81
    v_mfma_f32_16x16x32_bf16 v[140:143], v[100:103], v[76:79], v[140:143]
    s_add_u32 s32, s32, 0x4000
    v_exp_f32 v83, v27
    s_add_u32 s33, s33, 0x4000
    v_mfma_f32_16x16x32_bf16 v[132:135], v[100:103], v[72:75], v[132:135]
    s_waitcnt lgkmcnt(5)
    ds_read_b128 v[228:231], v3 offset:10240
    v_or3_b32 v94, v94, v67, v68
    v_mfma_f32_16x16x32_bf16 v[144:147], v[104:107], v[72:75], v[144:147]
    v_exp_f32 v84, v28
    v_mfma_f32_16x16x32_bf16 v[152:155], v[104:107], v[76:79], v[152:155]
    ds_read_b128 v[232:235], v3 offset:12288
    v_cvt_pk_bf16_f32 v69, v82, v83
    v_mfma_f32_16x16x32_bf16 v[156:159], v[108:111], v[76:79], v[156:159]
    s_add_u32 s31, s31, 0x8000
    v_exp_f32 v85, v29
    s_cmp_eq_u32 s31, 163840
    s_cselect_b32 s31, 0, s31
    v_mfma_f32_16x16x32_bf16 v[148:151], v[108:111], v[72:75], v[148:151]
    s_waitcnt lgkmcnt(5)
    ds_read_b128 v[236:239], v3 offset:14336
    v_mfma_f32_16x16x32_bf16 v[160:163], v[112:115], v[72:75], v[160:163]
    v_exp_f32 v86, v30
    v_mfma_f32_16x16x32_bf16 v[168:171], v[112:115], v[76:79], v[168:171]
    ds_read_b128 v[240:243], v3 offset:8448
    v_cvt_pk_bf16_f32 v70, v84, v85
    v_mfma_f32_16x16x32_bf16 v[172:175], v[116:119], v[76:79], v[172:175]
    v_exp_f32 v87, v31
    v_mfma_f32_16x16x32_bf16 v[164:167], v[116:119], v[72:75], v[164:167]
    s_waitcnt lgkmcnt(5)
    ds_read_b128 v[244:247], v3 offset:10496
    v_or3_b32 v94, v94, v69, v70
    v_mfma_f32_16x16x32_bf16 v[176:179], v[120:123], v[72:75], v[176:179]
    ds_read_b128 v[248:251], v3 offset:12544
    v_cvt_pk_bf16_f32 v71, v86, v87
    v_mfma_f32_16x16x32_bf16 v[184:187], v[120:123], v[76:79], v[184:187]
    v_bitop3_b32 v94, v94, v71, s38 bitop3:0xa8
    v_cmp_ne_u32 vcc, 0, v94
    v_mfma_f32_16x16x32_bf16 v[188:191], v[124:127], v[76:79], v[188:191]
    s_waitcnt lgkmcnt(5)
    v_mfma_f32_16x16x32_bf16 v[180:183], v[124:127], v[72:75], v[180:183]
    s_cbranch_vccnz Lfb_75
Lbk_76:
    ds_read_b128 v[252:255], v3 offset:14592
    s_cmp_eq_u32 s27, 1
    s_cbranch_scc0 Lyt1
    s_add_u32 m0, s31, s34
    s_nop 0
    buffer_load_dwordx4 v2, s[12:15], s32 offen offset:0 sc1 lds
    buffer_load_dwordx4 v2, s[12:15], s32 offen offset:1024 sc1 lds
    buffer_load_dwordx4 v2, s[12:15], s32 offen offset:2048 sc1 lds
    buffer_load_dwordx4 v2, s[12:15], s32 offen offset:3072 sc1 lds
    s_add_u32 m0, m0, 0x4000
    s_nop 0
    buffer_load_dwordx4 v2, s[12:15], s33 offen offset:0 sc1 lds
    buffer_load_dwordx4 v2, s[12:15], s33 offen offset:1024 sc1 lds
    buffer_load_dwordx4 v2, s[12:15], s33 offen offset:2048 sc1 lds
    buffer_load_dwordx4 v2, s[12:15], s33 offen offset:3072 sc1 lds
    s_add_u32 s32, s32, 0x4000
    s_add_u32 s33, s33, 0x4000
    s_add_u32 s31, s31, 0x8000
    s_cmp_eq_u32 s31, 163840
    s_cselect_b32 s31, 0, s31
    buffer_load_dword v7, v9, s[52:55], s61 offen
    s_add_u32 s61, s61, 4096
    s_min_u32 s61, s61, s62
    s_branch Lfin1
Lyt1:
    v_mfma_f32_16x16x32_bf16 v[16:19], v[224:227], v[192:195], v[48:51]
    s_add_u32 m0, s31, s34
    v_exp_f32 v80, v32
    buffer_load_dwordx4 v2, s[12:15], s32 offen offset:0 sc1 lds
    v_mfma_f32_16x16x32_bf16 v[16:19], v[228:231], v[200:203], v[16:19]
    s_waitcnt lgkmcnt(4)
    v_exp_f32 v81, v33
    v_mfma_f32_16x16x32_bf16 v[16:19], v[232:235], v[208:211], v[16:19]
    v_exp_f32 v82, v34
    buffer_load_dwordx4 v2, s[12:15], s32 offen offset:1024 sc1 lds
    v_mfma_f32_16x16x32_bf16 v[16:19], v[236:239], v[216:219], v[16:19]
    ds_read_b128 v[96:99], v3 offset:24576
    v_cvt_pk_bf16_f32 v72, v80, v81
    v_mfma_f32_16x16x32_bf16 v[24:27], v[236:239], v[220:223], v[52:55]
    v_exp_f32 v83, v35
    buffer_load_dwordx4 v2, s[12:15], s32 offen offset:2048 sc1 lds
    v_mfma_f32_16x16x32_bf16 v[24:27], v[232:235], v[212:215], v[24:27]
    ds_read_b128 v[100:103], v3 offset:24832
    v_mfma_f32_16x16x32_bf16 v[24:27], v[228:231], v[204:207], v[24:27]
    v_exp_f32 v84, v36
    buffer_load_dwordx4 v2, s[12:15], s32 offen offset:3072 sc1 lds
    v_mfma_f32_16x16x32_bf16 v[24:27], v[224:227], v[196:199], v[24:27]
    s_waitcnt lgkmcnt(4)
    ds_read_b128 v[104:107], v3 offset:26624
    v_cvt_pk_bf16_f32 v73, v82, v83
    v_mfma_f32_16x16x32_bf16 v[28:31], v[240:243], v[196:199], v[52:55]
    s_add_u32 m0, m0, 0x4000
    v_exp_f32 v85, v37
    buffer_load_dwordx4 v2, s[12:15], s33 offen offset:0 sc1 lds
    v_mfma_f32_16x16x32_bf16 v[28:31], v[244:247], v[204:207], v[28:31]
    s_waitcnt lgkmcnt(3)
    ds_read_b128 v[108:111], v3 offset:26880
    v_mfma_f32_16x16x32_bf16 v[28:31], v[248:251], v[212:215], v[28:31]
    v_exp_f32 v86, v38
    buffer_load_dwordx4 v2, s[12:15], s33 offen offset:1024 sc1 lds
    v_mfma_f32_16x16x32_bf16 v[28:31], v[252:255], v[220:223], v[28:31]
    ds_read_b128 v[112:115], v3 offset:28672
    v_cvt_pk_bf16_f32 v74, v84, v85
    v_mfma_f32_16x16x32_bf16 v[20:23], v[252:255], v[216:219], v[48:51]
    v_exp_f32 v87, v39
    buffer_load_dwordx4 v2, s[12:15], s33 offen offset:2048 sc1 lds
    v_mfma_f32_16x16x32_bf16 v[20:23], v[248:251], v[208:211], v[20:23]
    ds_read_b128 v[116:119], v3 offset:28928
    v_or3_b32 v94, v72, v73, v74
    v_mfma_f32_16x16x32_bf16 v[20:23], v[244:247], v[200:203], v[20:23]
    v_exp_f32 v80, v40
    buffer_load_dwordx4 v2, s[12:15], s33 offen offset:3072 sc1 lds
    v_mfma_f32_16x16x32_bf16 v[20:23], v[240:243], v[192:195], v[20:23]
    ds_read_b128 v[120:123], v3 offset:30720
    v_cvt_pk_bf16_f32 v75, v86, v87
    v_mfma_f32_16x16x32_bf16 v[60:63], v[88:91], v[68:71], v[60:63]
    v_exp_f32 v81, v41
    v_mfma_f32_16x16x32_bf16 v[56:59], v[88:91], v[64:67], v[56:59]
    s_waitcnt lgkmcnt(5)
    ds_read_b128 v[124:127], v3 offset:30976
    v_add_u32 v3, s30, v93
    v_mfma_f32_16x16x32_bf16 v[128:131], v[96:99], v[64:67], v[128:131]
    v_exp_f32 v82, v42
    v_mfma_f32_16x16x32_bf16 v[136:139], v[96:99], v[68:71], v[136:139]
    ds_read_b128 v[224:227], v3 offset:0
    v_cvt_pk_bf16_f32 v76, v80, v81
    v_mfma_f32_16x16x32_bf16 v[140:143], v[100:103], v[68:71], v[140:143]
    s_add_u32 s32, s32, 0x4000
    v_exp_f32 v83, v43
    s_add_u32 s33, s33, 0x4000
    v_mfma_f32_16x16x32_bf16 v[132:135], v[100:103], v[64:67], v[132:135]
    s_waitcnt lgkmcnt(5)
    ds_read_b128 v[228:231], v3 offset:2048
    v_or3_b32 v94, v94, v75, v76
    v_mfma_f32_16x16x32_bf16 v[144:147], v[104:107], v[64:67], v[144:147]
    v_exp_f32 v84, v44
    v_mfma_f32_16x16x32_bf16 v[152:155], v[104:107], v[68:71], v[152:155]
    ds_read_b128 v[232:235], v3 offset:4096
    v_cvt_pk_bf16_f32 v77, v82, v83
    v_mfma_f32_16x16x32_bf16 v[156:159], v[108:111], v[68:71], v[156:159]
    s_add_u32 s31, s31, 0x8000
    v_exp_f32 v85, v45
    s_cmp_eq_u32 s31, 163840
    s_cselect_b32 s31, 0, s31
    v_mfma_f32_16x16x32_bf16 v[148:151], v[108:111], v[64:67], v[148:151]
    s_waitcnt lgkmcnt(5)
    ds_read_b128 v[236:239], v3 offset:6144
    v_mfma_f32_16x16x32_bf16 v[160:163], v[112:115], v[64:67], v[160:163]
    v_exp_f32 v86, v46
    buffer_load_dword v7, v9, s[52:55], s61 offen
    s_add_u32 s61, s61, 4096
    s_min_u32 s61, s61, s62
    v_mfma_f32_16x16x32_bf16 v[168:171], v[112:115], v[68:71], v[168:171]
    ds_read_b128 v[240:243], v3 offset:256
    v_cvt_pk_bf16_f32 v78, v84, v85
    v_mfma_f32_16x16x32_bf16 v[172:175], v[116:119], v[68:71], v[172:175]
    v_exp_f32 v87, v47
    v_mfma_f32_16x16x32_bf16 v[164:167], v[116:119], v[64:67], v[164:167]
    s_waitcnt lgkmcnt(5)
    ds_read_b128 v[244:247], v3 offset:2304
    v_or3_b32 v94, v94, v77, v78
    v_mfma_f32_16x16x32_bf16 v[176:179], v[120:123], v[64:67], v[176:179]
    ds_read_b128 v[248:251], v3 offset:4352
    v_cvt_pk_bf16_f32 v79, v86, v87
    v_mfma_f32_16x16x32_bf16 v[184:187], v[120:123], v[68:71], v[184:187]
    v_bitop3_b32 v94, v94, v79, s38 bitop3:0xa8
    v_cmp_ne_u32 vcc, 0, v94
    v_mfma_f32_16x16x32_bf16 v[188:191], v[124:127], v[68:71], v[188:191]
    s_waitcnt lgkmcnt(5)
    v_mfma_f32_16x16x32_bf16 v[180:183], v[124:127], v[64:67], v[180:183]
    s_cbranch_vccnz Lfb_77
Lbk_78:
    ds_read_b128 v[252:255], v3 offset:6400
    s_branch Ltail2
Ltail:
    s_cmp_eq_u32 s27, 0
    s_cbranch_scc1 Lfin0
    v_mfma_f32_16x16x32_bf16 v[32:35], v[224:227], v[192:195], v[48:51]
    v_exp_f32 v80, v16
    v_mfma_f32_16x16x32_bf16 v[32:35], v[228:231], v[200:203], v[32:35]
    s_waitcnt lgkmcnt(4)
    v_exp_f32 v81, v17
    v_mfma_f32_16x16x32_bf16 v[32:35], v[232:235], v[208:211], v[32:35]
    v_exp_f32 v82, v18
    v_mfma_f32_16x16x32_bf16 v[32:35], v[236:239], v[216:219], v[32:35]
    ds_read_b128 v[96:99], v3 offset:16384
    v_cvt_pk_bf16_f32 v64, v80, v81
    v_mfma_f32_16x16x32_bf16 v[40:43], v[236:239], v[220:223], v[52:55]
    v_exp_f32 v83, v19
    v_mfma_f32_16x16x32_bf16 v[40:43], v[232:235], v[212:215], v[40:43]
    ds_read_b128 v[100:103], v3 offset:16640
    v_mfma_f32_16x16x32_bf16 v[40:43], v[228:231], v[204:207], v[40:43]
    v_exp_f32 v84, v20
    v_mfma_f32_16x16x32_bf16 v[40:43], v[224:227], v[196:199], v[40:43]
    s_waitcnt lgkmcnt(4)
    ds_read_b128 v[104:107], v3 offset:18432
    v_cvt_pk_bf16_f32 v65, v82, v83
    v_mfma_f32_16x16x32_bf16 v[44:47], v[240:243], v[196:199], v[52:55]
    v_exp_f32 v85, v21
    v_mfma_f32_16x16x32_bf16 v[44:47], v[244:247], v[204:207], v[44:47]
    s_waitcnt lgkmcnt(3)
    ds_read_b128 v[108:111], v3 offset:18688
    v_mfma_f32_16x16x32_bf16 v[44:47], v[248:251], v[212:215], v[44:47]
    v_exp_f32 v86, v22
    v_mfma_f32_16x16x32_bf16 v[44:47], v[252:255], v[220:223], v[44:47]
    ds_read_b128 v[112:115], v3 offset:20480
    v_cvt_pk_bf16_f32 v66, v84, v85
    v_mfma_f32_16x16x32_bf16 v[36:39], v[252:255], v[216:219], v[48:51]
    v_exp_f32 v87, v23
    v_mfma_f32_16x16x32_bf16 v[36:39], v[248:251], v[208:211], v[36:39]
    ds_read_b128 v[116:119], v3 offset:20736
    v_or3_b32 v94, v64, v65, v66
    v_mfma_f32_16x16x32_bf16 v[36:39], v[244:247], v[200:203], v[36:39]
    v_exp_f32 v80, v24
    v_mfma_f32_16x16x32_bf16 v[36:39], v[240:243], v[192:195], v[36:39]
    ds_read_b128 v[120:123], v3 offset:22528
    v_cvt_pk_bf16_f32 v67, v86, v87
    v_mfma_f32_16x16x32_bf16 v[60:63], v[88:91], v[76:79], v[60:63]
    s_add_u32 s30, s30, 0x8000
    v_exp_f32 v81, v25
    v_mfma_f32_16x16x32_bf16 v[56:59], v[88:91], v[72:75], v[56:59]
    s_waitcnt lgkmcnt(5)
    ds_read_b128 v[124:127], v3 offset:22784
    v_mfma_f32_16x16x32_bf16 v[128:131], v[96:99], v[72:75], v[128:131]
    s_cmp_eq_u32 s30, 163840
    v_exp_f32 v82, v26
    s_cselect_b32 s30, 0, s30
    v_mfma_f32_16x16x32_bf16 v[136:139], v[96:99], v[76:79], v[136:139]
    ds_read_b128 v[224:227], v3 offset:8192
    v_cvt_pk_bf16_f32 v68, v80, v81
    v_mfma_f32_16x16x32_bf16 v[140:143], v[100:103], v[76:79], v[140:143]
    v_exp_f32 v83, v27
    v_mfma_f32_16x16x32_bf16 v[132:135], v[100:103], v[72:75], v[132:135]
    s_waitcnt lgkmcnt(5)
    ds_read_b128 v[228:231], v3 offset:10240
    v_or3_b32 v94, v94, v67, v68
    v_mfma_f32_16x16x32_bf16 v[144:147], v[104:107], v[72:75], v[144:147]
    v_exp_f32 v84, v28
    v_mfma_f32_16x16x32_bf16 v[152:155], v[104:107], v[76:79], v[152:155]
    ds_read_b128 v[232:235], v3 offset:12288
    v_cvt_pk_bf16_f32 v69, v82, v83
    v_mfma_f32_16x16x32_bf16 v[156:159], v[108:111], v[76:79], v[156:159]
    v_exp_f32 v85, v29
    v_mfma_f32_16x16x32_bf16 v[148:151], v[108:111], v[72:75], v[148:151]
    s_waitcnt lgkmcnt(5)
    ds_read_b128 v[236:239], v3 offset:14336
    v_mfma_f32_16x16x32_bf16 v[160:163], v[112:115], v[72:75], v[160:163]
    v_exp_f32 v86, v30
    v_mfma_f32_16x16x32_bf16 v[168:171], v[112:115], v[76:79], v[168:171]
    ds_read_b128 v[240:243], v3 offset:8448
    v_cvt_pk_bf16_f32 v70, v84, v85
    v_mfma_f32_16x16x32_bf16 v[172:175], v[116:119], v[76:79], v[172:175]
    v_exp_f32 v87, v31
    v_mfma_f32_16x16x32_bf16 v[164:167], v[116:119], v[72:75], v[164:167]
    s_waitcnt lgkmcnt(5)
    ds_read_b128 v[244:247], v3 offset:10496
    v_or3_b32 v94, v94, v69, v70
    v_mfma_f32_16x16x32_bf16 v[176:179], v[120:123], v[72:75], v[176:179]
    ds_read_b128 v[248:251], v3 offset:12544
    v_cvt_pk_bf16_f32 v71, v86, v87
    v_mfma_f32_16x16x32_bf16 v[184:187], v[120:123], v[76:79], v[184:187]
    v_bitop3_b32 v94, v94, v71, s38 bitop3:0xa8
    v_cmp_ne_u32 vcc, 0, v94
    v_mfma_f32_16x16x32_bf16 v[188:191], v[124:127], v[76:79], v[188:191]
    s_waitcnt lgkmcnt(5)
    v_mfma_f32_16x16x32_bf16 v[180:183], v[124:127], v[72:75], v[180:183]
    s_cbranch_vccnz Lfb_79
Lbk_80:
    ds_read_b128 v[252:255], v3 offset:14592
    s_cmp_eq_u32 s27, 1
    s_cbranch_scc1 Lfin1
    v_mfma_f32_16x16x32_bf16 v[16:19], v[224:227], v[192:195], v[48:51]
    v_exp_f32 v80, v32
    v_mfma_f32_16x16x32_bf16 v[16:19], v[228:231], v[200:203], v[16:19]
    s_waitcnt lgkmcnt(4)
    v_exp_f32 v81, v33
    v_mfma_f32_16x16x32_bf16 v[16:19], v[232:235], v[208:211], v[16:19]
    v_exp_f32 v82, v34
    v_mfma_f32_16x16x32_bf16 v[16:19], v[236:239], v[216:219], v[16:19]
    ds_read_b128 v[96:99], v3 offset:24576
    v_cvt_pk_bf16_f32 v72, v80, v81
    v_mfma_f32_16x16x32_bf16 v[24:27], v[236:239], v[220:223], v[52:55]
    v_exp_f32 v83, v35
    v_mfma_f32_16x16x32_bf16 v[24:27], v[232:235], v[212:215], v[24:27]
    ds_read_b128 v[100:103], v3 offset:24832
    v_mfma_f32_16x16x32_bf16 v[24:27], v[228:231], v[204:207], v[24:27]
    v_exp_f32 v84, v36
    v_mfma_f32_16x16x32_bf16 v[24:27], v[224:227], v[196:199], v[24:27]
    s_waitcnt lgkmcnt(4)
    ds_read_b128 v[104:107], v3 offset:26624
    v_cvt_pk_bf16_f32 v73, v82, v83
    v_mfma_f32_16x16x32_bf16 v[28:31], v[240:243], v[196:199], v[52:55]
    v_exp_f32 v85, v37
    v_mfma_f32_16x16x32_bf16 v[28:31], v[244:247], v[204:207], v[28:31]
    s_waitcnt lgkmcnt(3)
    ds_read_b128 v[108:111], v3 offset:26880
    v_mfma_f32_16x16x32_bf16 v[28:31], v[248:251], v[212:215], v[28:31]
    v_exp_f32 v86, v38
    v_mfma_f32_16x16x32_bf16 v[28:31], v[252:255], v[220:223], v[28:31]
    ds_read_b128 v[112:115], v3 offset:28672
    v_cvt_pk_bf16_f32 v74, v84, v85
    v_mfma_f32_16x16x32_bf16 v[20:23], v[252:255], v[216:219], v[48:51]
    v_exp_f32 v87, v39
    v_mfma_f32_16x16x32_bf16 v[20:23], v[248:251], v[208:211], v[20:23]
    ds_read_b128 v[116:119], v3 offset:28928
    v_or3_b32 v94, v72, v73, v74
    v_mfma_f32_16x16x32_bf16 v[20:23], v[244:247], v[200:203], v[20:23]
    v_exp_f32 v80, v40
    v_mfma_f32_16x16x32_bf16 v[20:23], v[240:243], v[192:195], v[20:23]
    ds_read_b128 v[120:123], v3 offset:30720
    v_cvt_pk_bf16_f32 v75, v86, v87
    v_mfma_f32_16x16x32_bf16 v[60:63], v[88:91], v[68:71], v[60:63]
    v_exp_f32 v81, v41
    v_mfma_f32_16x16x32_bf16 v[56:59], v[88:91], v[64:67], v[56:59]
    s_waitcnt lgkmcnt(5)
    ds_read_b128 v[124:127], v3 offset:30976
    v_add_u32 v3, s30, v93
    v_mfma_f32_16x16x32_bf16 v[128:131], v[96:99], v[64:67], v[128:131]
    v_exp_f32 v82, v42
    v_mfma_f32_16x16x32_bf16 v[136:139], v[96:99], v[68:71], v[136:139]
    ds_read_b128 v[224:227], v3 offset:0
    v_cvt_pk_bf16_f32 v76, v80, v81
    v_mfma_f32_16x16x32_bf16 v[140:143], v[100:103], v[68:71], v[140:143]
    v_exp_f32 v83, v43
    v_mfma_f32_16x16x32_bf16 v[132:135], v[100:103], v[64:67], v[132:135]
    s_waitcnt lgkmcnt(5)
    ds_read_b128 v[228:231], v3 offset:2048
    v_or3_b32 v94, v94, v75, v76
    v_mfma_f32_16x16x32_bf16 v[144:147], v[104:107], v[64:67], v[144:147]
    v_exp_f32 v84, v44
    v_mfma_f32_16x16x32_bf16 v[152:155], v[104:107], v[68:71], v[152:155]
    ds_read_b128 v[232:235], v3 offset:4096
    v_cvt_pk_bf16_f32 v77, v82, v83
    v_mfma_f32_16x16x32_bf16 v[156:159], v[108:111], v[68:71], v[156:159]
    v_exp_f32 v85, v45
    v_mfma_f32_16x16x32_bf16 v[148:151], v[108:111], v[64:67], v[148:151]
    s_waitcnt lgkmcnt(5)
    ds_read_b128 v[236:239], v3 offset:6144
    v_mfma_f32_16x16x32_bf16 v[160:163], v[112:115], v[64:67], v[160:163]
    v_exp_f32 v86, v46
    v_mfma_f32_16x16x32_bf16 v[168:171], v[112:115], v[68:71], v[168:171]
    ds_read_b128 v[240:243], v3 offset:256
    v_cvt_pk_bf16_f32 v78, v84, v85
    v_mfma_f32_16x16x32_bf16 v[172:175], v[116:119], v[68:71], v[172:175]
    v_exp_f32 v87, v47
    v_mfma_f32_16x16x32_bf16 v[164:167], v[116:119], v[64:67], v[164:167]
    s_waitcnt lgkmcnt(5)
    ds_read_b128 v[244:247], v3 offset:2304
    v_or3_b32 v94, v94, v77, v78
    v_mfma_f32_16x16x32_bf16 v[176:179], v[120:123], v[64:67], v[176:179]
    ds_read_b128 v[248:251], v3 offset:4352
    v_cvt_pk_bf16_f32 v79, v86, v87
    v_mfma_f32_16x16x32_bf16 v[184:187], v[120:123], v[68:71], v[184:187]
    v_bitop3_b32 v94, v94, v79, s38 bitop3:0xa8
    v_cmp_ne_u32 vcc, 0, v94
    v_mfma_f32_16x16x32_bf16 v[188:191], v[124:127], v[68:71], v[188:191]
    s_waitcnt lgkmcnt(5)
    v_mfma_f32_16x16x32_bf16 v[180:183], v[124:127], v[64:67], v[180:183]
    s_cbranch_vccnz Lfb_81
Lbk_82:
    ds_read_b128 v[252:255], v3 offset:6400
Ltail2:
    s_cmp_eq_u32 s27, 2
    s_cbranch_scc1 Lfin2
    v_mfma_f32_16x16x32_bf16 v[32:35], v[224:227], v[192:195], v[48:51]
    v_exp_f32 v80, v16
    v_mfma_f32_16x16x32_bf16 v[32:35], v[228:231], v[200:203], v[32:35]
    s_waitcnt lgkmcnt(4)
    v_exp_f32 v81, v17
    v_mfma_f32_16x16x32_bf16 v[32:35], v[232:235], v[208:211], v[32:35]
    v_exp_f32 v82, v18
    v_mfma_f32_16x16x32_bf16 v[32:35], v[236:239], v[216:219], v[32:35]
    ds_read_b128 v[96:99], v3 offset:16384
    v_cvt_pk_bf16_f32 v64, v80, v81
    v_mfma_f32_16x16x32_bf16 v[40:43], v[236:239], v[220:223], v[52:55]
    v_exp_f32 v83, v19
    v_mfma_f32_16x16x32_bf16 v[40:43], v[232:235], v[212:215], v[40:43]
    ds_read_b128 v[100:103], v3 offset:16640
    v_mfma_f32_16x16x32_bf16 v[40:43], v[228:231], v[204:207], v[40:43]
    v_exp_f32 v84, v20
    v_mfma_f32_16x16x32_bf16 v[40:43], v[224:227], v[196:199], v[40:43]
    s_waitcnt lgkmcnt(4)
    ds_read_b128 v[104:107], v3 offset:18432
    v_cvt_pk_bf16_f32 v65, v82, v83
    v_mfma_f32_16x16x32_bf16 v[44:47], v[240:243], v[196:199], v[52:55]
    v_exp_f32 v85, v21
    v_mfma_f32_16x16x32_bf16 v[44:47], v[244:247], v[204:207], v[44:47]
    s_waitcnt lgkmcnt(3)
    ds_read_b128 v[108:111], v3 offset:18688
    v_mfma_f32_16x16x32_bf16 v[44:47], v[248:251], v[212:215], v[44:47]
    v_exp_f32 v86, v22
    v_mfma_f32_16x16x32_bf16 v[44:47], v[252:255], v[220:223], v[44:47]
    ds_read_b128 v[112:115], v3 offset:20480
    v_cvt_pk_bf16_f32 v66, v84, v85
    v_mfma_f32_16x16x32_bf16 v[36:39], v[252:255], v[216:219], v[48:51]
    v_exp_f32 v87, v23
    v_mfma_f32_16x16x32_bf16 v[36:39], v[248:251], v[208:211], v[36:39]
    ds_read_b128 v[116:119], v3 offset:20736
    v_or3_b32 v94, v64, v65, v66
    v_mfma_f32_16x16x32_bf16 v[36:39], v[244:247], v[200:203], v[36:39]
    v_exp_f32 v80, v24
    v_mfma_f32_16x16x32_bf16 v[36:39], v[240:243], v[192:195], v[36:39]
    ds_read_b128 v[120:123], v3 offset:22528
    v_cvt_pk_bf16_f32 v67, v86, v87
    v_mfma_f32_16x16x32_bf16 v[60:63], v[88:91], v[76:79], v[60:63]
    s_add_u32 s30, s30, 0x8000
    v_exp_f32 v81, v25
    v_mfma_f32_16x16x32_bf16 v[56:59], v[88:91], v[72:75], v[56:59]
    s_waitcnt lgkmcnt(5)
    ds_read_b128 v[124:127], v3 offset:22784
    v_mfma_f32_16x16x32_bf16 v[128:131], v[96:99], v[72:75], v[128:131]
    s_cmp_eq_u32 s30, 163840
    v_exp_f32 v82, v26
    s_cselect_b32 s30, 0, s30
    v_mfma_f32_16x16x32_bf16 v[136:139], v[96:99], v[76:79], v[136:139]
    ds_read_b128 v[224:227], v3 offset:8192
    v_cvt_pk_bf16_f32 v68, v80, v81
    v_mfma_f32_16x16x32_bf16 v[140:143], v[100:103], v[76:79], v[140:143]
    v_exp_f32 v83, v27
    v_mfma_f32_16x16x32_bf16 v[132:135], v[100:103], v[72:75], v[132:135]
    s_waitcnt lgkmcnt(5)
    ds_read_b128 v[228:231], v3 offset:10240
    v_or3_b32 v94, v94, v67, v68
    v_mfma_f32_16x16x32_bf16 v[144:147], v[104:107], v[72:75], v[144:147]
    v_exp_f32 v84, v28
    v_mfma_f32_16x16x32_bf16 v[152:155], v[104:107], v[76:79], v[152:155]
    ds_read_b128 v[232:235], v3 offset:12288
    v_cvt_pk_bf16_f32 v69, v82, v83
    v_mfma_f32_16x16x32_bf16 v[156:159], v[108:111], v[76:79], v[156:159]
    v_exp_f32 v85, v29
    v_mfma_f32_16x16x32_bf16 v[148:151], v[108:111], v[72:75], v[148:151]
    s_waitcnt lgkmcnt(5)
    ds_read_b128 v[236:239], v3 offset:14336
    v_mfma_f32_16x16x32_bf16 v[160:163], v[112:115], v[72:75], v[160:163]
    v_exp_f32 v86, v30
    v_mfma_f32_16x16x32_bf16 v[168:171], v[112:115], v[76:79], v[168:171]
    ds_read_b128 v[240:243], v3 offset:8448
    v_cvt_pk_bf16_f32 v70, v84, v85
    v_mfma_f32_16x16x32_bf16 v[172:175], v[116:119], v[76:79], v[172:175]
    v_exp_f32 v87, v31
    v_mfma_f32_16x16x32_bf16 v[164:167], v[116:119], v[72:75], v[164:167]
    s_waitcnt lgkmcnt(5)
    ds_read_b128 v[244:247], v3 offset:10496
    v_or3_b32 v94, v94, v69, v70
    v_mfma_f32_16x16x32_bf16 v[176:179], v[120:123], v[72:75], v[176:179]
    ds_read_b128 v[248:251], v3 offset:12544
    v_cvt_pk_bf16_f32 v71, v86, v87
    v_mfma_f32_16x16x32_bf16 v[184:187], v[120:123], v[76:79], v[184:187]
    v_bitop3_b32 v94, v94, v71, s38 bitop3:0xa8
    v_cmp_ne_u32 vcc, 0, v94
    v_mfma_f32_16x16x32_bf16 v[188:191], v[124:127], v[76:79], v[188:191]
    s_waitcnt lgkmcnt(5)
    v_mfma_f32_16x16x32_bf16 v[180:183], v[124:127], v[72:75], v[180:183]
    s_cbranch_vccnz Lfb_83
Lbk_84:
    ds_read_b128 v[252:255], v3 offset:14592
Lfin3:
    ds_read_b128 v[96:99], v3 offset:24576
    ds_read_b128 v[100:103], v3 offset:24832
    ds_read_b128 v[104:107], v3 offset:26624
    ds_read_b128 v[108:111], v3 offset:26880
    ds_read_b128 v[112:115], v3 offset:28672
    ds_read_b128 v[116:119], v3 offset:28928
    ds_read_b128 v[120:123], v3 offset:30720
    ds_read_b128 v[124:127], v3 offset:30976
    v_add_u32 v3, s30, v93
    v_cmp_le_i32 s[44:45], 0, v95
    v_cmp_le_i32 s[46:47], 1, v95
    v_cmp_le_i32 s[48:49], 2, v95
    v_cmp_le_i32 s[50:51], 3, v95
    v_cndmask_b32 v32, v92, v32, s[44:45]
    v_cndmask_b32 v33, v92, v33, s[46:47]
    v_cndmask_b32 v34, v92, v34, s[48:49]
    v_cndmask_b32 v35, v92, v35, s[50:51]
    v_cmp_le_i32 s[44:45], 8, v95
    v_cmp_le_i32 s[46:47], 9, v95
    v_cmp_le_i32 s[48:49], 10, v95
    v_cmp_le_i32 s[50:51], 11, v95
    v_cndmask_b32 v36, v92, v36, s[44:45]
    v_cndmask_b32 v37, v92, v37, s[46:47]
    v_cndmask_b32 v38, v92, v38, s[48:49]
    v_cndmask_b32 v39, v92, v39, s[50:51]
    s_cmp_eq_u32 s28, 0
    s_cbranch_scc1 Lyb_85
    s_waitcnt lgkmcnt(0)
    s_call_b64 s[58:59], Lysvc
Lyb_85:
    ds_read_b128 v[224:227], v3 offset:16384
    ds_read_b128 v[228:231], v3 offset:16640
    ds_read_b128 v[232:235], v3 offset:18432
    ds_read_b128 v[236:239], v3 offset:18688
    ds_read_b128 v[240:243], v3 offset:20480
    ds_read_b128 v[244:247], v3 offset:20736
    ds_read_b128 v[248:251], v3 offset:22528
    ds_read_b128 v[252:255], v3 offset:22784
    v_mfma_f32_16x16x32_bf16 v[56:59], v[88:91], v[64:67], v[56:59]
    v_mfma_f32_16x16x32_bf16 v[60:63], v[88:91], v[68:71], v[60:63]
    s_waitcnt lgkmcnt(8)
    v_mfma_f32_16x16x32_bf16 v[128:131], v[96:99], v[64:67], v[128:131]
    v_cmp_le_i32 s[44:45], -16, v95
    v_cmp_le_i32 s[46:47], -15, v95
    v_cmp_le_i32 s[48:49], -14, v95
    v_mfma_f32_16x16x32_bf16 v[136:139], v[96:99], v[68:71], v[136:139]
    v_cmp_le_i32 s[50:51], -13, v95
    v_cndmask_b32 v40, v92, v40, s[44:45]
    v_cndmask_b32 v41, v92, v41, s[46:47]
    v_mfma_f32_16x16x32_bf16 v[132:135], v[100:103], v[64:67], v[132:135]
    v_cndmask_b32 v42, v92, v42, s[48:49]
    v_cndmask_b32 v43, v92, v43, s[50:51]
    v_cmp_le_i32 s[44:45], -8, v95
    v_mfma_f32_16x16x32_bf16 v[140:143], v[100:103], v[68:71], v[140:143]
    v_cmp_le_i32 s[46:47], -7, v95
    v_cmp_le_i32 s[48:49], -6, v95
    v_cmp_le_i32 s[50:51], -5, v95
    v_mfma_f32_16x16x32_bf16 v[144:147], v[104:107], v[64:67], v[144:147]
    v_cndmask_b32 v44, v92, v44, s[44:45]
    v_cndmask_b32 v45, v92, v45, s[46:47]
    v_cndmask_b32 v46, v92, v46, s[48:49]
    v_mfma_f32_16x16x32_bf16 v[152:155], v[104:107], v[68:71], v[152:155]
    v_cndmask_b32 v47, v92, v47, s[50:51]
    v_exp_f32 v80, v32
    v_exp_f32 v81, v33
    v_mfma_f32_16x16x32_bf16 v[148:151], v[108:111], v[64:67], v[148:151]
    v_exp_f32 v82, v34
    v_cvt_pk_bf16_f32 v72, v80, v81
    v_exp_f32 v83, v35
    v_mfma_f32_16x16x32_bf16 v[156:159], v[108:111], v[68:71], v[156:159]
    v_exp_f32 v84, v36
    v_cvt_pk_bf16_f32 v73, v82, v83
    v_exp_f32 v85, v37
    v_mfma_f32_16x16x32_bf16 v[160:163], v[112:115], v[64:67], v[160:163]
    v_exp_f32 v86, v38
    v_cvt_pk_bf16_f32 v74, v84, v85
    v_or3_b32 v94, v72, v73, v74
    v_mfma_f32_16x16x32_bf16 v[168:171], v[112:115], v[68:71], v[168:171]
    v_exp_f32 v87, v39
    v_exp_f32 v80, v40
    v_cvt_pk_bf16_f32 v75, v86, v87
    v_mfma_f32_16x16x32_bf16 v[164:167], v[116:119], v[64:67], v[164:167]
    v_exp_f32 v81, v41
    v_exp_f32 v82, v42
    v_cvt_pk_bf16_f32 v76, v80, v81
    v_mfma_f32_16x16x32_bf16 v[172:175], v[116:119], v[68:71], v[172:175]
    v_or3_b32 v94, v94, v75, v76
    v_exp_f32 v83, v43
    v_exp_f32 v84, v44
    v_mfma_f32_16x16x32_bf16 v[176:179], v[120:123], v[64:67], v[176:179]
    v_cvt_pk_bf16_f32 v77, v82, v83
    v_exp_f32 v85, v45
    v_exp_f32 v86, v46
    v_mfma_f32_16x16x32_bf16 v[184:187], v[120:123], v[68:71], v[184:187]
    v_cvt_pk_bf16_f32 v78, v84, v85
    v_or3_b32 v94, v94, v77, v78
    v_exp_f32 v87, v47
    v_mfma_f32_16x16x32_bf16 v[180:183], v[124:127], v[64:67], v[180:183]
    v_cvt_pk_bf16_f32 v79, v86, v87
    v_bitop3_b32 v94, v94, v79, s38 bitop3:0xa8
    v_cmp_ne_u32 vcc, 0, v94
    v_mfma_f32_16x16x32_bf16 v[188:191], v[124:127], v[68:71], v[188:191]
    s_cbranch_vccnz Lfb_86
Lbk_87:
    v_mov_b32 v64, v72
    v_mov_b32 v65, v73
    v_mov_b32 v66, v74
    v_mov_b32 v67, v75
    v_mov_b32 v68, v76
    v_mov_b32 v69, v77
    v_mov_b32 v70, v78
    v_mov_b32 v71, v79
    s_branch Ltdone
Lfin2:
    ds_read_b128 v[96:99], v3 offset:16384
    ds_read_b128 v[100:103], v3 offset:16640
    ds_read_b128 v[104:107], v3 offset:18432
    ds_read_b128 v[108:111], v3 offset:18688
    ds_read_b128 v[112:115], v3 offset:20480
    ds_read_b128 v[116:119], v3 offset:20736
    ds_read_b128 v[120:123], v3 offset:22528
    ds_read_b128 v[124:127], v3 offset:22784
    ds_read_b128 v[224:227], v3 offset:24576
    ds_read_b128 v[228:231], v3 offset:24832
    ds_read_b128 v[232:235], v3 offset:26624
    ds_read_b128 v[236:239], v3 offset:26880
    ds_read_b128 v[240:243], v3 offset:28672
    ds_read_b128 v[244:247], v3 offset:28928
    ds_read_b128 v[248:251], v3 offset:30720
    ds_read_b128 v[252:255], v3 offset:30976
    v_cmp_le_i32 s[44:45], 0, v95
    v_cmp_le_i32 s[46:47], 1, v95
    v_cmp_le_i32 s[48:49], 2, v95
    v_cmp_le_i32 s[50:51], 3, v95
    v_cndmask_b32 v16, v92, v16, s[44:45]
    v_cndmask_b32 v17, v92, v17, s[46:47]
    v_cndmask_b32 v18, v92, v18, s[48:49]
    v_cndmask_b32 v19, v92, v19, s[50:51]
    v_cmp_le_i32 s[44:45], 8, v95
    v_cmp_le_i32 s[46:47], 9, v95
    v_cmp_le_i32 s[48:49], 10, v95
    v_cmp_le_i32 s[50:51], 11, v95
    v_cndmask_b32 v20, v92, v20, s[44:45]
    v_cndmask_b32 v21, v92, v21, s[46:47]
    v_cndmask_b32 v22, v92, v22, s[48:49]
    v_cndmask_b32 v23, v92, v23, s[50:51]
    s_cmp_eq_u32 s28, 0
    s_cbranch_scc1 Lyb_88
    s_waitcnt lgkmcnt(0)
    s_call_b64 s[58:59], Lysvc
Lyb_88:
    v_mfma_f32_16x16x32_bf16 v[56:59], v[88:91], v[72:75], v[56:59]
    v_mfma_f32_16x16x32_bf16 v[60:63], v[88:91], v[76:79], v[60:63]
    s_waitcnt lgkmcnt(8)
    v_mfma_f32_16x16x32_bf16 v[128:131], v[96:99], v[72:75], v[128:131]
    v_cmp_le_i32 s[44:45], -16, v95
    v_cmp_le_i32 s[46:47], -15, v95
    v_cmp_le_i32 s[48:49], -14, v95
    v_mfma_f32_16x16x32_bf16 v[136:139], v[96:99], v[76:79], v[136:139]
    v_cmp_le_i32 s[50:51], -13, v95
    v_cndmask_b32 v24, v92, v24, s[44:45]
    v_cndmask_b32 v25, v92, v25, s[46:47]
    v_mfma_f32_16x16x32_bf16 v[132:135], v[100:103], v[72:75], v[132:135]
    v_cndmask_b32 v26, v92, v26, s[48:49]
    v_cndmask_b32 v27, v92, v27, s[50:51]
    v_cmp_le_i32 s[44:45], -8, v95
    v_mfma_f32_16x16x32_bf16 v[140:143], v[100:103], v[76:79], v[140:143]
    v_cmp_le_i32 s[46:47], -7, v95
    v_cmp_le_i32 s[48:49], -6, v95
    v_cmp_le_i32 s[50:51], -5, v95
    v_mfma_f32_16x16x32_bf16 v[144:147], v[104:107], v[72:75], v[144:147]
    v_cndmask_b32 v28, v92, v28, s[44:45]
    v_cndmask_b32 v29, v92, v29, s[46:47]
    v_cndmask_b32 v30, v92, v30, s[48:49]
    v_mfma_f32_16x16x32_bf16 v[152:155], v[104:107], v[76:79], v[152:155]
    v_cndmask_b32 v31, v92, v31, s[50:51]
    v_exp_f32 v80, v16
    v_exp_f32 v81, v17
    v_mfma_f32_16x16x32_bf16 v[148:151], v[108:111], v[72:75], v[148:151]
    v_exp_f32 v82, v18
    v_cvt_pk_bf16_f32 v64, v80, v81
    v_exp_f32 v83, v19
    v_mfma_f32_16x16x32_bf16 v[156:159], v[108:111], v[76:79], v[156:159]
    v_exp_f32 v84, v20
    v_cvt_pk_bf16_f32 v65, v82, v83
    v_exp_f32 v85, v21
    v_mfma_f32_16x16x32_bf16 v[160:163], v[112:115], v[72:75], v[160:163]
    v_exp_f32 v86, v22
    v_cvt_pk_bf16_f32 v66, v84, v85
    v_or3_b32 v94, v64, v65, v66
    v_mfma_f32_16x16x32_bf16 v[168:171], v[112:115], v[76:79], v[168:171]
    v_exp_f32 v87, v23
    v_exp_f32 v80, v24
    v_cvt_pk_bf16_f32 v67, v86, v87
    v_mfma_f32_16x16x32_bf16 v[164:167], v[116:119], v[72:75], v[164:167]
    v_exp_f32 v81, v25
    v_exp_f32 v82, v26
    v_cvt_pk_bf16_f32 v68, v80, v81
    v_mfma_f32_16x16x32_bf16 v[172:175], v[116:119], v[76:79], v[172:175]
    v_or3_b32 v94, v94, v67, v68
    v_exp_f32 v83, v27
    v_exp_f32 v84, v28
    v_mfma_f32_16x16x32_bf16 v[176:179], v[120:123], v[72:75], v[176:179]
    v_cvt_pk_bf16_f32 v69, v82, v83
    v_exp_f32 v85, v29
    v_exp_f32 v86, v30
    v_mfma_f32_16x16x32_bf16 v[184:187], v[120:123], v[76:79], v[184:187]
    v_cvt_pk_bf16_f32 v70, v84, v85
    v_or3_b32 v94, v94, v69, v70
    v_exp_f32 v87, v31
    v_mfma_f32_16x16x32_bf16 v[180:183], v[124:127], v[72:75], v[180:183]
    v_cvt_pk_bf16_f32 v71, v86, v87
    v_bitop3_b32 v94, v94, v71, s38 bitop3:0xa8
    v_cmp_ne_u32 vcc, 0, v94
    v_mfma_f32_16x16x32_bf16 v[188:191], v[124:127], v[76:79], v[188:191]
    s_cbranch_vccnz Lfb_89
Lbk_90:
    s_branch Ltdone
Lfin1:
    ds_read_b128 v[96:99], v3 offset:24576
    ds_read_b128 v[100:103], v3 offset:24832
    ds_read_b128 v[104:107], v3 offset:26624
    ds_read_b128 v[108:111], v3 offset:26880
    ds_read_b128 v[112:115], v3 offset:28672
    ds_read_b128 v[116:119], v3 offset:28928
    ds_read_b128 v[120:123], v3 offset:30720
    ds_read_b128 v[124:127], v3 offset:30976
    v_add_u32 v3, s30, v93
    ds_read_b128 v[224:227], v3 offset:16384
    ds_read_b128 v[228:231], v3 offset:16640
    ds_read_b128 v[232:235], v3 offset:18432
    ds_read_b128 v[236:239], v3 offset:18688
    ds_read_b128 v[240:243], v3 offset:20480
    ds_read_b128 v[244:247], v3 offset:20736
    ds_read_b128 v[248:251], v3 offset:22528
    ds_read_b128 v[252:255], v3 offset:22784
    v_cmp_le_i32 s[44:45], 0, v95
    v_cmp_le_i32 s[46:47], 1, v95
    v_cmp_le_i32 s[48:49], 2, v95
    v_cmp_le_i32 s[50:51], 3, v95
    v_cndmask_b32 v32, v92, v32, s[44:45]
    v_cndmask_b32 v33, v92, v33, s[46:47]
    v_cndmask_b32 v34, v92, v34, s[48:49]
    v_cndmask_b32 v35, v92, v35, s[50:51]
    v_cmp_le_i32 s[44:45], 8, v95
    v_cmp_le_i32 s[46:47], 9, v95
    v_cmp_le_i32 s[48:49], 10, v95
    v_cmp_le_i32 s[50:51], 11, v95
    v_cndmask_b32 v36, v92, v36, s[44:45]
    v_cndmask_b32 v37, v92, v37, s[46:47]
    v_cndmask_b32 v38, v92, v38, s[48:49]
    v_cndmask_b32 v39, v92, v39, s[50:51]
    s_cmp_eq_u32 s28, 0
    s_cbranch_scc1 Lyb_91
    s_waitcnt lgkmcnt(0)
    s_call_b64 s[58:59], Lysvc
Lyb_91:
    v_mfma_f32_16x16x32_bf16 v[56:59], v[88:91], v[64:67], v[56:59]
    v_mfma_f32_16x16x32_bf16 v[60:63], v[88:91], v[68:71], v[60:63]
    s_waitcnt lgkmcnt(8)
    v_mfma_f32_16x16x32_bf16 v[128:131], v[96:99], v[64:67], v[128:131]
    v_cmp_le_i32 s[44:45], -16, v95
    v_cmp_le_i32 s[46:47], -15, v95
    v_cmp_le_i32 s[48:49], -14, v95
    v_mfma_f32_16x16x32_bf16 v[136:139], v[96:99], v[68:71], v[136:139]
    v_cmp_le_i32 s[50:51], -13, v95
    v_cndmask_b32 v40, v92, v40, s[44:45]
    v_cndmask_b32 v41, v92, v41, s[46:47]
    v_mfma_f32_16x16x32_bf16 v[132:135], v[100:103], v[64:67], v[132:135]
    v_cndmask_b32 v42, v92, v42, s[48:49]
    v_cndmask_b32 v43, v92, v43, s[50:51]
    v_cmp_le_i32 s[44:45], -8, v95
    v_mfma_f32_16x16x32_bf16 v[140:143], v[100:103], v[68:71], v[140:143]
    v_cmp_le_i32 s[46:47], -7, v95
    v_cmp_le_i32 s[48:49], -6, v95
    v_cmp_le_i32 s[50:51], -5, v95
    v_mfma_f32_16x16x32_bf16 v[144:147], v[104:107], v[64:67], v[144:147]
    v_cndmask_b32 v44, v92, v44, s[44:45]
    v_cndmask_b32 v45, v92, v45, s[46:47]
    v_cndmask_b32 v46, v92, v46, s[48:49]
    v_mfma_f32_16x16x32_bf16 v[152:155], v[104:107], v[68:71], v[152:155]
    v_cndmask_b32 v47, v92, v47, s[50:51]
    v_exp_f32 v80, v32
    v_exp_f32 v81, v33
    v_mfma_f32_16x16x32_bf16 v[148:151], v[108:111], v[64:67], v[148:151]
    v_exp_f32 v82, v34
    v_cvt_pk_bf16_f32 v72, v80, v81
    v_exp_f32 v83, v35
    v_mfma_f32_16x16x32_bf16 v[156:159], v[108:111], v[68:71], v[156:159]
    v_exp_f32 v84, v36
    v_cvt_pk_bf16_f32 v73, v82, v83
    v_exp_f32 v85, v37
    v_mfma_f32_16x16x32_bf16 v[160:163], v[112:115], v[64:67], v[160:163]
    v_exp_f32 v86, v38
    v_cvt_pk_bf16_f32 v74, v84, v85
    v_or3_b32 v94, v72, v73, v74
    v_mfma_f32_16x16x32_bf16 v[168:171], v[112:115], v[68:71], v[168:171]
    v_exp_f32 v87, v39
    v_exp_f32 v80, v40
    v_cvt_pk_bf16_f32 v75, v86, v87
    v_mfma_f32_16x16x32_bf16 v[164:167], v[116:119], v[64:67], v[164:167]
    v_exp_f32 v81, v41
    v_exp_f32 v82, v42
    v_cvt_pk_bf16_f32 v76, v80, v81
    v_mfma_f32_16x16x32_bf16 v[172:175], v[116:119], v[68:71], v[172:175]
    v_or3_b32 v94, v94, v75, v76
    v_exp_f32 v83, v43
    v_exp_f32 v84, v44
    v_mfma_f32_16x16x32_bf16 v[176:179], v[120:123], v[64:67], v[176:179]
    v_cvt_pk_bf16_f32 v77, v82, v83
    v_exp_f32 v85, v45
    v_exp_f32 v86, v46
    v_mfma_f32_16x16x32_bf16 v[184:187], v[120:123], v[68:71], v[184:187]
    v_cvt_pk_bf16_f32 v78, v84, v85
    v_or3_b32 v94, v94, v77, v78
    v_exp_f32 v87, v47
    v_mfma_f32_16x16x32_bf16 v[180:183], v[124:127], v[64:67], v[180:183]
    v_cvt_pk_bf16_f32 v79, v86, v87
    v_bitop3_b32 v94, v94, v79, s38 bitop3:0xa8
    v_cmp_ne_u32 vcc, 0, v94
    v_mfma_f32_16x16x32_bf16 v[188:191], v[124:127], v[68:71], v[188:191]
    s_cbranch_vccnz Lfb_92
Lbk_93:
    v_mov_b32 v64, v72
    v_mov_b32 v65, v73
    v_mov_b32 v66, v74
    v_mov_b32 v67, v75
    v_mov_b32 v68, v76
    v_mov_b32 v69, v77
    v_mov_b32 v70, v78
    v_mov_b32 v71, v79
    s_branch Ltdone
Lfin0:
    ds_read_b128 v[96:99], v3 offset:16384
    ds_read_b128 v[100:103], v3 offset:16640
    ds_read_b128 v[104:107], v3 offset:18432
    ds_read_b128 v[108:111], v3 offset:18688
    ds_read_b128 v[112:115], v3 offset:20480
    ds_read_b128 v[116:119], v3 offset:20736
    ds_read_b128 v[120:123], v3 offset:22528
    ds_read_b128 v[124:127], v3 offset:22784
    ds_read_b128 v[224:227], v3 offset:24576
    ds_read_b128 v[228:231], v3 offset:24832
    ds_read_b128 v[232:235], v3 offset:26624
    ds_read_b128 v[236:239], v3 offset:26880
    ds_read_b128 v[240:243], v3 offset:28672
    ds_read_b128 v[244:247], v3 offset:28928
    ds_read_b128 v[248:251], v3 offset:30720
    ds_read_b128 v[252:255], v3 offset:30976
    v_cmp_le_i32 s[44:45], 0, v95
    v_cmp_le_i32 s[46:47], 1, v95
    v_cmp_le_i32 s[48:49], 2, v95
    v_cmp_le_i32 s[50:51], 3, v95
    v_cndmask_b32 v16, v92, v16, s[44:45]
    v_cndmask_b32 v17, v92, v17, s[46:47]
    v_cndmask_b32 v18, v92, v18, s[48:49]
    v_cndmask_b32 v19, v92, v19, s[50:51]
    v_cmp_le_i32 s[44:45], 8, v95
    v_cmp_le_i32 s[46:47], 9, v95
    v_cmp_le_i32 s[48:49], 10, v95
    v_cmp_le_i32 s[50:51], 11, v95
    v_cndmask_b32 v20, v92, v20, s[44:45]
    v_cndmask_b32 v21, v92, v21, s[46:47]
    v_cndmask_b32 v22, v92, v22, s[48:49]
    v_cndmask_b32 v23, v92, v23, s[50:51]
    s_cmp_eq_u32 s28, 0
    s_cbranch_scc1 Lyb_94
    s_waitcnt lgkmcnt(0)
    s_call_b64 s[58:59], Lysvc
Lyb_94:
    v_mfma_f32_16x16x32_bf16 v[56:59], v[88:91], v[72:75], v[56:59]
    v_mfma_f32_16x16x32_bf16 v[60:63], v[88:91], v[76:79], v[60:63]
    s_waitcnt lgkmcnt(8)
    v_mfma_f32_16x16x32_bf16 v[128:131], v[96:99], v[72:75], v[128:131]
    v_cmp_le_i32 s[44:45], -16, v95
    v_cmp_le_i32 s[46:47], -15, v95
    v_cmp_le_i32 s[48:49], -14, v95
    v_mfma_f32_16x16x32_bf16 v[136:139], v[96:99], v[76:79], v[136:139]
    v_cmp_le_i32 s[50:51], -13, v95
    v_cndmask_b32 v24, v92, v24, s[44:45]
    v_cndmask_b32 v25, v92, v25, s[46:47]
    v_mfma_f32_16x16x32_bf16 v[132:135], v[100:103], v[72:75], v[132:135]
    v_cndmask_b32 v26, v92, v26, s[48:49]
    v_cndmask_b32 v27, v92, v27, s[50:51]
    v_cmp_le_i32 s[44:45], -8, v95
    v_mfma_f32_16x16x32_bf16 v[140:143], v[100:103], v[76:79], v[140:143]
    v_cmp_le_i32 s[46:47], -7, v95
    v_cmp_le_i32 s[48:49], -6, v95
    v_cmp_le_i32 s[50:51], -5, v95
    v_mfma_f32_16x16x32_bf16 v[144:147], v[104:107], v[72:75], v[144:147]
    v_cndmask_b32 v28, v92, v28, s[44:45]
    v_cndmask_b32 v29, v92, v29, s[46:47]
    v_cndmask_b32 v30, v92, v30, s[48:49]
    v_mfma_f32_16x16x32_bf16 v[152:155], v[104:107], v[76:79], v[152:155]
    v_cndmask_b32 v31, v92, v31, s[50:51]
    v_exp_f32 v80, v16
    v_exp_f32 v81, v17
    v_mfma_f32_16x16x32_bf16 v[148:151], v[108:111], v[72:75], v[148:151]
    v_exp_f32 v82, v18
    v_cvt_pk_bf16_f32 v64, v80, v81
    v_exp_f32 v83, v19
    v_mfma_f32_16x16x32_bf16 v[156:159], v[108:111], v[76:79], v[156:159]
    v_exp_f32 v84, v20
    v_cvt_pk_bf16_f32 v65, v82, v83
    v_exp_f32 v85, v21
    v_mfma_f32_16x16x32_bf16 v[160:163], v[112:115], v[72:75], v[160:163]
    v_exp_f32 v86, v22
    v_cvt_pk_bf16_f32 v66, v84, v85
    v_or3_b32 v94, v64, v65, v66
    v_mfma_f32_16x16x32_bf16 v[168:171], v[112:115], v[76:79], v[168:171]
    v_exp_f32 v87, v23
    v_exp_f32 v80, v24
    v_cvt_pk_bf16_f32 v67, v86, v87
    v_mfma_f32_16x16x32_bf16 v[164:167], v[116:119], v[72:75], v[164:167]
    v_exp_f32 v81, v25
    v_exp_f32 v82, v26
    v_cvt_pk_bf16_f32 v68, v80, v81
    v_mfma_f32_16x16x32_bf16 v[172:175], v[116:119], v[76:79], v[172:175]
    v_or3_b32 v94, v94, v67, v68
    v_exp_f32 v83, v27
    v_exp_f32 v84, v28
    v_mfma_f32_16x16x32_bf16 v[176:179], v[120:123], v[72:75], v[176:179]
    v_cvt_pk_bf16_f32 v69, v82, v83
    v_exp_f32 v85, v29
    v_exp_f32 v86, v30
    v_mfma_f32_16x16x32_bf16 v[184:187], v[120:123], v[76:79], v[184:187]
    v_cvt_pk_bf16_f32 v70, v84, v85
    v_or3_b32 v94, v94, v69, v70
    v_exp_f32 v87, v31
    v_mfma_f32_16x16x32_bf16 v[180:183], v[124:127], v[72:75], v[180:183]
    v_cvt_pk_bf16_f32 v71, v86, v87
    v_bitop3_b32 v94, v94, v71, s38 bitop3:0xa8
    v_cmp_ne_u32 vcc, 0, v94
    v_mfma_f32_16x16x32_bf16 v[188:191], v[124:127], v[76:79], v[188:191]
    s_cbranch_vccnz Lfb_95
Lbk_96:
Ltdone:
    s_cmp_eq_u32 s28, 0
    s_cbranch_scc0 Lyepi
    v_mfma_f32_16x16x32_bf16 v[56:59], v[88:91], v[64:67], v[56:59]
    v_mfma_f32_16x16x32_bf16 v[60:63], v[88:91], v[68:71], v[60:63]
    s_waitcnt lgkmcnt(0)
    v_mfma_f32_16x16x32_bf16 v[128:131], v[224:227], v[64:67], v[128:131]
    s_lshl_b32 s42, s29, 18
    s_lshl_b32 s43, s25, 13
    v_mfma_f32_16x16x32_bf16 v[136:139], v[224:227], v[68:71], v[136:139]
    s_add_u32 s42, s42, s43
    s_add_u32 s42, s42, 51380224
    v_mfma_f32_16x16x32_bf16 v[132:135], v[228:231], v[64:67], v[132:135]
    v_mfma_f32_16x16x32_bf16 v[140:143], v[228:231], v[68:71], v[140:143]
    v_mfma_f32_16x16x32_bf16 v[144:147], v[232:235], v[64:67], v[144:147]
    v_rcp_f32 v88, v56
    v_rcp_f32 v90, v60
    v_mfma_f32_16x16x32_bf16 v[152:155], v[232:235], v[68:71], v[152:155]
    v_mov_b32 v89, v88
    v_mov_b32 v91, v90
    v_mfma_f32_16x16x32_bf16 v[148:151], v[236:239], v[64:67], v[148:151]
    v_mul_f32 v128, v128, v88
    v_mul_f32 v129, v129, v88
    v_mul_f32 v130, v130, v88
    v_mfma_f32_16x16x32_bf16 v[156:159], v[236:239], v[68:71], v[156:159]
    v_mul_f32 v131, v131, v88
    v_mul_f32 v132, v132, v88
    v_mul_f32 v133, v133, v88
    v_mul_f32 v134, v134, v88
    v_mfma_f32_16x16x32_bf16 v[160:163], v[240:243], v[64:67], v[160:163]
    v_mul_f32 v135, v135, v88
    v_cvt_pk_bf16_f32 v16, v128, v129
    v_cvt_pk_bf16_f32 v17, v130, v131
    v_cvt_pk_bf16_f32 v18, v132, v133
    v_mfma_f32_16x16x32_bf16 v[168:171], v[240:243], v[68:71], v[168:171]
    v_cvt_pk_bf16_f32 v19, v134, v135
    buffer_store_dwordx4 v[16:19], v93, s[12:15], s42 offen offset:0 sc1
    v_mul_f32 v136, v136, v90
    v_mul_f32 v137, v137, v90
    v_mfma_f32_16x16x32_bf16 v[164:167], v[244:247], v[64:67], v[164:167]
    v_mul_f32 v138, v138, v90
    v_mul_f32 v139, v139, v90
    v_mul_f32 v140, v140, v90
    v_mul_f32 v141, v141, v90
    v_mfma_f32_16x16x32_bf16 v[172:175], v[244:247], v[68:71], v[172:175]
    v_mul_f32 v142, v142, v90
    v_mul_f32 v143, v143, v90
    v_cvt_pk_bf16_f32 v20, v136, v137
    v_cvt_pk_bf16_f32 v21, v138, v139
    v_mfma_f32_16x16x32_bf16 v[176:179], v[248:251], v[64:67], v[176:179]
    v_cvt_pk_bf16_f32 v22, v140, v141
    v_cvt_pk_bf16_f32 v23, v142, v143
    buffer_store_dwordx4 v[20:23], v93, s[12:15], s42 offen offset:256 sc1
    v_mul_f32 v144, v144, v88
    v_mfma_f32_16x16x32_bf16 v[184:187], v[248:251], v[68:71], v[184:187]
    v_mul_f32 v145, v145, v88
    v_mul_f32 v146, v146, v88
    v_mul_f32 v147, v147, v88
    v_mul_f32 v148, v148, v88
    v_mfma_f32_16x16x32_bf16 v[180:183], v[252:255], v[64:67], v[180:183]
    v_mul_f32 v149, v149, v88
    v_mul_f32 v150, v150, v88
    v_mul_f32 v151, v151, v88
    v_cvt_pk_bf16_f32 v24, v144, v145
    v_mfma_f32_16x16x32_bf16 v[188:191], v[252:255], v[68:71], v[188:191]
    v_cvt_pk_bf16_f32 v25, v146, v147
    v_cvt_pk_bf16_f32 v26, v148, v149
    v_cvt_pk_bf16_f32 v27, v150, v151
    buffer_store_dwordx4 v[24:27], v93, s[12:15], s42 offen offset:2048 sc1
    v_pk_mul_f32 v[152:153], v[152:153], v[90:91]
    v_pk_mul_f32 v[154:155], v[154:155], v[90:91]
    v_pk_mul_f32 v[156:157], v[156:157], v[90:91]
    v_pk_mul_f32 v[158:159], v[158:159], v[90:91]
    v_cvt_pk_bf16_f32 v28, v152, v153
    v_cvt_pk_bf16_f32 v29, v154, v155
    v_cvt_pk_bf16_f32 v30, v156, v157
    v_cvt_pk_bf16_f32 v31, v158, v159
    buffer_store_dwordx4 v[28:31], v93, s[12:15], s42 offen offset:2304 sc1
    s_add_u32 s42, s42, 4096
    v_pk_mul_f32 v[160:161], v[160:161], v[88:89]
    v_pk_mul_f32 v[162:163], v[162:163], v[88:89]
    v_pk_mul_f32 v[164:165], v[164:165], v[88:89]
    v_pk_mul_f32 v[166:167], v[166:167], v[88:89]
    v_cvt_pk_bf16_f32 v32, v160, v161
    v_cvt_pk_bf16_f32 v33, v162, v163
    v_cvt_pk_bf16_f32 v34, v164, v165
    v_cvt_pk_bf16_f32 v35, v166, v167
    buffer_store_dwordx4 v[32:35], v93, s[12:15], s42 offen offset:0 sc1
    v_pk_mul_f32 v[168:169], v[168:169], v[90:91]
    v_pk_mul_f32 v[170:171], v[170:171], v[90:91]
    v_pk_mul_f32 v[172:173], v[172:173], v[90:91]
    v_pk_mul_f32 v[174:175], v[174:175], v[90:91]
    v_cvt_pk_bf16_f32 v36, v168, v169
    v_cvt_pk_bf16_f32 v37, v170, v171
    v_cvt_pk_bf16_f32 v38, v172, v173
    v_cvt_pk_bf16_f32 v39, v174, v175
    buffer_store_dwordx4 v[36:39], v93, s[12:15], s42 offen offset:256 sc1
    v_pk_mul_f32 v[176:177], v[176:177], v[88:89]
    v_pk_mul_f32 v[178:179], v[178:179], v[88:89]
    v_pk_mul_f32 v[180:181], v[180:181], v[88:89]
    v_pk_mul_f32 v[182:183], v[182:183], v[88:89]
    v_cvt_pk_bf16_f32 v40, v176, v177
    v_cvt_pk_bf16_f32 v41, v178, v179
    v_cvt_pk_bf16_f32 v42, v180, v181
    v_cvt_pk_bf16_f32 v43, v182, v183
    buffer_store_dwordx4 v[40:43], v93, s[12:15], s42 offen offset:2048 sc1
    v_pk_mul_f32 v[184:185], v[184:185], v[90:91]
    v_pk_mul_f32 v[186:187], v[186:187], v[90:91]
    v_pk_mul_f32 v[188:189], v[188:189], v[90:91]
    v_pk_mul_f32 v[190:191], v[190:191], v[90:91]
    v_cvt_pk_bf16_f32 v44, v184, v185
    v_cvt_pk_bf16_f32 v45, v186, v187
    v_cvt_pk_bf16_f32 v46, v188, v189
    v_cvt_pk_bf16_f32 v47, v190, v191
    buffer_store_dwordx4 v[44:47], v93, s[12:15], s42 offen offset:2304 sc1
    s_branch Lfin
Lyepi:
    v_mfma_f32_16x16x32_bf16 v[56:59], v[88:91], v[64:67], v[56:59]
    v_mfma_f32_16x16x32_bf16 v[60:63], v[88:91], v[68:71], v[60:63]
    s_waitcnt lgkmcnt(0)
    v_mfma_f32_16x16x32_bf16 v[128:131], v[224:227], v[64:67], v[128:131]
    s_lshl_b32 s42, s29, 18
    s_lshl_b32 s43, s25, 13
    v_mfma_f32_16x16x32_bf16 v[136:139], v[224:227], v[68:71], v[136:139]
    s_add_u32 s42, s42, s43
    s_add_u32 s42, s42, 51380224
    v_mfma_f32_16x16x32_bf16 v[132:135], v[228:231], v[64:67], v[132:135]
    v_mfma_f32_16x16x32_bf16 v[140:143], v[228:231], v[68:71], v[140:143]
    v_mfma_f32_16x16x32_bf16 v[144:147], v[232:235], v[64:67], v[144:147]
    v_rcp_f32 v88, v56
    v_rcp_f32 v90, v60
    v_mfma_f32_16x16x32_bf16 v[152:155], v[232:235], v[68:71], v[152:155]
    v_mov_b32 v89, v88
    v_mov_b32 v91, v90
    v_mfma_f32_16x16x32_bf16 v[148:151], v[236:239], v[64:67], v[148:151]
    v_mul_f32 v128, v128, v88
    v_mul_f32 v129, v129, v88
    v_mul_f32 v130, v130, v88
    v_mfma_f32_16x16x32_bf16 v[156:159], v[236:239], v[68:71], v[156:159]
    v_mul_f32 v131, v131, v88
    v_mul_f32 v132, v132, v88
    v_mul_f32 v133, v133, v88
    v_mul_f32 v134, v134, v88
    v_mfma_f32_16x16x32_bf16 v[160:163], v[240:243], v[64:67], v[160:163]
    v_mul_f32 v135, v135, v88
    v_cvt_pk_bf16_f32 v16, v128, v129
    v_cvt_pk_bf16_f32 v17, v130, v131
    v_mfma_f32_16x16x32_bf16 v[168:171], v[240:243], v[68:71], v[168:171]
    v_cvt_pk_bf16_f32 v18, v132, v133
    v_cvt_pk_bf16_f32 v19, v134, v135
    v_mul_f32 v136, v136, v90
    v_mul_f32 v137, v137, v90
    v_mfma_f32_16x16x32_bf16 v[164:167], v[244:247], v[64:67], v[164:167]
    v_mul_f32 v138, v138, v90
    v_mul_f32 v139, v139, v90
    v_mul_f32 v140, v140, v90
    v_mul_f32 v141, v141, v90
    v_mfma_f32_16x16x32_bf16 v[172:175], v[244:247], v[68:71], v[172:175]
    v_mul_f32 v142, v142, v90
    v_mul_f32 v143, v143, v90
    v_cvt_pk_bf16_f32 v20, v136, v137
    v_mfma_f32_16x16x32_bf16 v[176:179], v[248:251], v[64:67], v[176:179]
    v_cvt_pk_bf16_f32 v21, v138, v139
    v_cvt_pk_bf16_f32 v22, v140, v141
    v_cvt_pk_bf16_f32 v23, v142, v143
    v_mul_f32 v144, v144, v88
    v_mfma_f32_16x16x32_bf16 v[184:187], v[248:251], v[68:71], v[184:187]
    v_mul_f32 v145, v145, v88
    v_mul_f32 v146, v146, v88
    v_mul_f32 v147, v147, v88
    v_mfma_f32_16x16x32_bf16 v[180:183], v[252:255], v[64:67], v[180:183]
    v_mul_f32 v148, v148, v88
    v_mul_f32 v149, v149, v88
    v_mul_f32 v150, v150, v88
    v_mul_f32 v151, v151, v88
    v_mfma_f32_16x16x32_bf16 v[188:191], v[252:255], v[68:71], v[188:191]
    v_cvt_pk_bf16_f32 v24, v144, v145
    v_cvt_pk_bf16_f32 v25, v146, v147
    v_cvt_pk_bf16_f32 v26, v148, v149
    v_cvt_pk_bf16_f32 v27, v150, v151
    v_pk_mul_f32 v[152:153], v[152:153], v[90:91]
    v_pk_mul_f32 v[154:155], v[154:155], v[90:91]
    v_pk_mul_f32 v[156:157], v[156:157], v[90:91]
    v_pk_mul_f32 v[158:159], v[158:159], v[90:91]
    v_cvt_pk_bf16_f32 v28, v152, v153
    v_cvt_pk_bf16_f32 v29, v154, v155
    v_cvt_pk_bf16_f32 v30, v156, v157
    v_cvt_pk_bf16_f32 v31, v158, v159
    v_pk_mul_f32 v[160:161], v[160:161], v[88:89]
    v_pk_mul_f32 v[162:163], v[162:163], v[88:89]
    v_pk_mul_f32 v[164:165], v[164:165], v[88:89]
    v_pk_mul_f32 v[166:167], v[166:167], v[88:89]
    v_cvt_pk_bf16_f32 v32, v160, v161
    v_cvt_pk_bf16_f32 v33, v162, v163
    v_cvt_pk_bf16_f32 v34, v164, v165
    v_cvt_pk_bf16_f32 v35, v166, v167
    v_pk_mul_f32 v[168:169], v[168:169], v[90:91]
    v_pk_mul_f32 v[170:171], v[170:171], v[90:91]
    v_pk_mul_f32 v[172:173], v[172:173], v[90:91]
    v_pk_mul_f32 v[174:175], v[174:175], v[90:91]
    v_cvt_pk_bf16_f32 v36, v168, v169
    v_cvt_pk_bf16_f32 v37, v170, v171
    v_cvt_pk_bf16_f32 v38, v172, v173
    v_cvt_pk_bf16_f32 v39, v174, v175
    v_pk_mul_f32 v[176:177], v[176:177], v[88:89]
    v_pk_mul_f32 v[178:179], v[178:179], v[88:89]
    v_pk_mul_f32 v[180:181], v[180:181], v[88:89]
    v_pk_mul_f32 v[182:183], v[182:183], v[88:89]
    v_cvt_pk_bf16_f32 v40, v176, v177
    v_cvt_pk_bf16_f32 v41, v178, v179
    v_cvt_pk_bf16_f32 v42, v180, v181
    v_cvt_pk_bf16_f32 v43, v182, v183
    v_pk_mul_f32 v[184:185], v[184:185], v[90:91]
    v_pk_mul_f32 v[186:187], v[186:187], v[90:91]
    v_pk_mul_f32 v[188:189], v[188:189], v[90:91]
    v_pk_mul_f32 v[190:191], v[190:191], v[90:91]
    v_cvt_pk_bf16_f32 v44, v184, v185
    v_cvt_pk_bf16_f32 v45, v186, v187
    v_cvt_pk_bf16_f32 v46, v188, v189
    v_cvt_pk_bf16_f32 v47, v190, v191
    s_mov_b32 s77, s42
    s_setprio 0
    s_call_b64 s[58:59], Lysvc
    buffer_store_dwordx4 v[16:19], v93, s[12:15], s77 offen offset:0 sc1
    buffer_store_dwordx4 v[20:23], v93, s[12:15], s77 offen offset:256 sc1
    buffer_store_dwordx4 v[24:27], v93, s[12:15], s77 offen offset:2048 sc1
    buffer_store_dwordx4 v[28:31], v93, s[12:15], s77 offen offset:2304 sc1
    s_add_u32 s77, s77, 4096
    buffer_store_dwordx4 v[32:35], v93, s[12:15], s77 offen offset:0 sc1
    buffer_store_dwordx4 v[36:39], v93, s[12:15], s77 offen offset:256 sc1
    buffer_store_dwordx4 v[40:43], v93, s[12:15], s77 offen offset:2048 sc1
    buffer_store_dwordx4 v[44:47], v93, s[12:15], s77 offen offset:2304 sc1
    v_mov_b32 v8, 0
    buffer_load_dword v7, v8, s[12:15], s63 offen sc1
    s_setprio 0
    s_call_b64 s[58:59], Lysvc18
    s_lshr_b32 s42, s2, 3
    s_cmp_eq_u32 s42, 12
    s_cbranch_scc0 Lp2
    s_cmp_eq_u32 s24, 4
    s_cbranch_scc0 Lp2
    s_and_b32 s43, s2, 7
    s_lshl_b32 s43, s43, 9
    v_lshlrev_b32 v23, 3, v1
    v_add_u32 v23, s43, v23
    s_mov_b32 s47, 200000
Lfml_97:
    s_mov_b32 s46, 8192
    buffer_load_dwordx2 v[96:97], v23, s[12:15], s46 offen sc1
    s_mov_b32 s46, 32768
    buffer_load_dwordx2 v[98:99], v23, s[12:15], s46 offen sc1
    s_mov_b32 s46, 57344
    buffer_load_dwordx2 v[100:101], v23, s[12:15], s46 offen sc1
    s_mov_b32 s46, 81920
    buffer_load_dwordx2 v[102:103], v23, s[12:15], s46 offen sc1
    s_mov_b32 s46, 16384
    buffer_load_dwordx2 v[104:105], v23, s[12:15], s46 offen sc1
    s_mov_b32 s46, 40960
    buffer_load_dwordx2 v[106:107], v23, s[12:15], s46 offen sc1
    s_mov_b32 s46, 65536
    buffer_load_dwordx2 v[108:109], v23, s[12:15], s46 offen sc1
    s_mov_b32 s46, 90112
    buffer_load_dwordx2 v[110:111], v23, s[12:15], s46 offen sc1
    s_mov_b32 s46, 12288
    buffer_load_dwordx2 v[112:113], v23, s[12:15], s46 offen sc1
    s_mov_b32 s46, 36864
    buffer_load_dwordx2 v[114:115], v23, s[12:15], s46 offen sc1
    s_mov_b32 s46, 61440
    buffer_load_dwordx2 v[116:117], v23, s[12:15], s46 offen sc1
    s_mov_b32 s46, 86016
    buffer_load_dwordx2 v[118:119], v23, s[12:15], s46 offen sc1
    s_mov_b32 s46, 20480
    buffer_load_dwordx2 v[120:121], v23, s[12:15], s46 offen sc1
    s_mov_b32 s46, 45056
    buffer_load_dwordx2 v[122:123], v23, s[12:15], s46 offen sc1
    s_mov_b32 s46, 69632
    buffer_load_dwordx2 v[124:125], v23, s[12:15], s46 offen sc1
    s_mov_b32 s46, 94208
    buffer_load_dwordx2 v[126:127], v23, s[12:15], s46 offen sc1
    s_waitcnt vmcnt(0)
    v_xor_b32 v92, s64, v97
    v_xor_b32 v93, s64, v99
    v_or_b32 v92, v92, v93
    v_xor_b32 v93, s64, v101
    v_or_b32 v92, v92, v93
    v_xor_b32 v93, s64, v103
    v_or_b32 v92, v92, v93
    v_xor_b32 v93, s64, v105
    v_or_b32 v92, v92, v93
    v_xor_b32 v93, s64, v107
    v_or_b32 v92, v92, v93
    v_xor_b32 v93, s64, v109
    v_or_b32 v92, v92, v93
    v_xor_b32 v93, s64, v111
    v_or_b32 v92, v92, v93
    v_xor_b32 v93, s64, v113
    v_or_b32 v92, v92, v93
    v_xor_b32 v93, s64, v115
    v_or_b32 v92, v92, v93
    v_xor_b32 v93, s64, v117
    v_or_b32 v92, v92, v93
    v_xor_b32 v93, s64, v119
    v_or_b32 v92, v92, v93
    v_xor_b32 v93, s64, v121
    v_or_b32 v92, v92, v93
    v_xor_b32 v93, s64, v123
    v_or_b32 v92, v92, v93
    v_xor_b32 v93, s64, v125
    v_or_b32 v92, v92, v93
    v_xor_b32 v93, s64, v127
    v_or_b32 v92, v92, v93
    v_cmp_ne_u32 vcc, 0, v92
    s_nop 0
    s_cbranch_vccz Lfmok_98
    s_sub_u32 s47, s47, 1
    s_cbranch_scc0 Lfml_97
Lfmok_98:
    v_add_f32 v96, v96, v98
    v_add_f32 v100, v100, v102
    v_add_f32 v96, v96, v100
    v_add_f32 v104, v104, v106
    v_add_f32 v108, v108, v110
    v_add_f32 v104, v104, v108
    v_add_f32 v112, v112, v114
    v_add_f32 v116, v116, v118
    v_add_f32 v112, v112, v116
    v_add_f32 v120, v120, v122
    v_add_f32 v124, v124, v126
    v_add_f32 v120, v120, v124
    v_cvt_pk_bf16_f32 v97, v96, v104
    v_lshlrev_b32 v96, 16, v97
    v_and_b32 v104, 0xffff0000, v97
    v_add_f32 v104, 1.0, v104
    v_cvt_pk_bf16_f32 v97, v112, v104
    v_cvt_pk_bf16_f32 v98, v120, v120
    v_and_b32 v98, 0xffff0000, v98
    v_mov_b32 v99, s64
    v_lshlrev_b32 v23, 1, v23
    s_mov_b32 s43, 327680
    buffer_store_dwordx4 v[96:99], v23, s[12:15], s43 offen sc1
Lp2:
    s_cmp_lt_u32 s26, 3
    s_cselect_b32 s42, 8, 4
    s_add_u32 s42, s35, s42
    s_cmp_ge_u32 s42, s37
    s_cbranch_scc1 Lp3
    s_call_b64 s[58:59], Lysvc
    s_branch Lp2
Lp3:
    s_cmp_ge_u32 s2, 224
    s_cbranch_scc1 Lp4
    v_lshrrev_b32 v16, 3, v1
    v_and_b32 v17, 7, v1
    v_bfe_u32 v18, v1, 4, 1
    v_lshlrev_b32 v18, 2, v18
    v_xor_b32 v17, v17, v18
    v_lshlrev_b32 v17, 4, v17
    v_lshl_add_u32 v10, v16, 10, v17
    v_add_u32 v11, 8192, v10
    v_xor_b32 v4, 16, v10
    v_xor_b32 v5, 16, v11
    s_mov_b32 s72, s56
    s_mov_b32 s73, s57
    s_mov_b32 s74, 1835008
    s_mov_b32 s75, 0x20000
    s_lshl_b32 s76, s27, 14
    s_lshl_b32 s42, s26, 7
    s_add_u32 s76, s76, s42
    s_add_u32 s76, s76, 786432
    s_cmp_lt_u32 s26, 3
    s_cbranch_scc1 Lp3f
    buffer_load_dwordx4 v[128:131], v10, s[72:75], s76 offen
    buffer_load_dwordx4 v[132:135], v11, s[72:75], s76 offen
    s_add_u32 s76, s76, 65536
    buffer_load_dwordx4 v[136:139], v4, s[72:75], s76 offen
    buffer_load_dwordx4 v[140:143], v5, s[72:75], s76 offen
    s_add_u32 s76, s76, 65536
    buffer_load_dwordx4 v[144:147], v10, s[72:75], s76 offen
    buffer_load_dwordx4 v[148:151], v11, s[72:75], s76 offen
    s_add_u32 s76, s76, 65536
    buffer_load_dwordx4 v[152:155], v4, s[72:75], s76 offen
    buffer_load_dwordx4 v[156:159], v5, s[72:75], s76 offen
    s_add_u32 s76, s76, 65536
    s_call_b64 s[58:59], Lysvc17
    buffer_load_dwordx4 v[160:163], v10, s[72:75], s76 offen
    buffer_load_dwordx4 v[164:167], v11, s[72:75], s76 offen
    s_add_u32 s76, s76, 65536
    buffer_load_dwordx4 v[168:171], v4, s[72:75], s76 offen
    buffer_load_dwordx4 v[172:175], v5, s[72:75], s76 offen
    s_add_u32 s76, s76, 65536
    buffer_load_dwordx4 v[176:179], v10, s[72:75], s76 offen
    buffer_load_dwordx4 v[180:183], v11, s[72:75], s76 offen
    s_add_u32 s76, s76, 65536
    buffer_load_dwordx4 v[184:187], v4, s[72:75], s76 offen
    buffer_load_dwordx4 v[188:191], v5, s[72:75], s76 offen
    s_add_u32 s76, s76, 65536
    s_call_b64 s[58:59], Lysvc17
    buffer_load_dwordx4 v[192:195], v10, s[72:75], s76 offen
    buffer_load_dwordx4 v[196:199], v11, s[72:75], s76 offen
    s_add_u32 s76, s76, 65536
    buffer_load_dwordx4 v[200:203], v4, s[72:75], s76 offen
    buffer_load_dwordx4 v[204:207], v5, s[72:75], s76 offen
    s_add_u32 s76, s76, 65536
    buffer_load_dwordx4 v[208:211], v10, s[72:75], s76 offen
    buffer_load_dwordx4 v[212:215], v11, s[72:75], s76 offen
    s_add_u32 s76, s76, 65536
    buffer_load_dwordx4 v[216:219], v4, s[72:75], s76 offen
    buffer_load_dwordx4 v[220:223], v5, s[72:75], s76 offen
    s_add_u32 s76, s76, 65536
    s_call_b64 s[58:59], Lysvc17
    buffer_load_dwordx4 v[224:227], v10, s[72:75], s76 offen
    buffer_load_dwordx4 v[228:231], v11, s[72:75], s76 offen
    s_add_u32 s76, s76, 65536
    buffer_load_dwordx4 v[232:235], v4, s[72:75], s76 offen
    buffer_load_dwordx4 v[236:239], v5, s[72:75], s76 offen
    s_add_u32 s76, s76, 65536
    buffer_load_dwordx4 v[240:243], v10, s[72:75], s76 offen
    buffer_load_dwordx4 v[244:247], v11, s[72:75], s76 offen
    s_add_u32 s76, s76, 65536
    buffer_load_dwordx4 v[248:251], v4, s[72:75], s76 offen
    buffer_load_dwordx4 v[252:255], v5, s[72:75], s76 offen
    s_add_u32 s76, s76, 65536
    s_call_b64 s[58:59], Lysvc17
    s_branch Lp4
Lp3f:
    buffer_load_dwordx4 v[128:131], v10, s[72:75], s76 offen
    buffer_load_dwordx4 v[132:135], v11, s[72:75], s76 offen
    s_add_u32 s76, s76, 65536
    buffer_load_dwordx4 v[136:139], v4, s[72:75], s76 offen
    buffer_load_dwordx4 v[140:143], v5, s[72:75], s76 offen
    s_add_u32 s76, s76, 65536
    s_call_b64 s[58:59], Lysvc13
    buffer_load_dwordx4 v[144:147], v10, s[72:75], s76 offen
    buffer_load_dwordx4 v[148:151], v11, s[72:75], s76 offen
    s_add_u32 s76, s76, 65536
    buffer_load_dwordx4 v[152:155], v4, s[72:75], s76 offen
    buffer_load_dwordx4 v[156:159], v5, s[72:75], s76 offen
    s_add_u32 s76, s76, 65536
    s_call_b64 s[58:59], Lysvc13
    buffer_load_dwordx4 v[160:163], v10, s[72:75], s76 offen
    buffer_load_dwordx4 v[164:167], v11, s[72:75], s76 offen
    s_add_u32 s76, s76, 65536
    buffer_load_dwordx4 v[168:171], v4, s[72:75], s76 offen
    buffer_load_dwordx4 v[172:175], v5, s[72:75], s76 offen
    s_add_u32 s76, s76, 65536
    s_call_b64 s[58:59], Lysvc13
    buffer_load_dwordx4 v[176:179], v10, s[72:75], s76 offen
    buffer_load_dwordx4 v[180:183], v11, s[72:75], s76 offen
    s_add_u32 s76, s76, 65536
    buffer_load_dwordx4 v[184:187], v4, s[72:75], s76 offen
    buffer_load_dwordx4 v[188:191], v5, s[72:75], s76 offen
    s_add_u32 s76, s76, 65536
    s_call_b64 s[58:59], Lysvc13
    buffer_load_dwordx4 v[192:195], v10, s[72:75], s76 offen
    buffer_load_dwordx4 v[196:199], v11, s[72:75], s76 offen
    s_add_u32 s76, s76, 65536
    buffer_load_dwordx4 v[200:203], v4, s[72:75], s76 offen
    buffer_load_dwordx4 v[204:207], v5, s[72:75], s76 offen
    s_add_u32 s76, s76, 65536
    s_call_b64 s[58:59], Lysvc13
    buffer_load_dwordx4 v[208:211], v10, s[72:75], s76 offen
    buffer_load_dwordx4 v[212:215], v11, s[72:75], s76 offen
    s_add_u32 s76, s76, 65536
    buffer_load_dwordx4 v[216:219], v4, s[72:75], s76 offen
    buffer_load_dwordx4 v[220:223], v5, s[72:75], s76 offen
    s_add_u32 s76, s76, 65536
    s_call_b64 s[58:59], Lysvc13
    buffer_load_dwordx4 v[224:227], v10, s[72:75], s76 offen
    buffer_load_dwordx4 v[228:231], v11, s[72:75], s76 offen
    s_add_u32 s76, s76, 65536
    buffer_load_dwordx4 v[232:235], v4, s[72:75], s76 offen
    buffer_load_dwordx4 v[236:239], v5, s[72:75], s76 offen
    s_add_u32 s76, s76, 65536
    s_call_b64 s[58:59], Lysvc13
    buffer_load_dwordx4 v[240:243], v10, s[72:75], s76 offen
    buffer_load_dwordx4 v[244:247], v11, s[72:75], s76 offen
    s_add_u32 s76, s76, 65536
    buffer_load_dwordx4 v[248:251], v4, s[72:75], s76 offen
    buffer_load_dwordx4 v[252:255], v5, s[72:75], s76 offen
    s_add_u32 s76, s76, 65536
    s_call_b64 s[58:59], Lysvc13
Lp4:
    s_cmp_eq_u32 s24, 7
    s_cbranch_scc0 Lc2_99
    s_getpc_b64 s[76:77]
Lct_100:
    s_sub_u32 s76, s76, Lct_100 - adaLN_cond__compressed_kv_cla__dense_activation_mish__prompt_kernel
    s_subb_u32 s77, s77, 0
    s_mov_b32 s78, CODE_END - adaLN_cond__compressed_kv_cla__dense_activation_mish__prompt_kernel
    s_mov_b32 s79, 0x20000
    s_lshr_b32 s42, s2, 3
    s_lshl_b32 s42, s42, 12
    v_and_b32 v16, 31, v1
    v_lshlrev_b32 v16, 7, v16
    buffer_load_dword v7, v16, s[76:79], s42 offen
Lc2_99:
    s_cmp_ge_u32 s2, 128
    s_cbranch_scc1 Lfin
    v_lshlrev_b32 v6, 7, v1
    buffer_load_dword v7, v6, s[68:71], s60 offen
    s_add_u32 s60, s60, 0x100000
    buffer_load_dword v7, v6, s[68:71], s60 offen
    s_lshl_b32 s42, s2, 3
    s_add_u32 s42, s42, s24
    s_cmp_eq_u32 s42, 836
    s_cbranch_scc0 Lfin
    v_lshrrev_b32 v5, 4, v1
    v_and_b32 v4, 15, v1
    v_lshlrev_b32 v4, 2, v4
    v_lshl_add_u32 v4, v5, 7, v4
    v_add_u32 v20, 135168, v4
    buffer_load_dword v16, v20, s[12:15], 0 offen sc1
    v_add_u32 v21, 135680, v4
    buffer_load_dword v17, v21, s[12:15], 0 offen sc1
    v_add_u32 v22, 136192, v4
    buffer_load_dword v18, v22, s[12:15], 0 offen sc1
    v_add_u32 v23, 136704, v4
    buffer_load_dword v19, v23, s[12:15], 0 offen sc1
    s_waitcnt vmcnt(0)
    s_mov_b32 s42, 200000
Lpl_101:
    v_cmp_ne_u32 vcc, s64, v16
    s_nop 0
    s_cbranch_vccz Lok_102
    s_sub_u32 s42, s42, 1
    s_cbranch_scc1 Lok_102
    s_sleep 4
    buffer_load_dword v16, v20, s[12:15], 0 offen sc1
    s_waitcnt vmcnt(0)
    s_branch Lpl_101
Lok_102:
    s_mov_b32 s42, 200000
Lpl_103:
    v_cmp_ne_u32 vcc, s64, v17
    s_nop 0
    s_cbranch_vccz Lok_104
    s_sub_u32 s42, s42, 1
    s_cbranch_scc1 Lok_104
    s_sleep 4
    buffer_load_dword v17, v21, s[12:15], 0 offen sc1
    s_waitcnt vmcnt(0)
    s_branch Lpl_103
Lok_104:
    s_mov_b32 s42, 200000
Lpl_105:
    v_cmp_ne_u32 vcc, s64, v18
    s_nop 0
    s_cbranch_vccz Lok_106
    s_sub_u32 s42, s42, 1
    s_cbranch_scc1 Lok_106
    s_sleep 4
    buffer_load_dword v18, v22, s[12:15], 0 offen sc1
    s_waitcnt vmcnt(0)
    s_branch Lpl_105
Lok_106:
    s_mov_b32 s42, 200000
Lpl_107:
    v_cmp_ne_u32 vcc, s64, v19
    s_nop 0
    s_cbranch_vccz Lok_108
    s_sub_u32 s42, s42, 1
    s_cbranch_scc1 Lok_108
    s_sleep 4
    buffer_load_dword v19, v23, s[12:15], 0 offen sc1
    s_waitcnt vmcnt(0)
    s_branch Lpl_107
Lok_108:
    v_mov_b32 v4, s64
    v_mov_b32 v5, 131072
    s_mov_b64 exec, 1
    buffer_store_dword v4, v5, s[12:15], 0 offen sc1
    s_mov_b64 exec, -1
Lfin:
    s_setprio 0
    v_mov_b32 v26, s26
    v_mov_b32 v27, s37
    v_cmp_gt_u32 vcc, 4, v1
    s_nop 1
    v_cndmask_b32 v26, v27, v26, vcc
    v_and_b32 v27, 3, v1
    v_lshlrev_b32 v27, 9, v27
    v_lshl_add_u32 v28, v26, 11, v27
    s_bfe_u32 s42, s25, 0x10002
    s_and_b32 s43, s25, 3
    s_bfe_u32 s44, s25, 0x10003
    s_lshl_b32 s44, s44, 2
    s_add_u32 s43, s43, s44
    s_and_b32 s44, s25, 15
    s_sub_u32 s45, s44, 8
    s_cmp_ge_u32 s44, 16
    s_cselect_b32 s42, 0, s42
    s_cselect_b32 s43, s45, s43
    s_lshr_b32 s44, s25, 4
    s_lshl_b32 s44, s44, 1
    s_add_u32 s42, s42, s44
    s_lshl_b32 s42, s42, 7
    s_lshl_b32 s43, s43, 2
    s_add_u32 s42, s42, s43
    s_add_u32 s74, s42, 16252928
    s_load_dwordx2 s[8:9], s[0:1], 40
    s_load_dwordx2 s[16:17], s[0:1], 0
    s_load_dwordx2 s[20:21], s[0:1], 56
    s_load_dwordx2 s[48:49], s[0:1], 64
    s_load_dwordx2 s[52:53], s[0:1], 72
    s_load_dwordx2 s[56:57], s[0:1], 96
    s_mov_b32 s10, 4194304
    s_mov_b32 s11, 0x20000
    s_mov_b32 s18, 2097152
    s_mov_b32 s19, 0x20000
    s_mov_b32 s22, 1835008
    s_mov_b32 s23, 0x20000
    s_mov_b32 s50, 3584
    s_mov_b32 s51, 0x20000
    s_mov_b32 s54, 1835008
    s_mov_b32 s55, 0x20000
    s_mov_b32 s58, 2097152
    s_mov_b32 s59, 0x20000
    s_bfe_u32 s31, s2, 131072
    s_bfe_u32 s25, s2, 65538
    s_lshl_b32 s25, s25, 3
    s_bfe_u32 s26, s2, 196611
    s_add_u32 s25, s25, s26
    s_lshr_b32 s26, s2, 6
    s_and_b32 s29, s24, 3
    s_lshl_b32 s27, s25, 2
    s_add_u32 s27, s27, s29
    s_lshl_b32 s27, s27, 18
    s_lshr_b32 s43, s31, 1
    s_lshl_b32 s43, s43, 2
    s_and_b32 s42, s31, 1
    s_add_u32 s43, s43, s42
    s_lshl_b32 s42, s43, 15
    s_add_u32 s27, s27, s42
    s_add_u32 s27, s27, 51380224
    s_lshl_b32 s28, s43, 19
    s_lshl_b32 s42, s29, 14
    s_add_u32 s28, s28, s42
    s_lshl_b32 s42, s26, 8
    s_add_u32 s28, s28, s42
    s_lshl_b32 s30, s29, 12
    v_lshrrev_b32 v13, 4, v1
    v_and_b32 v12, 15, v1
    v_lshlrev_b32 v14, 2, v13
    v_xor_b32 v14, v14, v12
    s_and_b32 s42, s29, 1
    v_xor_b32 v14, s42, v14
    v_lshlrev_b32 v14, 4, v14
    v_mul_u32_u24 v13, 1024, v13
    v_add_u32 v16, v13, v14
    v_add_u32 v17, 3072, v16
    v_add_u32 v18, 6144, v16
    v_add_u32 v19, 9216, v16
    s_lshl_b32 s32, s26, 2
    s_add_u32 s32, s32, s31
    s_and_b32 s60, s2, 7
    s_lshl_b32 s62, s60, 2
    s_lshl_b32 s60, s60, 1
    s_bfe_u32 s42, s2, 0x10003
    s_add_u32 s60, s60, s42
    s_lshr_b32 s61, s2, 4
    v_and_b32 v8, 15, v1
    v_lshlrev_b32 v8, 4, v8
    v_lshrrev_b32 v20, 5, v1
    v_lshl_add_u32 v8, v20, 9, v8
    v_bfe_u32 v20, v1, 4, 1
    v_lshl_add_u32 v8, v20, 10, v8
    v_and_b32 v20, 7, v1
    v_lshrrev_b32 v21, 3, v1
    v_lshrrev_b32 v22, 1, v21
    v_lshlrev_b32 v22, 4, v22
    v_and_b32 v23, 1, v21
    v_lshl_add_u32 v22, v23, 2, v22
    s_lshl_b32 s42, s24, 6
    v_add_u32 v22, s42, v22
    v_and_b32 v23, 3, v20
    v_add_u32 v23, v23, v22
    v_lshrrev_b32 v24, 2, v20
    v_lshl_add_u32 v23, v24, 3, v23
    v_lshlrev_b32 v23, 4, v23
    v_lshlrev_b32 v24, 10, v20
    v_lshl_add_u32 v24, v22, 1, v24
    s_lshl_b32 s33, s60, 17
    s_lshl_b32 s42, s61, 13
    s_add_u32 s33, s33, s42
    v_lshlrev_b32 v25, 4, v20
    v_lshl_add_u32 v25, v21, 9, v25
    s_lshr_b32 s34, s61, 2
    s_lshl_b32 s34, s34, 15
    s_lshl_b32 s42, s24, 12
    s_add_u32 s34, s34, s42
    s_and_b32 s42, s61, 3
    s_lshl_b32 s42, s42, 7
    s_add_u32 s34, s34, s42
    s_bfe_u32 s42, s2, 0x20003
    s_add_u32 s62, s62, s42
    s_lshr_b32 s63, s2, 5
    s_lshl_b32 s65, s63, 10
    s_add_u32 s65, s65, 327680
    s_mov_b32 s46, 327680
    v_lshlrev_b32 v29, 3, v1
    v_lshlrev_b32 v30, 5, v20
    s_min_u32 s66, s61, 13
    s_lshl_b32 s66, s66, 8
    s_lshl_b32 s35, s25, 19
    s_add_u32 s35, s35, 69206016
    s_lshr_b32 s72, s62, 1
    s_and_b32 s73, s62, 1
    s_lshl_b32 s73, s73, 3
    s_add_u32 s73, s73, s63
    s_waitcnt lgkmcnt(0)
    s_cmp_ge_u32 s24, 4
    s_cbranch_scc1 Loy
    s_and_b32 s42, s24, 1
    s_lshl_b32 s42, s42, 13
    v_add_u32 v6, s42, v8
    v_lshrrev_b32 v13, 5, v1
    v_bfe_u32 v12, v1, 2, 2
    v_bfe_u32 v15, v1, 4, 1
    v_lshl_add_u32 v14, v13, 2, v12
    v_lshl_add_u32 v14, v15, 4, v14
    v_lshlrev_b32 v14, 8, v14
    v_lshl_add_u32 v14, v15, 4, v14
    v_and_b32 v7, 1, v1
    v_lshl_add_u32 v14, v7, 5, v14
    v_bfe_u32 v7, v1, 1, 1
    v_lshl_add_u32 v14, v7, 3, v14
    v_add_u32 v14, 16384, v14
    s_and_b32 s42, s24, 2
    v_xor_b32 v7, s42, v12
    v_lshl_add_u32 v7, v7, 6, v14
    v_lshlrev_b32 v31, 5, v15
    v_lshl_add_u32 v31, v13, 3, v31
    s_and_b32 s42, s24, 2
    s_lshl_b32 s42, s42, 6
    s_add_u32 s67, s66, s42
    s_and_b32 s68, s24, 1
    s_lshl_b32 s68, s68, 1
    s_and_b32 s42, s24, 2
    s_lshl_b32 s69, s42, 11
    s_lshl_b32 s42, s31, 17
    s_add_u32 s36, s35, s42
    s_lshl_b32 s42, s68, 15
    s_add_u32 s36, s36, s42
    s_lshl_b32 s42, s26, 13
    s_add_u32 s36, s36, s42
    s_add_u32 s36, s36, s69
    s_add_u32 s37, s36, 32768
    s_waitcnt lgkmcnt(0)
    s_waitcnt vmcnt(0)
    s_barrier
    s_cmp_eq_u32 s24, 0
    s_cbranch_scc0 Lcs_109
    v_mov_b32 v26, s64
    s_mov_b64 exec, 0xff
    buffer_store_dword v26, v28, s[12:15], s74 offen sc1
    s_mov_b64 exec, -1
Lcs_109:
    buffer_load_dwordx4 v[96:99], v23, s[12:15], s46 offen sc1
    buffer_load_dwordx4 v[100:103], v2, s[12:15], s65 offen sc1
    buffer_load_dwordx2 v[88:89], v24, s[16:19], s33 offen
    buffer_load_dwordx2 v[90:91], v24, s[16:19], s33 offen offset:16
    v_lshlrev_b32 v94, 10, v20
    buffer_load_ushort v94, v94, s[16:19], s33 offen
    s_cmp_eq_u32 s24, 0
    s_cbranch_scc0 Lcs_110
    s_lshl_b32 s42, s25, 11
    s_lshl_b32 s43, s32, 7
    s_add_u32 s42, s42, s43
    s_add_u32 s42, s42, 16252928
    s_bitcmp1_b32 s31, 0
    s_cselect_b32 s43, 7, 7
    v_min_u32 v27, s43, v1
    v_lshlrev_b32 v27, 2, v27
    v_add_u32 v27, s42, v27
    s_mov_b32 s42, 200000
Lpl_111:
    buffer_load_dword v26, v27, s[12:15], 0 offen sc1
    s_waitcnt vmcnt(0)
    v_cmp_ne_u32 vcc, s64, v26
    s_nop 0
    s_cbranch_vccz Lok_112
    s_sleep 3
    s_sub_u32 s42, s42, 1
    s_cbranch_scc0 Lpl_111
Lok_112:
Lcs_110:
    s_barrier
    v_add_u32 v9, 0, v6
    v_add_u32 v10, 0, v7
    v_xor_b32 v11, 16, v10
    v_xor_b32 v12, 64, v10
    v_xor_b32 v13, 0x50, v10
    s_barrier
    ds_read_b64_tr_b16 v[32:33], v10 offset:0
    ds_read_b64_tr_b16 v[34:35], v10 offset:2048
    ds_read_b128 v[48:51], v9 offset:0
    ds_read_b64_tr_b16 v[36:37], v11 offset:0
    ds_read_b64_tr_b16 v[38:39], v11 offset:2048
    ds_read_b64_tr_b16 v[40:41], v12 offset:0
    ds_read_b64_tr_b16 v[42:43], v12 offset:2048
    ds_read_b64_tr_b16 v[44:45], v13 offset:0
    ds_read_b64_tr_b16 v[46:47], v13 offset:2048
    ds_read_b128 v[52:55], v9 offset:256
    ds_read_b128 v[56:59], v9 offset:4096
    ds_read_b128 v[60:63], v9 offset:4352
    s_waitcnt lgkmcnt(9)
    v_mfma_f32_16x16x32_bf16 v[128:131], v[32:35], v[48:51], 0
    ds_read_b64_tr_b16 v[192:193], v10 offset:8192
    s_waitcnt lgkmcnt(8)
    v_mfma_f32_16x16x32_bf16 v[132:135], v[36:39], v[48:51], 0
    ds_read_b64_tr_b16 v[194:195], v10 offset:10240
    s_waitcnt lgkmcnt(7)
    v_mfma_f32_16x16x32_bf16 v[136:139], v[40:43], v[48:51], 0
    ds_read_b128 v[208:211], v9 offset:2048
    s_waitcnt lgkmcnt(6)
    v_mfma_f32_16x16x32_bf16 v[140:143], v[44:47], v[48:51], 0
    ds_read_b64_tr_b16 v[196:197], v11 offset:8192
    s_waitcnt lgkmcnt(6)
    v_mfma_f32_16x16x32_bf16 v[156:159], v[44:47], v[52:55], 0
    ds_read_b64_tr_b16 v[198:199], v11 offset:10240
    v_mfma_f32_16x16x32_bf16 v[152:155], v[40:43], v[52:55], 0
    ds_read_b64_tr_b16 v[200:201], v12 offset:8192
    v_mfma_f32_16x16x32_bf16 v[148:151], v[36:39], v[52:55], 0
    ds_read_b64_tr_b16 v[202:203], v12 offset:10240
    v_mfma_f32_16x16x32_bf16 v[144:147], v[32:35], v[52:55], 0
    ds_read_b64_tr_b16 v[204:205], v13 offset:8192
    s_waitcnt lgkmcnt(9)
    v_mfma_f32_16x16x32_bf16 v[160:163], v[32:35], v[56:59], 0
    ds_read_b64_tr_b16 v[206:207], v13 offset:10240
    v_mfma_f32_16x16x32_bf16 v[164:167], v[36:39], v[56:59], 0
    ds_read_b128 v[212:215], v9 offset:2304
    v_mfma_f32_16x16x32_bf16 v[168:171], v[40:43], v[56:59], 0
    ds_read_b128 v[216:219], v9 offset:6144
    v_mfma_f32_16x16x32_bf16 v[172:175], v[44:47], v[56:59], 0
    ds_read_b128 v[220:223], v9 offset:6400
    s_waitcnt lgkmcnt(12)
    v_mfma_f32_16x16x32_bf16 v[188:191], v[44:47], v[60:63], 0
    v_add_u32 v9, 32768, v6
    v_add_u32 v10, 32768, v7
    v_mfma_f32_16x16x32_bf16 v[184:187], v[40:43], v[60:63], 0
    v_xor_b32 v11, 16, v10
    v_xor_b32 v12, 64, v10
    v_mfma_f32_16x16x32_bf16 v[180:183], v[36:39], v[60:63], 0
    v_xor_b32 v13, 0x50, v10
    v_mfma_f32_16x16x32_bf16 v[176:179], v[32:35], v[60:63], 0
    s_barrier
    s_waitcnt lgkmcnt(9)
    v_mfma_f32_16x16x32_bf16 v[128:131], v[192:195], v[208:211], v[128:131]
    ds_read_b64_tr_b16 v[32:33], v10 offset:0
    s_waitcnt lgkmcnt(8)
    v_mfma_f32_16x16x32_bf16 v[132:135], v[196:199], v[208:211], v[132:135]
    ds_read_b64_tr_b16 v[34:35], v10 offset:2048
    s_waitcnt lgkmcnt(7)
    v_mfma_f32_16x16x32_bf16 v[136:139], v[200:203], v[208:211], v[136:139]
    ds_read_b128 v[48:51], v9 offset:0
    s_waitcnt lgkmcnt(6)
    v_mfma_f32_16x16x32_bf16 v[140:143], v[204:207], v[208:211], v[140:143]
    ds_read_b64_tr_b16 v[36:37], v11 offset:0
    s_waitcnt lgkmcnt(6)
    v_mfma_f32_16x16x32_bf16 v[156:159], v[204:207], v[212:215], v[156:159]
    ds_read_b64_tr_b16 v[38:39], v11 offset:2048
    v_mfma_f32_16x16x32_bf16 v[152:155], v[200:203], v[212:215], v[152:155]
    ds_read_b64_tr_b16 v[40:41], v12 offset:0
    v_mfma_f32_16x16x32_bf16 v[148:151], v[196:199], v[212:215], v[148:151]
    ds_read_b64_tr_b16 v[42:43], v12 offset:2048
    v_mfma_f32_16x16x32_bf16 v[144:147], v[192:195], v[212:215], v[144:147]
    ds_read_b64_tr_b16 v[44:45], v13 offset:0
    s_waitcnt lgkmcnt(9)
    v_mfma_f32_16x16x32_bf16 v[160:163], v[192:195], v[216:219], v[160:163]
    ds_read_b64_tr_b16 v[46:47], v13 offset:2048
    v_mfma_f32_16x16x32_bf16 v[164:167], v[196:199], v[216:219], v[164:167]
    ds_read_b128 v[52:55], v9 offset:256
    v_mfma_f32_16x16x32_bf16 v[168:171], v[200:203], v[216:219], v[168:171]
    ds_read_b128 v[56:59], v9 offset:4096
    v_mfma_f32_16x16x32_bf16 v[172:175], v[204:207], v[216:219], v[172:175]
    ds_read_b128 v[60:63], v9 offset:4352
    s_waitcnt lgkmcnt(12)
    v_mfma_f32_16x16x32_bf16 v[188:191], v[204:207], v[220:223], v[188:191]
    v_mfma_f32_16x16x32_bf16 v[184:187], v[200:203], v[220:223], v[184:187]
    v_mfma_f32_16x16x32_bf16 v[180:183], v[196:199], v[220:223], v[180:183]
    v_mfma_f32_16x16x32_bf16 v[176:179], v[192:195], v[220:223], v[176:179]
    s_waitcnt lgkmcnt(9)
    v_mfma_f32_16x16x32_bf16 v[128:131], v[32:35], v[48:51], v[128:131]
    ds_read_b64_tr_b16 v[192:193], v10 offset:8192
    s_waitcnt lgkmcnt(8)
    v_mfma_f32_16x16x32_bf16 v[132:135], v[36:39], v[48:51], v[132:135]
    ds_read_b64_tr_b16 v[194:195], v10 offset:10240
    s_waitcnt lgkmcnt(7)
    v_mfma_f32_16x16x32_bf16 v[136:139], v[40:43], v[48:51], v[136:139]
    ds_read_b128 v[208:211], v9 offset:2048
    s_waitcnt lgkmcnt(6)
    v_mfma_f32_16x16x32_bf16 v[140:143], v[44:47], v[48:51], v[140:143]
    ds_read_b64_tr_b16 v[196:197], v11 offset:8192
    s_waitcnt lgkmcnt(6)
    v_mfma_f32_16x16x32_bf16 v[156:159], v[44:47], v[52:55], v[156:159]
    ds_read_b64_tr_b16 v[198:199], v11 offset:10240
    v_mfma_f32_16x16x32_bf16 v[152:155], v[40:43], v[52:55], v[152:155]
    ds_read_b64_tr_b16 v[200:201], v12 offset:8192
    v_mfma_f32_16x16x32_bf16 v[148:151], v[36:39], v[52:55], v[148:151]
    ds_read_b64_tr_b16 v[202:203], v12 offset:10240
    v_mfma_f32_16x16x32_bf16 v[144:147], v[32:35], v[52:55], v[144:147]
    ds_read_b64_tr_b16 v[204:205], v13 offset:8192
    s_waitcnt lgkmcnt(9)
    v_mfma_f32_16x16x32_bf16 v[160:163], v[32:35], v[56:59], v[160:163]
    ds_read_b64_tr_b16 v[206:207], v13 offset:10240
    v_mfma_f32_16x16x32_bf16 v[164:167], v[36:39], v[56:59], v[164:167]
    ds_read_b128 v[212:215], v9 offset:2304
    v_mfma_f32_16x16x32_bf16 v[168:171], v[40:43], v[56:59], v[168:171]
    ds_read_b128 v[216:219], v9 offset:6144
    v_mfma_f32_16x16x32_bf16 v[172:175], v[44:47], v[56:59], v[172:175]
    ds_read_b128 v[220:223], v9 offset:6400
    s_waitcnt lgkmcnt(12)
    v_mfma_f32_16x16x32_bf16 v[188:191], v[44:47], v[60:63], v[188:191]
    v_add_u32 v9, 65536, v6
    v_add_u32 v10, 65536, v7
    v_mfma_f32_16x16x32_bf16 v[184:187], v[40:43], v[60:63], v[184:187]
    v_xor_b32 v11, 16, v10
    v_xor_b32 v12, 64, v10
    v_mfma_f32_16x16x32_bf16 v[180:183], v[36:39], v[60:63], v[180:183]
    v_xor_b32 v13, 0x50, v10
    v_mfma_f32_16x16x32_bf16 v[176:179], v[32:35], v[60:63], v[176:179]
    s_waitcnt lgkmcnt(0)
    v_mfma_f32_16x16x32_bf16 v[128:131], v[192:195], v[208:211], v[128:131]
    s_barrier
    ds_read_b64_tr_b16 v[32:33], v10 offset:0
    v_mfma_f32_16x16x32_bf16 v[132:135], v[196:199], v[208:211], v[132:135]
    ds_read_b64_tr_b16 v[34:35], v10 offset:2048
    v_mfma_f32_16x16x32_bf16 v[136:139], v[200:203], v[208:211], v[136:139]
    ds_read_b128 v[48:51], v9 offset:0
    v_mfma_f32_16x16x32_bf16 v[140:143], v[204:207], v[208:211], v[140:143]
    ds_read_b64_tr_b16 v[36:37], v11 offset:0
    v_mfma_f32_16x16x32_bf16 v[156:159], v[204:207], v[212:215], v[156:159]
    ds_read_b64_tr_b16 v[38:39], v11 offset:2048
    v_mfma_f32_16x16x32_bf16 v[152:155], v[200:203], v[212:215], v[152:155]
    ds_read_b64_tr_b16 v[40:41], v12 offset:0
    v_mfma_f32_16x16x32_bf16 v[148:151], v[196:199], v[212:215], v[148:151]
    ds_read_b64_tr_b16 v[42:43], v12 offset:2048
    v_mfma_f32_16x16x32_bf16 v[144:147], v[192:195], v[212:215], v[144:147]
    ds_read_b64_tr_b16 v[44:45], v13 offset:0
    v_mfma_f32_16x16x32_bf16 v[160:163], v[192:195], v[216:219], v[160:163]
    ds_read_b64_tr_b16 v[46:47], v13 offset:2048
    v_mfma_f32_16x16x32_bf16 v[164:167], v[196:199], v[216:219], v[164:167]
    ds_read_b128 v[52:55], v9 offset:256
    v_mfma_f32_16x16x32_bf16 v[168:171], v[200:203], v[216:219], v[168:171]
    ds_read_b128 v[56:59], v9 offset:4096
    v_mfma_f32_16x16x32_bf16 v[172:175], v[204:207], v[216:219], v[172:175]
    ds_read_b128 v[60:63], v9 offset:4352
    v_mfma_f32_16x16x32_bf16 v[188:191], v[204:207], v[220:223], v[188:191]
    v_mfma_f32_16x16x32_bf16 v[184:187], v[200:203], v[220:223], v[184:187]
    v_mfma_f32_16x16x32_bf16 v[180:183], v[196:199], v[220:223], v[180:183]
    v_mfma_f32_16x16x32_bf16 v[176:179], v[192:195], v[220:223], v[176:179]
    s_waitcnt lgkmcnt(9)
    v_mfma_f32_16x16x32_bf16 v[128:131], v[32:35], v[48:51], v[128:131]
    ds_read_b64_tr_b16 v[192:193], v10 offset:8192
    s_waitcnt lgkmcnt(8)
    v_mfma_f32_16x16x32_bf16 v[132:135], v[36:39], v[48:51], v[132:135]
    ds_read_b64_tr_b16 v[194:195], v10 offset:10240
    s_waitcnt lgkmcnt(7)
    v_mfma_f32_16x16x32_bf16 v[136:139], v[40:43], v[48:51], v[136:139]
    ds_read_b128 v[208:211], v9 offset:2048
    s_waitcnt lgkmcnt(6)
    v_mfma_f32_16x16x32_bf16 v[140:143], v[44:47], v[48:51], v[140:143]
    ds_read_b64_tr_b16 v[196:197], v11 offset:8192
    s_waitcnt lgkmcnt(6)
    v_mfma_f32_16x16x32_bf16 v[156:159], v[44:47], v[52:55], v[156:159]
    ds_read_b64_tr_b16 v[198:199], v11 offset:10240
    v_mfma_f32_16x16x32_bf16 v[152:155], v[40:43], v[52:55], v[152:155]
    ds_read_b64_tr_b16 v[200:201], v12 offset:8192
    v_mfma_f32_16x16x32_bf16 v[148:151], v[36:39], v[52:55], v[148:151]
    ds_read_b64_tr_b16 v[202:203], v12 offset:10240
    v_mfma_f32_16x16x32_bf16 v[144:147], v[32:35], v[52:55], v[144:147]
    ds_read_b64_tr_b16 v[204:205], v13 offset:8192
    s_waitcnt lgkmcnt(9)
    v_mfma_f32_16x16x32_bf16 v[160:163], v[32:35], v[56:59], v[160:163]
    ds_read_b64_tr_b16 v[206:207], v13 offset:10240
    v_mfma_f32_16x16x32_bf16 v[164:167], v[36:39], v[56:59], v[164:167]
    ds_read_b128 v[212:215], v9 offset:2304
    v_mfma_f32_16x16x32_bf16 v[168:171], v[40:43], v[56:59], v[168:171]
    ds_read_b128 v[216:219], v9 offset:6144
    v_mfma_f32_16x16x32_bf16 v[172:175], v[44:47], v[56:59], v[172:175]
    ds_read_b128 v[220:223], v9 offset:6400
    s_waitcnt lgkmcnt(12)
    v_mfma_f32_16x16x32_bf16 v[188:191], v[44:47], v[60:63], v[188:191]
    v_add_u32 v9, 98304, v6
    v_add_u32 v10, 98304, v7
    v_mfma_f32_16x16x32_bf16 v[184:187], v[40:43], v[60:63], v[184:187]
    v_xor_b32 v11, 16, v10
    v_xor_b32 v12, 64, v10
    v_mfma_f32_16x16x32_bf16 v[180:183], v[36:39], v[60:63], v[180:183]
    v_xor_b32 v13, 0x50, v10
    v_mfma_f32_16x16x32_bf16 v[176:179], v[32:35], v[60:63], v[176:179]
    s_waitcnt lgkmcnt(9)
    v_mfma_f32_16x16x32_bf16 v[128:131], v[192:195], v[208:211], v[128:131]
    ds_read_b64_tr_b16 v[32:33], v10 offset:0
    s_waitcnt lgkmcnt(8)
    v_mfma_f32_16x16x32_bf16 v[132:135], v[196:199], v[208:211], v[132:135]
    ds_read_b64_tr_b16 v[34:35], v10 offset:2048
    s_waitcnt lgkmcnt(7)
    v_mfma_f32_16x16x32_bf16 v[136:139], v[200:203], v[208:211], v[136:139]
    ds_read_b128 v[48:51], v9 offset:0
    s_waitcnt lgkmcnt(6)
    v_mfma_f32_16x16x32_bf16 v[140:143], v[204:207], v[208:211], v[140:143]
    ds_read_b64_tr_b16 v[36:37], v11 offset:0
    s_waitcnt lgkmcnt(6)
    v_mfma_f32_16x16x32_bf16 v[156:159], v[204:207], v[212:215], v[156:159]
    ds_read_b64_tr_b16 v[38:39], v11 offset:2048
    v_mfma_f32_16x16x32_bf16 v[152:155], v[200:203], v[212:215], v[152:155]
    ds_read_b64_tr_b16 v[40:41], v12 offset:0
    v_mfma_f32_16x16x32_bf16 v[148:151], v[196:199], v[212:215], v[148:151]
    ds_read_b64_tr_b16 v[42:43], v12 offset:2048
    v_mfma_f32_16x16x32_bf16 v[144:147], v[192:195], v[212:215], v[144:147]
    ds_read_b64_tr_b16 v[44:45], v13 offset:0
    s_waitcnt lgkmcnt(9)
    v_mfma_f32_16x16x32_bf16 v[160:163], v[192:195], v[216:219], v[160:163]
    ds_read_b64_tr_b16 v[46:47], v13 offset:2048
    v_mfma_f32_16x16x32_bf16 v[164:167], v[196:199], v[216:219], v[164:167]
    ds_read_b128 v[52:55], v9 offset:256
    v_mfma_f32_16x16x32_bf16 v[168:171], v[200:203], v[216:219], v[168:171]
    ds_read_b128 v[56:59], v9 offset:4096
    v_mfma_f32_16x16x32_bf16 v[172:175], v[204:207], v[216:219], v[172:175]
    ds_read_b128 v[60:63], v9 offset:4352
    s_waitcnt lgkmcnt(12)
    v_mfma_f32_16x16x32_bf16 v[188:191], v[204:207], v[220:223], v[188:191]
    v_mfma_f32_16x16x32_bf16 v[184:187], v[200:203], v[220:223], v[184:187]
    v_mfma_f32_16x16x32_bf16 v[180:183], v[196:199], v[220:223], v[180:183]
    v_mfma_f32_16x16x32_bf16 v[176:179], v[192:195], v[220:223], v[176:179]
    s_waitcnt lgkmcnt(9)
    v_mfma_f32_16x16x32_bf16 v[128:131], v[32:35], v[48:51], v[128:131]
    ds_read_b64_tr_b16 v[192:193], v10 offset:8192
    s_waitcnt lgkmcnt(8)
    v_mfma_f32_16x16x32_bf16 v[132:135], v[36:39], v[48:51], v[132:135]
    ds_read_b64_tr_b16 v[194:195], v10 offset:10240
    s_waitcnt lgkmcnt(7)
    v_mfma_f32_16x16x32_bf16 v[136:139], v[40:43], v[48:51], v[136:139]
    ds_read_b128 v[208:211], v9 offset:2048
    s_waitcnt lgkmcnt(6)
    v_mfma_f32_16x16x32_bf16 v[140:143], v[44:47], v[48:51], v[140:143]
    ds_read_b64_tr_b16 v[196:197], v11 offset:8192
    s_waitcnt lgkmcnt(6)
    v_mfma_f32_16x16x32_bf16 v[156:159], v[44:47], v[52:55], v[156:159]
    ds_read_b64_tr_b16 v[198:199], v11 offset:10240
    v_mfma_f32_16x16x32_bf16 v[152:155], v[40:43], v[52:55], v[152:155]
    ds_read_b64_tr_b16 v[200:201], v12 offset:8192
    v_mfma_f32_16x16x32_bf16 v[148:151], v[36:39], v[52:55], v[148:151]
    ds_read_b64_tr_b16 v[202:203], v12 offset:10240
    v_mfma_f32_16x16x32_bf16 v[144:147], v[32:35], v[52:55], v[144:147]
    ds_read_b64_tr_b16 v[204:205], v13 offset:8192
    s_waitcnt lgkmcnt(9)
    v_mfma_f32_16x16x32_bf16 v[160:163], v[32:35], v[56:59], v[160:163]
    ds_read_b64_tr_b16 v[206:207], v13 offset:10240
    v_mfma_f32_16x16x32_bf16 v[164:167], v[36:39], v[56:59], v[164:167]
    ds_read_b128 v[212:215], v9 offset:2304
    v_mfma_f32_16x16x32_bf16 v[168:171], v[40:43], v[56:59], v[168:171]
    ds_read_b128 v[216:219], v9 offset:6144
    v_mfma_f32_16x16x32_bf16 v[172:175], v[44:47], v[56:59], v[172:175]
    ds_read_b128 v[220:223], v9 offset:6400
    s_waitcnt lgkmcnt(12)
    v_mfma_f32_16x16x32_bf16 v[188:191], v[44:47], v[60:63], v[188:191]
    v_add_u32 v9, 131072, v6
    v_add_u32 v10, 131072, v7
    v_mfma_f32_16x16x32_bf16 v[184:187], v[40:43], v[60:63], v[184:187]
    v_xor_b32 v11, 16, v10
    v_xor_b32 v12, 64, v10
    v_mfma_f32_16x16x32_bf16 v[180:183], v[36:39], v[60:63], v[180:183]
    v_xor_b32 v13, 0x50, v10
    v_mfma_f32_16x16x32_bf16 v[176:179], v[32:35], v[60:63], v[176:179]
    s_waitcnt lgkmcnt(0)
    v_mfma_f32_16x16x32_bf16 v[128:131], v[192:195], v[208:211], v[128:131]
    s_barrier
    ds_read_b64_tr_b16 v[32:33], v10 offset:0
    v_mfma_f32_16x16x32_bf16 v[132:135], v[196:199], v[208:211], v[132:135]
    ds_read_b64_tr_b16 v[34:35], v10 offset:2048
    v_mfma_f32_16x16x32_bf16 v[136:139], v[200:203], v[208:211], v[136:139]
    ds_read_b128 v[48:51], v9 offset:0
    v_mfma_f32_16x16x32_bf16 v[140:143], v[204:207], v[208:211], v[140:143]
    ds_read_b64_tr_b16 v[36:37], v11 offset:0
    v_mfma_f32_16x16x32_bf16 v[156:159], v[204:207], v[212:215], v[156:159]
    ds_read_b64_tr_b16 v[38:39], v11 offset:2048
    v_mfma_f32_16x16x32_bf16 v[152:155], v[200:203], v[212:215], v[152:155]
    ds_read_b64_tr_b16 v[40:41], v12 offset:0
    v_mfma_f32_16x16x32_bf16 v[148:151], v[196:199], v[212:215], v[148:151]
    ds_read_b64_tr_b16 v[42:43], v12 offset:2048
    v_mfma_f32_16x16x32_bf16 v[144:147], v[192:195], v[212:215], v[144:147]
    ds_read_b64_tr_b16 v[44:45], v13 offset:0
    v_mfma_f32_16x16x32_bf16 v[160:163], v[192:195], v[216:219], v[160:163]
    ds_read_b64_tr_b16 v[46:47], v13 offset:2048
    v_mfma_f32_16x16x32_bf16 v[164:167], v[196:199], v[216:219], v[164:167]
    ds_read_b128 v[52:55], v9 offset:256
    v_mfma_f32_16x16x32_bf16 v[168:171], v[200:203], v[216:219], v[168:171]
    ds_read_b128 v[56:59], v9 offset:4096
    v_mfma_f32_16x16x32_bf16 v[172:175], v[204:207], v[216:219], v[172:175]
    ds_read_b128 v[60:63], v9 offset:4352
    v_mfma_f32_16x16x32_bf16 v[188:191], v[204:207], v[220:223], v[188:191]
    v_mfma_f32_16x16x32_bf16 v[184:187], v[200:203], v[220:223], v[184:187]
    v_mfma_f32_16x16x32_bf16 v[180:183], v[196:199], v[220:223], v[180:183]
    v_mfma_f32_16x16x32_bf16 v[176:179], v[192:195], v[220:223], v[176:179]
    s_waitcnt lgkmcnt(9)
    v_mfma_f32_16x16x32_bf16 v[128:131], v[32:35], v[48:51], v[128:131]
    ds_read_b64_tr_b16 v[192:193], v10 offset:8192
    s_waitcnt lgkmcnt(8)
    v_mfma_f32_16x16x32_bf16 v[132:135], v[36:39], v[48:51], v[132:135]
    ds_read_b64_tr_b16 v[194:195], v10 offset:10240
    s_waitcnt lgkmcnt(7)
    v_mfma_f32_16x16x32_bf16 v[136:139], v[40:43], v[48:51], v[136:139]
    ds_read_b128 v[208:211], v9 offset:2048
    s_waitcnt lgkmcnt(6)
    v_mfma_f32_16x16x32_bf16 v[140:143], v[44:47], v[48:51], v[140:143]
    ds_read_b64_tr_b16 v[196:197], v11 offset:8192
    s_waitcnt lgkmcnt(6)
    v_mfma_f32_16x16x32_bf16 v[156:159], v[44:47], v[52:55], v[156:159]
    ds_read_b64_tr_b16 v[198:199], v11 offset:10240
    v_mfma_f32_16x16x32_bf16 v[152:155], v[40:43], v[52:55], v[152:155]
    ds_read_b64_tr_b16 v[200:201], v12 offset:8192
    v_mfma_f32_16x16x32_bf16 v[148:151], v[36:39], v[52:55], v[148:151]
    ds_read_b64_tr_b16 v[202:203], v12 offset:10240
    v_mfma_f32_16x16x32_bf16 v[144:147], v[32:35], v[52:55], v[144:147]
    ds_read_b64_tr_b16 v[204:205], v13 offset:8192
    s_waitcnt lgkmcnt(9)
    v_mfma_f32_16x16x32_bf16 v[160:163], v[32:35], v[56:59], v[160:163]
    ds_read_b64_tr_b16 v[206:207], v13 offset:10240
    v_mfma_f32_16x16x32_bf16 v[164:167], v[36:39], v[56:59], v[164:167]
    ds_read_b128 v[212:215], v9 offset:2304
    v_mfma_f32_16x16x32_bf16 v[168:171], v[40:43], v[56:59], v[168:171]
    ds_read_b128 v[216:219], v9 offset:6144
    v_mfma_f32_16x16x32_bf16 v[172:175], v[44:47], v[56:59], v[172:175]
    ds_read_b128 v[220:223], v9 offset:6400
    s_waitcnt lgkmcnt(12)
    v_mfma_f32_16x16x32_bf16 v[188:191], v[44:47], v[60:63], v[188:191]
    v_add_u32 v9, 0, v6
    v_add_u32 v10, 0, v7
    v_mfma_f32_16x16x32_bf16 v[184:187], v[40:43], v[60:63], v[184:187]
    v_xor_b32 v11, 16, v10
    v_xor_b32 v12, 64, v10
    v_mfma_f32_16x16x32_bf16 v[180:183], v[36:39], v[60:63], v[180:183]
    v_xor_b32 v13, 0x50, v10
    v_mfma_f32_16x16x32_bf16 v[176:179], v[32:35], v[60:63], v[176:179]
    s_waitcnt lgkmcnt(9)
    v_mfma_f32_16x16x32_bf16 v[128:131], v[192:195], v[208:211], v[128:131]
    ds_read_b64_tr_b16 v[32:33], v10 offset:0
    s_waitcnt lgkmcnt(8)
    v_mfma_f32_16x16x32_bf16 v[132:135], v[196:199], v[208:211], v[132:135]
    ds_read_b64_tr_b16 v[34:35], v10 offset:2048
    s_waitcnt lgkmcnt(7)
    v_mfma_f32_16x16x32_bf16 v[136:139], v[200:203], v[208:211], v[136:139]
    ds_read_b128 v[48:51], v9 offset:0
    s_waitcnt lgkmcnt(6)
    v_mfma_f32_16x16x32_bf16 v[140:143], v[204:207], v[208:211], v[140:143]
    ds_read_b64_tr_b16 v[36:37], v11 offset:0
    s_waitcnt lgkmcnt(6)
    v_mfma_f32_16x16x32_bf16 v[156:159], v[204:207], v[212:215], v[156:159]
    ds_read_b64_tr_b16 v[38:39], v11 offset:2048
    v_mfma_f32_16x16x32_bf16 v[152:155], v[200:203], v[212:215], v[152:155]
    ds_read_b64_tr_b16 v[40:41], v12 offset:0
    v_mfma_f32_16x16x32_bf16 v[148:151], v[196:199], v[212:215], v[148:151]
    ds_read_b64_tr_b16 v[42:43], v12 offset:2048
    v_mfma_f32_16x16x32_bf16 v[144:147], v[192:195], v[212:215], v[144:147]
    ds_read_b64_tr_b16 v[44:45], v13 offset:0
    s_waitcnt lgkmcnt(9)
    v_mfma_f32_16x16x32_bf16 v[160:163], v[192:195], v[216:219], v[160:163]
    ds_read_b64_tr_b16 v[46:47], v13 offset:2048
    v_mfma_f32_16x16x32_bf16 v[164:167], v[196:199], v[216:219], v[164:167]
    ds_read_b128 v[52:55], v9 offset:256
    v_mfma_f32_16x16x32_bf16 v[168:171], v[200:203], v[216:219], v[168:171]
    ds_read_b128 v[56:59], v9 offset:4096
    v_mfma_f32_16x16x32_bf16 v[172:175], v[204:207], v[216:219], v[172:175]
    ds_read_b128 v[60:63], v9 offset:4352
    s_waitcnt lgkmcnt(12)
    v_mfma_f32_16x16x32_bf16 v[188:191], v[204:207], v[220:223], v[188:191]
    v_mfma_f32_16x16x32_bf16 v[184:187], v[200:203], v[220:223], v[184:187]
    v_mfma_f32_16x16x32_bf16 v[180:183], v[196:199], v[220:223], v[180:183]
    v_mfma_f32_16x16x32_bf16 v[176:179], v[192:195], v[220:223], v[176:179]
    s_waitcnt lgkmcnt(9)
    v_mfma_f32_16x16x32_bf16 v[128:131], v[32:35], v[48:51], v[128:131]
    ds_read_b64_tr_b16 v[192:193], v10 offset:8192
    s_waitcnt lgkmcnt(8)
    v_mfma_f32_16x16x32_bf16 v[132:135], v[36:39], v[48:51], v[132:135]
    ds_read_b64_tr_b16 v[194:195], v10 offset:10240
    s_waitcnt lgkmcnt(7)
    v_mfma_f32_16x16x32_bf16 v[136:139], v[40:43], v[48:51], v[136:139]
    ds_read_b128 v[208:211], v9 offset:2048
    s_waitcnt lgkmcnt(6)
    v_mfma_f32_16x16x32_bf16 v[140:143], v[44:47], v[48:51], v[140:143]
    ds_read_b64_tr_b16 v[196:197], v11 offset:8192
    s_waitcnt lgkmcnt(6)
    v_mfma_f32_16x16x32_bf16 v[156:159], v[44:47], v[52:55], v[156:159]
    ds_read_b64_tr_b16 v[198:199], v11 offset:10240
    v_mfma_f32_16x16x32_bf16 v[152:155], v[40:43], v[52:55], v[152:155]
    ds_read_b64_tr_b16 v[200:201], v12 offset:8192
    v_mfma_f32_16x16x32_bf16 v[148:151], v[36:39], v[52:55], v[148:151]
    ds_read_b64_tr_b16 v[202:203], v12 offset:10240
    v_mfma_f32_16x16x32_bf16 v[144:147], v[32:35], v[52:55], v[144:147]
    ds_read_b64_tr_b16 v[204:205], v13 offset:8192
    s_waitcnt lgkmcnt(9)
    v_mfma_f32_16x16x32_bf16 v[160:163], v[32:35], v[56:59], v[160:163]
    ds_read_b64_tr_b16 v[206:207], v13 offset:10240
    v_mfma_f32_16x16x32_bf16 v[164:167], v[36:39], v[56:59], v[164:167]
    ds_read_b128 v[212:215], v9 offset:2304
    v_mfma_f32_16x16x32_bf16 v[168:171], v[40:43], v[56:59], v[168:171]
    ds_read_b128 v[216:219], v9 offset:6144
    v_mfma_f32_16x16x32_bf16 v[172:175], v[44:47], v[56:59], v[172:175]
    ds_read_b128 v[220:223], v9 offset:6400
    s_waitcnt lgkmcnt(12)
    v_mfma_f32_16x16x32_bf16 v[188:191], v[44:47], v[60:63], v[188:191]
    v_add_u32 v9, 32768, v6
    v_add_u32 v10, 32768, v7
    v_mfma_f32_16x16x32_bf16 v[184:187], v[40:43], v[60:63], v[184:187]
    v_xor_b32 v11, 16, v10
    v_xor_b32 v12, 64, v10
    v_mfma_f32_16x16x32_bf16 v[180:183], v[36:39], v[60:63], v[180:183]
    v_xor_b32 v13, 0x50, v10
    v_mfma_f32_16x16x32_bf16 v[176:179], v[32:35], v[60:63], v[176:179]
    s_waitcnt lgkmcnt(0)
    v_mfma_f32_16x16x32_bf16 v[128:131], v[192:195], v[208:211], v[128:131]
    s_barrier
    ds_read_b64_tr_b16 v[32:33], v10 offset:0
    v_mfma_f32_16x16x32_bf16 v[132:135], v[196:199], v[208:211], v[132:135]
    ds_read_b64_tr_b16 v[34:35], v10 offset:2048
    v_mfma_f32_16x16x32_bf16 v[136:139], v[200:203], v[208:211], v[136:139]
    ds_read_b128 v[48:51], v9 offset:0
    v_mfma_f32_16x16x32_bf16 v[140:143], v[204:207], v[208:211], v[140:143]
    ds_read_b64_tr_b16 v[36:37], v11 offset:0
    v_mfma_f32_16x16x32_bf16 v[156:159], v[204:207], v[212:215], v[156:159]
    ds_read_b64_tr_b16 v[38:39], v11 offset:2048
    v_mfma_f32_16x16x32_bf16 v[152:155], v[200:203], v[212:215], v[152:155]
    ds_read_b64_tr_b16 v[40:41], v12 offset:0
    v_mfma_f32_16x16x32_bf16 v[148:151], v[196:199], v[212:215], v[148:151]
    ds_read_b64_tr_b16 v[42:43], v12 offset:2048
    v_mfma_f32_16x16x32_bf16 v[144:147], v[192:195], v[212:215], v[144:147]
    ds_read_b64_tr_b16 v[44:45], v13 offset:0
    v_mfma_f32_16x16x32_bf16 v[160:163], v[192:195], v[216:219], v[160:163]
    ds_read_b64_tr_b16 v[46:47], v13 offset:2048
    v_mfma_f32_16x16x32_bf16 v[164:167], v[196:199], v[216:219], v[164:167]
    ds_read_b128 v[52:55], v9 offset:256
    v_mfma_f32_16x16x32_bf16 v[168:171], v[200:203], v[216:219], v[168:171]
    ds_read_b128 v[56:59], v9 offset:4096
    v_mfma_f32_16x16x32_bf16 v[172:175], v[204:207], v[216:219], v[172:175]
    ds_read_b128 v[60:63], v9 offset:4352
    v_mfma_f32_16x16x32_bf16 v[188:191], v[204:207], v[220:223], v[188:191]
    v_mfma_f32_16x16x32_bf16 v[184:187], v[200:203], v[220:223], v[184:187]
    v_mfma_f32_16x16x32_bf16 v[180:183], v[196:199], v[220:223], v[180:183]
    v_mfma_f32_16x16x32_bf16 v[176:179], v[192:195], v[220:223], v[176:179]
    s_waitcnt lgkmcnt(9)
    v_mfma_f32_16x16x32_bf16 v[128:131], v[32:35], v[48:51], v[128:131]
    ds_read_b64_tr_b16 v[192:193], v10 offset:8192
    s_waitcnt lgkmcnt(8)
    v_mfma_f32_16x16x32_bf16 v[132:135], v[36:39], v[48:51], v[132:135]
    ds_read_b64_tr_b16 v[194:195], v10 offset:10240
    s_waitcnt lgkmcnt(7)
    v_mfma_f32_16x16x32_bf16 v[136:139], v[40:43], v[48:51], v[136:139]
    ds_read_b128 v[208:211], v9 offset:2048
    s_waitcnt lgkmcnt(6)
    v_mfma_f32_16x16x32_bf16 v[140:143], v[44:47], v[48:51], v[140:143]
    ds_read_b64_tr_b16 v[196:197], v11 offset:8192
    s_waitcnt lgkmcnt(6)
    v_mfma_f32_16x16x32_bf16 v[156:159], v[44:47], v[52:55], v[156:159]
    ds_read_b64_tr_b16 v[198:199], v11 offset:10240
    v_mfma_f32_16x16x32_bf16 v[152:155], v[40:43], v[52:55], v[152:155]
    ds_read_b64_tr_b16 v[200:201], v12 offset:8192
    v_mfma_f32_16x16x32_bf16 v[148:151], v[36:39], v[52:55], v[148:151]
    ds_read_b64_tr_b16 v[202:203], v12 offset:10240
    v_mfma_f32_16x16x32_bf16 v[144:147], v[32:35], v[52:55], v[144:147]
    ds_read_b64_tr_b16 v[204:205], v13 offset:8192
    s_waitcnt lgkmcnt(9)
    v_mfma_f32_16x16x32_bf16 v[160:163], v[32:35], v[56:59], v[160:163]
    ds_read_b64_tr_b16 v[206:207], v13 offset:10240
    v_mfma_f32_16x16x32_bf16 v[164:167], v[36:39], v[56:59], v[164:167]
    ds_read_b128 v[212:215], v9 offset:2304
    v_mfma_f32_16x16x32_bf16 v[168:171], v[40:43], v[56:59], v[168:171]
    ds_read_b128 v[216:219], v9 offset:6144
    v_mfma_f32_16x16x32_bf16 v[172:175], v[44:47], v[56:59], v[172:175]
    ds_read_b128 v[220:223], v9 offset:6400
    s_waitcnt lgkmcnt(12)
    v_mfma_f32_16x16x32_bf16 v[188:191], v[44:47], v[60:63], v[188:191]
    v_add_u32 v9, 65536, v6
    v_add_u32 v10, 65536, v7
    v_mfma_f32_16x16x32_bf16 v[184:187], v[40:43], v[60:63], v[184:187]
    v_xor_b32 v11, 16, v10
    v_xor_b32 v12, 64, v10
    v_mfma_f32_16x16x32_bf16 v[180:183], v[36:39], v[60:63], v[180:183]
    v_xor_b32 v13, 0x50, v10
    v_mfma_f32_16x16x32_bf16 v[176:179], v[32:35], v[60:63], v[176:179]
    s_waitcnt lgkmcnt(9)
    v_mfma_f32_16x16x32_bf16 v[128:131], v[192:195], v[208:211], v[128:131]
    ds_read_b64_tr_b16 v[32:33], v10 offset:0
    s_waitcnt lgkmcnt(8)
    v_mfma_f32_16x16x32_bf16 v[132:135], v[196:199], v[208:211], v[132:135]
    ds_read_b64_tr_b16 v[34:35], v10 offset:2048
    s_waitcnt lgkmcnt(7)
    v_mfma_f32_16x16x32_bf16 v[136:139], v[200:203], v[208:211], v[136:139]
    ds_read_b128 v[48:51], v9 offset:0
    s_waitcnt lgkmcnt(6)
    v_mfma_f32_16x16x32_bf16 v[140:143], v[204:207], v[208:211], v[140:143]
    ds_read_b64_tr_b16 v[36:37], v11 offset:0
    s_waitcnt lgkmcnt(6)
    v_mfma_f32_16x16x32_bf16 v[156:159], v[204:207], v[212:215], v[156:159]
    ds_read_b64_tr_b16 v[38:39], v11 offset:2048
    v_mfma_f32_16x16x32_bf16 v[152:155], v[200:203], v[212:215], v[152:155]
    ds_read_b64_tr_b16 v[40:41], v12 offset:0
    v_mfma_f32_16x16x32_bf16 v[148:151], v[196:199], v[212:215], v[148:151]
    ds_read_b64_tr_b16 v[42:43], v12 offset:2048
    v_mfma_f32_16x16x32_bf16 v[144:147], v[192:195], v[212:215], v[144:147]
    ds_read_b64_tr_b16 v[44:45], v13 offset:0
    s_waitcnt lgkmcnt(9)
    v_mfma_f32_16x16x32_bf16 v[160:163], v[192:195], v[216:219], v[160:163]
    ds_read_b64_tr_b16 v[46:47], v13 offset:2048
    v_mfma_f32_16x16x32_bf16 v[164:167], v[196:199], v[216:219], v[164:167]
    ds_read_b128 v[52:55], v9 offset:256
    v_mfma_f32_16x16x32_bf16 v[168:171], v[200:203], v[216:219], v[168:171]
    ds_read_b128 v[56:59], v9 offset:4096
    v_mfma_f32_16x16x32_bf16 v[172:175], v[204:207], v[216:219], v[172:175]
    ds_read_b128 v[60:63], v9 offset:4352
    s_waitcnt lgkmcnt(12)
    v_mfma_f32_16x16x32_bf16 v[188:191], v[204:207], v[220:223], v[188:191]
    v_mfma_f32_16x16x32_bf16 v[184:187], v[200:203], v[220:223], v[184:187]
    v_mfma_f32_16x16x32_bf16 v[180:183], v[196:199], v[220:223], v[180:183]
    v_mfma_f32_16x16x32_bf16 v[176:179], v[192:195], v[220:223], v[176:179]
    s_waitcnt lgkmcnt(9)
    v_mfma_f32_16x16x32_bf16 v[128:131], v[32:35], v[48:51], v[128:131]
    ds_read_b64_tr_b16 v[192:193], v10 offset:8192
    s_waitcnt lgkmcnt(8)
    v_mfma_f32_16x16x32_bf16 v[132:135], v[36:39], v[48:51], v[132:135]
    ds_read_b64_tr_b16 v[194:195], v10 offset:10240
    s_waitcnt lgkmcnt(7)
    v_mfma_f32_16x16x32_bf16 v[136:139], v[40:43], v[48:51], v[136:139]
    ds_read_b128 v[208:211], v9 offset:2048
    s_waitcnt lgkmcnt(6)
    v_mfma_f32_16x16x32_bf16 v[140:143], v[44:47], v[48:51], v[140:143]
    ds_read_b64_tr_b16 v[196:197], v11 offset:8192
    s_waitcnt lgkmcnt(6)
    v_mfma_f32_16x16x32_bf16 v[156:159], v[44:47], v[52:55], v[156:159]
    ds_read_b64_tr_b16 v[198:199], v11 offset:10240
    v_mfma_f32_16x16x32_bf16 v[152:155], v[40:43], v[52:55], v[152:155]
    ds_read_b64_tr_b16 v[200:201], v12 offset:8192
    v_mfma_f32_16x16x32_bf16 v[148:151], v[36:39], v[52:55], v[148:151]
    ds_read_b64_tr_b16 v[202:203], v12 offset:10240
    v_mfma_f32_16x16x32_bf16 v[144:147], v[32:35], v[52:55], v[144:147]
    ds_read_b64_tr_b16 v[204:205], v13 offset:8192
    s_waitcnt lgkmcnt(9)
    v_mfma_f32_16x16x32_bf16 v[160:163], v[32:35], v[56:59], v[160:163]
    ds_read_b64_tr_b16 v[206:207], v13 offset:10240
    v_mfma_f32_16x16x32_bf16 v[164:167], v[36:39], v[56:59], v[164:167]
    ds_read_b128 v[212:215], v9 offset:2304
    v_mfma_f32_16x16x32_bf16 v[168:171], v[40:43], v[56:59], v[168:171]
    ds_read_b128 v[216:219], v9 offset:6144
    v_mfma_f32_16x16x32_bf16 v[172:175], v[44:47], v[56:59], v[172:175]
    ds_read_b128 v[220:223], v9 offset:6400
    s_waitcnt lgkmcnt(12)
    v_mfma_f32_16x16x32_bf16 v[188:191], v[44:47], v[60:63], v[188:191]
    v_add_u32 v9, 98304, v6
    v_add_u32 v10, 98304, v7
    v_mfma_f32_16x16x32_bf16 v[184:187], v[40:43], v[60:63], v[184:187]
    v_xor_b32 v11, 16, v10
    v_xor_b32 v12, 64, v10
    v_mfma_f32_16x16x32_bf16 v[180:183], v[36:39], v[60:63], v[180:183]
    v_xor_b32 v13, 0x50, v10
    v_mfma_f32_16x16x32_bf16 v[176:179], v[32:35], v[60:63], v[176:179]
    s_waitcnt lgkmcnt(0)
    v_mfma_f32_16x16x32_bf16 v[128:131], v[192:195], v[208:211], v[128:131]
    s_barrier
    ds_read_b64_tr_b16 v[32:33], v10 offset:0
    v_mfma_f32_16x16x32_bf16 v[132:135], v[196:199], v[208:211], v[132:135]
    ds_read_b64_tr_b16 v[34:35], v10 offset:2048
    v_mfma_f32_16x16x32_bf16 v[136:139], v[200:203], v[208:211], v[136:139]
    ds_read_b128 v[48:51], v9 offset:0
    v_mfma_f32_16x16x32_bf16 v[140:143], v[204:207], v[208:211], v[140:143]
    ds_read_b64_tr_b16 v[36:37], v11 offset:0
    v_mfma_f32_16x16x32_bf16 v[156:159], v[204:207], v[212:215], v[156:159]
    ds_read_b64_tr_b16 v[38:39], v11 offset:2048
    v_mfma_f32_16x16x32_bf16 v[152:155], v[200:203], v[212:215], v[152:155]
    ds_read_b64_tr_b16 v[40:41], v12 offset:0
    v_mfma_f32_16x16x32_bf16 v[148:151], v[196:199], v[212:215], v[148:151]
    ds_read_b64_tr_b16 v[42:43], v12 offset:2048
    v_mfma_f32_16x16x32_bf16 v[144:147], v[192:195], v[212:215], v[144:147]
    ds_read_b64_tr_b16 v[44:45], v13 offset:0
    v_mfma_f32_16x16x32_bf16 v[160:163], v[192:195], v[216:219], v[160:163]
    ds_read_b64_tr_b16 v[46:47], v13 offset:2048
    v_mfma_f32_16x16x32_bf16 v[164:167], v[196:199], v[216:219], v[164:167]
    ds_read_b128 v[52:55], v9 offset:256
    v_mfma_f32_16x16x32_bf16 v[168:171], v[200:203], v[216:219], v[168:171]
    ds_read_b128 v[56:59], v9 offset:4096
    v_mfma_f32_16x16x32_bf16 v[172:175], v[204:207], v[216:219], v[172:175]
    ds_read_b128 v[60:63], v9 offset:4352
    v_mfma_f32_16x16x32_bf16 v[188:191], v[204:207], v[220:223], v[188:191]
    v_mfma_f32_16x16x32_bf16 v[184:187], v[200:203], v[220:223], v[184:187]
    v_mfma_f32_16x16x32_bf16 v[180:183], v[196:199], v[220:223], v[180:183]
    v_mfma_f32_16x16x32_bf16 v[176:179], v[192:195], v[220:223], v[176:179]
    s_waitcnt lgkmcnt(9)
    v_mfma_f32_16x16x32_bf16 v[128:131], v[32:35], v[48:51], v[128:131]
    ds_read_b64_tr_b16 v[192:193], v10 offset:8192
    s_waitcnt lgkmcnt(8)
    v_mfma_f32_16x16x32_bf16 v[132:135], v[36:39], v[48:51], v[132:135]
    ds_read_b64_tr_b16 v[194:195], v10 offset:10240
    s_waitcnt lgkmcnt(7)
    v_mfma_f32_16x16x32_bf16 v[136:139], v[40:43], v[48:51], v[136:139]
    ds_read_b128 v[208:211], v9 offset:2048
    s_waitcnt lgkmcnt(6)
    v_mfma_f32_16x16x32_bf16 v[140:143], v[44:47], v[48:51], v[140:143]
    ds_read_b64_tr_b16 v[196:197], v11 offset:8192
    s_waitcnt lgkmcnt(6)
    v_mfma_f32_16x16x32_bf16 v[156:159], v[44:47], v[52:55], v[156:159]
    ds_read_b64_tr_b16 v[198:199], v11 offset:10240
    v_mfma_f32_16x16x32_bf16 v[152:155], v[40:43], v[52:55], v[152:155]
    ds_read_b64_tr_b16 v[200:201], v12 offset:8192
    v_mfma_f32_16x16x32_bf16 v[148:151], v[36:39], v[52:55], v[148:151]
    ds_read_b64_tr_b16 v[202:203], v12 offset:10240
    v_mfma_f32_16x16x32_bf16 v[144:147], v[32:35], v[52:55], v[144:147]
    ds_read_b64_tr_b16 v[204:205], v13 offset:8192
    s_waitcnt lgkmcnt(9)
    v_mfma_f32_16x16x32_bf16 v[160:163], v[32:35], v[56:59], v[160:163]
    ds_read_b64_tr_b16 v[206:207], v13 offset:10240
    v_mfma_f32_16x16x32_bf16 v[164:167], v[36:39], v[56:59], v[164:167]
    ds_read_b128 v[212:215], v9 offset:2304
    v_mfma_f32_16x16x32_bf16 v[168:171], v[40:43], v[56:59], v[168:171]
    ds_read_b128 v[216:219], v9 offset:6144
    v_mfma_f32_16x16x32_bf16 v[172:175], v[44:47], v[56:59], v[172:175]
    ds_read_b128 v[220:223], v9 offset:6400
    s_waitcnt lgkmcnt(12)
    v_mfma_f32_16x16x32_bf16 v[188:191], v[44:47], v[60:63], v[188:191]
    v_add_u32 v9, 131072, v6
    v_add_u32 v10, 131072, v7
    v_mfma_f32_16x16x32_bf16 v[184:187], v[40:43], v[60:63], v[184:187]
    v_xor_b32 v11, 16, v10
    v_xor_b32 v12, 64, v10
    v_mfma_f32_16x16x32_bf16 v[180:183], v[36:39], v[60:63], v[180:183]
    v_xor_b32 v13, 0x50, v10
    v_mfma_f32_16x16x32_bf16 v[176:179], v[32:35], v[60:63], v[176:179]
    s_waitcnt lgkmcnt(9)
    v_mfma_f32_16x16x32_bf16 v[128:131], v[192:195], v[208:211], v[128:131]
    ds_read_b64_tr_b16 v[32:33], v10 offset:0
    s_waitcnt lgkmcnt(8)
    v_mfma_f32_16x16x32_bf16 v[132:135], v[196:199], v[208:211], v[132:135]
    ds_read_b64_tr_b16 v[34:35], v10 offset:2048
    s_waitcnt lgkmcnt(7)
    v_mfma_f32_16x16x32_bf16 v[136:139], v[200:203], v[208:211], v[136:139]
    ds_read_b128 v[48:51], v9 offset:0
    s_waitcnt lgkmcnt(6)
    v_mfma_f32_16x16x32_bf16 v[140:143], v[204:207], v[208:211], v[140:143]
    ds_read_b64_tr_b16 v[36:37], v11 offset:0
    s_waitcnt lgkmcnt(6)
    v_mfma_f32_16x16x32_bf16 v[156:159], v[204:207], v[212:215], v[156:159]
    ds_read_b64_tr_b16 v[38:39], v11 offset:2048
    v_mfma_f32_16x16x32_bf16 v[152:155], v[200:203], v[212:215], v[152:155]
    ds_read_b64_tr_b16 v[40:41], v12 offset:0
    v_mfma_f32_16x16x32_bf16 v[148:151], v[196:199], v[212:215], v[148:151]
    ds_read_b64_tr_b16 v[42:43], v12 offset:2048
    v_mfma_f32_16x16x32_bf16 v[144:147], v[192:195], v[212:215], v[144:147]
    ds_read_b64_tr_b16 v[44:45], v13 offset:0
    s_waitcnt lgkmcnt(9)
    v_mfma_f32_16x16x32_bf16 v[160:163], v[192:195], v[216:219], v[160:163]
    ds_read_b64_tr_b16 v[46:47], v13 offset:2048
    v_mfma_f32_16x16x32_bf16 v[164:167], v[196:199], v[216:219], v[164:167]
    ds_read_b128 v[52:55], v9 offset:256
    v_mfma_f32_16x16x32_bf16 v[168:171], v[200:203], v[216:219], v[168:171]
    ds_read_b128 v[56:59], v9 offset:4096
    v_mfma_f32_16x16x32_bf16 v[172:175], v[204:207], v[216:219], v[172:175]
    ds_read_b128 v[60:63], v9 offset:4352
    s_waitcnt lgkmcnt(12)
    v_mfma_f32_16x16x32_bf16 v[188:191], v[204:207], v[220:223], v[188:191]
    v_mfma_f32_16x16x32_bf16 v[184:187], v[200:203], v[220:223], v[184:187]
    v_mfma_f32_16x16x32_bf16 v[180:183], v[196:199], v[220:223], v[180:183]
    v_mfma_f32_16x16x32_bf16 v[176:179], v[192:195], v[220:223], v[176:179]
    s_waitcnt lgkmcnt(9)
    v_mfma_f32_16x16x32_bf16 v[128:131], v[32:35], v[48:51], v[128:131]
    ds_read_b64_tr_b16 v[192:193], v10 offset:8192
    s_waitcnt lgkmcnt(8)
    v_mfma_f32_16x16x32_bf16 v[132:135], v[36:39], v[48:51], v[132:135]
    ds_read_b64_tr_b16 v[194:195], v10 offset:10240
    s_waitcnt lgkmcnt(7)
    v_mfma_f32_16x16x32_bf16 v[136:139], v[40:43], v[48:51], v[136:139]
    ds_read_b128 v[208:211], v9 offset:2048
    s_waitcnt lgkmcnt(6)
    v_mfma_f32_16x16x32_bf16 v[140:143], v[44:47], v[48:51], v[140:143]
    ds_read_b64_tr_b16 v[196:197], v11 offset:8192
    s_waitcnt lgkmcnt(6)
    v_mfma_f32_16x16x32_bf16 v[156:159], v[44:47], v[52:55], v[156:159]
    ds_read_b64_tr_b16 v[198:199], v11 offset:10240
    v_mfma_f32_16x16x32_bf16 v[152:155], v[40:43], v[52:55], v[152:155]
    ds_read_b64_tr_b16 v[200:201], v12 offset:8192
    v_mfma_f32_16x16x32_bf16 v[148:151], v[36:39], v[52:55], v[148:151]
    ds_read_b64_tr_b16 v[202:203], v12 offset:10240
    v_mfma_f32_16x16x32_bf16 v[144:147], v[32:35], v[52:55], v[144:147]
    ds_read_b64_tr_b16 v[204:205], v13 offset:8192
    s_waitcnt lgkmcnt(9)
    v_mfma_f32_16x16x32_bf16 v[160:163], v[32:35], v[56:59], v[160:163]
    ds_read_b64_tr_b16 v[206:207], v13 offset:10240
    v_mfma_f32_16x16x32_bf16 v[164:167], v[36:39], v[56:59], v[164:167]
    ds_read_b128 v[212:215], v9 offset:2304
    v_mfma_f32_16x16x32_bf16 v[168:171], v[40:43], v[56:59], v[168:171]
    ds_read_b128 v[216:219], v9 offset:6144
    v_mfma_f32_16x16x32_bf16 v[172:175], v[44:47], v[56:59], v[172:175]
    ds_read_b128 v[220:223], v9 offset:6400
    s_waitcnt lgkmcnt(12)
    v_mfma_f32_16x16x32_bf16 v[188:191], v[44:47], v[60:63], v[188:191]
    v_add_u32 v9, 0, v6
    v_add_u32 v10, 0, v7
    v_mfma_f32_16x16x32_bf16 v[184:187], v[40:43], v[60:63], v[184:187]
    v_xor_b32 v11, 16, v10
    v_xor_b32 v12, 64, v10
    v_mfma_f32_16x16x32_bf16 v[180:183], v[36:39], v[60:63], v[180:183]
    v_xor_b32 v13, 0x50, v10
    v_mfma_f32_16x16x32_bf16 v[176:179], v[32:35], v[60:63], v[176:179]
    s_waitcnt lgkmcnt(0)
    v_mfma_f32_16x16x32_bf16 v[128:131], v[192:195], v[208:211], v[128:131]
    s_barrier
    ds_read_b64_tr_b16 v[32:33], v10 offset:0
    v_mfma_f32_16x16x32_bf16 v[132:135], v[196:199], v[208:211], v[132:135]
    ds_read_b64_tr_b16 v[34:35], v10 offset:2048
    v_mfma_f32_16x16x32_bf16 v[136:139], v[200:203], v[208:211], v[136:139]
    ds_read_b128 v[48:51], v9 offset:0
    v_mfma_f32_16x16x32_bf16 v[140:143], v[204:207], v[208:211], v[140:143]
    ds_read_b64_tr_b16 v[36:37], v11 offset:0
    v_mfma_f32_16x16x32_bf16 v[156:159], v[204:207], v[212:215], v[156:159]
    ds_read_b64_tr_b16 v[38:39], v11 offset:2048
    v_mfma_f32_16x16x32_bf16 v[152:155], v[200:203], v[212:215], v[152:155]
    ds_read_b64_tr_b16 v[40:41], v12 offset:0
    v_mfma_f32_16x16x32_bf16 v[148:151], v[196:199], v[212:215], v[148:151]
    ds_read_b64_tr_b16 v[42:43], v12 offset:2048
    v_mfma_f32_16x16x32_bf16 v[144:147], v[192:195], v[212:215], v[144:147]
    ds_read_b64_tr_b16 v[44:45], v13 offset:0
    v_mfma_f32_16x16x32_bf16 v[160:163], v[192:195], v[216:219], v[160:163]
    ds_read_b64_tr_b16 v[46:47], v13 offset:2048
    v_mfma_f32_16x16x32_bf16 v[164:167], v[196:199], v[216:219], v[164:167]
    ds_read_b128 v[52:55], v9 offset:256
    v_mfma_f32_16x16x32_bf16 v[168:171], v[200:203], v[216:219], v[168:171]
    ds_read_b128 v[56:59], v9 offset:4096
    v_mfma_f32_16x16x32_bf16 v[172:175], v[204:207], v[216:219], v[172:175]
    ds_read_b128 v[60:63], v9 offset:4352
    v_mfma_f32_16x16x32_bf16 v[188:191], v[204:207], v[220:223], v[188:191]
    v_mfma_f32_16x16x32_bf16 v[184:187], v[200:203], v[220:223], v[184:187]
    v_mfma_f32_16x16x32_bf16 v[180:183], v[196:199], v[220:223], v[180:183]
    v_mfma_f32_16x16x32_bf16 v[176:179], v[192:195], v[220:223], v[176:179]
    s_waitcnt lgkmcnt(9)
    v_mfma_f32_16x16x32_bf16 v[128:131], v[32:35], v[48:51], v[128:131]
    ds_read_b64_tr_b16 v[192:193], v10 offset:8192
    s_waitcnt lgkmcnt(8)
    v_mfma_f32_16x16x32_bf16 v[132:135], v[36:39], v[48:51], v[132:135]
    ds_read_b64_tr_b16 v[194:195], v10 offset:10240
    s_waitcnt lgkmcnt(7)
    v_mfma_f32_16x16x32_bf16 v[136:139], v[40:43], v[48:51], v[136:139]
    ds_read_b128 v[208:211], v9 offset:2048
    s_waitcnt lgkmcnt(6)
    v_mfma_f32_16x16x32_bf16 v[140:143], v[44:47], v[48:51], v[140:143]
    ds_read_b64_tr_b16 v[196:197], v11 offset:8192
    s_waitcnt lgkmcnt(6)
    v_mfma_f32_16x16x32_bf16 v[156:159], v[44:47], v[52:55], v[156:159]
    ds_read_b64_tr_b16 v[198:199], v11 offset:10240
    v_mfma_f32_16x16x32_bf16 v[152:155], v[40:43], v[52:55], v[152:155]
    ds_read_b64_tr_b16 v[200:201], v12 offset:8192
    v_mfma_f32_16x16x32_bf16 v[148:151], v[36:39], v[52:55], v[148:151]
    ds_read_b64_tr_b16 v[202:203], v12 offset:10240
    v_mfma_f32_16x16x32_bf16 v[144:147], v[32:35], v[52:55], v[144:147]
    ds_read_b64_tr_b16 v[204:205], v13 offset:8192
    s_waitcnt lgkmcnt(9)
    v_mfma_f32_16x16x32_bf16 v[160:163], v[32:35], v[56:59], v[160:163]
    ds_read_b64_tr_b16 v[206:207], v13 offset:10240
    v_mfma_f32_16x16x32_bf16 v[164:167], v[36:39], v[56:59], v[164:167]
    ds_read_b128 v[212:215], v9 offset:2304
    v_mfma_f32_16x16x32_bf16 v[168:171], v[40:43], v[56:59], v[168:171]
    ds_read_b128 v[216:219], v9 offset:6144
    v_mfma_f32_16x16x32_bf16 v[172:175], v[44:47], v[56:59], v[172:175]
    ds_read_b128 v[220:223], v9 offset:6400
    s_waitcnt lgkmcnt(12)
    v_mfma_f32_16x16x32_bf16 v[188:191], v[44:47], v[60:63], v[188:191]
    v_add_u32 v9, 32768, v6
    v_add_u32 v10, 32768, v7
    v_mfma_f32_16x16x32_bf16 v[184:187], v[40:43], v[60:63], v[184:187]
    v_xor_b32 v11, 16, v10
    v_xor_b32 v12, 64, v10
    v_mfma_f32_16x16x32_bf16 v[180:183], v[36:39], v[60:63], v[180:183]
    v_xor_b32 v13, 0x50, v10
    v_mfma_f32_16x16x32_bf16 v[176:179], v[32:35], v[60:63], v[176:179]
    s_waitcnt lgkmcnt(9)
    v_mfma_f32_16x16x32_bf16 v[128:131], v[192:195], v[208:211], v[128:131]
    ds_read_b64_tr_b16 v[32:33], v10 offset:0
    s_waitcnt lgkmcnt(8)
    v_mfma_f32_16x16x32_bf16 v[132:135], v[196:199], v[208:211], v[132:135]
    ds_read_b64_tr_b16 v[34:35], v10 offset:2048
    s_waitcnt lgkmcnt(7)
    v_mfma_f32_16x16x32_bf16 v[136:139], v[200:203], v[208:211], v[136:139]
    ds_read_b128 v[48:51], v9 offset:0
    s_waitcnt lgkmcnt(6)
    v_mfma_f32_16x16x32_bf16 v[140:143], v[204:207], v[208:211], v[140:143]
    ds_read_b64_tr_b16 v[36:37], v11 offset:0
    s_waitcnt lgkmcnt(6)
    v_mfma_f32_16x16x32_bf16 v[156:159], v[204:207], v[212:215], v[156:159]
    ds_read_b64_tr_b16 v[38:39], v11 offset:2048
    v_mfma_f32_16x16x32_bf16 v[152:155], v[200:203], v[212:215], v[152:155]
    ds_read_b64_tr_b16 v[40:41], v12 offset:0
    v_mfma_f32_16x16x32_bf16 v[148:151], v[196:199], v[212:215], v[148:151]
    ds_read_b64_tr_b16 v[42:43], v12 offset:2048
    v_mfma_f32_16x16x32_bf16 v[144:147], v[192:195], v[212:215], v[144:147]
    ds_read_b64_tr_b16 v[44:45], v13 offset:0
    s_waitcnt lgkmcnt(9)
    v_mfma_f32_16x16x32_bf16 v[160:163], v[192:195], v[216:219], v[160:163]
    ds_read_b64_tr_b16 v[46:47], v13 offset:2048
    v_mfma_f32_16x16x32_bf16 v[164:167], v[196:199], v[216:219], v[164:167]
    ds_read_b128 v[52:55], v9 offset:256
    v_mfma_f32_16x16x32_bf16 v[168:171], v[200:203], v[216:219], v[168:171]
    ds_read_b128 v[56:59], v9 offset:4096
    v_mfma_f32_16x16x32_bf16 v[172:175], v[204:207], v[216:219], v[172:175]
    ds_read_b128 v[60:63], v9 offset:4352
    s_waitcnt lgkmcnt(12)
    v_mfma_f32_16x16x32_bf16 v[188:191], v[204:207], v[220:223], v[188:191]
    v_mfma_f32_16x16x32_bf16 v[184:187], v[200:203], v[220:223], v[184:187]
    v_mfma_f32_16x16x32_bf16 v[180:183], v[196:199], v[220:223], v[180:183]
    v_mfma_f32_16x16x32_bf16 v[176:179], v[192:195], v[220:223], v[176:179]
    s_waitcnt lgkmcnt(9)
    v_mfma_f32_16x16x32_bf16 v[128:131], v[32:35], v[48:51], v[128:131]
    ds_read_b64_tr_b16 v[192:193], v10 offset:8192
    s_waitcnt lgkmcnt(8)
    v_mfma_f32_16x16x32_bf16 v[132:135], v[36:39], v[48:51], v[132:135]
    ds_read_b64_tr_b16 v[194:195], v10 offset:10240
    s_waitcnt lgkmcnt(7)
    v_mfma_f32_16x16x32_bf16 v[136:139], v[40:43], v[48:51], v[136:139]
    ds_read_b128 v[208:211], v9 offset:2048
    s_waitcnt lgkmcnt(6)
    v_mfma_f32_16x16x32_bf16 v[140:143], v[44:47], v[48:51], v[140:143]
    ds_read_b64_tr_b16 v[196:197], v11 offset:8192
    s_waitcnt lgkmcnt(6)
    v_mfma_f32_16x16x32_bf16 v[156:159], v[44:47], v[52:55], v[156:159]
    ds_read_b64_tr_b16 v[198:199], v11 offset:10240
    v_mfma_f32_16x16x32_bf16 v[152:155], v[40:43], v[52:55], v[152:155]
    ds_read_b64_tr_b16 v[200:201], v12 offset:8192
    v_mfma_f32_16x16x32_bf16 v[148:151], v[36:39], v[52:55], v[148:151]
    ds_read_b64_tr_b16 v[202:203], v12 offset:10240
    v_mfma_f32_16x16x32_bf16 v[144:147], v[32:35], v[52:55], v[144:147]
    ds_read_b64_tr_b16 v[204:205], v13 offset:8192
    s_waitcnt lgkmcnt(9)
    v_mfma_f32_16x16x32_bf16 v[160:163], v[32:35], v[56:59], v[160:163]
    ds_read_b64_tr_b16 v[206:207], v13 offset:10240
    v_mfma_f32_16x16x32_bf16 v[164:167], v[36:39], v[56:59], v[164:167]
    ds_read_b128 v[212:215], v9 offset:2304
    v_mfma_f32_16x16x32_bf16 v[168:171], v[40:43], v[56:59], v[168:171]
    ds_read_b128 v[216:219], v9 offset:6144
    v_mfma_f32_16x16x32_bf16 v[172:175], v[44:47], v[56:59], v[172:175]
    ds_read_b128 v[220:223], v9 offset:6400
    s_waitcnt lgkmcnt(12)
    v_mfma_f32_16x16x32_bf16 v[188:191], v[44:47], v[60:63], v[188:191]
    v_add_u32 v9, 65536, v6
    v_add_u32 v10, 65536, v7
    v_mfma_f32_16x16x32_bf16 v[184:187], v[40:43], v[60:63], v[184:187]
    v_xor_b32 v11, 16, v10
    v_xor_b32 v12, 64, v10
    v_mfma_f32_16x16x32_bf16 v[180:183], v[36:39], v[60:63], v[180:183]
    v_xor_b32 v13, 0x50, v10
    v_mfma_f32_16x16x32_bf16 v[176:179], v[32:35], v[60:63], v[176:179]
    s_waitcnt lgkmcnt(0)
    v_mfma_f32_16x16x32_bf16 v[128:131], v[192:195], v[208:211], v[128:131]
    s_barrier
    ds_read_b64_tr_b16 v[32:33], v10 offset:0
    v_mfma_f32_16x16x32_bf16 v[132:135], v[196:199], v[208:211], v[132:135]
    ds_read_b64_tr_b16 v[34:35], v10 offset:2048
    v_mfma_f32_16x16x32_bf16 v[136:139], v[200:203], v[208:211], v[136:139]
    ds_read_b128 v[48:51], v9 offset:0
    v_mfma_f32_16x16x32_bf16 v[140:143], v[204:207], v[208:211], v[140:143]
    ds_read_b64_tr_b16 v[36:37], v11 offset:0
    v_mfma_f32_16x16x32_bf16 v[156:159], v[204:207], v[212:215], v[156:159]
    ds_read_b64_tr_b16 v[38:39], v11 offset:2048
    v_mfma_f32_16x16x32_bf16 v[152:155], v[200:203], v[212:215], v[152:155]
    ds_read_b64_tr_b16 v[40:41], v12 offset:0
    v_mfma_f32_16x16x32_bf16 v[148:151], v[196:199], v[212:215], v[148:151]
    ds_read_b64_tr_b16 v[42:43], v12 offset:2048
    v_mfma_f32_16x16x32_bf16 v[144:147], v[192:195], v[212:215], v[144:147]
    ds_read_b64_tr_b16 v[44:45], v13 offset:0
    v_mfma_f32_16x16x32_bf16 v[160:163], v[192:195], v[216:219], v[160:163]
    ds_read_b64_tr_b16 v[46:47], v13 offset:2048
    v_mfma_f32_16x16x32_bf16 v[164:167], v[196:199], v[216:219], v[164:167]
    ds_read_b128 v[52:55], v9 offset:256
    v_mfma_f32_16x16x32_bf16 v[168:171], v[200:203], v[216:219], v[168:171]
    ds_read_b128 v[56:59], v9 offset:4096
    v_mfma_f32_16x16x32_bf16 v[172:175], v[204:207], v[216:219], v[172:175]
    ds_read_b128 v[60:63], v9 offset:4352
    v_mfma_f32_16x16x32_bf16 v[188:191], v[204:207], v[220:223], v[188:191]
    v_mfma_f32_16x16x32_bf16 v[184:187], v[200:203], v[220:223], v[184:187]
    v_mfma_f32_16x16x32_bf16 v[180:183], v[196:199], v[220:223], v[180:183]
    v_mfma_f32_16x16x32_bf16 v[176:179], v[192:195], v[220:223], v[176:179]
    s_waitcnt lgkmcnt(9)
    v_mfma_f32_16x16x32_bf16 v[128:131], v[32:35], v[48:51], v[128:131]
    ds_read_b64_tr_b16 v[192:193], v10 offset:8192
    s_waitcnt lgkmcnt(8)
    v_mfma_f32_16x16x32_bf16 v[132:135], v[36:39], v[48:51], v[132:135]
    ds_read_b64_tr_b16 v[194:195], v10 offset:10240
    s_waitcnt lgkmcnt(7)
    v_mfma_f32_16x16x32_bf16 v[136:139], v[40:43], v[48:51], v[136:139]
    ds_read_b128 v[208:211], v9 offset:2048
    s_waitcnt lgkmcnt(6)
    v_mfma_f32_16x16x32_bf16 v[140:143], v[44:47], v[48:51], v[140:143]
    ds_read_b64_tr_b16 v[196:197], v11 offset:8192
    s_waitcnt lgkmcnt(6)
    v_mfma_f32_16x16x32_bf16 v[156:159], v[44:47], v[52:55], v[156:159]
    ds_read_b64_tr_b16 v[198:199], v11 offset:10240
    v_mfma_f32_16x16x32_bf16 v[152:155], v[40:43], v[52:55], v[152:155]
    ds_read_b64_tr_b16 v[200:201], v12 offset:8192
    v_mfma_f32_16x16x32_bf16 v[148:151], v[36:39], v[52:55], v[148:151]
    ds_read_b64_tr_b16 v[202:203], v12 offset:10240
    v_mfma_f32_16x16x32_bf16 v[144:147], v[32:35], v[52:55], v[144:147]
    ds_read_b64_tr_b16 v[204:205], v13 offset:8192
    s_waitcnt lgkmcnt(9)
    v_mfma_f32_16x16x32_bf16 v[160:163], v[32:35], v[56:59], v[160:163]
    ds_read_b64_tr_b16 v[206:207], v13 offset:10240
    v_mfma_f32_16x16x32_bf16 v[164:167], v[36:39], v[56:59], v[164:167]
    ds_read_b128 v[212:215], v9 offset:2304
    v_mfma_f32_16x16x32_bf16 v[168:171], v[40:43], v[56:59], v[168:171]
    ds_read_b128 v[216:219], v9 offset:6144
    v_mfma_f32_16x16x32_bf16 v[172:175], v[44:47], v[56:59], v[172:175]
    ds_read_b128 v[220:223], v9 offset:6400
    s_waitcnt lgkmcnt(12)
    v_mfma_f32_16x16x32_bf16 v[188:191], v[44:47], v[60:63], v[188:191]
    v_add_u32 v9, 98304, v6
    v_add_u32 v10, 98304, v7
    v_mfma_f32_16x16x32_bf16 v[184:187], v[40:43], v[60:63], v[184:187]
    v_xor_b32 v11, 16, v10
    v_xor_b32 v12, 64, v10
    v_mfma_f32_16x16x32_bf16 v[180:183], v[36:39], v[60:63], v[180:183]
    v_xor_b32 v13, 0x50, v10
    v_mfma_f32_16x16x32_bf16 v[176:179], v[32:35], v[60:63], v[176:179]
    s_waitcnt lgkmcnt(9)
    v_mfma_f32_16x16x32_bf16 v[128:131], v[192:195], v[208:211], v[128:131]
    ds_read_b64_tr_b16 v[32:33], v10 offset:0
    s_waitcnt lgkmcnt(8)
    v_mfma_f32_16x16x32_bf16 v[132:135], v[196:199], v[208:211], v[132:135]
    ds_read_b64_tr_b16 v[34:35], v10 offset:2048
    s_waitcnt lgkmcnt(7)
    v_mfma_f32_16x16x32_bf16 v[136:139], v[200:203], v[208:211], v[136:139]
    ds_read_b128 v[48:51], v9 offset:0
    s_waitcnt lgkmcnt(6)
    v_mfma_f32_16x16x32_bf16 v[140:143], v[204:207], v[208:211], v[140:143]
    ds_read_b64_tr_b16 v[36:37], v11 offset:0
    s_waitcnt lgkmcnt(6)
    v_mfma_f32_16x16x32_bf16 v[156:159], v[204:207], v[212:215], v[156:159]
    ds_read_b64_tr_b16 v[38:39], v11 offset:2048
    v_mfma_f32_16x16x32_bf16 v[152:155], v[200:203], v[212:215], v[152:155]
    ds_read_b64_tr_b16 v[40:41], v12 offset:0
    v_mfma_f32_16x16x32_bf16 v[148:151], v[196:199], v[212:215], v[148:151]
    ds_read_b64_tr_b16 v[42:43], v12 offset:2048
    v_mfma_f32_16x16x32_bf16 v[144:147], v[192:195], v[212:215], v[144:147]
    ds_read_b64_tr_b16 v[44:45], v13 offset:0
    s_waitcnt lgkmcnt(9)
    v_mfma_f32_16x16x32_bf16 v[160:163], v[192:195], v[216:219], v[160:163]
    ds_read_b64_tr_b16 v[46:47], v13 offset:2048
    v_mfma_f32_16x16x32_bf16 v[164:167], v[196:199], v[216:219], v[164:167]
    ds_read_b128 v[52:55], v9 offset:256
    v_mfma_f32_16x16x32_bf16 v[168:171], v[200:203], v[216:219], v[168:171]
    ds_read_b128 v[56:59], v9 offset:4096
    v_mfma_f32_16x16x32_bf16 v[172:175], v[204:207], v[216:219], v[172:175]
    ds_read_b128 v[60:63], v9 offset:4352
    s_waitcnt lgkmcnt(12)
    v_mfma_f32_16x16x32_bf16 v[188:191], v[204:207], v[220:223], v[188:191]
    v_mfma_f32_16x16x32_bf16 v[184:187], v[200:203], v[220:223], v[184:187]
    v_mfma_f32_16x16x32_bf16 v[180:183], v[196:199], v[220:223], v[180:183]
    v_mfma_f32_16x16x32_bf16 v[176:179], v[192:195], v[220:223], v[176:179]
    s_waitcnt lgkmcnt(9)
    v_mfma_f32_16x16x32_bf16 v[128:131], v[32:35], v[48:51], v[128:131]
    ds_read_b64_tr_b16 v[192:193], v10 offset:8192
    s_waitcnt lgkmcnt(8)
    v_mfma_f32_16x16x32_bf16 v[132:135], v[36:39], v[48:51], v[132:135]
    ds_read_b64_tr_b16 v[194:195], v10 offset:10240
    s_waitcnt lgkmcnt(7)
    v_mfma_f32_16x16x32_bf16 v[136:139], v[40:43], v[48:51], v[136:139]
    ds_read_b128 v[208:211], v9 offset:2048
    s_waitcnt lgkmcnt(6)
    v_mfma_f32_16x16x32_bf16 v[140:143], v[44:47], v[48:51], v[140:143]
    ds_read_b64_tr_b16 v[196:197], v11 offset:8192
    s_waitcnt lgkmcnt(6)
    v_mfma_f32_16x16x32_bf16 v[156:159], v[44:47], v[52:55], v[156:159]
    ds_read_b64_tr_b16 v[198:199], v11 offset:10240
    v_mfma_f32_16x16x32_bf16 v[152:155], v[40:43], v[52:55], v[152:155]
    ds_read_b64_tr_b16 v[200:201], v12 offset:8192
    v_mfma_f32_16x16x32_bf16 v[148:151], v[36:39], v[52:55], v[148:151]
    ds_read_b64_tr_b16 v[202:203], v12 offset:10240
    v_mfma_f32_16x16x32_bf16 v[144:147], v[32:35], v[52:55], v[144:147]
    ds_read_b64_tr_b16 v[204:205], v13 offset:8192
    s_waitcnt lgkmcnt(9)
    v_mfma_f32_16x16x32_bf16 v[160:163], v[32:35], v[56:59], v[160:163]
    ds_read_b64_tr_b16 v[206:207], v13 offset:10240
    v_mfma_f32_16x16x32_bf16 v[164:167], v[36:39], v[56:59], v[164:167]
    ds_read_b128 v[212:215], v9 offset:2304
    v_mfma_f32_16x16x32_bf16 v[168:171], v[40:43], v[56:59], v[168:171]
    ds_read_b128 v[216:219], v9 offset:6144
    v_mfma_f32_16x16x32_bf16 v[172:175], v[44:47], v[56:59], v[172:175]
    ds_read_b128 v[220:223], v9 offset:6400
    s_waitcnt lgkmcnt(12)
    v_mfma_f32_16x16x32_bf16 v[188:191], v[44:47], v[60:63], v[188:191]
    v_add_u32 v9, 131072, v6
    v_add_u32 v10, 131072, v7
    v_mfma_f32_16x16x32_bf16 v[184:187], v[40:43], v[60:63], v[184:187]
    v_xor_b32 v11, 16, v10
    v_xor_b32 v12, 64, v10
    v_mfma_f32_16x16x32_bf16 v[180:183], v[36:39], v[60:63], v[180:183]
    v_xor_b32 v13, 0x50, v10
    v_mfma_f32_16x16x32_bf16 v[176:179], v[32:35], v[60:63], v[176:179]
    s_waitcnt lgkmcnt(0)
    v_mfma_f32_16x16x32_bf16 v[128:131], v[192:195], v[208:211], v[128:131]
    s_barrier
    ds_read_b64_tr_b16 v[32:33], v10 offset:0
    v_mfma_f32_16x16x32_bf16 v[132:135], v[196:199], v[208:211], v[132:135]
    ds_read_b64_tr_b16 v[34:35], v10 offset:2048
    v_mfma_f32_16x16x32_bf16 v[136:139], v[200:203], v[208:211], v[136:139]
    ds_read_b128 v[48:51], v9 offset:0
    v_mfma_f32_16x16x32_bf16 v[140:143], v[204:207], v[208:211], v[140:143]
    ds_read_b64_tr_b16 v[36:37], v11 offset:0
    v_mfma_f32_16x16x32_bf16 v[156:159], v[204:207], v[212:215], v[156:159]
    ds_read_b64_tr_b16 v[38:39], v11 offset:2048
    v_mfma_f32_16x16x32_bf16 v[152:155], v[200:203], v[212:215], v[152:155]
    ds_read_b64_tr_b16 v[40:41], v12 offset:0
    v_mfma_f32_16x16x32_bf16 v[148:151], v[196:199], v[212:215], v[148:151]
    ds_read_b64_tr_b16 v[42:43], v12 offset:2048
    v_mfma_f32_16x16x32_bf16 v[144:147], v[192:195], v[212:215], v[144:147]
    ds_read_b64_tr_b16 v[44:45], v13 offset:0
    v_mfma_f32_16x16x32_bf16 v[160:163], v[192:195], v[216:219], v[160:163]
    ds_read_b64_tr_b16 v[46:47], v13 offset:2048
    v_mfma_f32_16x16x32_bf16 v[164:167], v[196:199], v[216:219], v[164:167]
    ds_read_b128 v[52:55], v9 offset:256
    v_mfma_f32_16x16x32_bf16 v[168:171], v[200:203], v[216:219], v[168:171]
    ds_read_b128 v[56:59], v9 offset:4096
    v_mfma_f32_16x16x32_bf16 v[172:175], v[204:207], v[216:219], v[172:175]
    ds_read_b128 v[60:63], v9 offset:4352
    v_mfma_f32_16x16x32_bf16 v[188:191], v[204:207], v[220:223], v[188:191]
    v_mfma_f32_16x16x32_bf16 v[184:187], v[200:203], v[220:223], v[184:187]
    v_mfma_f32_16x16x32_bf16 v[180:183], v[196:199], v[220:223], v[180:183]
    v_mfma_f32_16x16x32_bf16 v[176:179], v[192:195], v[220:223], v[176:179]
    s_waitcnt lgkmcnt(9)
    v_mfma_f32_16x16x32_bf16 v[128:131], v[32:35], v[48:51], v[128:131]
    ds_read_b64_tr_b16 v[192:193], v10 offset:8192
    s_waitcnt lgkmcnt(8)
    v_mfma_f32_16x16x32_bf16 v[132:135], v[36:39], v[48:51], v[132:135]
    ds_read_b64_tr_b16 v[194:195], v10 offset:10240
    s_waitcnt lgkmcnt(7)
    v_mfma_f32_16x16x32_bf16 v[136:139], v[40:43], v[48:51], v[136:139]
    ds_read_b128 v[208:211], v9 offset:2048
    s_waitcnt lgkmcnt(6)
    v_mfma_f32_16x16x32_bf16 v[140:143], v[44:47], v[48:51], v[140:143]
    ds_read_b64_tr_b16 v[196:197], v11 offset:8192
    s_waitcnt lgkmcnt(6)
    v_mfma_f32_16x16x32_bf16 v[156:159], v[44:47], v[52:55], v[156:159]
    ds_read_b64_tr_b16 v[198:199], v11 offset:10240
    v_mfma_f32_16x16x32_bf16 v[152:155], v[40:43], v[52:55], v[152:155]
    ds_read_b64_tr_b16 v[200:201], v12 offset:8192
    v_mfma_f32_16x16x32_bf16 v[148:151], v[36:39], v[52:55], v[148:151]
    ds_read_b64_tr_b16 v[202:203], v12 offset:10240
    v_mfma_f32_16x16x32_bf16 v[144:147], v[32:35], v[52:55], v[144:147]
    ds_read_b64_tr_b16 v[204:205], v13 offset:8192
    s_waitcnt lgkmcnt(9)
    v_mfma_f32_16x16x32_bf16 v[160:163], v[32:35], v[56:59], v[160:163]
    ds_read_b64_tr_b16 v[206:207], v13 offset:10240
    v_mfma_f32_16x16x32_bf16 v[164:167], v[36:39], v[56:59], v[164:167]
    ds_read_b128 v[212:215], v9 offset:2304
    v_mfma_f32_16x16x32_bf16 v[168:171], v[40:43], v[56:59], v[168:171]
    ds_read_b128 v[216:219], v9 offset:6144
    v_mfma_f32_16x16x32_bf16 v[172:175], v[44:47], v[56:59], v[172:175]
    ds_read_b128 v[220:223], v9 offset:6400
    s_waitcnt lgkmcnt(12)
    v_mfma_f32_16x16x32_bf16 v[188:191], v[44:47], v[60:63], v[188:191]
    v_add_u32 v9, 0, v6
    v_add_u32 v10, 0, v7
    v_mfma_f32_16x16x32_bf16 v[184:187], v[40:43], v[60:63], v[184:187]
    v_xor_b32 v11, 16, v10
    v_xor_b32 v12, 64, v10
    v_mfma_f32_16x16x32_bf16 v[180:183], v[36:39], v[60:63], v[180:183]
    v_xor_b32 v13, 0x50, v10
    v_mfma_f32_16x16x32_bf16 v[176:179], v[32:35], v[60:63], v[176:179]
    s_waitcnt lgkmcnt(9)
    v_mfma_f32_16x16x32_bf16 v[128:131], v[192:195], v[208:211], v[128:131]
    ds_read_b64_tr_b16 v[32:33], v10 offset:0
    ds_read_b64_tr_b16 v[34:35], v10 offset:2048
    s_waitcnt lgkmcnt(9)
    v_mfma_f32_16x16x32_bf16 v[132:135], v[196:199], v[208:211], v[132:135]
    ds_read_b128 v[48:51], v9 offset:0
    ds_read_b64_tr_b16 v[36:37], v11 offset:0
    s_waitcnt lgkmcnt(9)
    v_mfma_f32_16x16x32_bf16 v[136:139], v[200:203], v[208:211], v[136:139]
    ds_read_b64_tr_b16 v[38:39], v11 offset:2048
    ds_read_b64_tr_b16 v[40:41], v12 offset:0
    s_waitcnt lgkmcnt(9)
    v_mfma_f32_16x16x32_bf16 v[140:143], v[204:207], v[208:211], v[140:143]
    ds_read_b64_tr_b16 v[42:43], v12 offset:2048
    ds_read_b64_tr_b16 v[44:45], v13 offset:0
    s_waitcnt lgkmcnt(10)
    v_mfma_f32_16x16x32_bf16 v[156:159], v[204:207], v[212:215], v[156:159]
    ds_read_b64_tr_b16 v[46:47], v13 offset:2048
    ds_read_b128 v[52:55], v9 offset:256
    v_mfma_f32_16x16x32_bf16 v[152:155], v[200:203], v[212:215], v[152:155]
    ds_read_b128 v[56:59], v9 offset:4096
    ds_read_b128 v[60:63], v9 offset:4352
    v_mfma_f32_16x16x32_bf16 v[148:151], v[196:199], v[212:215], v[148:151]
    ds_read_b64_tr_b16 v[224:225], v10 offset:8192
    ds_read_b64_tr_b16 v[226:227], v10 offset:10240
    v_mfma_f32_16x16x32_bf16 v[144:147], v[192:195], v[212:215], v[144:147]
    ds_read_b128 v[240:243], v9 offset:2048
    ds_read_b64_tr_b16 v[228:229], v11 offset:8192
    s_waitcnt lgkmcnt(15)
    v_mfma_f32_16x16x32_bf16 v[160:163], v[192:195], v[216:219], v[160:163]
    ds_read_b64_tr_b16 v[230:231], v11 offset:10240
    v_mfma_f32_16x16x32_bf16 v[164:167], v[196:199], v[216:219], v[164:167]
    ds_read_b64_tr_b16 v[232:233], v12 offset:8192
    v_mfma_f32_16x16x32_bf16 v[168:171], v[200:203], v[216:219], v[168:171]
    ds_read_b64_tr_b16 v[234:235], v12 offset:10240
    v_mfma_f32_16x16x32_bf16 v[172:175], v[204:207], v[216:219], v[172:175]
    ds_read_b64_tr_b16 v[236:237], v13 offset:8192
    s_waitcnt lgkmcnt(15)
    v_mfma_f32_16x16x32_bf16 v[188:191], v[204:207], v[220:223], v[188:191]
    ds_read_b64_tr_b16 v[238:239], v13 offset:10240
    v_mfma_f32_16x16x32_bf16 v[184:187], v[200:203], v[220:223], v[184:187]
    ds_read_b128 v[244:247], v9 offset:2304
    v_mfma_f32_16x16x32_bf16 v[180:183], v[196:199], v[220:223], v[180:183]
    ds_read_b128 v[248:251], v9 offset:6144
    v_mfma_f32_16x16x32_bf16 v[176:179], v[192:195], v[220:223], v[176:179]
    ds_read_b128 v[252:255], v9 offset:6400
    s_waitcnt lgkmcnt(15)
    v_mfma_f32_16x16x32_bf16 v[128:131], v[32:35], v[48:51], v[128:131]
    s_waitcnt lgkmcnt(15)
    v_mfma_f32_16x16x32_bf16 v[132:135], v[36:39], v[48:51], v[132:135]
    s_waitcnt lgkmcnt(15)
    v_mfma_f32_16x16x32_bf16 v[136:139], v[40:43], v[48:51], v[136:139]
    s_waitcnt lgkmcnt(15)
    v_mfma_f32_16x16x32_bf16 v[140:143], v[44:47], v[48:51], v[140:143]
    s_waitcnt lgkmcnt(9)
    v_mfma_f32_16x16x32_bf16 v[128:131], v[224:227], v[240:243], v[128:131]
    s_waitcnt lgkmcnt(7)
    v_mfma_f32_16x16x32_bf16 v[132:135], v[228:231], v[240:243], v[132:135]
    s_waitcnt lgkmcnt(5)
    v_mfma_f32_16x16x32_bf16 v[136:139], v[232:235], v[240:243], v[136:139]
    s_waitcnt lgkmcnt(3)
    v_mfma_f32_16x16x32_bf16 v[140:143], v[236:239], v[240:243], v[140:143]
    v_mfma_f32_16x16x32_bf16 v[144:147], v[32:35], v[52:55], v[144:147]
    v_mfma_f32_16x16x32_bf16 v[148:151], v[36:39], v[52:55], v[148:151]
    v_mfma_f32_16x16x32_bf16 v[152:155], v[40:43], v[52:55], v[152:155]
    v_cvt_pk_bf16_f32 v80, v128, v129
    v_cvt_pk_bf16_f32 v81, v130, v131
    v_mfma_f32_16x16x32_bf16 v[156:159], v[44:47], v[52:55], v[156:159]
    v_cvt_pk_bf16_f32 v82, v132, v133
    v_cvt_pk_bf16_f32 v83, v134, v135
    s_waitcnt lgkmcnt(2)
    v_mfma_f32_16x16x32_bf16 v[144:147], v[224:227], v[244:247], v[144:147]
    buffer_store_dwordx4 v[80:83], v8, s[12:15], s36 offen offset:0 sc1
    v_cvt_pk_bf16_f32 v104, v136, v137
    v_mfma_f32_16x16x32_bf16 v[148:151], v[228:231], v[244:247], v[148:151]
    v_cvt_pk_bf16_f32 v105, v138, v139
    v_cvt_pk_bf16_f32 v106, v140, v141
    v_mfma_f32_16x16x32_bf16 v[152:155], v[232:235], v[244:247], v[152:155]
    v_cvt_pk_bf16_f32 v107, v142, v143
    v_mfma_f32_16x16x32_bf16 v[156:159], v[236:239], v[244:247], v[156:159]
    buffer_store_dwordx4 v[104:107], v8, s[12:15], s36 offen offset:2048 sc1
    v_mfma_f32_16x16x32_bf16 v[160:163], v[32:35], v[56:59], v[160:163]
    v_mfma_f32_16x16x32_bf16 v[164:167], v[36:39], v[56:59], v[164:167]
    v_mfma_f32_16x16x32_bf16 v[168:171], v[40:43], v[56:59], v[168:171]
    v_cvt_pk_bf16_f32 v84, v144, v145
    v_cvt_pk_bf16_f32 v85, v146, v147
    v_mfma_f32_16x16x32_bf16 v[172:175], v[44:47], v[56:59], v[172:175]
    v_cvt_pk_bf16_f32 v86, v148, v149
    v_cvt_pk_bf16_f32 v87, v150, v151
    s_waitcnt lgkmcnt(1)
    v_mfma_f32_16x16x32_bf16 v[160:163], v[224:227], v[248:251], v[160:163]
    buffer_store_dwordx4 v[84:87], v8, s[12:15], s36 offen offset:256 sc1
    v_cvt_pk_bf16_f32 v108, v152, v153
    v_mfma_f32_16x16x32_bf16 v[164:167], v[228:231], v[248:251], v[164:167]
    v_cvt_pk_bf16_f32 v109, v154, v155
    v_cvt_pk_bf16_f32 v110, v156, v157
    v_mfma_f32_16x16x32_bf16 v[168:171], v[232:235], v[248:251], v[168:171]
    v_cvt_pk_bf16_f32 v111, v158, v159
    v_mfma_f32_16x16x32_bf16 v[172:175], v[236:239], v[248:251], v[172:175]
    buffer_store_dwordx4 v[108:111], v8, s[12:15], s36 offen offset:2304 sc1
    v_mfma_f32_16x16x32_bf16 v[176:179], v[32:35], v[60:63], v[176:179]
    v_mfma_f32_16x16x32_bf16 v[180:183], v[36:39], v[60:63], v[180:183]
    v_mfma_f32_16x16x32_bf16 v[184:187], v[40:43], v[60:63], v[184:187]
    v_cvt_pk_bf16_f32 v80, v160, v161
    v_cvt_pk_bf16_f32 v81, v162, v163
    v_mfma_f32_16x16x32_bf16 v[188:191], v[44:47], v[60:63], v[188:191]
    v_cvt_pk_bf16_f32 v82, v164, v165
    v_cvt_pk_bf16_f32 v83, v166, v167
    s_waitcnt lgkmcnt(0)
    v_mfma_f32_16x16x32_bf16 v[176:179], v[224:227], v[252:255], v[176:179]
    buffer_store_dwordx4 v[80:83], v8, s[12:15], s37 offen offset:0 sc1
    v_cvt_pk_bf16_f32 v104, v168, v169
    v_mfma_f32_16x16x32_bf16 v[180:183], v[228:231], v[252:255], v[180:183]
    v_cvt_pk_bf16_f32 v105, v170, v171
    v_cvt_pk_bf16_f32 v106, v172, v173
    v_mfma_f32_16x16x32_bf16 v[184:187], v[232:235], v[252:255], v[184:187]
    v_cvt_pk_bf16_f32 v107, v174, v175
    v_mfma_f32_16x16x32_bf16 v[188:191], v[236:239], v[252:255], v[188:191]
    buffer_store_dwordx4 v[104:107], v8, s[12:15], s37 offen offset:2048 sc1
    v_cvt_pk_bf16_f32 v84, v176, v177
    v_cvt_pk_bf16_f32 v85, v178, v179
    v_cvt_pk_bf16_f32 v86, v180, v181
    v_cvt_pk_bf16_f32 v87, v182, v183
    buffer_store_dwordx4 v[84:87], v8, s[12:15], s37 offen offset:256 sc1
    v_cvt_pk_bf16_f32 v108, v184, v185
    v_cvt_pk_bf16_f32 v109, v186, v187
    v_cvt_pk_bf16_f32 v110, v188, v189
    v_cvt_pk_bf16_f32 v111, v190, v191
    buffer_store_dwordx4 v[108:111], v8, s[12:15], s37 offen offset:2304 sc1
Loxe:
    s_waitcnt vmcnt(8)
    s_mov_b32 s47, 200000
Ltml_113:
    v_xor_b32 v92, s64, v99
    v_xor_b32 v93, s64, v103
    v_or_b32 v92, v92, v93
    v_cmp_ne_u32 vcc, 0, v92
    s_nop 0
    s_cbranch_vccz Ltmok_114
    s_sub_u32 s47, s47, 1
    s_cbranch_scc1 Ltmok_114
    buffer_load_dwordx4 v[96:99], v23, s[12:15], s46 offen sc1
    buffer_load_dwordx4 v[100:103], v2, s[12:15], s65 offen sc1
    s_waitcnt vmcnt(0)
    s_branch Ltml_113
Ltmok_114:
    v_mov_b32 v3, v102
    ds_swizzle_b32 v112, v96 offset:24
    ds_swizzle_b32 v113, v96 offset:56
    ds_swizzle_b32 v114, v96 offset:88
    ds_swizzle_b32 v115, v96 offset:120
    ds_swizzle_b32 v116, v96 offset:152
    ds_swizzle_b32 v117, v96 offset:184
    ds_swizzle_b32 v118, v96 offset:216
    ds_swizzle_b32 v119, v96 offset:248
    ds_swizzle_b32 v120, v97 offset:24
    ds_swizzle_b32 v121, v97 offset:56
    ds_swizzle_b32 v122, v97 offset:88
    ds_swizzle_b32 v123, v97 offset:120
    ds_swizzle_b32 v124, v97 offset:152
    ds_swizzle_b32 v125, v97 offset:184
    ds_swizzle_b32 v126, v97 offset:216
    ds_swizzle_b32 v127, v97 offset:248
    buffer_load_dwordx2 v[240:241], v31, s[48:51], s67 offen offset:0
    buffer_load_dwordx2 v[242:243], v31, s[48:51], s67 offen offset:16
    buffer_load_dwordx2 v[244:245], v31, s[48:51], s67 offen offset:64
    buffer_load_dwordx2 v[246:247], v31, s[48:51], s67 offen offset:80
    s_waitcnt vmcnt(4)
    s_branch Lln
Loy:
    v_lshlrev_b32 v15, 7, v1
    buffer_load_dword v31, v15, s[48:51], 0 offen
    v_and_b32 v9, 1, v1
    v_lshlrev_b32 v9, 18, v9
    s_lshl_b32 s42, s60, 11
    s_lshl_b32 s43, s61, 7
    s_add_u32 s42, s42, s43
    s_add_u32 s42, s42, 14680064
    buffer_load_dword v7, v9, s[12:15], s42 offen sc1
    s_lshl_b32 s42, s60, 11
    s_lshl_b32 s43, s61, 7
    s_add_u32 s42, s42, s43
    s_add_u32 s42, s42, 15204352
    buffer_load_dword v7, v9, s[12:15], s42 offen sc1
    s_lshl_b32 s42, s72, 11
    s_lshl_b32 s43, s73, 7
    s_add_u32 s42, s42, s43
    s_add_u32 s42, s42, 15728640
    buffer_load_dword v7, v9, s[12:15], s42 offen sc1
    buffer_load_dwordx4 v[96:99], v23, s[12:15], s46 offen sc1
    buffer_load_dwordx4 v[100:103], v2, s[12:15], s65 offen sc1
    buffer_load_dwordx2 v[88:89], v24, s[16:19], s33 offen
    buffer_load_dwordx2 v[90:91], v24, s[16:19], s33 offen offset:16
    v_lshlrev_b32 v94, 10, v20
    buffer_load_ushort v94, v94, s[16:19], s33 offen
    s_waitcnt vmcnt(0)
    s_mov_b32 s47, 200000
Ltml_115:
    v_xor_b32 v92, s64, v99
    v_xor_b32 v93, s64, v103
    v_or_b32 v92, v92, v93
    v_cmp_ne_u32 vcc, 0, v92
    s_nop 0
    s_cbranch_vccz Ltmok_116
    s_sub_u32 s47, s47, 1
    s_cbranch_scc1 Ltmok_116
    buffer_load_dwordx4 v[96:99], v23, s[12:15], s46 offen sc1
    buffer_load_dwordx4 v[100:103], v2, s[12:15], s65 offen sc1
    s_waitcnt vmcnt(0)
    s_branch Ltml_115
Ltmok_116:
    v_mov_b32 v3, v102
    ds_swizzle_b32 v112, v96 offset:24
    ds_swizzle_b32 v113, v96 offset:56
    ds_swizzle_b32 v114, v96 offset:88
    ds_swizzle_b32 v115, v96 offset:120
    ds_swizzle_b32 v116, v96 offset:152
    ds_swizzle_b32 v117, v96 offset:184
    ds_swizzle_b32 v118, v96 offset:216
    ds_swizzle_b32 v119, v96 offset:248
    ds_swizzle_b32 v120, v97 offset:24
    ds_swizzle_b32 v121, v97 offset:56
    ds_swizzle_b32 v122, v97 offset:88
    ds_swizzle_b32 v123, v97 offset:120
    ds_swizzle_b32 v124, v97 offset:152
    ds_swizzle_b32 v125, v97 offset:184
    ds_swizzle_b32 v126, v97 offset:216
    ds_swizzle_b32 v127, v97 offset:248
    s_lshl_b32 s42, s25, 11
    s_lshl_b32 s43, s32, 7
    s_add_u32 s42, s42, s43
    s_add_u32 s42, s42, 16252960
    v_min_u32 v27, 0, v1
    v_lshlrev_b32 v27, 2, v27
    v_add_u32 v27, s42, v27
    s_barrier
    s_mov_b32 s39, s28
    s_add_u32 m0, s30, 16384
    s_nop 0
    buffer_load_dwordx4 v16, s[8:11], s28 offen offset:0 lds
    buffer_load_dwordx4 v17, s[8:11], s28 offen offset:1024 lds
    buffer_load_dwordx4 v18, s[8:11], s28 offen offset:2048 lds
    buffer_load_dwordx4 v19, s[8:11], s28 offen offset:3072 lds
    s_add_u32 s28, s28, 65536
    s_add_u32 m0, s30, 49152
    s_nop 0
    buffer_load_dwordx4 v16, s[8:11], s28 offen offset:0 lds
    buffer_load_dwordx4 v17, s[8:11], s28 offen offset:1024 lds
    buffer_load_dwordx4 v18, s[8:11], s28 offen offset:2048 lds
    buffer_load_dwordx4 v19, s[8:11], s28 offen offset:3072 lds
    s_add_u32 s28, s28, 65536
    s_add_u32 m0, s30, 81920
    s_nop 0
    buffer_load_dwordx4 v16, s[8:11], s28 offen offset:0 lds
    buffer_load_dwordx4 v17, s[8:11], s28 offen offset:1024 lds
    buffer_load_dwordx4 v18, s[8:11], s28 offen offset:2048 lds
    buffer_load_dwordx4 v19, s[8:11], s28 offen offset:3072 lds
    s_add_u32 s28, s28, 65536
    s_add_u32 m0, s30, 114688
    s_nop 0
    buffer_load_dwordx4 v16, s[8:11], s28 offen offset:0 lds
    buffer_load_dwordx4 v17, s[8:11], s28 offen offset:1024 lds
    buffer_load_dwordx4 v18, s[8:11], s28 offen offset:2048 lds
    buffer_load_dwordx4 v19, s[8:11], s28 offen offset:3072 lds
    s_add_u32 s28, s28, 65536
    s_add_u32 m0, s30, 147456
    s_nop 0
    buffer_load_dwordx4 v16, s[8:11], s28 offen offset:0 lds
    buffer_load_dwordx4 v17, s[8:11], s28 offen offset:1024 lds
    buffer_load_dwordx4 v18, s[8:11], s28 offen offset:2048 lds
    buffer_load_dwordx4 v19, s[8:11], s28 offen offset:3072 lds
    s_add_u32 s28, s28, 65536
    s_waitcnt lgkmcnt(0)
    s_barrier
    s_add_u32 m0, s30, 0
    s_nop 0
    buffer_load_dwordx4 v2, s[12:15], s27 offen offset:0 sc1 lds
    buffer_load_dwordx4 v2, s[12:15], s27 offen offset:1024 sc1 lds
    buffer_load_dwordx4 v2, s[12:15], s27 offen offset:2048 sc1 lds
    buffer_load_dwordx4 v2, s[12:15], s27 offen offset:3072 sc1 lds
    s_add_u32 s27, s27, 4096
    s_add_u32 m0, s30, 32768
    s_nop 0
    buffer_load_dwordx4 v2, s[12:15], s27 offen offset:0 sc1 lds
    buffer_load_dwordx4 v2, s[12:15], s27 offen offset:1024 sc1 lds
    buffer_load_dwordx4 v2, s[12:15], s27 offen offset:2048 sc1 lds
    buffer_load_dwordx4 v2, s[12:15], s27 offen offset:3072 sc1 lds
    s_add_u32 s27, s27, 4096
    s_waitcnt vmcnt(4)
    s_barrier
    s_add_u32 m0, s30, 65536
    s_nop 0
    buffer_load_dwordx4 v2, s[12:15], s27 offen offset:0 sc1 lds
    buffer_load_dwordx4 v2, s[12:15], s27 offen offset:1024 sc1 lds
    buffer_load_dwordx4 v2, s[12:15], s27 offen offset:2048 sc1 lds
    buffer_load_dwordx4 v2, s[12:15], s27 offen offset:3072 sc1 lds
    s_add_u32 s27, s27, 4096
    s_waitcnt vmcnt(4)
    s_barrier
    s_add_u32 m0, s30, 98304
    s_nop 0
    buffer_load_dwordx4 v2, s[12:15], s27 offen offset:0 sc1 lds
    buffer_load_dwordx4 v2, s[12:15], s27 offen offset:1024 sc1 lds
    buffer_load_dwordx4 v2, s[12:15], s27 offen offset:2048 sc1 lds
    buffer_load_dwordx4 v2, s[12:15], s27 offen offset:3072 sc1 lds
    s_add_u32 s27, s27, 4096
    s_add_u32 m0, s30, 131072
    s_nop 0
    buffer_load_dwordx4 v2, s[12:15], s27 offen offset:0 sc1 lds
    buffer_load_dwordx4 v2, s[12:15], s27 offen offset:1024 sc1 lds
    buffer_load_dwordx4 v2, s[12:15], s27 offen offset:2048 sc1 lds
    buffer_load_dwordx4 v2, s[12:15], s27 offen offset:3072 sc1 lds
    s_add_u32 s27, s27, 4096
    s_waitcnt vmcnt(4) lgkmcnt(0)
    s_barrier
    s_add_u32 m0, s30, 0
    s_nop 0
    buffer_load_dwordx4 v2, s[12:15], s27 offen offset:0 sc1 lds
    buffer_load_dwordx4 v2, s[12:15], s27 offen offset:1024 sc1 lds
    buffer_load_dwordx4 v2, s[12:15], s27 offen offset:2048 sc1 lds
    buffer_load_dwordx4 v2, s[12:15], s27 offen offset:3072 sc1 lds
    s_add_u32 s27, s27, 4096
    s_add_u32 m0, s30, 16384
    s_nop 0
    buffer_load_dwordx4 v16, s[8:11], s28 offen offset:0 lds
    buffer_load_dwordx4 v17, s[8:11], s28 offen offset:1024 lds
    buffer_load_dwordx4 v18, s[8:11], s28 offen offset:2048 lds
    buffer_load_dwordx4 v19, s[8:11], s28 offen offset:3072 lds
    s_add_u32 s28, s28, 65536
    s_add_u32 m0, s30, 32768
    s_nop 0
    buffer_load_dwordx4 v2, s[12:15], s27 offen offset:0 sc1 lds
    buffer_load_dwordx4 v2, s[12:15], s27 offen offset:1024 sc1 lds
    buffer_load_dwordx4 v2, s[12:15], s27 offen offset:2048 sc1 lds
    buffer_load_dwordx4 v2, s[12:15], s27 offen offset:3072 sc1 lds
    s_add_u32 s27, s27, 4096
    s_add_u32 m0, s30, 49152
    s_nop 0
    buffer_load_dwordx4 v16, s[8:11], s28 offen offset:0 lds
    buffer_load_dwordx4 v17, s[8:11], s28 offen offset:1024 lds
    buffer_load_dwordx4 v18, s[8:11], s28 offen offset:2048 lds
    buffer_load_dwordx4 v19, s[8:11], s28 offen offset:3072 lds
    s_add_u32 s28, s28, 65536
    s_waitcnt vmcnt(8) lgkmcnt(0)
    s_barrier
    s_add_u32 m0, s30, 65536
    s_nop 0
    buffer_load_dwordx4 v2, s[12:15], s27 offen offset:0 sc1 lds
    buffer_load_dwordx4 v2, s[12:15], s27 offen offset:1024 sc1 lds
    buffer_load_dwordx4 v2, s[12:15], s27 offen offset:2048 sc1 lds
    buffer_load_dwordx4 v2, s[12:15], s27 offen offset:3072 sc1 lds
    s_add_u32 s27, s27, 36864
    s_add_u32 m0, s30, 81920
    s_nop 0
    buffer_load_dwordx4 v16, s[8:11], s28 offen offset:0 lds
    buffer_load_dwordx4 v17, s[8:11], s28 offen offset:1024 lds
    buffer_load_dwordx4 v18, s[8:11], s28 offen offset:2048 lds
    buffer_load_dwordx4 v19, s[8:11], s28 offen offset:3072 lds
    s_add_u32 s28, s28, 589824
    s_add_u32 m0, s30, 98304
    s_nop 0
    buffer_load_dwordx4 v2, s[12:15], s27 offen offset:0 sc1 lds
    buffer_load_dwordx4 v2, s[12:15], s27 offen offset:1024 sc1 lds
    buffer_load_dwordx4 v2, s[12:15], s27 offen offset:2048 sc1 lds
    buffer_load_dwordx4 v2, s[12:15], s27 offen offset:3072 sc1 lds
    s_add_u32 s27, s27, 4096
    s_add_u32 m0, s30, 114688
    s_nop 0
    buffer_load_dwordx4 v16, s[8:11], s28 offen offset:0 lds
    buffer_load_dwordx4 v17, s[8:11], s28 offen offset:1024 lds
    buffer_load_dwordx4 v18, s[8:11], s28 offen offset:2048 lds
    buffer_load_dwordx4 v19, s[8:11], s28 offen offset:3072 lds
    s_add_u32 s28, s28, 65536
    s_waitcnt vmcnt(8) lgkmcnt(0)
    s_barrier
    s_add_u32 m0, s30, 131072
    s_nop 0
    buffer_load_dwordx4 v2, s[12:15], s27 offen offset:0 sc1 lds
    buffer_load_dwordx4 v2, s[12:15], s27 offen offset:1024 sc1 lds
    buffer_load_dwordx4 v2, s[12:15], s27 offen offset:2048 sc1 lds
    buffer_load_dwordx4 v2, s[12:15], s27 offen offset:3072 sc1 lds
    s_add_u32 s27, s27, 4096
    s_add_u32 m0, s30, 147456
    s_nop 0
    buffer_load_dwordx4 v16, s[8:11], s28 offen offset:0 lds
    buffer_load_dwordx4 v17, s[8:11], s28 offen offset:1024 lds
    buffer_load_dwordx4 v18, s[8:11], s28 offen offset:2048 lds
    buffer_load_dwordx4 v19, s[8:11], s28 offen offset:3072 lds
    s_add_u32 s28, s28, 65536
    s_add_u32 m0, s30, 0
    s_nop 0
    buffer_load_dwordx4 v2, s[12:15], s27 offen offset:0 sc1 lds
    buffer_load_dwordx4 v2, s[12:15], s27 offen offset:1024 sc1 lds
    buffer_load_dwordx4 v2, s[12:15], s27 offen offset:2048 sc1 lds
    buffer_load_dwordx4 v2, s[12:15], s27 offen offset:3072 sc1 lds
    s_add_u32 s27, s27, 4096
    s_add_u32 m0, s30, 16384
    s_nop 0
    buffer_load_dwordx4 v16, s[8:11], s28 offen offset:0 lds
    buffer_load_dwordx4 v17, s[8:11], s28 offen offset:1024 lds
    buffer_load_dwordx4 v18, s[8:11], s28 offen offset:2048 lds
    buffer_load_dwordx4 v19, s[8:11], s28 offen offset:3072 lds
    s_add_u32 s28, s28, 65536
    s_waitcnt vmcnt(8) lgkmcnt(0)
    s_barrier
    s_add_u32 m0, s30, 32768
    s_nop 0
    buffer_load_dwordx4 v2, s[12:15], s27 offen offset:0 sc1 lds
    buffer_load_dwordx4 v2, s[12:15], s27 offen offset:1024 sc1 lds
    buffer_load_dwordx4 v2, s[12:15], s27 offen offset:2048 sc1 lds
    buffer_load_dwordx4 v2, s[12:15], s27 offen offset:3072 sc1 lds
    s_add_u32 s27, s27, 4096
    s_add_u32 m0, s30, 49152
    s_nop 0
    buffer_load_dwordx4 v16, s[8:11], s28 offen offset:0 lds
    buffer_load_dwordx4 v17, s[8:11], s28 offen offset:1024 lds
    buffer_load_dwordx4 v18, s[8:11], s28 offen offset:2048 lds
    buffer_load_dwordx4 v19, s[8:11], s28 offen offset:3072 lds
    s_add_u32 s28, s28, 65536
    s_add_u32 m0, s30, 65536
    s_nop 0
    buffer_load_dwordx4 v2, s[12:15], s27 offen offset:0 sc1 lds
    buffer_load_dwordx4 v2, s[12:15], s27 offen offset:1024 sc1 lds
    buffer_load_dwordx4 v2, s[12:15], s27 offen offset:2048 sc1 lds
    buffer_load_dwordx4 v2, s[12:15], s27 offen offset:3072 sc1 lds
    s_add_u32 s27, s27, 4096
    s_add_u32 m0, s30, 81920
    s_nop 0
    buffer_load_dwordx4 v16, s[8:11], s28 offen offset:0 lds
    buffer_load_dwordx4 v17, s[8:11], s28 offen offset:1024 lds
    buffer_load_dwordx4 v18, s[8:11], s28 offen offset:2048 lds
    buffer_load_dwordx4 v19, s[8:11], s28 offen offset:3072 lds
    s_add_u32 s28, s28, 65536
    s_waitcnt vmcnt(8) lgkmcnt(0)
    s_barrier
    s_add_u32 m0, s30, 98304
    s_nop 0
    buffer_load_dwordx4 v2, s[12:15], s27 offen offset:0 sc1 lds
    buffer_load_dwordx4 v2, s[12:15], s27 offen offset:1024 sc1 lds
    buffer_load_dwordx4 v2, s[12:15], s27 offen offset:2048 sc1 lds
    buffer_load_dwordx4 v2, s[12:15], s27 offen offset:3072 sc1 lds
    s_add_u32 s27, s27, 4096
    s_add_u32 m0, s30, 114688
    s_nop 0
    buffer_load_dwordx4 v16, s[8:11], s28 offen offset:0 lds
    buffer_load_dwordx4 v17, s[8:11], s28 offen offset:1024 lds
    buffer_load_dwordx4 v18, s[8:11], s28 offen offset:2048 lds
    buffer_load_dwordx4 v19, s[8:11], s28 offen offset:3072 lds
    s_add_u32 s28, s28, 65536
    s_add_u32 m0, s30, 131072
    s_nop 0
    buffer_load_dwordx4 v2, s[12:15], s27 offen offset:0 sc1 lds
    buffer_load_dwordx4 v2, s[12:15], s27 offen offset:1024 sc1 lds
    buffer_load_dwordx4 v2, s[12:15], s27 offen offset:2048 sc1 lds
    buffer_load_dwordx4 v2, s[12:15], s27 offen offset:3072 sc1 lds
    s_add_u32 s27, s27, 4096
    s_add_u32 m0, s30, 147456
    s_nop 0
    buffer_load_dwordx4 v16, s[8:11], s28 offen offset:0 lds
    buffer_load_dwordx4 v17, s[8:11], s28 offen offset:1024 lds
    buffer_load_dwordx4 v18, s[8:11], s28 offen offset:2048 lds
    buffer_load_dwordx4 v19, s[8:11], s28 offen offset:3072 lds
    s_add_u32 s28, s28, 65536
    s_cmp_eq_u32 s24, 7
    s_cbranch_scc0 Lc3_117
    s_getpc_b64 s[80:81]
Lct_118:
    s_sub_u32 s80, s80, Lct_118 - adaLN_cond__compressed_kv_cla__dense_activation_mish__prompt_kernel
    s_subb_u32 s81, s81, 0
    s_mov_b32 s82, CODE_END - adaLN_cond__compressed_kv_cla__dense_activation_mish__prompt_kernel
    s_mov_b32 s83, 0x20000
    s_lshr_b32 s42, s2, 3
    s_lshl_b32 s42, s42, 12
    v_and_b32 v9, 31, v1
    v_lshlrev_b32 v9, 7, v9
    buffer_load_dword v7, v9, s[80:83], s42 offen
Lc3_117:
    s_waitcnt vmcnt(8) lgkmcnt(0)
    s_barrier
    s_add_u32 m0, s30, 0
    s_nop 0
    buffer_load_dwordx4 v2, s[12:15], s27 offen offset:0 sc1 lds
    buffer_load_dwordx4 v2, s[12:15], s27 offen offset:1024 sc1 lds
    buffer_load_dwordx4 v2, s[12:15], s27 offen offset:2048 sc1 lds
    buffer_load_dwordx4 v2, s[12:15], s27 offen offset:3072 sc1 lds
    s_add_u32 s27, s27, 36864
    s_add_u32 m0, s30, 16384
    s_nop 0
    buffer_load_dwordx4 v16, s[8:11], s28 offen offset:0 lds
    buffer_load_dwordx4 v17, s[8:11], s28 offen offset:1024 lds
    buffer_load_dwordx4 v18, s[8:11], s28 offen offset:2048 lds
    buffer_load_dwordx4 v19, s[8:11], s28 offen offset:3072 lds
    s_add_u32 s28, s28, 589824
    v_lshrrev_b32 v13, 4, v1
    v_and_b32 v12, 15, v1
    v_lshlrev_b32 v14, 2, v13
    v_xor_b32 v14, v14, v12
    s_and_b32 s42, s29, 1
    v_xor_b32 v14, s42, v14
    v_lshlrev_b32 v14, 4, v14
    v_mul_u32_u24 v13, 3584, v13
    v_add_u32 v16, v13, v14
    v_add_u32 v17, 13312, v16
    v_add_u32 v18, 26624, v16
    v_add_u32 v19, 39936, v16
    s_mul_i32 s28, s29, 57344
    s_add_u32 s28, s28, s66
    s_and_b32 s75, s61, 7
    s_mov_b32 s76, s75
    s_mul_i32 s42, s75, 229376
    s_add_u32 s28, s28, s42
    s_add_u32 m0, s30, 49152
    s_nop 0
    buffer_load_dwordx4 v16, s[20:23], s28 offen offset:0 lds
    buffer_load_dwordx4 v17, s[20:23], s28 offen offset:1024 lds
    buffer_load_dwordx4 v18, s[20:23], s28 offen offset:2048 lds
    buffer_load_dwordx4 v19, s[20:23], s28 offen offset:3072 lds
    s_mov_b32 s45, 229376
    s_add_u32 s76, s76, 1
    s_cmp_eq_u32 s76, 8
    s_cselect_b32 s44, 4293361664, s45
    s_cselect_b32 s76, 0, s76
    s_add_u32 s28, s28, s44
    s_waitcnt vmcnt(4) lgkmcnt(0)
    s_barrier
Loye:
    s_add_u32 m0, s30, 81920
    s_nop 0
    buffer_load_dwordx4 v16, s[20:23], s28 offen offset:0 lds
    buffer_load_dwordx4 v17, s[20:23], s28 offen offset:1024 lds
    buffer_load_dwordx4 v18, s[20:23], s28 offen offset:2048 lds
    buffer_load_dwordx4 v19, s[20:23], s28 offen offset:3072 lds
    s_mov_b32 s45, 229376
    s_add_u32 s76, s76, 1
    s_cmp_eq_u32 s76, 8
    s_cselect_b32 s44, 4293361664, s45
    s_cselect_b32 s76, 0, s76
    s_add_u32 s28, s28, s44
    s_add_u32 m0, s30, 114688
    s_nop 0
    buffer_load_dwordx4 v16, s[20:23], s28 offen offset:0 lds
    buffer_load_dwordx4 v17, s[20:23], s28 offen offset:1024 lds
    buffer_load_dwordx4 v18, s[20:23], s28 offen offset:2048 lds
    buffer_load_dwordx4 v19, s[20:23], s28 offen offset:3072 lds
    s_mov_b32 s45, 229376
    s_add_u32 s76, s76, 1
    s_cmp_eq_u32 s76, 8
    s_cselect_b32 s44, 4293361664, s45
    s_cselect_b32 s76, 0, s76
    s_add_u32 s28, s28, s44
Lln:
    v_mov_b32 v50, 32768
    v_mov_b32 v51, 0
    ds_write_b32 v50, v51
    s_lshl_b32 s39, s60, 19
    s_add_u32 s39, s39, s34
    s_add_u32 s39, s39, 69206016
    s_lshl_b32 s42, s60, 11
    s_lshl_b32 s43, s61, 7
    s_add_u32 s42, s42, s43
    s_add_u32 s42, s42, 14680064
    v_and_b32 v27, 15, v1
    v_lshlrev_b32 v27, 2, v27
    v_add_u32 v27, s42, v27
    s_lshr_b32 s40, s24, 1
    s_lshl_b32 s40, s40, 2
    s_mov_b32 s41, 0
    s_mov_b32 s47, 1600000
    s_waitcnt lgkmcnt(0)
    s_barrier
    s_cmp_eq_u32 s24, 1
    s_cbranch_scc0 Lpp_119
    s_lshl_b32 s42, s25, 11
    s_lshl_b32 s43, s32, 2
    s_add_u32 s42, s42, s43
    s_add_u32 s42, s42, 14680064
    v_lshlrev_b32 v28, 7, v1
    v_mov_b32 v26, s64
    s_mov_b64 exec, 0xffff
    buffer_store_dword v26, v28, s[12:15], s42 offen sc1
    s_mov_b64 exec, -1
Lpp_119:
Lpl_120:
    s_cmp_eq_u32 s24, 0
    s_cbranch_scc0 Lpr_122
    buffer_load_dword v26, v27, s[12:15], 0 offen sc1
    s_waitcnt vmcnt(0)
    v_cmp_eq_u32 vcc, s64, v26
    s_nop 0
    s_and_b32 s42, vcc_lo, 0xffff
    v_mov_b32 v51, s42
    ds_write_b32 v50, v51
    s_branch Lpj_123
Lpr_122:
    ds_read_b32 v51, v50
    s_waitcnt lgkmcnt(0)
    v_readfirstlane_b32 s42, v51
Lpj_123:
    s_nop 0
    s_lshr_b32 s43, s42, s40
    s_andn2_b32 s43, s43, s41
    s_bitcmp1_b32 s43, 0
    s_cbranch_scc0 Lps_124
    s_add_u32 s44, s39, 0
    buffer_load_dwordx4 v[32:35], v25, s[12:15], s44 offen sc1
Lps_124:
    s_bitcmp1_b32 s43, 1
    s_cbranch_scc0 Lps_125
    s_add_u32 s44, s39, 131072
    buffer_load_dwordx4 v[36:39], v25, s[12:15], s44 offen sc1
Lps_125:
    s_bitcmp1_b32 s43, 2
    s_cbranch_scc0 Lps_126
    s_add_u32 s44, s39, 262144
    buffer_load_dwordx4 v[40:43], v25, s[12:15], s44 offen sc1
Lps_126:
    s_bitcmp1_b32 s43, 3
    s_cbranch_scc0 Lps_127
    s_add_u32 s44, s39, 393216
    buffer_load_dwordx4 v[44:47], v25, s[12:15], s44 offen sc1
Lps_127:
    s_or_b32 s41, s41, s43
    s_cmp_eq_u32 s24, 0
    s_cselect_b32 s44, 0xffff, 15
    s_and_b32 s45, s41, s44
    s_cmp_eq_u32 s45, s44
    s_cbranch_scc1 Lok_121
    s_sleep 2
    s_sub_u32 s47, s47, 1
    s_cbranch_scc0 Lpl_120
Lok_121:
    v_lshlrev_b32 v80, 16, v88
    v_and_b32 v81, 0xffff0000, v88
    v_lshlrev_b32 v82, 16, v89
    v_and_b32 v83, 0xffff0000, v89
    v_lshlrev_b32 v84, 16, v90
    v_and_b32 v85, 0xffff0000, v90
    v_lshlrev_b32 v86, 16, v91
    v_and_b32 v87, 0xffff0000, v91
    v_lshlrev_b32 v96, 16, v94
    s_waitcnt lgkmcnt(0)
    v_and_b32 v88, 0xffff0000, v120
    v_and_b32 v89, 0xffff0000, v121
    v_and_b32 v90, 0xffff0000, v122
    v_and_b32 v91, 0xffff0000, v123
    v_and_b32 v92, 0xffff0000, v124
    v_and_b32 v93, 0xffff0000, v125
    v_and_b32 v94, 0xffff0000, v126
    v_and_b32 v95, 0xffff0000, v127
    v_lshlrev_b32 v120, 16, v120
    v_lshlrev_b32 v121, 16, v121
    v_lshlrev_b32 v122, 16, v122
    v_lshlrev_b32 v123, 16, v123
    v_lshlrev_b32 v124, 16, v124
    v_lshlrev_b32 v125, 16, v125
    v_lshlrev_b32 v126, 16, v126
    v_lshlrev_b32 v127, 16, v127
    s_lshl_b32 s36, s60, 17
    s_add_u32 s36, s36, s34
    s_add_u32 s37, s36, 3145728
    s_add_u32 s36, s36, 5242880
    v_lshlrev_b32 v98, 6, v20
    s_lshl_b32 s42, s24, 3
    v_add_u32 v99, s42, v98
    s_waitcnt vmcnt(0)
    v_lshlrev_b32 v48, 16, v32
    v_and_b32 v49, 0xffff0000, v32
    v_lshlrev_b32 v50, 16, v33
    v_and_b32 v51, 0xffff0000, v33
    v_lshlrev_b32 v52, 16, v34
    v_and_b32 v53, 0xffff0000, v34
    v_lshlrev_b32 v54, 16, v35
    v_and_b32 v55, 0xffff0000, v35
    s_waitcnt vmcnt(0)
    v_lshlrev_b32 v56, 16, v36
    v_and_b32 v57, 0xffff0000, v36
    v_lshlrev_b32 v58, 16, v37
    v_and_b32 v59, 0xffff0000, v37
    v_lshlrev_b32 v60, 16, v38
    v_and_b32 v61, 0xffff0000, v38
    v_lshlrev_b32 v62, 16, v39
    v_and_b32 v63, 0xffff0000, v39
    v_pk_add_f32 v[48:49], v[48:49], v[56:57]
    v_pk_add_f32 v[50:51], v[50:51], v[58:59]
    v_pk_add_f32 v[52:53], v[52:53], v[60:61]
    v_pk_add_f32 v[54:55], v[54:55], v[62:63]
    s_waitcnt vmcnt(0)
    v_lshlrev_b32 v56, 16, v40
    v_and_b32 v57, 0xffff0000, v40
    v_lshlrev_b32 v58, 16, v41
    v_and_b32 v59, 0xffff0000, v41
    v_lshlrev_b32 v60, 16, v42
    v_and_b32 v61, 0xffff0000, v42
    v_lshlrev_b32 v62, 16, v43
    v_and_b32 v63, 0xffff0000, v43
    v_pk_add_f32 v[48:49], v[48:49], v[56:57]
    v_pk_add_f32 v[50:51], v[50:51], v[58:59]
    v_pk_add_f32 v[52:53], v[52:53], v[60:61]
    v_pk_add_f32 v[54:55], v[54:55], v[62:63]
    s_waitcnt vmcnt(0)
    v_lshlrev_b32 v56, 16, v44
    v_and_b32 v57, 0xffff0000, v44
    v_lshlrev_b32 v58, 16, v45
    v_and_b32 v59, 0xffff0000, v45
    v_lshlrev_b32 v60, 16, v46
    v_and_b32 v61, 0xffff0000, v46
    v_lshlrev_b32 v62, 16, v47
    v_and_b32 v63, 0xffff0000, v47
    v_pk_add_f32 v[48:49], v[48:49], v[56:57]
    v_pk_add_f32 v[50:51], v[50:51], v[58:59]
    v_pk_add_f32 v[52:53], v[52:53], v[60:61]
    v_pk_add_f32 v[54:55], v[54:55], v[62:63]
    v_cvt_pk_bf16_f32 v56, v48, v49
    v_cvt_pk_bf16_f32 v57, v50, v51
    v_cvt_pk_bf16_f32 v58, v52, v53
    v_cvt_pk_bf16_f32 v59, v54, v55
    v_lshlrev_b32 v48, 16, v56
    v_and_b32 v49, 0xffff0000, v56
    v_lshlrev_b32 v50, 16, v57
    v_and_b32 v51, 0xffff0000, v57
    v_lshlrev_b32 v52, 16, v58
    v_and_b32 v53, 0xffff0000, v58
    v_lshlrev_b32 v54, 16, v59
    v_and_b32 v55, 0xffff0000, v59
    v_pk_mul_f32 v[48:49], v[48:49], v[112:113]
    v_pk_mul_f32 v[50:51], v[50:51], v[114:115]
    v_pk_mul_f32 v[52:53], v[52:53], v[116:117]
    v_pk_mul_f32 v[54:55], v[54:55], v[118:119]
    v_cvt_pk_bf16_f32 v56, v48, v49
    v_cvt_pk_bf16_f32 v57, v50, v51
    v_cvt_pk_bf16_f32 v58, v52, v53
    v_cvt_pk_bf16_f32 v59, v54, v55
    v_lshlrev_b32 v48, 16, v56
    v_and_b32 v49, 0xffff0000, v56
    v_lshlrev_b32 v50, 16, v57
    v_and_b32 v51, 0xffff0000, v57
    v_lshlrev_b32 v52, 16, v58
    v_and_b32 v53, 0xffff0000, v58
    v_lshlrev_b32 v54, 16, v59
    v_and_b32 v55, 0xffff0000, v59
    v_pk_add_f32 v[48:49], v[48:49], v[80:81]
    v_pk_add_f32 v[50:51], v[50:51], v[82:83]
    v_pk_add_f32 v[52:53], v[52:53], v[84:85]
    v_pk_add_f32 v[54:55], v[54:55], v[86:87]
    v_cvt_pk_bf16_f32 v76, v48, v49
    v_cvt_pk_bf16_f32 v77, v50, v51
    v_cvt_pk_bf16_f32 v78, v52, v53
    v_cvt_pk_bf16_f32 v79, v54, v55
    v_lshlrev_b32 v48, 16, v76
    v_and_b32 v49, 0xffff0000, v76
    v_lshlrev_b32 v50, 16, v77
    v_and_b32 v51, 0xffff0000, v77
    v_lshlrev_b32 v52, 16, v78
    v_and_b32 v53, 0xffff0000, v78
    v_lshlrev_b32 v54, 16, v79
    v_and_b32 v55, 0xffff0000, v79
    buffer_store_dwordx4 v[76:79], v25, s[12:15], s37 offen sc1
    v_pk_add_f32 v[68:69], v[48:49], v[96:97] op_sel_hi:[1,0] neg_lo:[0,1] neg_hi:[0,1]
    v_pk_add_f32 v[70:71], v[50:51], v[96:97] op_sel_hi:[1,0] neg_lo:[0,1] neg_hi:[0,1]
    v_pk_add_f32 v[72:73], v[52:53], v[96:97] op_sel_hi:[1,0] neg_lo:[0,1] neg_hi:[0,1]
    v_pk_add_f32 v[74:75], v[54:55], v[96:97] op_sel_hi:[1,0] neg_lo:[0,1] neg_hi:[0,1]
    v_pk_mul_f32 v[60:61], v[68:69], v[68:69]
    v_pk_mul_f32 v[62:63], v[70:71], v[70:71]
    v_pk_mul_f32 v[64:65], v[72:73], v[72:73]
    v_pk_mul_f32 v[66:67], v[74:75], v[74:75]
    v_pk_add_f32 v[56:57], v[68:69], v[70:71]
    v_pk_add_f32 v[58:59], v[72:73], v[74:75]
    v_pk_add_f32 v[60:61], v[60:61], v[62:63]
    v_pk_add_f32 v[64:65], v[64:65], v[66:67]
    v_pk_add_f32 v[56:57], v[56:57], v[58:59]
    v_pk_add_f32 v[60:61], v[60:61], v[64:65]
    v_add_f32 v56, v56, v57
    v_add_f32 v57, v60, v61
    s_nop 0
    v_add_f32_dpp v56, v56, v56 row_ror:8 row_mask:0xf bank_mask:0xf
    v_add_f32_dpp v57, v57, v57 row_ror:8 row_mask:0xf bank_mask:0xf
    v_mov_b32 v58, v56
    v_mov_b32 v59, v57
    s_nop 0
    v_permlane16_swap_b32 v58, v56
    v_permlane16_swap_b32 v59, v57
    v_pk_add_f32 v[56:57], v[56:57], v[58:59]
    v_mov_b32 v58, v56
    v_mov_b32 v59, v57
    s_nop 0
    v_permlane32_swap_b32 v58, v56
    v_permlane32_swap_b32 v59, v57
    v_pk_add_f32 v[56:57], v[56:57], v[58:59]
    ds_write_b64 v99, v[56:57]
    s_waitcnt lgkmcnt(0)
    s_barrier
    ds_read_b128 v[60:63], v98 offset:0
    ds_read_b128 v[64:67], v98 offset:16
    ds_read_b128 v[68:71], v98 offset:32
    ds_read_b128 v[72:75], v98 offset:48
    s_cmp_ge_u32 s24, 4
    s_cbranch_scc0 Lw1_128
    s_add_u32 m0, s30, 147456
    s_nop 0
    buffer_load_dwordx4 v16, s[20:23], s28 offen offset:0 lds
    buffer_load_dwordx4 v17, s[20:23], s28 offen offset:1024 lds
    buffer_load_dwordx4 v18, s[20:23], s28 offen offset:2048 lds
    buffer_load_dwordx4 v19, s[20:23], s28 offen offset:3072 lds
    s_mov_b32 s45, 229376
    s_add_u32 s76, s76, 1
    s_cmp_eq_u32 s76, 8
    s_cselect_b32 s44, 4293361664, s45
    s_cselect_b32 s76, 0, s76
    s_add_u32 s28, s28, s44
    s_add_u32 m0, s30, 16384
    s_nop 0
    buffer_load_dwordx4 v16, s[20:23], s28 offen offset:0 lds
    buffer_load_dwordx4 v17, s[20:23], s28 offen offset:1024 lds
    buffer_load_dwordx4 v18, s[20:23], s28 offen offset:2048 lds
    buffer_load_dwordx4 v19, s[20:23], s28 offen offset:3072 lds
    s_mov_b32 s45, 229376
    s_add_u32 s76, s76, 1
    s_cmp_eq_u32 s76, 8
    s_cselect_b32 s44, 4293361664, s45
    s_cselect_b32 s76, 0, s76
    s_add_u32 s28, s28, s44
Lw1_128:
    s_waitcnt lgkmcnt(0)
    v_pk_add_f32 v[60:61], v[60:61], v[62:63]
    v_pk_add_f32 v[64:65], v[64:65], v[66:67]
    v_pk_add_f32 v[68:69], v[68:69], v[70:71]
    v_pk_add_f32 v[72:73], v[72:73], v[74:75]
    v_pk_add_f32 v[60:61], v[60:61], v[64:65]
    v_pk_add_f32 v[68:69], v[68:69], v[72:73]
    v_pk_add_f32 v[56:57], v[60:61], v[68:69]
    v_mul_f32 v56, 0x3b000000, v56
    v_mul_f32 v57, 0x3b000000, v57
    v_fma_f32 v57, -v56, v56, v57
    v_add_f32 v56, v56, v96
    v_max_f32 v57, 0, v57
    v_cvt_pk_bf16_f32 v59, v56, v57
    v_lshlrev_b32 v56, 16, v59
    v_and_b32 v58, 0xffff0000, v59
    v_add_f32 v58, 0x3727c5ac, v58
    v_cvt_pk_bf16_f32 v58, v58, v58
    v_and_b32 v58, 0xffff0000, v58
    v_sqrt_f32 v58, v58
    v_pk_add_f32 v[48:49], v[48:49], v[56:57] op_sel_hi:[1,0] neg_lo:[0,1] neg_hi:[0,1]
    v_pk_add_f32 v[50:51], v[50:51], v[56:57] op_sel_hi:[1,0] neg_lo:[0,1] neg_hi:[0,1]
    v_pk_add_f32 v[52:53], v[52:53], v[56:57] op_sel_hi:[1,0] neg_lo:[0,1] neg_hi:[0,1]
    v_pk_add_f32 v[54:55], v[54:55], v[56:57] op_sel_hi:[1,0] neg_lo:[0,1] neg_hi:[0,1]
    v_cvt_pk_bf16_f32 v58, v58, v58
    v_and_b32 v58, 0xffff0000, v58
    v_rcp_f32 v58, v58
    v_cvt_pk_bf16_f32 v60, v48, v49
    v_cvt_pk_bf16_f32 v61, v50, v51
    v_cvt_pk_bf16_f32 v62, v52, v53
    v_cvt_pk_bf16_f32 v63, v54, v55
    v_lshlrev_b32 v48, 16, v60
    v_and_b32 v49, 0xffff0000, v60
    v_lshlrev_b32 v50, 16, v61
    v_and_b32 v51, 0xffff0000, v61
    v_lshlrev_b32 v52, 16, v62
    v_and_b32 v53, 0xffff0000, v62
    v_lshlrev_b32 v54, 16, v63
    v_and_b32 v55, 0xffff0000, v63
    v_pk_mul_f32 v[48:49], v[48:49], v[58:59] op_sel_hi:[1,0]
    v_pk_mul_f32 v[50:51], v[50:51], v[58:59] op_sel_hi:[1,0]
    v_pk_mul_f32 v[52:53], v[52:53], v[58:59] op_sel_hi:[1,0]
    v_pk_mul_f32 v[54:55], v[54:55], v[58:59] op_sel_hi:[1,0]
    v_cvt_pk_bf16_f32 v60, v48, v49
    v_cvt_pk_bf16_f32 v61, v50, v51
    v_cvt_pk_bf16_f32 v62, v52, v53
    v_cvt_pk_bf16_f32 v63, v54, v55
    v_lshlrev_b32 v48, 16, v60
    v_and_b32 v49, 0xffff0000, v60
    v_lshlrev_b32 v50, 16, v61
    v_and_b32 v51, 0xffff0000, v61
    v_lshlrev_b32 v52, 16, v62
    v_and_b32 v53, 0xffff0000, v62
    v_lshlrev_b32 v54, 16, v63
    v_and_b32 v55, 0xffff0000, v63
    v_pk_mul_f32 v[48:49], v[48:49], v[88:89]
    v_pk_mul_f32 v[50:51], v[50:51], v[90:91]
    v_pk_mul_f32 v[52:53], v[52:53], v[92:93]
    v_pk_mul_f32 v[54:55], v[54:55], v[94:95]
    v_cvt_pk_bf16_f32 v60, v48, v49
    v_cvt_pk_bf16_f32 v61, v50, v51
    v_cvt_pk_bf16_f32 v62, v52, v53
    v_cvt_pk_bf16_f32 v63, v54, v55
    v_lshlrev_b32 v48, 16, v60
    v_and_b32 v49, 0xffff0000, v60
    v_lshlrev_b32 v50, 16, v61
    v_and_b32 v51, 0xffff0000, v61
    v_lshlrev_b32 v52, 16, v62
    v_and_b32 v53, 0xffff0000, v62
    v_lshlrev_b32 v54, 16, v63
    v_and_b32 v55, 0xffff0000, v63
    v_pk_add_f32 v[48:49], v[48:49], v[120:121]
    v_pk_add_f32 v[50:51], v[50:51], v[122:123]
    v_pk_add_f32 v[52:53], v[52:53], v[124:125]
    v_pk_add_f32 v[54:55], v[54:55], v[126:127]
    v_cvt_pk_bf16_f32 v72, v48, v49
    v_cvt_pk_bf16_f32 v73, v50, v51
    v_cvt_pk_bf16_f32 v74, v52, v53
    v_cvt_pk_bf16_f32 v75, v54, v55
    buffer_store_dwordx4 v[72:75], v25, s[12:15], s36 offen sc1
    v_lshrrev_b32 v12, 3, v1
    v_and_b32 v13, 7, v1
    v_bfe_u32 v14, v1, 4, 1
    v_lshlrev_b32 v14, 2, v14
    v_xor_b32 v13, v13, v14
    v_lshlrev_b32 v13, 4, v13
    v_lshl_add_u32 v4, v12, 10, v13
    v_add_u32 v5, 7168, v4
    v_xor_b32 v21, 16, v4
    v_xor_b32 v22, 16, v5
    s_lshl_b32 s70, s29, 13
    s_lshl_b32 s71, s29, 14
    s_lshl_b32 s42, s63, 7
    s_add_u32 s71, s71, s42
    s_lshl_b32 s27, s60, 2
    s_add_u32 s27, s27, s29
    s_lshl_b32 s27, s27, 15
    s_add_u32 s27, s27, 5242880
    s_lshl_b32 s77, s60, 2
    s_and_b32 s42, s29, 1
    s_lshl_b32 s42, s42, 1
    s_add_u32 s77, s77, s42
    s_lshr_b32 s42, s24, 2
    s_add_u32 s77, s77, s42
    s_mul_i32 s77, s77, 114688
    s_lshl_b32 s42, s61, 13
    s_add_u32 s77, s77, s42
    s_and_b32 s42, s29, 2
    s_lshl_b32 s42, s42, 11
    s_add_u32 s77, s77, s42
    s_add_u32 s77, s77, 7340032
    s_mov_b32 s78, 0x3fb8aa3b
    s_mov_b32 s79, s78
    s_mov_b32 s80, 2.0
    s_mov_b32 s81, 2.0
    s_mov_b32 s34, 0x42200000
    s_add_u32 s42, s70, 98304
    v_add_u32 v31, s42, v2
    s_waitcnt vmcnt(0)
    s_barrier
    s_cmp_eq_u32 s24, 1
    s_cbranch_scc0 Lsq_130
    s_lshl_b32 s42, s60, 11
    s_lshl_b32 s43, s61, 2
    s_add_u32 s42, s42, s43
    s_add_u32 s42, s42, 15204352
    v_lshlrev_b32 v28, 7, v1
    v_mov_b32 v26, s64
    s_mov_b64 exec, 0xffff
    buffer_store_dword v26, v28, s[12:15], s42 offen sc1
    s_mov_b64 exec, -1
Lsq_130:
    s_cmp_eq_u32 s24, 0
    s_cbranch_scc0 Lsy_129
    s_lshl_b32 s42, s60, 11
    s_lshl_b32 s43, s61, 2
    s_add_u32 s42, s42, s43
    s_add_u32 s42, s42, 15204352
    v_lshlrev_b32 v28, 7, v1
    v_mov_b32 v26, s64
    s_mov_b64 exec, 0xffff
    s_add_u32 s43, s42, 262144
    buffer_store_dword v26, v28, s[12:15], s43 offen
    s_mov_b64 exec, -1
Lnp_131:
    s_lshl_b32 s42, s60, 11
    s_lshl_b32 s43, s61, 7
    s_add_u32 s42, s42, s43
    s_add_u32 s42, s42, 15204352
    v_min_u32 v27, 15, v1
    v_lshlrev_b32 v27, 2, v27
    v_add_u32 v27, s42, v27
    s_mov_b32 s42, 800003
    s_mov_b32 s43, 0
Lpl_132:
    s_and_b32 s44, s42, 3
    s_cselect_b32 s44, 262144, 0
    buffer_load_dword v26, v27, s[12:15], s44 offen sc1
    s_waitcnt vmcnt(0)
    v_cmp_eq_u32 vcc, s64, v26
    s_nop 0
    s_or_b32 s43, s43, vcc_lo
    s_cmp_eq_u32 s43, -1
    s_cbranch_scc1 Lok_133
    s_sleep 3
    s_sub_u32 s42, s42, 1
    s_cbranch_scc0 Lpl_132
Lok_133:
Lsy_129:
    s_barrier
    s_cmp_ge_u32 s24, 4
    s_cbranch_scc1 Lfy
    s_add_u32 s71, s71, 1310720
    s_cmp_ge_u32 s61, 14
    s_cbranch_scc1 Lf2n
    v_lshlrev_b32 v224, 16, v240
    v_and_b32 v225, 0xffff0000, v240
    v_lshlrev_b32 v226, 16, v241
    v_and_b32 v227, 0xffff0000, v241
    v_lshlrev_b32 v228, 16, v242
    v_and_b32 v229, 0xffff0000, v242
    v_lshlrev_b32 v230, 16, v243
    v_and_b32 v231, 0xffff0000, v243
    v_lshlrev_b32 v232, 16, v244
    v_and_b32 v233, 0xffff0000, v244
    v_lshlrev_b32 v234, 16, v245
    v_and_b32 v235, 0xffff0000, v245
    v_lshlrev_b32 v236, 16, v246
    v_and_b32 v237, 0xffff0000, v246
    v_lshlrev_b32 v238, 16, v247
    v_and_b32 v239, 0xffff0000, v247
    v_add_u32 v9, 32768, v6
    v_add_u32 v10, 32768, v7
    v_xor_b32 v11, 16, v10
    v_xor_b32 v12, 64, v10
    v_xor_b32 v13, 0x50, v10
    s_barrier
    ds_read_b64_tr_b16 v[32:33], v10 offset:0
    ds_read_b64_tr_b16 v[34:35], v10 offset:2048
    ds_read_b128 v[48:51], v9 offset:0
    ds_read_b64_tr_b16 v[36:37], v11 offset:0
    ds_read_b64_tr_b16 v[38:39], v11 offset:2048
    ds_read_b64_tr_b16 v[40:41], v12 offset:0
    ds_read_b64_tr_b16 v[42:43], v12 offset:2048
    ds_read_b64_tr_b16 v[44:45], v13 offset:0
    ds_read_b64_tr_b16 v[46:47], v13 offset:2048
    ds_read_b128 v[52:55], v9 offset:256
    ds_read_b128 v[56:59], v9 offset:4096
    ds_read_b128 v[60:63], v9 offset:4352
    s_waitcnt lgkmcnt(9)
    v_mfma_f32_16x16x32_bf16 v[128:131], v[32:35], v[48:51], v[224:227]
    ds_read_b64_tr_b16 v[192:193], v10 offset:8192
    s_waitcnt lgkmcnt(8)
    v_mfma_f32_16x16x32_bf16 v[132:135], v[36:39], v[48:51], v[228:231]
    ds_read_b64_tr_b16 v[194:195], v10 offset:10240
    s_waitcnt lgkmcnt(7)
    v_mfma_f32_16x16x32_bf16 v[136:139], v[40:43], v[48:51], v[232:235]
    ds_read_b128 v[208:211], v9 offset:2048
    s_waitcnt lgkmcnt(6)
    v_mfma_f32_16x16x32_bf16 v[140:143], v[44:47], v[48:51], v[236:239]
    ds_read_b64_tr_b16 v[196:197], v11 offset:8192
    s_waitcnt lgkmcnt(6)
    v_mfma_f32_16x16x32_bf16 v[156:159], v[44:47], v[52:55], v[236:239]
    ds_read_b64_tr_b16 v[198:199], v11 offset:10240
    v_mfma_f32_16x16x32_bf16 v[152:155], v[40:43], v[52:55], v[232:235]
    ds_read_b64_tr_b16 v[200:201], v12 offset:8192
    v_mfma_f32_16x16x32_bf16 v[148:151], v[36:39], v[52:55], v[228:231]
    ds_read_b64_tr_b16 v[202:203], v12 offset:10240
    v_mfma_f32_16x16x32_bf16 v[144:147], v[32:35], v[52:55], v[224:227]
    ds_read_b64_tr_b16 v[204:205], v13 offset:8192
    s_waitcnt lgkmcnt(9)
    v_mfma_f32_16x16x32_bf16 v[160:163], v[32:35], v[56:59], v[224:227]
    ds_read_b64_tr_b16 v[206:207], v13 offset:10240
    v_mfma_f32_16x16x32_bf16 v[164:167], v[36:39], v[56:59], v[228:231]
    ds_read_b128 v[212:215], v9 offset:2304
    v_mfma_f32_16x16x32_bf16 v[168:171], v[40:43], v[56:59], v[232:235]
    ds_read_b128 v[216:219], v9 offset:6144
    v_mfma_f32_16x16x32_bf16 v[172:175], v[44:47], v[56:59], v[236:239]
    ds_read_b128 v[220:223], v9 offset:6400
    s_waitcnt lgkmcnt(12)
    v_mfma_f32_16x16x32_bf16 v[188:191], v[44:47], v[60:63], v[236:239]
    v_add_u32 v9, 65536, v6
    v_add_u32 v10, 65536, v7
    v_mfma_f32_16x16x32_bf16 v[184:187], v[40:43], v[60:63], v[232:235]
    v_xor_b32 v11, 16, v10
    v_xor_b32 v12, 64, v10
    v_mfma_f32_16x16x32_bf16 v[180:183], v[36:39], v[60:63], v[228:231]
    v_xor_b32 v13, 0x50, v10
    v_mfma_f32_16x16x32_bf16 v[176:179], v[32:35], v[60:63], v[224:227]
    s_barrier
    s_waitcnt lgkmcnt(9)
    v_mfma_f32_16x16x32_bf16 v[128:131], v[192:195], v[208:211], v[128:131]
    ds_read_b64_tr_b16 v[32:33], v10 offset:0
    s_waitcnt lgkmcnt(8)
    v_mfma_f32_16x16x32_bf16 v[132:135], v[196:199], v[208:211], v[132:135]
    ds_read_b64_tr_b16 v[34:35], v10 offset:2048
    s_waitcnt lgkmcnt(7)
    v_mfma_f32_16x16x32_bf16 v[136:139], v[200:203], v[208:211], v[136:139]
    ds_read_b128 v[48:51], v9 offset:0
    s_waitcnt lgkmcnt(6)
    v_mfma_f32_16x16x32_bf16 v[140:143], v[204:207], v[208:211], v[140:143]
    ds_read_b64_tr_b16 v[36:37], v11 offset:0
    s_waitcnt lgkmcnt(6)
    v_mfma_f32_16x16x32_bf16 v[156:159], v[204:207], v[212:215], v[156:159]
    ds_read_b64_tr_b16 v[38:39], v11 offset:2048
    v_mfma_f32_16x16x32_bf16 v[152:155], v[200:203], v[212:215], v[152:155]
    ds_read_b64_tr_b16 v[40:41], v12 offset:0
    v_mfma_f32_16x16x32_bf16 v[148:151], v[196:199], v[212:215], v[148:151]
    ds_read_b64_tr_b16 v[42:43], v12 offset:2048
    v_mfma_f32_16x16x32_bf16 v[144:147], v[192:195], v[212:215], v[144:147]
    ds_read_b64_tr_b16 v[44:45], v13 offset:0
    s_waitcnt lgkmcnt(9)
    v_mfma_f32_16x16x32_bf16 v[160:163], v[192:195], v[216:219], v[160:163]
    ds_read_b64_tr_b16 v[46:47], v13 offset:2048
    v_mfma_f32_16x16x32_bf16 v[164:167], v[196:199], v[216:219], v[164:167]
    ds_read_b128 v[52:55], v9 offset:256
    v_mfma_f32_16x16x32_bf16 v[168:171], v[200:203], v[216:219], v[168:171]
    ds_read_b128 v[56:59], v9 offset:4096
    v_mfma_f32_16x16x32_bf16 v[172:175], v[204:207], v[216:219], v[172:175]
    ds_read_b128 v[60:63], v9 offset:4352
    s_waitcnt lgkmcnt(12)
    v_mfma_f32_16x16x32_bf16 v[188:191], v[204:207], v[220:223], v[188:191]
    v_mfma_f32_16x16x32_bf16 v[184:187], v[200:203], v[220:223], v[184:187]
    v_mfma_f32_16x16x32_bf16 v[180:183], v[196:199], v[220:223], v[180:183]
    v_mfma_f32_16x16x32_bf16 v[176:179], v[192:195], v[220:223], v[176:179]
    s_waitcnt lgkmcnt(9)
    v_mfma_f32_16x16x32_bf16 v[128:131], v[32:35], v[48:51], v[128:131]
    ds_read_b64_tr_b16 v[192:193], v10 offset:8192
    s_waitcnt lgkmcnt(8)
    v_mfma_f32_16x16x32_bf16 v[132:135], v[36:39], v[48:51], v[132:135]
    ds_read_b64_tr_b16 v[194:195], v10 offset:10240
    s_waitcnt lgkmcnt(7)
    v_mfma_f32_16x16x32_bf16 v[136:139], v[40:43], v[48:51], v[136:139]
    ds_read_b128 v[208:211], v9 offset:2048
    s_waitcnt lgkmcnt(6)
    v_mfma_f32_16x16x32_bf16 v[140:143], v[44:47], v[48:51], v[140:143]
    ds_read_b64_tr_b16 v[196:197], v11 offset:8192
    s_waitcnt lgkmcnt(6)
    v_mfma_f32_16x16x32_bf16 v[156:159], v[44:47], v[52:55], v[156:159]
    ds_read_b64_tr_b16 v[198:199], v11 offset:10240
    v_mfma_f32_16x16x32_bf16 v[152:155], v[40:43], v[52:55], v[152:155]
    ds_read_b64_tr_b16 v[200:201], v12 offset:8192
    v_mfma_f32_16x16x32_bf16 v[148:151], v[36:39], v[52:55], v[148:151]
    ds_read_b64_tr_b16 v[202:203], v12 offset:10240
    v_mfma_f32_16x16x32_bf16 v[144:147], v[32:35], v[52:55], v[144:147]
    ds_read_b64_tr_b16 v[204:205], v13 offset:8192
    s_waitcnt lgkmcnt(9)
    v_mfma_f32_16x16x32_bf16 v[160:163], v[32:35], v[56:59], v[160:163]
    ds_read_b64_tr_b16 v[206:207], v13 offset:10240
    v_mfma_f32_16x16x32_bf16 v[164:167], v[36:39], v[56:59], v[164:167]
    ds_read_b128 v[212:215], v9 offset:2304
    v_mfma_f32_16x16x32_bf16 v[168:171], v[40:43], v[56:59], v[168:171]
    ds_read_b128 v[216:219], v9 offset:6144
    v_mfma_f32_16x16x32_bf16 v[172:175], v[44:47], v[56:59], v[172:175]
    ds_read_b128 v[220:223], v9 offset:6400
    s_waitcnt lgkmcnt(12)
    v_mfma_f32_16x16x32_bf16 v[188:191], v[44:47], v[60:63], v[188:191]
    v_add_u32 v9, 98304, v6
    v_add_u32 v10, 98304, v7
    v_mfma_f32_16x16x32_bf16 v[184:187], v[40:43], v[60:63], v[184:187]
    v_xor_b32 v11, 16, v10
    v_xor_b32 v12, 64, v10
    v_mfma_f32_16x16x32_bf16 v[180:183], v[36:39], v[60:63], v[180:183]
    v_xor_b32 v13, 0x50, v10
    v_mfma_f32_16x16x32_bf16 v[176:179], v[32:35], v[60:63], v[176:179]
    s_waitcnt lgkmcnt(0)
    v_mfma_f32_16x16x32_bf16 v[128:131], v[192:195], v[208:211], v[128:131]
    s_barrier
    ds_read_b64_tr_b16 v[32:33], v10 offset:0
    v_mfma_f32_16x16x32_bf16 v[132:135], v[196:199], v[208:211], v[132:135]
    ds_read_b64_tr_b16 v[34:35], v10 offset:2048
    v_mfma_f32_16x16x32_bf16 v[136:139], v[200:203], v[208:211], v[136:139]
    ds_read_b128 v[48:51], v9 offset:0
    v_mfma_f32_16x16x32_bf16 v[140:143], v[204:207], v[208:211], v[140:143]
    ds_read_b64_tr_b16 v[36:37], v11 offset:0
    v_mfma_f32_16x16x32_bf16 v[156:159], v[204:207], v[212:215], v[156:159]
    ds_read_b64_tr_b16 v[38:39], v11 offset:2048
    v_mfma_f32_16x16x32_bf16 v[152:155], v[200:203], v[212:215], v[152:155]
    ds_read_b64_tr_b16 v[40:41], v12 offset:0
    v_mfma_f32_16x16x32_bf16 v[148:151], v[196:199], v[212:215], v[148:151]
    ds_read_b64_tr_b16 v[42:43], v12 offset:2048
    v_mfma_f32_16x16x32_bf16 v[144:147], v[192:195], v[212:215], v[144:147]
    ds_read_b64_tr_b16 v[44:45], v13 offset:0
    v_mfma_f32_16x16x32_bf16 v[160:163], v[192:195], v[216:219], v[160:163]
    ds_read_b64_tr_b16 v[46:47], v13 offset:2048
    v_mfma_f32_16x16x32_bf16 v[164:167], v[196:199], v[216:219], v[164:167]
    ds_read_b128 v[52:55], v9 offset:256
    v_mfma_f32_16x16x32_bf16 v[168:171], v[200:203], v[216:219], v[168:171]
    ds_read_b128 v[56:59], v9 offset:4096
    v_mfma_f32_16x16x32_bf16 v[172:175], v[204:207], v[216:219], v[172:175]
    ds_read_b128 v[60:63], v9 offset:4352
    v_mfma_f32_16x16x32_bf16 v[188:191], v[204:207], v[220:223], v[188:191]
    v_mfma_f32_16x16x32_bf16 v[184:187], v[200:203], v[220:223], v[184:187]
    v_mfma_f32_16x16x32_bf16 v[180:183], v[196:199], v[220:223], v[180:183]
    v_mfma_f32_16x16x32_bf16 v[176:179], v[192:195], v[220:223], v[176:179]
    s_waitcnt lgkmcnt(9)
    v_mfma_f32_16x16x32_bf16 v[128:131], v[32:35], v[48:51], v[128:131]
    ds_read_b64_tr_b16 v[192:193], v10 offset:8192
    s_waitcnt lgkmcnt(8)
    v_mfma_f32_16x16x32_bf16 v[132:135], v[36:39], v[48:51], v[132:135]
    ds_read_b64_tr_b16 v[194:195], v10 offset:10240
    s_waitcnt lgkmcnt(7)
    v_mfma_f32_16x16x32_bf16 v[136:139], v[40:43], v[48:51], v[136:139]
    ds_read_b128 v[208:211], v9 offset:2048
    s_waitcnt lgkmcnt(6)
    v_mfma_f32_16x16x32_bf16 v[140:143], v[44:47], v[48:51], v[140:143]
    ds_read_b64_tr_b16 v[196:197], v11 offset:8192
    s_waitcnt lgkmcnt(6)
    v_mfma_f32_16x16x32_bf16 v[156:159], v[44:47], v[52:55], v[156:159]
    ds_read_b64_tr_b16 v[198:199], v11 offset:10240
    v_mfma_f32_16x16x32_bf16 v[152:155], v[40:43], v[52:55], v[152:155]
    ds_read_b64_tr_b16 v[200:201], v12 offset:8192
    v_mfma_f32_16x16x32_bf16 v[148:151], v[36:39], v[52:55], v[148:151]
    ds_read_b64_tr_b16 v[202:203], v12 offset:10240
    v_mfma_f32_16x16x32_bf16 v[144:147], v[32:35], v[52:55], v[144:147]
    ds_read_b64_tr_b16 v[204:205], v13 offset:8192
    s_waitcnt lgkmcnt(9)
    v_mfma_f32_16x16x32_bf16 v[160:163], v[32:35], v[56:59], v[160:163]
    ds_read_b64_tr_b16 v[206:207], v13 offset:10240
    v_mfma_f32_16x16x32_bf16 v[164:167], v[36:39], v[56:59], v[164:167]
    ds_read_b128 v[212:215], v9 offset:2304
    v_mfma_f32_16x16x32_bf16 v[168:171], v[40:43], v[56:59], v[168:171]
    ds_read_b128 v[216:219], v9 offset:6144
    v_mfma_f32_16x16x32_bf16 v[172:175], v[44:47], v[56:59], v[172:175]
    ds_read_b128 v[220:223], v9 offset:6400
    s_waitcnt lgkmcnt(12)
    v_mfma_f32_16x16x32_bf16 v[188:191], v[44:47], v[60:63], v[188:191]
    v_add_u32 v9, 131072, v6
    v_add_u32 v10, 131072, v7
    v_mfma_f32_16x16x32_bf16 v[184:187], v[40:43], v[60:63], v[184:187]
    v_xor_b32 v11, 16, v10
    v_xor_b32 v12, 64, v10
    v_mfma_f32_16x16x32_bf16 v[180:183], v[36:39], v[60:63], v[180:183]
    v_xor_b32 v13, 0x50, v10
    v_mfma_f32_16x16x32_bf16 v[176:179], v[32:35], v[60:63], v[176:179]
    s_waitcnt lgkmcnt(9)
    v_mfma_f32_16x16x32_bf16 v[128:131], v[192:195], v[208:211], v[128:131]
    ds_read_b64_tr_b16 v[32:33], v10 offset:0
    s_waitcnt lgkmcnt(8)
    v_mfma_f32_16x16x32_bf16 v[132:135], v[196:199], v[208:211], v[132:135]
    ds_read_b64_tr_b16 v[34:35], v10 offset:2048
    s_waitcnt lgkmcnt(7)
    v_mfma_f32_16x16x32_bf16 v[136:139], v[200:203], v[208:211], v[136:139]
    ds_read_b128 v[48:51], v9 offset:0
    s_waitcnt lgkmcnt(6)
    v_mfma_f32_16x16x32_bf16 v[140:143], v[204:207], v[208:211], v[140:143]
    ds_read_b64_tr_b16 v[36:37], v11 offset:0
    s_waitcnt lgkmcnt(6)
    v_mfma_f32_16x16x32_bf16 v[156:159], v[204:207], v[212:215], v[156:159]
    ds_read_b64_tr_b16 v[38:39], v11 offset:2048
    v_mfma_f32_16x16x32_bf16 v[152:155], v[200:203], v[212:215], v[152:155]
    ds_read_b64_tr_b16 v[40:41], v12 offset:0
    v_mfma_f32_16x16x32_bf16 v[148:151], v[196:199], v[212:215], v[148:151]
    ds_read_b64_tr_b16 v[42:43], v12 offset:2048
    v_mfma_f32_16x16x32_bf16 v[144:147], v[192:195], v[212:215], v[144:147]
    ds_read_b64_tr_b16 v[44:45], v13 offset:0
    s_waitcnt lgkmcnt(9)
    v_mfma_f32_16x16x32_bf16 v[160:163], v[192:195], v[216:219], v[160:163]
    ds_read_b64_tr_b16 v[46:47], v13 offset:2048
    v_mfma_f32_16x16x32_bf16 v[164:167], v[196:199], v[216:219], v[164:167]
    ds_read_b128 v[52:55], v9 offset:256
    v_mfma_f32_16x16x32_bf16 v[168:171], v[200:203], v[216:219], v[168:171]
    ds_read_b128 v[56:59], v9 offset:4096
    v_mfma_f32_16x16x32_bf16 v[172:175], v[204:207], v[216:219], v[172:175]
    ds_read_b128 v[60:63], v9 offset:4352
    s_waitcnt lgkmcnt(12)
    v_mfma_f32_16x16x32_bf16 v[188:191], v[204:207], v[220:223], v[188:191]
    v_mfma_f32_16x16x32_bf16 v[184:187], v[200:203], v[220:223], v[184:187]
    v_mfma_f32_16x16x32_bf16 v[180:183], v[196:199], v[220:223], v[180:183]
    v_mfma_f32_16x16x32_bf16 v[176:179], v[192:195], v[220:223], v[176:179]
    s_waitcnt lgkmcnt(9)
    v_mfma_f32_16x16x32_bf16 v[128:131], v[32:35], v[48:51], v[128:131]
    ds_read_b64_tr_b16 v[192:193], v10 offset:8192
    s_waitcnt lgkmcnt(8)
    v_mfma_f32_16x16x32_bf16 v[132:135], v[36:39], v[48:51], v[132:135]
    ds_read_b64_tr_b16 v[194:195], v10 offset:10240
    s_waitcnt lgkmcnt(7)
    v_mfma_f32_16x16x32_bf16 v[136:139], v[40:43], v[48:51], v[136:139]
    ds_read_b128 v[208:211], v9 offset:2048
    s_waitcnt lgkmcnt(6)
    v_mfma_f32_16x16x32_bf16 v[140:143], v[44:47], v[48:51], v[140:143]
    ds_read_b64_tr_b16 v[196:197], v11 offset:8192
    s_waitcnt lgkmcnt(6)
    v_mfma_f32_16x16x32_bf16 v[156:159], v[44:47], v[52:55], v[156:159]
    ds_read_b64_tr_b16 v[198:199], v11 offset:10240
    v_mfma_f32_16x16x32_bf16 v[152:155], v[40:43], v[52:55], v[152:155]
    ds_read_b64_tr_b16 v[200:201], v12 offset:8192
    v_mfma_f32_16x16x32_bf16 v[148:151], v[36:39], v[52:55], v[148:151]
    ds_read_b64_tr_b16 v[202:203], v12 offset:10240
    v_mfma_f32_16x16x32_bf16 v[144:147], v[32:35], v[52:55], v[144:147]
    ds_read_b64_tr_b16 v[204:205], v13 offset:8192
    s_waitcnt lgkmcnt(9)
    v_mfma_f32_16x16x32_bf16 v[160:163], v[32:35], v[56:59], v[160:163]
    ds_read_b64_tr_b16 v[206:207], v13 offset:10240
    v_mfma_f32_16x16x32_bf16 v[164:167], v[36:39], v[56:59], v[164:167]
    ds_read_b128 v[212:215], v9 offset:2304
    v_mfma_f32_16x16x32_bf16 v[168:171], v[40:43], v[56:59], v[168:171]
    ds_read_b128 v[216:219], v9 offset:6144
    v_mfma_f32_16x16x32_bf16 v[172:175], v[44:47], v[56:59], v[172:175]
    ds_read_b128 v[220:223], v9 offset:6400
    s_waitcnt lgkmcnt(12)
    v_mfma_f32_16x16x32_bf16 v[188:191], v[44:47], v[60:63], v[188:191]
    v_add_u32 v9, 0, v6
    v_add_u32 v10, 0, v7
    v_mfma_f32_16x16x32_bf16 v[184:187], v[40:43], v[60:63], v[184:187]
    v_xor_b32 v11, 16, v10
    v_xor_b32 v12, 64, v10
    v_mfma_f32_16x16x32_bf16 v[180:183], v[36:39], v[60:63], v[180:183]
    v_xor_b32 v13, 0x50, v10
    v_mfma_f32_16x16x32_bf16 v[176:179], v[32:35], v[60:63], v[176:179]
    s_waitcnt lgkmcnt(0)
    v_mfma_f32_16x16x32_bf16 v[128:131], v[192:195], v[208:211], v[128:131]
    s_barrier
    ds_read_b64_tr_b16 v[32:33], v10 offset:0
    v_mfma_f32_16x16x32_bf16 v[132:135], v[196:199], v[208:211], v[132:135]
    ds_read_b64_tr_b16 v[34:35], v10 offset:2048
    v_mfma_f32_16x16x32_bf16 v[136:139], v[200:203], v[208:211], v[136:139]
    ds_read_b128 v[48:51], v9 offset:0
    v_mfma_f32_16x16x32_bf16 v[140:143], v[204:207], v[208:211], v[140:143]
    ds_read_b64_tr_b16 v[36:37], v11 offset:0
    v_mfma_f32_16x16x32_bf16 v[156:159], v[204:207], v[212:215], v[156:159]
    ds_read_b64_tr_b16 v[38:39], v11 offset:2048
    v_mfma_f32_16x16x32_bf16 v[152:155], v[200:203], v[212:215], v[152:155]
    ds_read_b64_tr_b16 v[40:41], v12 offset:0
    v_mfma_f32_16x16x32_bf16 v[148:151], v[196:199], v[212:215], v[148:151]
    ds_read_b64_tr_b16 v[42:43], v12 offset:2048
    v_mfma_f32_16x16x32_bf16 v[144:147], v[192:195], v[212:215], v[144:147]
    ds_read_b64_tr_b16 v[44:45], v13 offset:0
    v_mfma_f32_16x16x32_bf16 v[160:163], v[192:195], v[216:219], v[160:163]
    ds_read_b64_tr_b16 v[46:47], v13 offset:2048
    v_mfma_f32_16x16x32_bf16 v[164:167], v[196:199], v[216:219], v[164:167]
    ds_read_b128 v[52:55], v9 offset:256
    v_mfma_f32_16x16x32_bf16 v[168:171], v[200:203], v[216:219], v[168:171]
    ds_read_b128 v[56:59], v9 offset:4096
    v_mfma_f32_16x16x32_bf16 v[172:175], v[204:207], v[216:219], v[172:175]
    ds_read_b128 v[60:63], v9 offset:4352
    v_mfma_f32_16x16x32_bf16 v[188:191], v[204:207], v[220:223], v[188:191]
    v_mfma_f32_16x16x32_bf16 v[184:187], v[200:203], v[220:223], v[184:187]
    v_mfma_f32_16x16x32_bf16 v[180:183], v[196:199], v[220:223], v[180:183]
    v_mfma_f32_16x16x32_bf16 v[176:179], v[192:195], v[220:223], v[176:179]
    s_waitcnt lgkmcnt(9)
    v_mfma_f32_16x16x32_bf16 v[128:131], v[32:35], v[48:51], v[128:131]
    ds_read_b64_tr_b16 v[192:193], v10 offset:8192
    s_waitcnt lgkmcnt(8)
    v_mfma_f32_16x16x32_bf16 v[132:135], v[36:39], v[48:51], v[132:135]
    ds_read_b64_tr_b16 v[194:195], v10 offset:10240
    s_waitcnt lgkmcnt(7)
    v_mfma_f32_16x16x32_bf16 v[136:139], v[40:43], v[48:51], v[136:139]
    ds_read_b128 v[208:211], v9 offset:2048
    s_waitcnt lgkmcnt(6)
    v_mfma_f32_16x16x32_bf16 v[140:143], v[44:47], v[48:51], v[140:143]
    ds_read_b64_tr_b16 v[196:197], v11 offset:8192
    s_waitcnt lgkmcnt(6)
    v_mfma_f32_16x16x32_bf16 v[156:159], v[44:47], v[52:55], v[156:159]
    ds_read_b64_tr_b16 v[198:199], v11 offset:10240
    v_mfma_f32_16x16x32_bf16 v[152:155], v[40:43], v[52:55], v[152:155]
    ds_read_b64_tr_b16 v[200:201], v12 offset:8192
    v_mfma_f32_16x16x32_bf16 v[148:151], v[36:39], v[52:55], v[148:151]
    ds_read_b64_tr_b16 v[202:203], v12 offset:10240
    v_mfma_f32_16x16x32_bf16 v[144:147], v[32:35], v[52:55], v[144:147]
    ds_read_b64_tr_b16 v[204:205], v13 offset:8192
    s_waitcnt lgkmcnt(9)
    v_mfma_f32_16x16x32_bf16 v[160:163], v[32:35], v[56:59], v[160:163]
    ds_read_b64_tr_b16 v[206:207], v13 offset:10240
    v_mfma_f32_16x16x32_bf16 v[164:167], v[36:39], v[56:59], v[164:167]
    ds_read_b128 v[212:215], v9 offset:2304
    v_mfma_f32_16x16x32_bf16 v[168:171], v[40:43], v[56:59], v[168:171]
    ds_read_b128 v[216:219], v9 offset:6144
    v_mfma_f32_16x16x32_bf16 v[172:175], v[44:47], v[56:59], v[172:175]
    ds_read_b128 v[220:223], v9 offset:6400
    s_waitcnt lgkmcnt(12)
    v_mfma_f32_16x16x32_bf16 v[188:191], v[44:47], v[60:63], v[188:191]
    v_add_u32 v9, 32768, v6
    v_add_u32 v10, 32768, v7
    v_mfma_f32_16x16x32_bf16 v[184:187], v[40:43], v[60:63], v[184:187]
    v_xor_b32 v11, 16, v10
    v_xor_b32 v12, 64, v10
    v_mfma_f32_16x16x32_bf16 v[180:183], v[36:39], v[60:63], v[180:183]
    v_xor_b32 v13, 0x50, v10
    v_mfma_f32_16x16x32_bf16 v[176:179], v[32:35], v[60:63], v[176:179]
    s_waitcnt lgkmcnt(9)
    v_mfma_f32_16x16x32_bf16 v[128:131], v[192:195], v[208:211], v[128:131]
    ds_read_b64_tr_b16 v[32:33], v10 offset:0
    s_waitcnt lgkmcnt(8)
    v_mfma_f32_16x16x32_bf16 v[132:135], v[196:199], v[208:211], v[132:135]
    ds_read_b64_tr_b16 v[34:35], v10 offset:2048
    s_waitcnt lgkmcnt(7)
    v_mfma_f32_16x16x32_bf16 v[136:139], v[200:203], v[208:211], v[136:139]
    ds_read_b128 v[48:51], v9 offset:0
    s_waitcnt lgkmcnt(6)
    v_mfma_f32_16x16x32_bf16 v[140:143], v[204:207], v[208:211], v[140:143]
    ds_read_b64_tr_b16 v[36:37], v11 offset:0
    s_waitcnt lgkmcnt(6)
    v_mfma_f32_16x16x32_bf16 v[156:159], v[204:207], v[212:215], v[156:159]
    ds_read_b64_tr_b16 v[38:39], v11 offset:2048
    v_mfma_f32_16x16x32_bf16 v[152:155], v[200:203], v[212:215], v[152:155]
    ds_read_b64_tr_b16 v[40:41], v12 offset:0
    v_mfma_f32_16x16x32_bf16 v[148:151], v[196:199], v[212:215], v[148:151]
    ds_read_b64_tr_b16 v[42:43], v12 offset:2048
    v_mfma_f32_16x16x32_bf16 v[144:147], v[192:195], v[212:215], v[144:147]
    ds_read_b64_tr_b16 v[44:45], v13 offset:0
    s_waitcnt lgkmcnt(9)
    v_mfma_f32_16x16x32_bf16 v[160:163], v[192:195], v[216:219], v[160:163]
    ds_read_b64_tr_b16 v[46:47], v13 offset:2048
    v_mfma_f32_16x16x32_bf16 v[164:167], v[196:199], v[216:219], v[164:167]
    ds_read_b128 v[52:55], v9 offset:256
    v_mfma_f32_16x16x32_bf16 v[168:171], v[200:203], v[216:219], v[168:171]
    ds_read_b128 v[56:59], v9 offset:4096
    v_mfma_f32_16x16x32_bf16 v[172:175], v[204:207], v[216:219], v[172:175]
    ds_read_b128 v[60:63], v9 offset:4352
    s_waitcnt lgkmcnt(12)
    v_mfma_f32_16x16x32_bf16 v[188:191], v[204:207], v[220:223], v[188:191]
    v_mfma_f32_16x16x32_bf16 v[184:187], v[200:203], v[220:223], v[184:187]
    v_mfma_f32_16x16x32_bf16 v[180:183], v[196:199], v[220:223], v[180:183]
    v_mfma_f32_16x16x32_bf16 v[176:179], v[192:195], v[220:223], v[176:179]
    s_waitcnt lgkmcnt(9)
    v_mfma_f32_16x16x32_bf16 v[128:131], v[32:35], v[48:51], v[128:131]
    ds_read_b64_tr_b16 v[192:193], v10 offset:8192
    s_waitcnt lgkmcnt(8)
    v_mfma_f32_16x16x32_bf16 v[132:135], v[36:39], v[48:51], v[132:135]
    ds_read_b64_tr_b16 v[194:195], v10 offset:10240
    s_waitcnt lgkmcnt(7)
    v_mfma_f32_16x16x32_bf16 v[136:139], v[40:43], v[48:51], v[136:139]
    ds_read_b128 v[208:211], v9 offset:2048
    s_waitcnt lgkmcnt(6)
    v_mfma_f32_16x16x32_bf16 v[140:143], v[44:47], v[48:51], v[140:143]
    ds_read_b64_tr_b16 v[196:197], v11 offset:8192
    s_waitcnt lgkmcnt(6)
    v_mfma_f32_16x16x32_bf16 v[156:159], v[44:47], v[52:55], v[156:159]
    ds_read_b64_tr_b16 v[198:199], v11 offset:10240
    v_mfma_f32_16x16x32_bf16 v[152:155], v[40:43], v[52:55], v[152:155]
    ds_read_b64_tr_b16 v[200:201], v12 offset:8192
    v_mfma_f32_16x16x32_bf16 v[148:151], v[36:39], v[52:55], v[148:151]
    ds_read_b64_tr_b16 v[202:203], v12 offset:10240
    v_mfma_f32_16x16x32_bf16 v[144:147], v[32:35], v[52:55], v[144:147]
    ds_read_b64_tr_b16 v[204:205], v13 offset:8192
    s_waitcnt lgkmcnt(9)
    v_mfma_f32_16x16x32_bf16 v[160:163], v[32:35], v[56:59], v[160:163]
    ds_read_b64_tr_b16 v[206:207], v13 offset:10240
    v_mfma_f32_16x16x32_bf16 v[164:167], v[36:39], v[56:59], v[164:167]
    ds_read_b128 v[212:215], v9 offset:2304
    v_mfma_f32_16x16x32_bf16 v[168:171], v[40:43], v[56:59], v[168:171]
    ds_read_b128 v[216:219], v9 offset:6144
    v_mfma_f32_16x16x32_bf16 v[172:175], v[44:47], v[56:59], v[172:175]
    ds_read_b128 v[220:223], v9 offset:6400
    s_waitcnt lgkmcnt(12)
    v_mfma_f32_16x16x32_bf16 v[188:191], v[44:47], v[60:63], v[188:191]
    v_add_u32 v9, 65536, v6
    v_add_u32 v10, 65536, v7
    v_mfma_f32_16x16x32_bf16 v[184:187], v[40:43], v[60:63], v[184:187]
    v_xor_b32 v11, 16, v10
    v_xor_b32 v12, 64, v10
    v_mfma_f32_16x16x32_bf16 v[180:183], v[36:39], v[60:63], v[180:183]
    v_xor_b32 v13, 0x50, v10
    v_mfma_f32_16x16x32_bf16 v[176:179], v[32:35], v[60:63], v[176:179]
    s_waitcnt lgkmcnt(0)
    v_mfma_f32_16x16x32_bf16 v[128:131], v[192:195], v[208:211], v[128:131]
    s_barrier
    ds_read_b64_tr_b16 v[32:33], v10 offset:0
    v_mfma_f32_16x16x32_bf16 v[132:135], v[196:199], v[208:211], v[132:135]
    ds_read_b64_tr_b16 v[34:35], v10 offset:2048
    v_mfma_f32_16x16x32_bf16 v[136:139], v[200:203], v[208:211], v[136:139]
    ds_read_b128 v[48:51], v9 offset:0
    v_mfma_f32_16x16x32_bf16 v[140:143], v[204:207], v[208:211], v[140:143]
    ds_read_b64_tr_b16 v[36:37], v11 offset:0
    v_mfma_f32_16x16x32_bf16 v[156:159], v[204:207], v[212:215], v[156:159]
    ds_read_b64_tr_b16 v[38:39], v11 offset:2048
    v_mfma_f32_16x16x32_bf16 v[152:155], v[200:203], v[212:215], v[152:155]
    ds_read_b64_tr_b16 v[40:41], v12 offset:0
    v_mfma_f32_16x16x32_bf16 v[148:151], v[196:199], v[212:215], v[148:151]
    ds_read_b64_tr_b16 v[42:43], v12 offset:2048
    v_mfma_f32_16x16x32_bf16 v[144:147], v[192:195], v[212:215], v[144:147]
    ds_read_b64_tr_b16 v[44:45], v13 offset:0
    v_mfma_f32_16x16x32_bf16 v[160:163], v[192:195], v[216:219], v[160:163]
    ds_read_b64_tr_b16 v[46:47], v13 offset:2048
    v_mfma_f32_16x16x32_bf16 v[164:167], v[196:199], v[216:219], v[164:167]
    ds_read_b128 v[52:55], v9 offset:256
    v_mfma_f32_16x16x32_bf16 v[168:171], v[200:203], v[216:219], v[168:171]
    ds_read_b128 v[56:59], v9 offset:4096
    v_mfma_f32_16x16x32_bf16 v[172:175], v[204:207], v[216:219], v[172:175]
    ds_read_b128 v[60:63], v9 offset:4352
    v_mfma_f32_16x16x32_bf16 v[188:191], v[204:207], v[220:223], v[188:191]
    v_mfma_f32_16x16x32_bf16 v[184:187], v[200:203], v[220:223], v[184:187]
    v_mfma_f32_16x16x32_bf16 v[180:183], v[196:199], v[220:223], v[180:183]
    v_mfma_f32_16x16x32_bf16 v[176:179], v[192:195], v[220:223], v[176:179]
    s_waitcnt lgkmcnt(9)
    v_mfma_f32_16x16x32_bf16 v[128:131], v[32:35], v[48:51], v[128:131]
    ds_read_b64_tr_b16 v[192:193], v10 offset:8192
    s_waitcnt lgkmcnt(8)
    v_mfma_f32_16x16x32_bf16 v[132:135], v[36:39], v[48:51], v[132:135]
    ds_read_b64_tr_b16 v[194:195], v10 offset:10240
    s_waitcnt lgkmcnt(7)
    v_mfma_f32_16x16x32_bf16 v[136:139], v[40:43], v[48:51], v[136:139]
    ds_read_b128 v[208:211], v9 offset:2048
    s_waitcnt lgkmcnt(6)
    v_mfma_f32_16x16x32_bf16 v[140:143], v[44:47], v[48:51], v[140:143]
    ds_read_b64_tr_b16 v[196:197], v11 offset:8192
    s_waitcnt lgkmcnt(6)
    v_mfma_f32_16x16x32_bf16 v[156:159], v[44:47], v[52:55], v[156:159]
    ds_read_b64_tr_b16 v[198:199], v11 offset:10240
    v_mfma_f32_16x16x32_bf16 v[152:155], v[40:43], v[52:55], v[152:155]
    ds_read_b64_tr_b16 v[200:201], v12 offset:8192
    v_mfma_f32_16x16x32_bf16 v[148:151], v[36:39], v[52:55], v[148:151]
    ds_read_b64_tr_b16 v[202:203], v12 offset:10240
    v_mfma_f32_16x16x32_bf16 v[144:147], v[32:35], v[52:55], v[144:147]
    ds_read_b64_tr_b16 v[204:205], v13 offset:8192
    s_waitcnt lgkmcnt(9)
    v_mfma_f32_16x16x32_bf16 v[160:163], v[32:35], v[56:59], v[160:163]
    ds_read_b64_tr_b16 v[206:207], v13 offset:10240
    v_mfma_f32_16x16x32_bf16 v[164:167], v[36:39], v[56:59], v[164:167]
    ds_read_b128 v[212:215], v9 offset:2304
    v_mfma_f32_16x16x32_bf16 v[168:171], v[40:43], v[56:59], v[168:171]
    ds_read_b128 v[216:219], v9 offset:6144
    v_mfma_f32_16x16x32_bf16 v[172:175], v[44:47], v[56:59], v[172:175]
    ds_read_b128 v[220:223], v9 offset:6400
    s_waitcnt lgkmcnt(12)
    v_mfma_f32_16x16x32_bf16 v[188:191], v[44:47], v[60:63], v[188:191]
    v_add_u32 v9, 98304, v6
    v_add_u32 v10, 98304, v7
    v_mfma_f32_16x16x32_bf16 v[184:187], v[40:43], v[60:63], v[184:187]
    v_xor_b32 v11, 16, v10
    v_xor_b32 v12, 64, v10
    v_mfma_f32_16x16x32_bf16 v[180:183], v[36:39], v[60:63], v[180:183]
    v_xor_b32 v13, 0x50, v10
    v_mfma_f32_16x16x32_bf16 v[176:179], v[32:35], v[60:63], v[176:179]
    s_waitcnt lgkmcnt(9)
    v_mfma_f32_16x16x32_bf16 v[128:131], v[192:195], v[208:211], v[128:131]
    ds_read_b64_tr_b16 v[32:33], v10 offset:0
    ds_read_b64_tr_b16 v[34:35], v10 offset:2048
    s_waitcnt lgkmcnt(9)
    v_mfma_f32_16x16x32_bf16 v[132:135], v[196:199], v[208:211], v[132:135]
    ds_read_b128 v[48:51], v9 offset:0
    ds_read_b64_tr_b16 v[36:37], v11 offset:0
    s_waitcnt lgkmcnt(9)
    v_mfma_f32_16x16x32_bf16 v[136:139], v[200:203], v[208:211], v[136:139]
    ds_read_b64_tr_b16 v[38:39], v11 offset:2048
    ds_read_b64_tr_b16 v[40:41], v12 offset:0
    s_waitcnt lgkmcnt(9)
    v_mfma_f32_16x16x32_bf16 v[140:143], v[204:207], v[208:211], v[140:143]
    ds_read_b64_tr_b16 v[42:43], v12 offset:2048
    ds_read_b64_tr_b16 v[44:45], v13 offset:0
    s_waitcnt lgkmcnt(10)
    v_mfma_f32_16x16x32_bf16 v[156:159], v[204:207], v[212:215], v[156:159]
    ds_read_b64_tr_b16 v[46:47], v13 offset:2048
    ds_read_b128 v[52:55], v9 offset:256
    v_mfma_f32_16x16x32_bf16 v[152:155], v[200:203], v[212:215], v[152:155]
    ds_read_b128 v[56:59], v9 offset:4096
    ds_read_b128 v[60:63], v9 offset:4352
    v_mfma_f32_16x16x32_bf16 v[148:151], v[196:199], v[212:215], v[148:151]
    ds_read_b64_tr_b16 v[224:225], v10 offset:8192
    ds_read_b64_tr_b16 v[226:227], v10 offset:10240
    v_mfma_f32_16x16x32_bf16 v[144:147], v[192:195], v[212:215], v[144:147]
    ds_read_b128 v[240:243], v9 offset:2048
    ds_read_b64_tr_b16 v[228:229], v11 offset:8192
    s_waitcnt lgkmcnt(15)
    v_mfma_f32_16x16x32_bf16 v[160:163], v[192:195], v[216:219], v[160:163]
    ds_read_b64_tr_b16 v[230:231], v11 offset:10240
    v_mfma_f32_16x16x32_bf16 v[164:167], v[196:199], v[216:219], v[164:167]
    ds_read_b64_tr_b16 v[232:233], v12 offset:8192
    v_mfma_f32_16x16x32_bf16 v[168:171], v[200:203], v[216:219], v[168:171]
    ds_read_b64_tr_b16 v[234:235], v12 offset:10240
    v_mfma_f32_16x16x32_bf16 v[172:175], v[204:207], v[216:219], v[172:175]
    ds_read_b64_tr_b16 v[236:237], v13 offset:8192
    s_waitcnt lgkmcnt(15)
    v_mfma_f32_16x16x32_bf16 v[188:191], v[204:207], v[220:223], v[188:191]
    ds_read_b64_tr_b16 v[238:239], v13 offset:10240
    v_mfma_f32_16x16x32_bf16 v[184:187], v[200:203], v[220:223], v[184:187]
    ds_read_b128 v[244:247], v9 offset:2304
    v_mfma_f32_16x16x32_bf16 v[180:183], v[196:199], v[220:223], v[180:183]
    ds_read_b128 v[248:251], v9 offset:6144
    v_mfma_f32_16x16x32_bf16 v[176:179], v[192:195], v[220:223], v[176:179]
    ds_read_b128 v[252:255], v9 offset:6400
    s_waitcnt lgkmcnt(13)
    v_mfma_f32_16x16x32_bf16 v[160:163], v[32:35], v[56:59], v[160:163]
    v_mfma_f32_16x16x32_bf16 v[164:167], v[36:39], v[56:59], v[164:167]
    v_mfma_f32_16x16x32_bf16 v[168:171], v[40:43], v[56:59], v[168:171]
    v_mfma_f32_16x16x32_bf16 v[172:175], v[44:47], v[56:59], v[172:175]
    s_waitcnt lgkmcnt(0)
    s_barrier
    v_mfma_f32_16x16x32_bf16 v[160:163], v[224:227], v[248:251], v[160:163]
    v_mfma_f32_16x16x32_bf16 v[164:167], v[228:231], v[248:251], v[164:167]
    v_mfma_f32_16x16x32_bf16 v[168:171], v[232:235], v[248:251], v[168:171]
    v_mfma_f32_16x16x32_bf16 v[172:175], v[236:239], v[248:251], v[172:175]
    v_mfma_f32_16x16x32_bf16 v[176:179], v[32:35], v[60:63], v[176:179]
    v_mfma_f32_16x16x32_bf16 v[180:183], v[36:39], v[60:63], v[180:183]
    v_mfma_f32_16x16x32_bf16 v[184:187], v[40:43], v[60:63], v[184:187]
    s_nop 1
    ds_write_b128 v31, v[160:163] offset:0
    v_mfma_f32_16x16x32_bf16 v[188:191], v[44:47], v[60:63], v[188:191]
    ds_write_b128 v31, v[164:167] offset:1024
    v_mfma_f32_16x16x32_bf16 v[176:179], v[224:227], v[252:255], v[176:179]
    ds_write_b128 v31, v[168:171] offset:2048
    v_mfma_f32_16x16x32_bf16 v[180:183], v[228:231], v[252:255], v[180:183]
    ds_write_b128 v31, v[172:175] offset:3072
    v_mfma_f32_16x16x32_bf16 v[184:187], v[232:235], v[252:255], v[184:187]
    v_mfma_f32_16x16x32_bf16 v[188:191], v[236:239], v[252:255], v[188:191]
    v_mfma_f32_16x16x32_bf16 v[128:131], v[32:35], v[48:51], v[128:131]
    v_mfma_f32_16x16x32_bf16 v[132:135], v[36:39], v[48:51], v[132:135]
    v_mfma_f32_16x16x32_bf16 v[136:139], v[40:43], v[48:51], v[136:139]
    ds_write_b128 v31, v[176:179] offset:4096
    v_mfma_f32_16x16x32_bf16 v[140:143], v[44:47], v[48:51], v[140:143]
    ds_write_b128 v31, v[180:183] offset:5120
    v_mfma_f32_16x16x32_bf16 v[128:131], v[224:227], v[240:243], v[128:131]
    ds_write_b128 v31, v[184:187] offset:6144
    v_mfma_f32_16x16x32_bf16 v[132:135], v[228:231], v[240:243], v[132:135]
    ds_write_b128 v31, v[188:191] offset:7168
    v_mfma_f32_16x16x32_bf16 v[136:139], v[232:235], v[240:243], v[136:139]
    v_mfma_f32_16x16x32_bf16 v[140:143], v[236:239], v[240:243], v[140:143]
    v_mfma_f32_16x16x32_bf16 v[144:147], v[32:35], v[52:55], v[144:147]
    v_mfma_f32_16x16x32_bf16 v[148:151], v[36:39], v[52:55], v[148:151]
    v_mfma_f32_16x16x32_bf16 v[152:155], v[40:43], v[52:55], v[152:155]
    s_waitcnt lgkmcnt(0)
    v_mfma_f32_16x16x32_bf16 v[156:159], v[44:47], v[52:55], v[156:159]
    s_barrier
    v_mfma_f32_16x16x32_bf16 v[144:147], v[224:227], v[244:247], v[144:147]
    v_mfma_f32_16x16x32_bf16 v[148:151], v[228:231], v[244:247], v[148:151]
    v_mfma_f32_16x16x32_bf16 v[152:155], v[232:235], v[244:247], v[152:155]
    v_mfma_f32_16x16x32_bf16 v[156:159], v[236:239], v[244:247], v[156:159]
    v_pk_mul_f32 v[80:81], s[78:79], v[128:129]
    v_pk_mul_f32 v[82:83], s[78:79], v[130:131]
    v_pk_mul_f32 v[84:85], s[78:79], v[132:133]
    v_pk_mul_f32 v[86:87], s[78:79], v[134:135]
    v_min_f32 v80, s34, v80
    v_min_f32 v81, s34, v81
    v_min_f32 v82, s34, v82
    v_min_f32 v83, s34, v83
    v_min_f32 v84, s34, v84
    v_min_f32 v85, s34, v85
    v_min_f32 v86, s34, v86
    v_min_f32 v87, s34, v87
    v_exp_f32 v80, v80
    v_exp_f32 v81, v81
    v_exp_f32 v82, v82
    v_exp_f32 v83, v83
    v_exp_f32 v84, v84
    v_exp_f32 v85, v85
    v_exp_f32 v86, v86
    v_exp_f32 v87, v87
    v_pk_add_f32 v[88:89], v[80:81], s[80:81]
    v_pk_add_f32 v[90:91], v[82:83], s[80:81]
    v_pk_add_f32 v[92:93], v[84:85], s[80:81]
    v_pk_add_f32 v[94:95], v[86:87], s[80:81]
    v_pk_mul_f32 v[80:81], v[80:81], v[88:89]
    v_pk_mul_f32 v[82:83], v[82:83], v[90:91]
    v_pk_mul_f32 v[84:85], v[84:85], v[92:93]
    v_pk_mul_f32 v[86:87], v[86:87], v[94:95]
    v_pk_add_f32 v[88:89], v[80:81], s[80:81]
    v_pk_add_f32 v[90:91], v[82:83], s[80:81]
    v_pk_add_f32 v[92:93], v[84:85], s[80:81]
    v_pk_add_f32 v[94:95], v[86:87], s[80:81]
    v_rcp_f32 v88, v88
    v_rcp_f32 v89, v89
    v_rcp_f32 v90, v90
    v_rcp_f32 v91, v91
    v_rcp_f32 v92, v92
    v_rcp_f32 v93, v93
    v_rcp_f32 v94, v94
    v_rcp_f32 v95, v95
    v_pk_mul_f32 v[80:81], v[80:81], v[88:89]
    v_pk_mul_f32 v[82:83], v[82:83], v[90:91]
    v_pk_mul_f32 v[84:85], v[84:85], v[92:93]
    v_pk_mul_f32 v[86:87], v[86:87], v[94:95]
    v_pk_mul_f32 v[80:81], v[80:81], v[128:129]
    v_pk_mul_f32 v[82:83], v[82:83], v[130:131]
    v_pk_mul_f32 v[84:85], v[84:85], v[132:133]
    v_pk_mul_f32 v[86:87], v[86:87], v[134:135]
    v_cvt_pk_bf16_f32 v64, v80, v81
    v_cvt_pk_bf16_f32 v65, v82, v83
    v_cvt_pk_bf16_f32 v66, v84, v85
    v_cvt_pk_bf16_f32 v67, v86, v87
    buffer_store_dwordx4 v[64:67], v8, s[12:15], s77 offen offset:0 sc1
    v_pk_mul_f32 v[80:81], s[78:79], v[136:137]
    v_pk_mul_f32 v[82:83], s[78:79], v[138:139]
    v_pk_mul_f32 v[84:85], s[78:79], v[140:141]
    v_pk_mul_f32 v[86:87], s[78:79], v[142:143]
    v_min_f32 v80, s34, v80
    v_min_f32 v81, s34, v81
    v_min_f32 v82, s34, v82
    v_min_f32 v83, s34, v83
    v_min_f32 v84, s34, v84
    v_min_f32 v85, s34, v85
    v_min_f32 v86, s34, v86
    v_min_f32 v87, s34, v87
    v_exp_f32 v80, v80
    v_exp_f32 v81, v81
    v_exp_f32 v82, v82
    v_exp_f32 v83, v83
    v_exp_f32 v84, v84
    v_exp_f32 v85, v85
    v_exp_f32 v86, v86
    v_exp_f32 v87, v87
    v_pk_add_f32 v[88:89], v[80:81], s[80:81]
    v_pk_add_f32 v[90:91], v[82:83], s[80:81]
    v_pk_add_f32 v[92:93], v[84:85], s[80:81]
    v_pk_add_f32 v[94:95], v[86:87], s[80:81]
    v_pk_mul_f32 v[80:81], v[80:81], v[88:89]
    v_pk_mul_f32 v[82:83], v[82:83], v[90:91]
    v_pk_mul_f32 v[84:85], v[84:85], v[92:93]
    v_pk_mul_f32 v[86:87], v[86:87], v[94:95]
    v_pk_add_f32 v[88:89], v[80:81], s[80:81]
    v_pk_add_f32 v[90:91], v[82:83], s[80:81]
    v_pk_add_f32 v[92:93], v[84:85], s[80:81]
    v_pk_add_f32 v[94:95], v[86:87], s[80:81]
    v_rcp_f32 v88, v88
    v_rcp_f32 v89, v89
    v_rcp_f32 v90, v90
    v_rcp_f32 v91, v91
    v_rcp_f32 v92, v92
    v_rcp_f32 v93, v93
    v_rcp_f32 v94, v94
    v_rcp_f32 v95, v95
    v_pk_mul_f32 v[80:81], v[80:81], v[88:89]
    v_pk_mul_f32 v[82:83], v[82:83], v[90:91]
    v_pk_mul_f32 v[84:85], v[84:85], v[92:93]
    v_pk_mul_f32 v[86:87], v[86:87], v[94:95]
    v_pk_mul_f32 v[80:81], v[80:81], v[136:137]
    v_pk_mul_f32 v[82:83], v[82:83], v[138:139]
    v_pk_mul_f32 v[84:85], v[84:85], v[140:141]
    v_pk_mul_f32 v[86:87], v[86:87], v[142:143]
    v_cvt_pk_bf16_f32 v68, v80, v81
    v_cvt_pk_bf16_f32 v69, v82, v83
    v_cvt_pk_bf16_f32 v70, v84, v85
    v_cvt_pk_bf16_f32 v71, v86, v87
    buffer_store_dwordx4 v[68:71], v8, s[12:15], s77 offen offset:2048 sc1
    v_pk_mul_f32 v[80:81], s[78:79], v[144:145]
    v_pk_mul_f32 v[82:83], s[78:79], v[146:147]
    v_pk_mul_f32 v[84:85], s[78:79], v[148:149]
    v_pk_mul_f32 v[86:87], s[78:79], v[150:151]
    v_min_f32 v80, s34, v80
    v_min_f32 v81, s34, v81
    v_min_f32 v82, s34, v82
    v_min_f32 v83, s34, v83
    v_min_f32 v84, s34, v84
    v_min_f32 v85, s34, v85
    v_min_f32 v86, s34, v86
    v_min_f32 v87, s34, v87
    v_exp_f32 v80, v80
    v_exp_f32 v81, v81
    v_exp_f32 v82, v82
    v_exp_f32 v83, v83
    v_exp_f32 v84, v84
    v_exp_f32 v85, v85
    v_exp_f32 v86, v86
    v_exp_f32 v87, v87
    v_pk_add_f32 v[88:89], v[80:81], s[80:81]
    v_pk_add_f32 v[90:91], v[82:83], s[80:81]
    v_pk_add_f32 v[92:93], v[84:85], s[80:81]
    v_pk_add_f32 v[94:95], v[86:87], s[80:81]
    v_pk_mul_f32 v[80:81], v[80:81], v[88:89]
    v_pk_mul_f32 v[82:83], v[82:83], v[90:91]
    v_pk_mul_f32 v[84:85], v[84:85], v[92:93]
    v_pk_mul_f32 v[86:87], v[86:87], v[94:95]
    v_pk_add_f32 v[88:89], v[80:81], s[80:81]
    v_pk_add_f32 v[90:91], v[82:83], s[80:81]
    v_pk_add_f32 v[92:93], v[84:85], s[80:81]
    v_pk_add_f32 v[94:95], v[86:87], s[80:81]
    v_rcp_f32 v88, v88
    v_rcp_f32 v89, v89
    v_rcp_f32 v90, v90
    v_rcp_f32 v91, v91
    v_rcp_f32 v92, v92
    v_rcp_f32 v93, v93
    v_rcp_f32 v94, v94
    v_rcp_f32 v95, v95
    v_pk_mul_f32 v[80:81], v[80:81], v[88:89]
    v_pk_mul_f32 v[82:83], v[82:83], v[90:91]
    v_pk_mul_f32 v[84:85], v[84:85], v[92:93]
    v_pk_mul_f32 v[86:87], v[86:87], v[94:95]
    v_pk_mul_f32 v[80:81], v[80:81], v[144:145]
    v_pk_mul_f32 v[82:83], v[82:83], v[146:147]
    v_pk_mul_f32 v[84:85], v[84:85], v[148:149]
    v_pk_mul_f32 v[86:87], v[86:87], v[150:151]
    v_cvt_pk_bf16_f32 v72, v80, v81
    v_cvt_pk_bf16_f32 v73, v82, v83
    v_cvt_pk_bf16_f32 v74, v84, v85
    v_cvt_pk_bf16_f32 v75, v86, v87
    buffer_store_dwordx4 v[72:75], v8, s[12:15], s77 offen offset:256 sc1
    v_pk_mul_f32 v[80:81], s[78:79], v[152:153]
    v_pk_mul_f32 v[82:83], s[78:79], v[154:155]
    v_pk_mul_f32 v[84:85], s[78:79], v[156:157]
    v_pk_mul_f32 v[86:87], s[78:79], v[158:159]
    v_min_f32 v80, s34, v80
    v_min_f32 v81, s34, v81
    v_min_f32 v82, s34, v82
    v_min_f32 v83, s34, v83
    v_min_f32 v84, s34, v84
    v_min_f32 v85, s34, v85
    v_min_f32 v86, s34, v86
    v_min_f32 v87, s34, v87
    v_exp_f32 v80, v80
    v_exp_f32 v81, v81
    v_exp_f32 v82, v82
    v_exp_f32 v83, v83
    v_exp_f32 v84, v84
    v_exp_f32 v85, v85
    v_exp_f32 v86, v86
    v_exp_f32 v87, v87
    v_pk_add_f32 v[88:89], v[80:81], s[80:81]
    v_pk_add_f32 v[90:91], v[82:83], s[80:81]
    v_pk_add_f32 v[92:93], v[84:85], s[80:81]
    v_pk_add_f32 v[94:95], v[86:87], s[80:81]
    v_pk_mul_f32 v[80:81], v[80:81], v[88:89]
    v_pk_mul_f32 v[82:83], v[82:83], v[90:91]
    v_pk_mul_f32 v[84:85], v[84:85], v[92:93]
    v_pk_mul_f32 v[86:87], v[86:87], v[94:95]
    v_pk_add_f32 v[88:89], v[80:81], s[80:81]
    v_pk_add_f32 v[90:91], v[82:83], s[80:81]
    v_pk_add_f32 v[92:93], v[84:85], s[80:81]
    v_pk_add_f32 v[94:95], v[86:87], s[80:81]
    v_rcp_f32 v88, v88
    v_rcp_f32 v89, v89
    v_rcp_f32 v90, v90
    v_rcp_f32 v91, v91
    v_rcp_f32 v92, v92
    v_rcp_f32 v93, v93
    v_rcp_f32 v94, v94
    v_rcp_f32 v95, v95
    v_pk_mul_f32 v[80:81], v[80:81], v[88:89]
    v_pk_mul_f32 v[82:83], v[82:83], v[90:91]
    v_pk_mul_f32 v[84:85], v[84:85], v[92:93]
    v_pk_mul_f32 v[86:87], v[86:87], v[94:95]
    v_pk_mul_f32 v[80:81], v[80:81], v[152:153]
    v_pk_mul_f32 v[82:83], v[82:83], v[154:155]
    v_pk_mul_f32 v[84:85], v[84:85], v[156:157]
    v_pk_mul_f32 v[86:87], v[86:87], v[158:159]
    v_cvt_pk_bf16_f32 v76, v80, v81
    v_cvt_pk_bf16_f32 v77, v82, v83
    v_cvt_pk_bf16_f32 v78, v84, v85
    v_cvt_pk_bf16_f32 v79, v86, v87
    buffer_store_dwordx4 v[76:79], v8, s[12:15], s77 offen offset:2304 sc1
    s_mul_i32 s27, s62, 229376
    s_lshl_b32 s42, s29, 10
    s_add_u32 s27, s27, s42
    s_add_u32 s27, s27, 7340032
    s_add_u32 s28, s27, 114688
    v_lshrrev_b32 v13, 5, v1
    v_bfe_u32 v9, v1, 2, 2
    v_bfe_u32 v15, v1, 4, 1
    v_lshl_add_u32 v6, v13, 2, v9
    v_lshlrev_b32 v6, 7, v6
    v_lshl_add_u32 v6, v15, 11, v6
    v_lshl_add_u32 v6, v15, 4, v6
    v_and_b32 v14, 1, v1
    v_lshl_add_u32 v6, v14, 5, v6
    v_bfe_u32 v14, v1, 1, 1
    v_lshl_add_u32 v6, v14, 3, v6
    v_lshrrev_b32 v9, 1, v9
    v_lshl_add_u32 v6, v9, 6, v6
    v_add_u32 v6, s70, v6
    v_and_b32 v14, 15, v1
    v_lshlrev_b32 v7, 4, v14
    v_lshl_add_u32 v7, v13, 9, v7
    v_lshl_add_u32 v7, v15, 12, v7
    v_mul_u32_u24 v9, 144, v14
    v_lshl_add_u32 v9, v15, 6, v9
    v_lshl_add_u32 v9, v13, 4, v9
    v_add_u32 v9, s70, v9
    v_add_u32 v20, 65536, v9
    s_waitcnt vmcnt(0) lgkmcnt(0)
    s_barrier
    v_add_u32 v24, 131072, v6
    v_xor_b32 v25, 16, v24
    v_xor_b32 v26, 64, v24
    v_xor_b32 v27, 0x50, v24
    ds_read_b64_tr_b16 v[192:193], v24 offset:0
    ds_read_b64_tr_b16 v[194:195], v24 offset:1024
    ds_read_b64_tr_b16 v[196:197], v25 offset:0
    ds_read_b64_tr_b16 v[198:199], v25 offset:1024
    ds_read_b64_tr_b16 v[200:201], v26 offset:0
    ds_read_b64_tr_b16 v[202:203], v26 offset:1024
    ds_read_b64_tr_b16 v[204:205], v27 offset:0
    ds_read_b64_tr_b16 v[206:207], v27 offset:1024
    ds_read_b64_tr_b16 v[208:209], v24 offset:4096
    ds_read_b64_tr_b16 v[210:211], v24 offset:5120
    ds_read_b64_tr_b16 v[212:213], v25 offset:4096
    ds_read_b64_tr_b16 v[214:215], v25 offset:5120
    ds_read_b64_tr_b16 v[216:217], v26 offset:4096
    ds_read_b64_tr_b16 v[218:219], v26 offset:5120
    ds_read_b64_tr_b16 v[220:221], v27 offset:4096
    ds_read_b64_tr_b16 v[222:223], v27 offset:5120
    v_add_u32 v24, 0, v6
    v_xor_b32 v25, 16, v24
    v_xor_b32 v26, 64, v24
    v_xor_b32 v27, 0x50, v24
    ds_read_b64_tr_b16 v[224:225], v24 offset:0
    ds_read_b64_tr_b16 v[226:227], v24 offset:1024
    ds_read_b64_tr_b16 v[228:229], v25 offset:0
    ds_read_b64_tr_b16 v[230:231], v25 offset:1024
    ds_read_b64_tr_b16 v[232:233], v26 offset:0
    ds_read_b64_tr_b16 v[234:235], v26 offset:1024
    ds_read_b64_tr_b16 v[236:237], v27 offset:0
    ds_read_b64_tr_b16 v[238:239], v27 offset:1024
    ds_read_b64_tr_b16 v[240:241], v24 offset:4096
    ds_read_b64_tr_b16 v[242:243], v24 offset:5120
    ds_read_b64_tr_b16 v[244:245], v25 offset:4096
    ds_read_b64_tr_b16 v[246:247], v25 offset:5120
    ds_read_b64_tr_b16 v[248:249], v26 offset:4096
    ds_read_b64_tr_b16 v[250:251], v26 offset:5120
    ds_read_b64_tr_b16 v[252:253], v27 offset:4096
    ds_read_b64_tr_b16 v[254:255], v27 offset:5120
    s_waitcnt lgkmcnt(0)
    s_barrier
    s_branch Lf2x
Lf2n:
    s_mul_i32 s27, s62, 229376
    s_lshl_b32 s42, s29, 10
    s_add_u32 s27, s27, s42
    s_add_u32 s27, s27, 7340032
    s_add_u32 s28, s27, 114688
    v_lshrrev_b32 v13, 5, v1
    v_bfe_u32 v9, v1, 2, 2
    v_bfe_u32 v15, v1, 4, 1
    v_lshl_add_u32 v6, v13, 2, v9
    v_lshlrev_b32 v6, 7, v6
    v_lshl_add_u32 v6, v15, 11, v6
    v_lshl_add_u32 v6, v15, 4, v6
    v_and_b32 v14, 1, v1
    v_lshl_add_u32 v6, v14, 5, v6
    v_bfe_u32 v14, v1, 1, 1
    v_lshl_add_u32 v6, v14, 3, v6
    v_lshrrev_b32 v9, 1, v9
    v_lshl_add_u32 v6, v9, 6, v6
    v_add_u32 v6, s70, v6
    v_and_b32 v14, 15, v1
    v_lshlrev_b32 v7, 4, v14
    v_lshl_add_u32 v7, v13, 9, v7
    v_lshl_add_u32 v7, v15, 12, v7
    v_mul_u32_u24 v9, 144, v14
    v_lshl_add_u32 v9, v15, 6, v9
    v_lshl_add_u32 v9, v13, 4, v9
    v_add_u32 v9, s70, v9
    v_add_u32 v20, 65536, v9
    s_barrier
    v_add_u32 v24, 131072, v6
    v_xor_b32 v25, 16, v24
    v_xor_b32 v26, 64, v24
    v_xor_b32 v27, 0x50, v24
    ds_read_b64_tr_b16 v[192:193], v24 offset:0
    ds_read_b64_tr_b16 v[194:195], v24 offset:1024
    ds_read_b64_tr_b16 v[196:197], v25 offset:0
    ds_read_b64_tr_b16 v[198:199], v25 offset:1024
    ds_read_b64_tr_b16 v[200:201], v26 offset:0
    ds_read_b64_tr_b16 v[202:203], v26 offset:1024
    ds_read_b64_tr_b16 v[204:205], v27 offset:0
    ds_read_b64_tr_b16 v[206:207], v27 offset:1024
    ds_read_b64_tr_b16 v[208:209], v24 offset:4096
    ds_read_b64_tr_b16 v[210:211], v24 offset:5120
    ds_read_b64_tr_b16 v[212:213], v25 offset:4096
    ds_read_b64_tr_b16 v[214:215], v25 offset:5120
    ds_read_b64_tr_b16 v[216:217], v26 offset:4096
    ds_read_b64_tr_b16 v[218:219], v26 offset:5120
    ds_read_b64_tr_b16 v[220:221], v27 offset:4096
    ds_read_b64_tr_b16 v[222:223], v27 offset:5120
    v_add_u32 v24, 0, v6
    v_xor_b32 v25, 16, v24
    v_xor_b32 v26, 64, v24
    v_xor_b32 v27, 0x50, v24
    ds_read_b64_tr_b16 v[224:225], v24 offset:0
    ds_read_b64_tr_b16 v[226:227], v24 offset:1024
    ds_read_b64_tr_b16 v[228:229], v25 offset:0
    ds_read_b64_tr_b16 v[230:231], v25 offset:1024
    ds_read_b64_tr_b16 v[232:233], v26 offset:0
    ds_read_b64_tr_b16 v[234:235], v26 offset:1024
    ds_read_b64_tr_b16 v[236:237], v27 offset:0
    ds_read_b64_tr_b16 v[238:239], v27 offset:1024
    ds_read_b64_tr_b16 v[240:241], v24 offset:4096
    ds_read_b64_tr_b16 v[242:243], v24 offset:5120
    ds_read_b64_tr_b16 v[244:245], v25 offset:4096
    ds_read_b64_tr_b16 v[246:247], v25 offset:5120
    ds_read_b64_tr_b16 v[248:249], v26 offset:4096
    ds_read_b64_tr_b16 v[250:251], v26 offset:5120
    ds_read_b64_tr_b16 v[252:253], v27 offset:4096
    ds_read_b64_tr_b16 v[254:255], v27 offset:5120
    s_waitcnt lgkmcnt(0)
    s_add_u32 m0, s70, 131072
    s_nop 0
    buffer_load_dwordx4 v4, s[52:55], s71 offen lds
    buffer_load_dwordx4 v5, s[52:55], s71 offen offset:1024 lds
    s_add_u32 s71, s71, 65536
    s_add_u32 m0, s70, 133120
    s_nop 0
    buffer_load_dwordx4 v21, s[52:55], s71 offen lds
    buffer_load_dwordx4 v22, s[52:55], s71 offen offset:1024 lds
    s_add_u32 s71, s71, 65536
    s_add_u32 m0, s70, 135168
    s_nop 0
    buffer_load_dwordx4 v4, s[52:55], s71 offen lds
    buffer_load_dwordx4 v5, s[52:55], s71 offen offset:1024 lds
    s_add_u32 s71, s71, 65536
    s_add_u32 m0, s70, 137216
    s_nop 0
    buffer_load_dwordx4 v21, s[52:55], s71 offen lds
    buffer_load_dwordx4 v22, s[52:55], s71 offen offset:1024 lds
    s_add_u32 s71, s71, 65536
    s_add_u32 m0, s70, 0
    s_nop 0
    buffer_load_dwordx4 v4, s[52:55], s71 offen lds
    buffer_load_dwordx4 v5, s[52:55], s71 offen offset:1024 lds
    s_add_u32 s71, s71, 65536
    s_add_u32 m0, s70, 2048
    s_nop 0
    buffer_load_dwordx4 v21, s[52:55], s71 offen lds
    buffer_load_dwordx4 v22, s[52:55], s71 offen offset:1024 lds
    s_add_u32 s71, s71, 65536
    s_add_u32 m0, s70, 4096
    s_nop 0
    buffer_load_dwordx4 v4, s[52:55], s71 offen lds
    buffer_load_dwordx4 v5, s[52:55], s71 offen offset:1024 lds
    s_add_u32 s71, s71, 65536
    s_add_u32 m0, s70, 6144
    s_nop 0
    buffer_load_dwordx4 v21, s[52:55], s71 offen lds
    buffer_load_dwordx4 v22, s[52:55], s71 offen offset:1024 lds
    s_add_u32 s71, s71, 65536
    s_barrier
Lf2x:
    buffer_load_dwordx4 v[32:35], v7, s[12:15], s27 offen offset:0 sc1
    buffer_load_dwordx4 v[36:39], v7, s[12:15], s27 offen offset:256 sc1
    s_add_u32 s27, s27, 8192
    buffer_load_dwordx4 v[40:43], v7, s[12:15], s28 offen offset:0 sc1
    buffer_load_dwordx4 v[44:47], v7, s[12:15], s28 offen offset:256 sc1
    s_add_u32 s28, s28, 8192
    buffer_load_dwordx4 v[48:51], v7, s[12:15], s27 offen offset:0 sc1
    buffer_load_dwordx4 v[52:55], v7, s[12:15], s27 offen offset:256 sc1
    s_add_u32 s27, s27, 8192
    buffer_load_dwordx4 v[56:59], v7, s[12:15], s28 offen offset:0 sc1
    buffer_load_dwordx4 v[60:63], v7, s[12:15], s28 offen offset:256 sc1
    s_add_u32 s28, s28, 8192
    buffer_load_dwordx4 v[64:67], v7, s[12:15], s27 offen offset:0 sc1
    buffer_load_dwordx4 v[68:71], v7, s[12:15], s27 offen offset:256 sc1
    s_add_u32 s27, s27, 8192
    buffer_load_dwordx4 v[72:75], v7, s[12:15], s28 offen offset:0 sc1
    buffer_load_dwordx4 v[76:79], v7, s[12:15], s28 offen offset:256 sc1
    s_add_u32 s28, s28, 8192
    v_lshrrev_b32 v10, 3, v0
    v_and_b32 v11, 7, v0
    s_lshl_b32 s31, s62, 16
    s_lshl_b32 s32, s63, 7
    s_add_u32 s31, s31, s32
    v_lshlrev_b32 v12, 10, v10
    v_lshl_add_u32 v12, v11, 4, v12
    v_lshrrev_b32 v13, 5, v10
    v_lshlrev_b32 v13, 15, v13
    v_and_b32 v14, 31, v10
    v_mul_u32_u24 v15, 144, v14
    v_add_u32 v15, v15, v13
    v_lshl_add_u32 v13, v14, 4, v13
    v_lshrrev_b32 v14, 1, v11
    v_lshl_add_u32 v13, v14, 10, v13
    v_and_b32 v14, 1, v11
    v_lshl_add_u32 v13, v14, 3, v13
    v_lshrrev_b32 v14, 2, v11
    v_lshl_add_u32 v15, v14, 16, v15
    v_and_b32 v14, 3, v11
    v_lshl_add_u32 v15, v14, 5, v15
    s_lshl_b32 s32, s62, 16
    s_lshl_b32 s33, s63, 12
    s_add_u32 s32, s32, s33
    s_add_u32 s32, s32, 3145728
    s_waitcnt vmcnt(11)
    v_mfma_f32_16x16x32_bf16 v[128:131], v[192:195], v[32:35], 0
    buffer_load_dwordx4 v[80:83], v7, s[12:15], s27 offen offset:0 sc1
    v_mfma_f32_16x16x32_bf16 v[132:135], v[196:199], v[32:35], 0
    v_mfma_f32_16x16x32_bf16 v[136:139], v[200:203], v[32:35], 0
    v_mfma_f32_16x16x32_bf16 v[140:143], v[204:207], v[32:35], 0
    s_waitcnt vmcnt(11)
    v_mfma_f32_16x16x32_bf16 v[156:159], v[204:207], v[36:39], 0
    buffer_load_dwordx4 v[84:87], v7, s[12:15], s27 offen offset:256 sc1
    s_add_u32 s27, s27, 8192
    v_mfma_f32_16x16x32_bf16 v[152:155], v[200:203], v[36:39], 0
    v_mfma_f32_16x16x32_bf16 v[148:151], v[196:199], v[36:39], 0
    v_mfma_f32_16x16x32_bf16 v[144:147], v[192:195], v[36:39], 0
    s_waitcnt vmcnt(11)
    v_mfma_f32_16x16x32_bf16 v[160:163], v[192:195], v[40:43], 0
    buffer_load_dwordx4 v[88:91], v7, s[12:15], s28 offen offset:0 sc1
    v_mfma_f32_16x16x32_bf16 v[164:167], v[196:199], v[40:43], 0
    v_mfma_f32_16x16x32_bf16 v[168:171], v[200:203], v[40:43], 0
    v_mfma_f32_16x16x32_bf16 v[172:175], v[204:207], v[40:43], 0
    s_waitcnt vmcnt(11)
    v_mfma_f32_16x16x32_bf16 v[188:191], v[204:207], v[44:47], 0
    buffer_load_dwordx4 v[92:95], v7, s[12:15], s28 offen offset:256 sc1
    s_add_u32 s28, s28, 8192
    v_mfma_f32_16x16x32_bf16 v[184:187], v[200:203], v[44:47], 0
    v_mfma_f32_16x16x32_bf16 v[180:183], v[196:199], v[44:47], 0
    v_mfma_f32_16x16x32_bf16 v[176:179], v[192:195], v[44:47], 0
    s_waitcnt vmcnt(11)
    v_mfma_f32_16x16x32_bf16 v[128:131], v[208:211], v[48:51], v[128:131]
    buffer_load_dwordx4 v[32:35], v7, s[12:15], s27 offen offset:0 sc1
    v_mfma_f32_16x16x32_bf16 v[132:135], v[212:215], v[48:51], v[132:135]
    v_mfma_f32_16x16x32_bf16 v[136:139], v[216:219], v[48:51], v[136:139]
    v_mfma_f32_16x16x32_bf16 v[140:143], v[220:223], v[48:51], v[140:143]
    s_waitcnt vmcnt(11)
    v_mfma_f32_16x16x32_bf16 v[156:159], v[220:223], v[52:55], v[156:159]
    buffer_load_dwordx4 v[36:39], v7, s[12:15], s27 offen offset:256 sc1
    s_add_u32 s27, s27, 8192
    v_mfma_f32_16x16x32_bf16 v[152:155], v[216:219], v[52:55], v[152:155]
    v_mfma_f32_16x16x32_bf16 v[148:151], v[212:215], v[52:55], v[148:151]
    v_mfma_f32_16x16x32_bf16 v[144:147], v[208:211], v[52:55], v[144:147]
    s_waitcnt vmcnt(11)
    v_mfma_f32_16x16x32_bf16 v[160:163], v[208:211], v[56:59], v[160:163]
    buffer_load_dwordx4 v[40:43], v7, s[12:15], s28 offen offset:0 sc1
    v_mfma_f32_16x16x32_bf16 v[164:167], v[212:215], v[56:59], v[164:167]
    v_mfma_f32_16x16x32_bf16 v[168:171], v[216:219], v[56:59], v[168:171]
    v_mfma_f32_16x16x32_bf16 v[172:175], v[220:223], v[56:59], v[172:175]
    s_waitcnt vmcnt(11)
    v_mfma_f32_16x16x32_bf16 v[188:191], v[220:223], v[60:63], v[188:191]
    buffer_load_dwordx4 v[44:47], v7, s[12:15], s28 offen offset:256 sc1
    s_add_u32 s28, s28, 8192
    v_mfma_f32_16x16x32_bf16 v[184:187], v[216:219], v[60:63], v[184:187]
    v_mfma_f32_16x16x32_bf16 v[180:183], v[212:215], v[60:63], v[180:183]
    v_mfma_f32_16x16x32_bf16 v[176:179], v[208:211], v[60:63], v[176:179]
    s_waitcnt vmcnt(11)
    v_mfma_f32_16x16x32_bf16 v[128:131], v[224:227], v[64:67], v[128:131]
    buffer_load_dwordx4 v[48:51], v7, s[12:15], s27 offen offset:0 sc1
    v_mfma_f32_16x16x32_bf16 v[132:135], v[228:231], v[64:67], v[132:135]
    v_mfma_f32_16x16x32_bf16 v[136:139], v[232:235], v[64:67], v[136:139]
    v_mfma_f32_16x16x32_bf16 v[140:143], v[236:239], v[64:67], v[140:143]
    s_waitcnt vmcnt(11)
    v_mfma_f32_16x16x32_bf16 v[156:159], v[236:239], v[68:71], v[156:159]
    buffer_load_dwordx4 v[52:55], v7, s[12:15], s27 offen offset:256 sc1
    s_add_u32 s27, s27, 8192
    v_mfma_f32_16x16x32_bf16 v[152:155], v[232:235], v[68:71], v[152:155]
    v_mfma_f32_16x16x32_bf16 v[148:151], v[228:231], v[68:71], v[148:151]
    v_mfma_f32_16x16x32_bf16 v[144:147], v[224:227], v[68:71], v[144:147]
    s_waitcnt vmcnt(11)
    v_mfma_f32_16x16x32_bf16 v[160:163], v[224:227], v[72:75], v[160:163]
    buffer_load_dwordx4 v[56:59], v7, s[12:15], s28 offen offset:0 sc1
    v_mfma_f32_16x16x32_bf16 v[164:167], v[228:231], v[72:75], v[164:167]
    v_mfma_f32_16x16x32_bf16 v[168:171], v[232:235], v[72:75], v[168:171]
    v_mfma_f32_16x16x32_bf16 v[172:175], v[236:239], v[72:75], v[172:175]
    s_waitcnt vmcnt(11)
    v_mfma_f32_16x16x32_bf16 v[188:191], v[236:239], v[76:79], v[188:191]
    buffer_load_dwordx4 v[60:63], v7, s[12:15], s28 offen offset:256 sc1
    s_add_u32 s28, s28, 8192
    v_mfma_f32_16x16x32_bf16 v[184:187], v[232:235], v[76:79], v[184:187]
    v_add_u32 v24, 32768, v6
    v_xor_b32 v25, 16, v24
    v_mfma_f32_16x16x32_bf16 v[180:183], v[228:231], v[76:79], v[180:183]
    v_xor_b32 v26, 64, v24
    v_xor_b32 v27, 0x50, v24
    v_mfma_f32_16x16x32_bf16 v[176:179], v[224:227], v[76:79], v[176:179]
    s_waitcnt vmcnt(11)
    v_mfma_f32_16x16x32_bf16 v[128:131], v[240:243], v[80:83], v[128:131]
    buffer_load_dwordx4 v[64:67], v7, s[12:15], s27 offen offset:0 sc1
    v_mfma_f32_16x16x32_bf16 v[132:135], v[244:247], v[80:83], v[132:135]
    ds_read_b64_tr_b16 v[96:97], v24 offset:0
    v_mfma_f32_16x16x32_bf16 v[136:139], v[248:251], v[80:83], v[136:139]
    ds_read_b64_tr_b16 v[98:99], v24 offset:1024
    v_mfma_f32_16x16x32_bf16 v[140:143], v[252:255], v[80:83], v[140:143]
    ds_read_b64_tr_b16 v[100:101], v25 offset:0
    s_waitcnt vmcnt(11)
    v_mfma_f32_16x16x32_bf16 v[156:159], v[252:255], v[84:87], v[156:159]
    buffer_load_dwordx4 v[68:71], v7, s[12:15], s27 offen offset:256 sc1
    s_add_u32 s27, s27, 8192
    v_mfma_f32_16x16x32_bf16 v[152:155], v[248:251], v[84:87], v[152:155]
    ds_read_b64_tr_b16 v[102:103], v25 offset:1024
    v_mfma_f32_16x16x32_bf16 v[148:151], v[244:247], v[84:87], v[148:151]
    ds_read_b64_tr_b16 v[104:105], v26 offset:0
    v_mfma_f32_16x16x32_bf16 v[144:147], v[240:243], v[84:87], v[144:147]
    ds_read_b64_tr_b16 v[106:107], v26 offset:1024
    s_waitcnt vmcnt(11)
    v_mfma_f32_16x16x32_bf16 v[160:163], v[240:243], v[88:91], v[160:163]
    buffer_load_dwordx4 v[72:75], v7, s[12:15], s28 offen offset:0 sc1
    v_mfma_f32_16x16x32_bf16 v[164:167], v[244:247], v[88:91], v[164:167]
    ds_read_b64_tr_b16 v[108:109], v27 offset:0
    v_mfma_f32_16x16x32_bf16 v[168:171], v[248:251], v[88:91], v[168:171]
    ds_read_b64_tr_b16 v[110:111], v27 offset:1024
    v_mfma_f32_16x16x32_bf16 v[172:175], v[252:255], v[88:91], v[172:175]
    s_waitcnt vmcnt(11)
    v_mfma_f32_16x16x32_bf16 v[188:191], v[252:255], v[92:95], v[188:191]
    buffer_load_dwordx4 v[76:79], v7, s[12:15], s28 offen offset:256 sc1
    s_add_u32 s28, s28, 8192
    v_mfma_f32_16x16x32_bf16 v[184:187], v[248:251], v[92:95], v[184:187]
    v_mfma_f32_16x16x32_bf16 v[180:183], v[244:247], v[92:95], v[180:183]
    v_mfma_f32_16x16x32_bf16 v[176:179], v[240:243], v[92:95], v[176:179]
    s_waitcnt lgkmcnt(0)
    s_waitcnt vmcnt(11)
    v_mfma_f32_16x16x32_bf16 v[128:131], v[96:99], v[32:35], v[128:131]
    buffer_load_dwordx4 v[80:83], v7, s[12:15], s27 offen offset:0 sc1
    v_mfma_f32_16x16x32_bf16 v[132:135], v[100:103], v[32:35], v[132:135]
    ds_read_b64_tr_b16 v[112:113], v24 offset:4096
    v_mfma_f32_16x16x32_bf16 v[136:139], v[104:107], v[32:35], v[136:139]
    ds_read_b64_tr_b16 v[114:115], v24 offset:5120
    v_mfma_f32_16x16x32_bf16 v[140:143], v[108:111], v[32:35], v[140:143]
    ds_read_b64_tr_b16 v[116:117], v25 offset:4096
    s_waitcnt vmcnt(11)
    v_mfma_f32_16x16x32_bf16 v[156:159], v[108:111], v[36:39], v[156:159]
    buffer_load_dwordx4 v[84:87], v7, s[12:15], s27 offen offset:256 sc1
    s_add_u32 s27, s27, 8192
    v_mfma_f32_16x16x32_bf16 v[152:155], v[104:107], v[36:39], v[152:155]
    ds_read_b64_tr_b16 v[118:119], v25 offset:5120
    v_mfma_f32_16x16x32_bf16 v[148:151], v[100:103], v[36:39], v[148:151]
    ds_read_b64_tr_b16 v[120:121], v26 offset:4096
    v_mfma_f32_16x16x32_bf16 v[144:147], v[96:99], v[36:39], v[144:147]
    ds_read_b64_tr_b16 v[122:123], v26 offset:5120
    s_waitcnt vmcnt(11)
    v_mfma_f32_16x16x32_bf16 v[160:163], v[96:99], v[40:43], v[160:163]
    buffer_load_dwordx4 v[88:91], v7, s[12:15], s28 offen offset:0 sc1
    v_mfma_f32_16x16x32_bf16 v[164:167], v[100:103], v[40:43], v[164:167]
    ds_read_b64_tr_b16 v[124:125], v27 offset:4096
    v_mfma_f32_16x16x32_bf16 v[168:171], v[104:107], v[40:43], v[168:171]
    ds_read_b64_tr_b16 v[126:127], v27 offset:5120
    v_mfma_f32_16x16x32_bf16 v[172:175], v[108:111], v[40:43], v[172:175]
    s_waitcnt vmcnt(11)
    v_mfma_f32_16x16x32_bf16 v[188:191], v[108:111], v[44:47], v[188:191]
    buffer_load_dwordx4 v[92:95], v7, s[12:15], s28 offen offset:256 sc1
    s_add_u32 s28, s28, 8192
    v_mfma_f32_16x16x32_bf16 v[184:187], v[104:107], v[44:47], v[184:187]
    v_add_u32 v24, 65536, v6
    v_xor_b32 v25, 16, v24
    v_mfma_f32_16x16x32_bf16 v[180:183], v[100:103], v[44:47], v[180:183]
    v_xor_b32 v26, 64, v24
    v_xor_b32 v27, 0x50, v24
    v_mfma_f32_16x16x32_bf16 v[176:179], v[96:99], v[44:47], v[176:179]
    s_barrier
    s_waitcnt lgkmcnt(0)
    s_waitcnt vmcnt(11)
    v_mfma_f32_16x16x32_bf16 v[128:131], v[112:115], v[48:51], v[128:131]
    buffer_load_dwordx4 v[32:35], v7, s[12:15], s27 offen offset:0 sc1
    v_mfma_f32_16x16x32_bf16 v[132:135], v[116:119], v[48:51], v[132:135]
    ds_read_b64_tr_b16 v[96:97], v24 offset:0
    v_mfma_f32_16x16x32_bf16 v[136:139], v[120:123], v[48:51], v[136:139]
    ds_read_b64_tr_b16 v[98:99], v24 offset:1024
    v_mfma_f32_16x16x32_bf16 v[140:143], v[124:127], v[48:51], v[140:143]
    ds_read_b64_tr_b16 v[100:101], v25 offset:0
    s_waitcnt vmcnt(11)
    v_mfma_f32_16x16x32_bf16 v[156:159], v[124:127], v[52:55], v[156:159]
    buffer_load_dwordx4 v[36:39], v7, s[12:15], s27 offen offset:256 sc1
    s_add_u32 s27, s27, 8192
    v_mfma_f32_16x16x32_bf16 v[152:155], v[120:123], v[52:55], v[152:155]
    ds_read_b64_tr_b16 v[102:103], v25 offset:1024
    v_mfma_f32_16x16x32_bf16 v[148:151], v[116:119], v[52:55], v[148:151]
    ds_read_b64_tr_b16 v[104:105], v26 offset:0
    v_mfma_f32_16x16x32_bf16 v[144:147], v[112:115], v[52:55], v[144:147]
    ds_read_b64_tr_b16 v[106:107], v26 offset:1024
    s_waitcnt vmcnt(11)
    v_mfma_f32_16x16x32_bf16 v[160:163], v[112:115], v[56:59], v[160:163]
    buffer_load_dwordx4 v[40:43], v7, s[12:15], s28 offen offset:0 sc1
    v_mfma_f32_16x16x32_bf16 v[164:167], v[116:119], v[56:59], v[164:167]
    ds_read_b64_tr_b16 v[108:109], v27 offset:0
    v_mfma_f32_16x16x32_bf16 v[168:171], v[120:123], v[56:59], v[168:171]
    ds_read_b64_tr_b16 v[110:111], v27 offset:1024
    v_mfma_f32_16x16x32_bf16 v[172:175], v[124:127], v[56:59], v[172:175]
    s_waitcnt vmcnt(11)
    v_mfma_f32_16x16x32_bf16 v[188:191], v[124:127], v[60:63], v[188:191]
    buffer_load_dwordx4 v[44:47], v7, s[12:15], s28 offen offset:256 sc1
    s_add_u32 s28, s28, 8192
    v_mfma_f32_16x16x32_bf16 v[184:187], v[120:123], v[60:63], v[184:187]
    v_mfma_f32_16x16x32_bf16 v[180:183], v[116:119], v[60:63], v[180:183]
    v_mfma_f32_16x16x32_bf16 v[176:179], v[112:115], v[60:63], v[176:179]
    s_waitcnt lgkmcnt(0)
    s_waitcnt vmcnt(11)
    v_mfma_f32_16x16x32_bf16 v[128:131], v[96:99], v[64:67], v[128:131]
    buffer_load_dwordx4 v[48:51], v7, s[12:15], s27 offen offset:0 sc1
    v_mfma_f32_16x16x32_bf16 v[132:135], v[100:103], v[64:67], v[132:135]
    ds_read_b64_tr_b16 v[112:113], v24 offset:4096
    v_mfma_f32_16x16x32_bf16 v[136:139], v[104:107], v[64:67], v[136:139]
    ds_read_b64_tr_b16 v[114:115], v24 offset:5120
    v_mfma_f32_16x16x32_bf16 v[140:143], v[108:111], v[64:67], v[140:143]
    ds_read_b64_tr_b16 v[116:117], v25 offset:4096
    s_waitcnt vmcnt(11)
    v_mfma_f32_16x16x32_bf16 v[156:159], v[108:111], v[68:71], v[156:159]
    buffer_load_dwordx4 v[52:55], v7, s[12:15], s27 offen offset:256 sc1
    s_add_u32 s27, s27, 8192
    v_mfma_f32_16x16x32_bf16 v[152:155], v[104:107], v[68:71], v[152:155]
    ds_read_b64_tr_b16 v[118:119], v25 offset:5120
    v_mfma_f32_16x16x32_bf16 v[148:151], v[100:103], v[68:71], v[148:151]
    ds_read_b64_tr_b16 v[120:121], v26 offset:4096
    v_mfma_f32_16x16x32_bf16 v[144:147], v[96:99], v[68:71], v[144:147]
    ds_read_b64_tr_b16 v[122:123], v26 offset:5120
    s_waitcnt vmcnt(11)
    v_mfma_f32_16x16x32_bf16 v[160:163], v[96:99], v[72:75], v[160:163]
    buffer_load_dwordx4 v[56:59], v7, s[12:15], s28 offen offset:0 sc1
    v_mfma_f32_16x16x32_bf16 v[164:167], v[100:103], v[72:75], v[164:167]
    ds_read_b64_tr_b16 v[124:125], v27 offset:4096
    v_mfma_f32_16x16x32_bf16 v[168:171], v[104:107], v[72:75], v[168:171]
    ds_read_b64_tr_b16 v[126:127], v27 offset:5120
    v_mfma_f32_16x16x32_bf16 v[172:175], v[108:111], v[72:75], v[172:175]
    s_waitcnt vmcnt(11)
    v_mfma_f32_16x16x32_bf16 v[188:191], v[108:111], v[76:79], v[188:191]
    buffer_load_dwordx4 v[60:63], v7, s[12:15], s28 offen offset:256 sc1
    s_add_u32 s28, s28, 8192
    v_mfma_f32_16x16x32_bf16 v[184:187], v[104:107], v[76:79], v[184:187]
    v_add_u32 v24, 98304, v6
    v_xor_b32 v25, 16, v24
    v_mfma_f32_16x16x32_bf16 v[180:183], v[100:103], v[76:79], v[180:183]
    v_xor_b32 v26, 64, v24
    v_xor_b32 v27, 0x50, v24
    v_mfma_f32_16x16x32_bf16 v[176:179], v[96:99], v[76:79], v[176:179]
    s_waitcnt lgkmcnt(0)
    s_waitcnt vmcnt(11)
    v_mfma_f32_16x16x32_bf16 v[128:131], v[112:115], v[80:83], v[128:131]
    buffer_load_dwordx4 v[64:67], v7, s[12:15], s27 offen offset:0 sc1
    v_mfma_f32_16x16x32_bf16 v[132:135], v[116:119], v[80:83], v[132:135]
    ds_read_b64_tr_b16 v[96:97], v24 offset:0
    v_mfma_f32_16x16x32_bf16 v[136:139], v[120:123], v[80:83], v[136:139]
    ds_read_b64_tr_b16 v[98:99], v24 offset:1024
    v_mfma_f32_16x16x32_bf16 v[140:143], v[124:127], v[80:83], v[140:143]
    ds_read_b64_tr_b16 v[100:101], v25 offset:0
    s_waitcnt vmcnt(11)
    v_mfma_f32_16x16x32_bf16 v[156:159], v[124:127], v[84:87], v[156:159]
    buffer_load_dwordx4 v[68:71], v7, s[12:15], s27 offen offset:256 sc1
    s_add_u32 s27, s27, 8192
    v_mfma_f32_16x16x32_bf16 v[152:155], v[120:123], v[84:87], v[152:155]
    ds_read_b64_tr_b16 v[102:103], v25 offset:1024
    v_mfma_f32_16x16x32_bf16 v[148:151], v[116:119], v[84:87], v[148:151]
    ds_read_b64_tr_b16 v[104:105], v26 offset:0
    v_mfma_f32_16x16x32_bf16 v[144:147], v[112:115], v[84:87], v[144:147]
    ds_read_b64_tr_b16 v[106:107], v26 offset:1024
    s_waitcnt vmcnt(11)
    v_mfma_f32_16x16x32_bf16 v[160:163], v[112:115], v[88:91], v[160:163]
    buffer_load_dwordx4 v[72:75], v7, s[12:15], s28 offen offset:0 sc1
    v_mfma_f32_16x16x32_bf16 v[164:167], v[116:119], v[88:91], v[164:167]
    ds_read_b64_tr_b16 v[108:109], v27 offset:0
    v_mfma_f32_16x16x32_bf16 v[168:171], v[120:123], v[88:91], v[168:171]
    ds_read_b64_tr_b16 v[110:111], v27 offset:1024
    v_mfma_f32_16x16x32_bf16 v[172:175], v[124:127], v[88:91], v[172:175]
    s_waitcnt vmcnt(11)
    v_mfma_f32_16x16x32_bf16 v[188:191], v[124:127], v[92:95], v[188:191]
    buffer_load_dwordx4 v[76:79], v7, s[12:15], s28 offen offset:256 sc1
    s_add_u32 s28, s28, 8192
    v_mfma_f32_16x16x32_bf16 v[184:187], v[120:123], v[92:95], v[184:187]
    v_mfma_f32_16x16x32_bf16 v[180:183], v[116:119], v[92:95], v[180:183]
    v_mfma_f32_16x16x32_bf16 v[176:179], v[112:115], v[92:95], v[176:179]
    s_waitcnt lgkmcnt(0)
    s_waitcnt vmcnt(11)
    v_mfma_f32_16x16x32_bf16 v[128:131], v[96:99], v[32:35], v[128:131]
    buffer_load_dwordx4 v[80:83], v7, s[12:15], s27 offen offset:0 sc1
    v_mfma_f32_16x16x32_bf16 v[132:135], v[100:103], v[32:35], v[132:135]
    ds_read_b64_tr_b16 v[112:113], v24 offset:4096
    v_mfma_f32_16x16x32_bf16 v[136:139], v[104:107], v[32:35], v[136:139]
    ds_read_b64_tr_b16 v[114:115], v24 offset:5120
    v_mfma_f32_16x16x32_bf16 v[140:143], v[108:111], v[32:35], v[140:143]
    ds_read_b64_tr_b16 v[116:117], v25 offset:4096
    s_waitcnt vmcnt(11)
    v_mfma_f32_16x16x32_bf16 v[156:159], v[108:111], v[36:39], v[156:159]
    buffer_load_dwordx4 v[84:87], v7, s[12:15], s27 offen offset:256 sc1
    s_add_u32 s27, s27, 8192
    v_mfma_f32_16x16x32_bf16 v[152:155], v[104:107], v[36:39], v[152:155]
    ds_read_b64_tr_b16 v[118:119], v25 offset:5120
    v_mfma_f32_16x16x32_bf16 v[148:151], v[100:103], v[36:39], v[148:151]
    ds_read_b64_tr_b16 v[120:121], v26 offset:4096
    v_mfma_f32_16x16x32_bf16 v[144:147], v[96:99], v[36:39], v[144:147]
    ds_read_b64_tr_b16 v[122:123], v26 offset:5120
    s_waitcnt vmcnt(11)
    v_mfma_f32_16x16x32_bf16 v[160:163], v[96:99], v[40:43], v[160:163]
    buffer_load_dwordx4 v[88:91], v7, s[12:15], s28 offen offset:0 sc1
    v_mfma_f32_16x16x32_bf16 v[164:167], v[100:103], v[40:43], v[164:167]
    ds_read_b64_tr_b16 v[124:125], v27 offset:4096
    v_mfma_f32_16x16x32_bf16 v[168:171], v[104:107], v[40:43], v[168:171]
    ds_read_b64_tr_b16 v[126:127], v27 offset:5120
    v_mfma_f32_16x16x32_bf16 v[172:175], v[108:111], v[40:43], v[172:175]
    s_waitcnt vmcnt(11)
    v_mfma_f32_16x16x32_bf16 v[188:191], v[108:111], v[44:47], v[188:191]
    buffer_load_dwordx4 v[92:95], v7, s[12:15], s28 offen offset:256 sc1
    s_add_u32 s28, s28, 8192
    v_mfma_f32_16x16x32_bf16 v[184:187], v[104:107], v[44:47], v[184:187]
    v_add_u32 v24, 131072, v6
    v_xor_b32 v25, 16, v24
    v_mfma_f32_16x16x32_bf16 v[180:183], v[100:103], v[44:47], v[180:183]
    v_xor_b32 v26, 64, v24
    v_xor_b32 v27, 0x50, v24
    v_mfma_f32_16x16x32_bf16 v[176:179], v[96:99], v[44:47], v[176:179]
    s_waitcnt lgkmcnt(0)
    s_waitcnt vmcnt(11)
    v_mfma_f32_16x16x32_bf16 v[128:131], v[112:115], v[48:51], v[128:131]
    buffer_load_dwordx4 v[32:35], v7, s[12:15], s27 offen offset:0 sc1
    v_mfma_f32_16x16x32_bf16 v[132:135], v[116:119], v[48:51], v[132:135]
    ds_read_b64_tr_b16 v[96:97], v24 offset:0
    v_mfma_f32_16x16x32_bf16 v[136:139], v[120:123], v[48:51], v[136:139]
    ds_read_b64_tr_b16 v[98:99], v24 offset:1024
    v_mfma_f32_16x16x32_bf16 v[140:143], v[124:127], v[48:51], v[140:143]
    ds_read_b64_tr_b16 v[100:101], v25 offset:0
    s_waitcnt vmcnt(11)
    v_mfma_f32_16x16x32_bf16 v[156:159], v[124:127], v[52:55], v[156:159]
    buffer_load_dwordx4 v[36:39], v7, s[12:15], s27 offen offset:256 sc1
    s_add_u32 s27, s27, 8192
    v_mfma_f32_16x16x32_bf16 v[152:155], v[120:123], v[52:55], v[152:155]
    ds_read_b64_tr_b16 v[102:103], v25 offset:1024
    v_mfma_f32_16x16x32_bf16 v[148:151], v[116:119], v[52:55], v[148:151]
    ds_read_b64_tr_b16 v[104:105], v26 offset:0
    v_mfma_f32_16x16x32_bf16 v[144:147], v[112:115], v[52:55], v[144:147]
    ds_read_b64_tr_b16 v[106:107], v26 offset:1024
    s_waitcnt vmcnt(11)
    v_mfma_f32_16x16x32_bf16 v[160:163], v[112:115], v[56:59], v[160:163]
    buffer_load_dwordx4 v[40:43], v7, s[12:15], s28 offen offset:0 sc1
    v_mfma_f32_16x16x32_bf16 v[164:167], v[116:119], v[56:59], v[164:167]
    ds_read_b64_tr_b16 v[108:109], v27 offset:0
    v_mfma_f32_16x16x32_bf16 v[168:171], v[120:123], v[56:59], v[168:171]
    ds_read_b64_tr_b16 v[110:111], v27 offset:1024
    v_mfma_f32_16x16x32_bf16 v[172:175], v[124:127], v[56:59], v[172:175]
    s_waitcnt vmcnt(11)
    v_mfma_f32_16x16x32_bf16 v[188:191], v[124:127], v[60:63], v[188:191]
    buffer_load_dwordx4 v[44:47], v7, s[12:15], s28 offen offset:256 sc1
    s_add_u32 s28, s28, 8192
    v_mfma_f32_16x16x32_bf16 v[184:187], v[120:123], v[60:63], v[184:187]
    v_mfma_f32_16x16x32_bf16 v[180:183], v[116:119], v[60:63], v[180:183]
    v_mfma_f32_16x16x32_bf16 v[176:179], v[112:115], v[60:63], v[176:179]
    s_waitcnt lgkmcnt(0)
    s_waitcnt vmcnt(11)
    v_mfma_f32_16x16x32_bf16 v[128:131], v[96:99], v[64:67], v[128:131]
    buffer_load_dwordx4 v[48:51], v7, s[12:15], s27 offen offset:0 sc1
    v_mfma_f32_16x16x32_bf16 v[132:135], v[100:103], v[64:67], v[132:135]
    ds_read_b64_tr_b16 v[112:113], v24 offset:4096
    v_mfma_f32_16x16x32_bf16 v[136:139], v[104:107], v[64:67], v[136:139]
    ds_read_b64_tr_b16 v[114:115], v24 offset:5120
    v_mfma_f32_16x16x32_bf16 v[140:143], v[108:111], v[64:67], v[140:143]
    ds_read_b64_tr_b16 v[116:117], v25 offset:4096
    s_waitcnt vmcnt(11)
    v_mfma_f32_16x16x32_bf16 v[156:159], v[108:111], v[68:71], v[156:159]
    buffer_load_dwordx4 v[52:55], v7, s[12:15], s27 offen offset:256 sc1
    s_add_u32 s27, s27, 8192
    v_mfma_f32_16x16x32_bf16 v[152:155], v[104:107], v[68:71], v[152:155]
    ds_read_b64_tr_b16 v[118:119], v25 offset:5120
    v_mfma_f32_16x16x32_bf16 v[148:151], v[100:103], v[68:71], v[148:151]
    ds_read_b64_tr_b16 v[120:121], v26 offset:4096
    v_mfma_f32_16x16x32_bf16 v[144:147], v[96:99], v[68:71], v[144:147]
    ds_read_b64_tr_b16 v[122:123], v26 offset:5120
    s_waitcnt vmcnt(11)
    v_mfma_f32_16x16x32_bf16 v[160:163], v[96:99], v[72:75], v[160:163]
    buffer_load_dwordx4 v[56:59], v7, s[12:15], s28 offen offset:0 sc1
    v_mfma_f32_16x16x32_bf16 v[164:167], v[100:103], v[72:75], v[164:167]
    ds_read_b64_tr_b16 v[124:125], v27 offset:4096
    v_mfma_f32_16x16x32_bf16 v[168:171], v[104:107], v[72:75], v[168:171]
    ds_read_b64_tr_b16 v[126:127], v27 offset:5120
    v_mfma_f32_16x16x32_bf16 v[172:175], v[108:111], v[72:75], v[172:175]
    s_waitcnt vmcnt(11)
    v_mfma_f32_16x16x32_bf16 v[188:191], v[108:111], v[76:79], v[188:191]
    buffer_load_dwordx4 v[60:63], v7, s[12:15], s28 offen offset:256 sc1
    s_add_u32 s28, s28, 8192
    v_mfma_f32_16x16x32_bf16 v[184:187], v[104:107], v[76:79], v[184:187]
    v_add_u32 v24, 0, v6
    v_xor_b32 v25, 16, v24
    v_mfma_f32_16x16x32_bf16 v[180:183], v[100:103], v[76:79], v[180:183]
    v_xor_b32 v26, 64, v24
    v_xor_b32 v27, 0x50, v24
    v_mfma_f32_16x16x32_bf16 v[176:179], v[96:99], v[76:79], v[176:179]
    s_waitcnt lgkmcnt(0)
    s_waitcnt vmcnt(11)
    v_mfma_f32_16x16x32_bf16 v[128:131], v[112:115], v[80:83], v[128:131]
    buffer_load_dwordx2 v[16:17], v13, s[12:15], s32 offen sc1
    v_mfma_f32_16x16x32_bf16 v[132:135], v[116:119], v[80:83], v[132:135]
    ds_read_b64_tr_b16 v[96:97], v24 offset:0
    v_mfma_f32_16x16x32_bf16 v[136:139], v[120:123], v[80:83], v[136:139]
    ds_read_b64_tr_b16 v[98:99], v24 offset:1024
    v_mfma_f32_16x16x32_bf16 v[140:143], v[124:127], v[80:83], v[140:143]
    ds_read_b64_tr_b16 v[100:101], v25 offset:0
    s_waitcnt vmcnt(11)
    v_mfma_f32_16x16x32_bf16 v[156:159], v[124:127], v[84:87], v[156:159]
    buffer_load_dwordx2 v[18:19], v13, s[12:15], s32 offen offset:512 sc1
    v_mfma_f32_16x16x32_bf16 v[152:155], v[120:123], v[84:87], v[152:155]
    ds_read_b64_tr_b16 v[102:103], v25 offset:1024
    v_mfma_f32_16x16x32_bf16 v[148:151], v[116:119], v[84:87], v[148:151]
    ds_read_b64_tr_b16 v[104:105], v26 offset:0
    v_mfma_f32_16x16x32_bf16 v[144:147], v[112:115], v[84:87], v[144:147]
    ds_read_b64_tr_b16 v[106:107], v26 offset:1024
    s_waitcnt vmcnt(11)
    v_mfma_f32_16x16x32_bf16 v[160:163], v[112:115], v[88:91], v[160:163]
    v_mfma_f32_16x16x32_bf16 v[164:167], v[116:119], v[88:91], v[164:167]
    ds_read_b64_tr_b16 v[108:109], v27 offset:0
    v_mfma_f32_16x16x32_bf16 v[168:171], v[120:123], v[88:91], v[168:171]
    ds_read_b64_tr_b16 v[110:111], v27 offset:1024
    v_mfma_f32_16x16x32_bf16 v[172:175], v[124:127], v[88:91], v[172:175]
    s_waitcnt vmcnt(10)
    v_mfma_f32_16x16x32_bf16 v[188:191], v[124:127], v[92:95], v[188:191]
    v_mfma_f32_16x16x32_bf16 v[184:187], v[120:123], v[92:95], v[184:187]
    v_mfma_f32_16x16x32_bf16 v[180:183], v[116:119], v[92:95], v[180:183]
    v_mfma_f32_16x16x32_bf16 v[176:179], v[112:115], v[92:95], v[176:179]
    s_waitcnt lgkmcnt(0)
    s_waitcnt vmcnt(9)
    v_mfma_f32_16x16x32_bf16 v[128:131], v[96:99], v[32:35], v[128:131]
    v_mfma_f32_16x16x32_bf16 v[132:135], v[100:103], v[32:35], v[132:135]
    ds_read_b64_tr_b16 v[112:113], v24 offset:4096
    v_mfma_f32_16x16x32_bf16 v[136:139], v[104:107], v[32:35], v[136:139]
    ds_read_b64_tr_b16 v[114:115], v24 offset:5120
    v_mfma_f32_16x16x32_bf16 v[140:143], v[108:111], v[32:35], v[140:143]
    ds_read_b64_tr_b16 v[116:117], v25 offset:4096
    s_waitcnt vmcnt(8)
    v_mfma_f32_16x16x32_bf16 v[156:159], v[108:111], v[36:39], v[156:159]
    v_mfma_f32_16x16x32_bf16 v[152:155], v[104:107], v[36:39], v[152:155]
    ds_read_b64_tr_b16 v[118:119], v25 offset:5120
    v_mfma_f32_16x16x32_bf16 v[148:151], v[100:103], v[36:39], v[148:151]
    ds_read_b64_tr_b16 v[120:121], v26 offset:4096
    v_mfma_f32_16x16x32_bf16 v[144:147], v[96:99], v[36:39], v[144:147]
    ds_read_b64_tr_b16 v[122:123], v26 offset:5120
    s_waitcnt vmcnt(7)
    v_mfma_f32_16x16x32_bf16 v[160:163], v[96:99], v[40:43], v[160:163]
    v_mfma_f32_16x16x32_bf16 v[164:167], v[100:103], v[40:43], v[164:167]
    ds_read_b64_tr_b16 v[124:125], v27 offset:4096
    v_mfma_f32_16x16x32_bf16 v[168:171], v[104:107], v[40:43], v[168:171]
    ds_read_b64_tr_b16 v[126:127], v27 offset:5120
    v_mfma_f32_16x16x32_bf16 v[172:175], v[108:111], v[40:43], v[172:175]
    s_waitcnt vmcnt(6)
    v_mfma_f32_16x16x32_bf16 v[188:191], v[108:111], v[44:47], v[188:191]
    v_mfma_f32_16x16x32_bf16 v[184:187], v[104:107], v[44:47], v[184:187]
    v_mfma_f32_16x16x32_bf16 v[180:183], v[100:103], v[44:47], v[180:183]
    v_mfma_f32_16x16x32_bf16 v[176:179], v[96:99], v[44:47], v[176:179]
    s_waitcnt lgkmcnt(0)
    s_waitcnt vmcnt(5)
    v_mfma_f32_16x16x32_bf16 v[128:131], v[112:115], v[48:51], v[128:131]
    v_mfma_f32_16x16x32_bf16 v[132:135], v[116:119], v[48:51], v[132:135]
    v_mfma_f32_16x16x32_bf16 v[136:139], v[120:123], v[48:51], v[136:139]
    v_mfma_f32_16x16x32_bf16 v[140:143], v[124:127], v[48:51], v[140:143]
    s_waitcnt vmcnt(4)
    v_mfma_f32_16x16x32_bf16 v[156:159], v[124:127], v[52:55], v[156:159]
    v_mfma_f32_16x16x32_bf16 v[152:155], v[120:123], v[52:55], v[152:155]
    v_mfma_f32_16x16x32_bf16 v[148:151], v[116:119], v[52:55], v[148:151]
    v_mfma_f32_16x16x32_bf16 v[144:147], v[112:115], v[52:55], v[144:147]
    s_waitcnt vmcnt(3)
    v_mfma_f32_16x16x32_bf16 v[160:163], v[112:115], v[56:59], v[160:163]
    v_mfma_f32_16x16x32_bf16 v[164:167], v[116:119], v[56:59], v[164:167]
    v_mfma_f32_16x16x32_bf16 v[168:171], v[120:123], v[56:59], v[168:171]
    v_mfma_f32_16x16x32_bf16 v[172:175], v[124:127], v[56:59], v[172:175]
    s_waitcnt vmcnt(2)
    v_mfma_f32_16x16x32_bf16 v[188:191], v[124:127], v[60:63], v[188:191]
    v_mfma_f32_16x16x32_bf16 v[184:187], v[120:123], v[60:63], v[184:187]
    v_mfma_f32_16x16x32_bf16 v[180:183], v[116:119], v[60:63], v[180:183]
    v_mfma_f32_16x16x32_bf16 v[176:179], v[112:115], v[60:63], v[176:179]
    ds_write_b128 v9, v[128:131] offset:0
    ds_write_b128 v9, v[132:135] offset:32
    ds_write_b128 v20, v[136:139] offset:0
    ds_write_b128 v20, v[140:143] offset:32
    ds_write_b128 v9, v[144:147] offset:2304
    ds_write_b128 v9, v[148:151] offset:2336
    ds_write_b128 v20, v[152:155] offset:2304
    ds_write_b128 v20, v[156:159] offset:2336
    ds_write_b128 v9, v[160:163] offset:32768
    ds_write_b128 v9, v[164:167] offset:32800
    ds_write_b128 v20, v[168:171] offset:32768
    ds_write_b128 v20, v[172:175] offset:32800
    ds_write_b128 v9, v[176:179] offset:35072
    ds_write_b128 v9, v[180:183] offset:35104
    ds_write_b128 v20, v[184:187] offset:35072
    ds_write_b128 v20, v[188:191] offset:35104
    s_branch Ltfin
Lfy:
    s_cmp_ge_u32 s61, 14
    s_cbranch_scc1 Lf2y
    s_lshl_b32 s42, s75, 12
    s_add_u32 s27, s27, s42
    s_add_u32 m0, s30, 32768
    s_nop 0
    buffer_load_dwordx4 v2, s[12:15], s27 offen offset:0 sc1 lds
    buffer_load_dwordx4 v2, s[12:15], s27 offen offset:1024 sc1 lds
    buffer_load_dwordx4 v2, s[12:15], s27 offen offset:2048 sc1 lds
    buffer_load_dwordx4 v2, s[12:15], s27 offen offset:3072 sc1 lds
    s_mov_b32 s45, 4096
    s_add_u32 s75, s75, 1
    s_cmp_eq_u32 s75, 8
    s_cselect_b32 s44, 4294938624, s45
    s_cselect_b32 s75, 0, s75
    s_add_u32 s27, s27, s44
    s_add_u32 m0, s30, 65536
    s_nop 0
    buffer_load_dwordx4 v2, s[12:15], s27 offen offset:0 sc1 lds
    buffer_load_dwordx4 v2, s[12:15], s27 offen offset:1024 sc1 lds
    buffer_load_dwordx4 v2, s[12:15], s27 offen offset:2048 sc1 lds
    buffer_load_dwordx4 v2, s[12:15], s27 offen offset:3072 sc1 lds
    s_mov_b32 s45, 4096
    s_add_u32 s75, s75, 1
    s_cmp_eq_u32 s75, 8
    s_cselect_b32 s44, 4294938624, s45
    s_cselect_b32 s75, 0, s75
    s_add_u32 s27, s27, s44
    s_waitcnt vmcnt(4)
    s_barrier
    s_add_u32 m0, s30, 98304
    s_nop 0
    buffer_load_dwordx4 v2, s[12:15], s27 offen offset:0 sc1 lds
    buffer_load_dwordx4 v2, s[12:15], s27 offen offset:1024 sc1 lds
    buffer_load_dwordx4 v2, s[12:15], s27 offen offset:2048 sc1 lds
    buffer_load_dwordx4 v2, s[12:15], s27 offen offset:3072 sc1 lds
    s_mov_b32 s45, 4096
    s_add_u32 s75, s75, 1
    s_cmp_eq_u32 s75, 8
    s_cselect_b32 s44, 4294938624, s45
    s_cselect_b32 s75, 0, s75
    s_add_u32 s27, s27, s44
    s_waitcnt vmcnt(4)
    s_barrier
    s_add_u32 m0, s30, 131072
    s_nop 0
    buffer_load_dwordx4 v2, s[12:15], s27 offen offset:0 sc1 lds
    buffer_load_dwordx4 v2, s[12:15], s27 offen offset:1024 sc1 lds
    buffer_load_dwordx4 v2, s[12:15], s27 offen offset:2048 sc1 lds
    buffer_load_dwordx4 v2, s[12:15], s27 offen offset:3072 sc1 lds
    s_mov_b32 s45, 4096
    s_add_u32 s75, s75, 1
    s_cmp_eq_u32 s75, 8
    s_cselect_b32 s44, 4294938624, s45
    s_cselect_b32 s75, 0, s75
    s_add_u32 s27, s27, s44
    s_add_u32 m0, s30, 0
    s_nop 0
    buffer_load_dwordx4 v2, s[12:15], s27 offen offset:0 sc1 lds
    buffer_load_dwordx4 v2, s[12:15], s27 offen offset:1024 sc1 lds
    buffer_load_dwordx4 v2, s[12:15], s27 offen offset:2048 sc1 lds
    buffer_load_dwordx4 v2, s[12:15], s27 offen offset:3072 sc1 lds
    s_mov_b32 s45, 4096
    s_add_u32 s75, s75, 1
    s_cmp_eq_u32 s75, 8
    s_cselect_b32 s44, 4294938624, s45
    s_cselect_b32 s75, 0, s75
    s_add_u32 s27, s27, s44
    s_waitcnt vmcnt(4) lgkmcnt(0)
    s_barrier
    s_add_u32 m0, s30, 32768
    s_nop 0
    buffer_load_dwordx4 v2, s[12:15], s27 offen offset:0 sc1 lds
    buffer_load_dwordx4 v2, s[12:15], s27 offen offset:1024 sc1 lds
    buffer_load_dwordx4 v2, s[12:15], s27 offen offset:2048 sc1 lds
    buffer_load_dwordx4 v2, s[12:15], s27 offen offset:3072 sc1 lds
    s_mov_b32 s45, 4096
    s_add_u32 s75, s75, 1
    s_cmp_eq_u32 s75, 8
    s_cselect_b32 s44, 4294938624, s45
    s_cselect_b32 s75, 0, s75
    s_add_u32 s27, s27, s44
    s_add_u32 m0, s30, 49152
    s_nop 0
    buffer_load_dwordx4 v16, s[20:23], s28 offen offset:0 lds
    buffer_load_dwordx4 v17, s[20:23], s28 offen offset:1024 lds
    buffer_load_dwordx4 v18, s[20:23], s28 offen offset:2048 lds
    buffer_load_dwordx4 v19, s[20:23], s28 offen offset:3072 lds
    s_mov_b32 s45, 229376
    s_add_u32 s76, s76, 1
    s_cmp_eq_u32 s76, 8
    s_cselect_b32 s44, 4293361664, s45
    s_cselect_b32 s76, 0, s76
    s_add_u32 s28, s28, s44
    s_add_u32 m0, s30, 65536
    s_nop 0
    buffer_load_dwordx4 v2, s[12:15], s27 offen offset:0 sc1 lds
    buffer_load_dwordx4 v2, s[12:15], s27 offen offset:1024 sc1 lds
    buffer_load_dwordx4 v2, s[12:15], s27 offen offset:2048 sc1 lds
    buffer_load_dwordx4 v2, s[12:15], s27 offen offset:3072 sc1 lds
    s_mov_b32 s45, 4096
    s_add_u32 s75, s75, 1
    s_cmp_eq_u32 s75, 8
    s_cselect_b32 s44, 4294938624, s45
    s_cselect_b32 s75, 0, s75
    s_add_u32 s27, s27, s44
    s_add_u32 m0, s30, 81920
    s_nop 0
    buffer_load_dwordx4 v16, s[20:23], s28 offen offset:0 lds
    buffer_load_dwordx4 v17, s[20:23], s28 offen offset:1024 lds
    buffer_load_dwordx4 v18, s[20:23], s28 offen offset:2048 lds
    buffer_load_dwordx4 v19, s[20:23], s28 offen offset:3072 lds
    s_mov_b32 s45, 229376
    s_add_u32 s76, s76, 1
    s_cmp_eq_u32 s76, 8
    s_cselect_b32 s44, 4293361664, s45
    s_cselect_b32 s76, 0, s76
    s_add_u32 s28, s28, s44
    s_waitcnt vmcnt(8) lgkmcnt(0)
    s_barrier
    s_add_u32 m0, s30, 98304
    s_nop 0
    buffer_load_dwordx4 v2, s[12:15], s27 offen offset:0 sc1 lds
    buffer_load_dwordx4 v2, s[12:15], s27 offen offset:1024 sc1 lds
    buffer_load_dwordx4 v2, s[12:15], s27 offen offset:2048 sc1 lds
    buffer_load_dwordx4 v2, s[12:15], s27 offen offset:3072 sc1 lds
    s_mov_b32 s45, 4096
    s_add_u32 s75, s75, 1
    s_cmp_eq_u32 s75, 8
    s_cselect_b32 s44, 4294938624, s45
    s_cselect_b32 s75, 0, s75
    s_add_u32 s27, s27, s44
    s_add_u32 s27, s27, 32768
    s_add_u32 m0, s30, 114688
    s_nop 0
    buffer_load_dwordx4 v16, s[20:23], s28 offen offset:0 lds
    buffer_load_dwordx4 v17, s[20:23], s28 offen offset:1024 lds
    buffer_load_dwordx4 v18, s[20:23], s28 offen offset:2048 lds
    buffer_load_dwordx4 v19, s[20:23], s28 offen offset:3072 lds
    s_mov_b32 s45, 229376
    s_add_u32 s76, s76, 1
    s_cmp_eq_u32 s76, 8
    s_cselect_b32 s44, 4293361664, s45
    s_cselect_b32 s76, 0, s76
    s_add_u32 s28, s28, s44
    s_add_u32 s28, s28, 1835008
    s_add_u32 m0, s70, 131072
    s_nop 0
    buffer_load_dwordx4 v4, s[52:55], s71 offen lds
    buffer_load_dwordx4 v5, s[52:55], s71 offen offset:1024 lds
    s_add_u32 s71, s71, 65536
    s_add_u32 m0, s70, 133120
    s_nop 0
    buffer_load_dwordx4 v21, s[52:55], s71 offen lds
    buffer_load_dwordx4 v22, s[52:55], s71 offen offset:1024 lds
    s_add_u32 s71, s71, 65536
    s_add_u32 m0, s70, 135168
    s_nop 0
    buffer_load_dwordx4 v4, s[52:55], s71 offen lds
    buffer_load_dwordx4 v5, s[52:55], s71 offen offset:1024 lds
    s_add_u32 s71, s71, 65536
    s_add_u32 m0, s70, 137216
    s_nop 0
    buffer_load_dwordx4 v21, s[52:55], s71 offen lds
    buffer_load_dwordx4 v22, s[52:55], s71 offen offset:1024 lds
    s_add_u32 s71, s71, 65536
    s_waitcnt vmcnt(8) lgkmcnt(0)
    s_barrier
    s_add_u32 m0, s70, 0
    s_nop 0
    buffer_load_dwordx4 v4, s[52:55], s71 offen lds
    buffer_load_dwordx4 v5, s[52:55], s71 offen offset:1024 lds
    s_add_u32 s71, s71, 65536
    s_add_u32 m0, s70, 2048
    s_nop 0
    buffer_load_dwordx4 v21, s[52:55], s71 offen lds
    buffer_load_dwordx4 v22, s[52:55], s71 offen offset:1024 lds
    s_add_u32 s71, s71, 65536
    s_add_u32 m0, s70, 4096
    s_nop 0
    buffer_load_dwordx4 v4, s[52:55], s71 offen lds
    buffer_load_dwordx4 v5, s[52:55], s71 offen offset:1024 lds
    s_add_u32 s71, s71, 65536
    s_add_u32 m0, s70, 6144
    s_nop 0
    buffer_load_dwordx4 v21, s[52:55], s71 offen lds
    buffer_load_dwordx4 v22, s[52:55], s71 offen offset:1024 lds
    s_add_u32 s71, s71, 65536
    s_barrier
    v_add_u32 v29, s70, v2
    v_add_u32 v28, 65536, v29
    v_add_u32 v27, 131072, v29
    s_barrier
    ds_read_b128 v[32:35], v31 offset:0
    ds_read_b128 v[36:39], v31 offset:1024
    ds_read_b128 v[40:43], v31 offset:2048
    ds_read_b128 v[44:47], v31 offset:3072
    ds_read_b128 v[48:51], v31 offset:4096
    ds_read_b128 v[52:55], v31 offset:5120
    ds_read_b128 v[56:59], v31 offset:6144
    ds_read_b128 v[60:63], v31 offset:7168
    s_setprio 1
    s_add_u32 m0, s70, 32768
    s_nop 0
    buffer_load_dwordx4 v4, s[52:55], s71 offen lds
    buffer_load_dwordx4 v5, s[52:55], s71 offen offset:1024 lds
    s_add_u32 s71, s71, 65536
    s_add_u32 m0, s70, 34816
    s_nop 0
    buffer_load_dwordx4 v21, s[52:55], s71 offen lds
    buffer_load_dwordx4 v22, s[52:55], s71 offen offset:1024 lds
    s_add_u32 s71, s71, 65536
    s_add_u32 m0, s70, 36864
    s_nop 0
    buffer_load_dwordx4 v4, s[52:55], s71 offen lds
    buffer_load_dwordx4 v5, s[52:55], s71 offen offset:1024 lds
    s_add_u32 s71, s71, 65536
    s_add_u32 m0, s70, 38912
    s_nop 0
    buffer_load_dwordx4 v21, s[52:55], s71 offen lds
    buffer_load_dwordx4 v22, s[52:55], s71 offen offset:1024 lds
    s_add_u32 s71, s71, 65536
    s_waitcnt lgkmcnt(0)
    v_pk_mul_f32 v[80:81], s[78:79], v[32:33]
    v_pk_mul_f32 v[82:83], s[78:79], v[34:35]
    v_pk_mul_f32 v[84:85], s[78:79], v[36:37]
    v_pk_mul_f32 v[86:87], s[78:79], v[38:39]
    v_min_f32 v80, s34, v80
    v_min_f32 v81, s34, v81
    v_min_f32 v82, s34, v82
    v_min_f32 v83, s34, v83
    v_min_f32 v84, s34, v84
    v_min_f32 v85, s34, v85
    v_min_f32 v86, s34, v86
    v_min_f32 v87, s34, v87
    v_exp_f32 v80, v80
    v_exp_f32 v81, v81
    v_exp_f32 v82, v82
    v_exp_f32 v83, v83
    v_exp_f32 v84, v84
    v_exp_f32 v85, v85
    v_exp_f32 v86, v86
    v_exp_f32 v87, v87
    v_pk_add_f32 v[88:89], v[80:81], s[80:81]
    v_pk_add_f32 v[90:91], v[82:83], s[80:81]
    v_pk_add_f32 v[92:93], v[84:85], s[80:81]
    v_pk_add_f32 v[94:95], v[86:87], s[80:81]
    v_pk_mul_f32 v[80:81], v[80:81], v[88:89]
    v_pk_mul_f32 v[82:83], v[82:83], v[90:91]
    v_pk_mul_f32 v[84:85], v[84:85], v[92:93]
    v_pk_mul_f32 v[86:87], v[86:87], v[94:95]
    v_pk_add_f32 v[88:89], v[80:81], s[80:81]
    v_pk_add_f32 v[90:91], v[82:83], s[80:81]
    v_pk_add_f32 v[92:93], v[84:85], s[80:81]
    v_pk_add_f32 v[94:95], v[86:87], s[80:81]
    v_rcp_f32 v88, v88
    v_rcp_f32 v89, v89
    v_rcp_f32 v90, v90
    v_rcp_f32 v91, v91
    v_rcp_f32 v92, v92
    v_rcp_f32 v93, v93
    v_rcp_f32 v94, v94
    v_rcp_f32 v95, v95
    v_pk_mul_f32 v[80:81], v[80:81], v[88:89]
    v_pk_mul_f32 v[82:83], v[82:83], v[90:91]
    v_pk_mul_f32 v[84:85], v[84:85], v[92:93]
    v_pk_mul_f32 v[86:87], v[86:87], v[94:95]
    v_pk_mul_f32 v[80:81], v[80:81], v[32:33]
    v_pk_mul_f32 v[82:83], v[82:83], v[34:35]
    v_pk_mul_f32 v[84:85], v[84:85], v[36:37]
    v_pk_mul_f32 v[86:87], v[86:87], v[38:39]
    v_cvt_pk_bf16_f32 v64, v80, v81
    v_cvt_pk_bf16_f32 v65, v82, v83
    v_cvt_pk_bf16_f32 v66, v84, v85
    v_cvt_pk_bf16_f32 v67, v86, v87
    buffer_store_dwordx4 v[64:67], v8, s[12:15], s77 offen offset:0 sc1
    v_pk_mul_f32 v[80:81], s[78:79], v[40:41]
    v_pk_mul_f32 v[82:83], s[78:79], v[42:43]
    v_pk_mul_f32 v[84:85], s[78:79], v[44:45]
    v_pk_mul_f32 v[86:87], s[78:79], v[46:47]
    v_min_f32 v80, s34, v80
    v_min_f32 v81, s34, v81
    v_min_f32 v82, s34, v82
    v_min_f32 v83, s34, v83
    v_min_f32 v84, s34, v84
    v_min_f32 v85, s34, v85
    v_min_f32 v86, s34, v86
    v_min_f32 v87, s34, v87
    v_exp_f32 v80, v80
    v_exp_f32 v81, v81
    v_exp_f32 v82, v82
    v_exp_f32 v83, v83
    v_exp_f32 v84, v84
    v_exp_f32 v85, v85
    v_exp_f32 v86, v86
    v_exp_f32 v87, v87
    v_pk_add_f32 v[88:89], v[80:81], s[80:81]
    v_pk_add_f32 v[90:91], v[82:83], s[80:81]
    v_pk_add_f32 v[92:93], v[84:85], s[80:81]
    v_pk_add_f32 v[94:95], v[86:87], s[80:81]
    v_pk_mul_f32 v[80:81], v[80:81], v[88:89]
    v_pk_mul_f32 v[82:83], v[82:83], v[90:91]
    v_pk_mul_f32 v[84:85], v[84:85], v[92:93]
    v_pk_mul_f32 v[86:87], v[86:87], v[94:95]
    v_pk_add_f32 v[88:89], v[80:81], s[80:81]
    v_pk_add_f32 v[90:91], v[82:83], s[80:81]
    v_pk_add_f32 v[92:93], v[84:85], s[80:81]
    v_pk_add_f32 v[94:95], v[86:87], s[80:81]
    v_rcp_f32 v88, v88
    v_rcp_f32 v89, v89
    v_rcp_f32 v90, v90
    v_rcp_f32 v91, v91
    v_rcp_f32 v92, v92
    v_rcp_f32 v93, v93
    v_rcp_f32 v94, v94
    v_rcp_f32 v95, v95
    v_pk_mul_f32 v[80:81], v[80:81], v[88:89]
    v_pk_mul_f32 v[82:83], v[82:83], v[90:91]
    v_pk_mul_f32 v[84:85], v[84:85], v[92:93]
    v_pk_mul_f32 v[86:87], v[86:87], v[94:95]
    v_pk_mul_f32 v[80:81], v[80:81], v[40:41]
    v_pk_mul_f32 v[82:83], v[82:83], v[42:43]
    v_pk_mul_f32 v[84:85], v[84:85], v[44:45]
    v_pk_mul_f32 v[86:87], v[86:87], v[46:47]
    v_cvt_pk_bf16_f32 v68, v80, v81
    v_cvt_pk_bf16_f32 v69, v82, v83
    v_cvt_pk_bf16_f32 v70, v84, v85
    v_cvt_pk_bf16_f32 v71, v86, v87
    buffer_store_dwordx4 v[68:71], v8, s[12:15], s77 offen offset:2048 sc1
    v_pk_mul_f32 v[80:81], s[78:79], v[48:49]
    v_pk_mul_f32 v[82:83], s[78:79], v[50:51]
    v_pk_mul_f32 v[84:85], s[78:79], v[52:53]
    v_pk_mul_f32 v[86:87], s[78:79], v[54:55]
    v_min_f32 v80, s34, v80
    v_min_f32 v81, s34, v81
    v_min_f32 v82, s34, v82
    v_min_f32 v83, s34, v83
    v_min_f32 v84, s34, v84
    v_min_f32 v85, s34, v85
    v_min_f32 v86, s34, v86
    v_min_f32 v87, s34, v87
    v_exp_f32 v80, v80
    v_exp_f32 v81, v81
    v_exp_f32 v82, v82
    v_exp_f32 v83, v83
    v_exp_f32 v84, v84
    v_exp_f32 v85, v85
    v_exp_f32 v86, v86
    v_exp_f32 v87, v87
    v_pk_add_f32 v[88:89], v[80:81], s[80:81]
    v_pk_add_f32 v[90:91], v[82:83], s[80:81]
    v_pk_add_f32 v[92:93], v[84:85], s[80:81]
    v_pk_add_f32 v[94:95], v[86:87], s[80:81]
    v_pk_mul_f32 v[80:81], v[80:81], v[88:89]
    v_pk_mul_f32 v[82:83], v[82:83], v[90:91]
    v_pk_mul_f32 v[84:85], v[84:85], v[92:93]
    v_pk_mul_f32 v[86:87], v[86:87], v[94:95]
    v_pk_add_f32 v[88:89], v[80:81], s[80:81]
    v_pk_add_f32 v[90:91], v[82:83], s[80:81]
    v_pk_add_f32 v[92:93], v[84:85], s[80:81]
    v_pk_add_f32 v[94:95], v[86:87], s[80:81]
    v_rcp_f32 v88, v88
    v_rcp_f32 v89, v89
    v_rcp_f32 v90, v90
    v_rcp_f32 v91, v91
    v_rcp_f32 v92, v92
    v_rcp_f32 v93, v93
    v_rcp_f32 v94, v94
    v_rcp_f32 v95, v95
    v_pk_mul_f32 v[80:81], v[80:81], v[88:89]
    v_pk_mul_f32 v[82:83], v[82:83], v[90:91]
    v_pk_mul_f32 v[84:85], v[84:85], v[92:93]
    v_pk_mul_f32 v[86:87], v[86:87], v[94:95]
    v_pk_mul_f32 v[80:81], v[80:81], v[48:49]
    v_pk_mul_f32 v[82:83], v[82:83], v[50:51]
    v_pk_mul_f32 v[84:85], v[84:85], v[52:53]
    v_pk_mul_f32 v[86:87], v[86:87], v[54:55]
    v_cvt_pk_bf16_f32 v72, v80, v81
    v_cvt_pk_bf16_f32 v73, v82, v83
    v_cvt_pk_bf16_f32 v74, v84, v85
    v_cvt_pk_bf16_f32 v75, v86, v87
    buffer_store_dwordx4 v[72:75], v8, s[12:15], s77 offen offset:256 sc1
    v_pk_mul_f32 v[80:81], s[78:79], v[56:57]
    v_pk_mul_f32 v[82:83], s[78:79], v[58:59]
    v_pk_mul_f32 v[84:85], s[78:79], v[60:61]
    v_pk_mul_f32 v[86:87], s[78:79], v[62:63]
    v_min_f32 v80, s34, v80
    v_min_f32 v81, s34, v81
    v_min_f32 v82, s34, v82
    v_min_f32 v83, s34, v83
    v_min_f32 v84, s34, v84
    v_min_f32 v85, s34, v85
    v_min_f32 v86, s34, v86
    v_min_f32 v87, s34, v87
    v_exp_f32 v80, v80
    v_exp_f32 v81, v81
    v_exp_f32 v82, v82
    v_exp_f32 v83, v83
    v_exp_f32 v84, v84
    v_exp_f32 v85, v85
    v_exp_f32 v86, v86
    v_exp_f32 v87, v87
    v_pk_add_f32 v[88:89], v[80:81], s[80:81]
    v_pk_add_f32 v[90:91], v[82:83], s[80:81]
    v_pk_add_f32 v[92:93], v[84:85], s[80:81]
    v_pk_add_f32 v[94:95], v[86:87], s[80:81]
    v_pk_mul_f32 v[80:81], v[80:81], v[88:89]
    v_pk_mul_f32 v[82:83], v[82:83], v[90:91]
    v_pk_mul_f32 v[84:85], v[84:85], v[92:93]
    v_pk_mul_f32 v[86:87], v[86:87], v[94:95]
    v_pk_add_f32 v[88:89], v[80:81], s[80:81]
    v_pk_add_f32 v[90:91], v[82:83], s[80:81]
    v_pk_add_f32 v[92:93], v[84:85], s[80:81]
    v_pk_add_f32 v[94:95], v[86:87], s[80:81]
    v_rcp_f32 v88, v88
    v_rcp_f32 v89, v89
    v_rcp_f32 v90, v90
    v_rcp_f32 v91, v91
    v_rcp_f32 v92, v92
    v_rcp_f32 v93, v93
    v_rcp_f32 v94, v94
    v_rcp_f32 v95, v95
    v_pk_mul_f32 v[80:81], v[80:81], v[88:89]
    v_pk_mul_f32 v[82:83], v[82:83], v[90:91]
    v_pk_mul_f32 v[84:85], v[84:85], v[92:93]
    v_pk_mul_f32 v[86:87], v[86:87], v[94:95]
    v_pk_mul_f32 v[80:81], v[80:81], v[56:57]
    v_pk_mul_f32 v[82:83], v[82:83], v[58:59]
    v_pk_mul_f32 v[84:85], v[84:85], v[60:61]
    v_pk_mul_f32 v[86:87], v[86:87], v[62:63]
    v_cvt_pk_bf16_f32 v76, v80, v81
    v_cvt_pk_bf16_f32 v77, v82, v83
    v_cvt_pk_bf16_f32 v78, v84, v85
    v_cvt_pk_bf16_f32 v79, v86, v87
    buffer_store_dwordx4 v[76:79], v8, s[12:15], s77 offen offset:2304 sc1
    s_setprio 0
    v_mov_b32 v24, v27
    v_mov_b32 v23, v28
    s_waitcnt vmcnt(0) lgkmcnt(0)
    s_barrier
    s_cmp_eq_u32 s24, 5
    s_cbranch_scc0 Lsq_135
    s_lshl_b32 s42, s60, 11
    s_lshl_b32 s43, s61, 2
    s_add_u32 s42, s42, s43
    s_add_u32 s42, s42, 15728640
    v_lshlrev_b32 v28, 7, v1
    v_mov_b32 v26, s64
    s_mov_b64 exec, 0xffff
    buffer_store_dword v26, v28, s[12:15], s42 offen sc1
    s_mov_b64 exec, -1
Lsq_135:
    s_cmp_eq_u32 s24, 4
    s_cbranch_scc0 Lsy_134
    s_lshl_b32 s42, s60, 11
    s_lshl_b32 s43, s61, 2
    s_add_u32 s42, s42, s43
    s_add_u32 s42, s42, 15728640
    v_lshlrev_b32 v28, 7, v1
    v_mov_b32 v26, s64
    s_mov_b64 exec, 0xffff
    s_add_u32 s43, s42, 262144
    buffer_store_dword v26, v28, s[12:15], s43 offen
    s_mov_b64 exec, -1
Lnp_136:
    s_lshl_b32 s42, s72, 11
    s_lshl_b32 s43, s73, 7
    s_add_u32 s42, s42, s43
    s_add_u32 s42, s42, 15728640
    v_min_u32 v27, 13, v1
    v_lshlrev_b32 v27, 2, v27
    v_add_u32 v27, s42, v27
    s_mov_b32 s42, 800003
    s_mov_b32 s43, 0
Lpl_137:
    s_and_b32 s44, s42, 3
    s_cselect_b32 s44, 262144, 0
    buffer_load_dword v26, v27, s[12:15], s44 offen sc1
    s_waitcnt vmcnt(0)
    v_cmp_eq_u32 vcc, s64, v26
    s_nop 0
    s_or_b32 s43, s43, vcc_lo
    s_cmp_eq_u32 s43, -1
    s_cbranch_scc1 Lok_138
    s_sleep 3
    s_sub_u32 s42, s42, 1
    s_cbranch_scc0 Lpl_137
Lok_138:
Lsy_134:
    s_barrier
    ds_write_b128 v23, v[128:131] offset:0
    ds_write_b128 v23, v[132:135] offset:1024
    ds_write_b128 v23, v[136:139] offset:2048
    ds_write_b128 v23, v[140:143] offset:3072
    ds_write_b128 v23, v[144:147] offset:4096
    ds_write_b128 v23, v[148:151] offset:5120
    ds_write_b128 v23, v[152:155] offset:6144
    ds_write_b128 v23, v[156:159] offset:7168
    ds_write_b128 v23, v[160:163] offset:32768
    ds_write_b128 v23, v[164:167] offset:33792
    ds_write_b128 v23, v[168:171] offset:34816
    ds_write_b128 v23, v[172:175] offset:35840
    ds_write_b128 v23, v[176:179] offset:36864
    ds_write_b128 v23, v[180:183] offset:37888
    ds_write_b128 v23, v[184:187] offset:38912
    ds_write_b128 v23, v[188:191] offset:39936
    ds_write_b128 v24, v[192:195] offset:0
    ds_write_b128 v24, v[196:199] offset:1024
    ds_write_b128 v24, v[200:203] offset:2048
    ds_write_b128 v24, v[204:207] offset:3072
    ds_write_b128 v24, v[208:211] offset:4096
    ds_write_b128 v24, v[212:215] offset:5120
    ds_write_b128 v24, v[216:219] offset:6144
    ds_write_b128 v24, v[220:223] offset:7168
    ds_write_b128 v29, v[224:227] offset:0
    ds_write_b128 v29, v[228:231] offset:1024
    ds_write_b128 v29, v[232:235] offset:2048
    ds_write_b128 v29, v[236:239] offset:3072
    ds_write_b128 v29, v[240:243] offset:4096
    ds_write_b128 v29, v[244:247] offset:5120
    ds_write_b128 v29, v[248:251] offset:6144
    ds_write_b128 v29, v[252:255] offset:7168
    v_lshrrev_b32 v10, 3, v0
    v_and_b32 v11, 7, v0
    s_lshl_b32 s31, s62, 16
    s_lshl_b32 s32, s63, 7
    s_add_u32 s31, s31, s32
    v_lshlrev_b32 v12, 10, v10
    v_lshl_add_u32 v12, v11, 4, v12
    v_lshrrev_b32 v13, 5, v10
    v_lshlrev_b32 v13, 15, v13
    v_and_b32 v14, 31, v10
    v_mul_u32_u24 v15, 144, v14
    v_add_u32 v15, v15, v13
    v_lshl_add_u32 v13, v14, 4, v13
    v_lshrrev_b32 v14, 1, v11
    v_lshl_add_u32 v13, v14, 10, v13
    v_and_b32 v14, 1, v11
    v_lshl_add_u32 v13, v14, 3, v13
    v_lshrrev_b32 v14, 2, v11
    v_lshl_add_u32 v15, v14, 16, v15
    v_and_b32 v14, 3, v11
    v_lshl_add_u32 v15, v14, 5, v15
    s_lshl_b32 s32, s62, 16
    s_lshl_b32 s33, s63, 12
    s_add_u32 s32, s32, s33
    s_add_u32 s32, s32, 3145728
    s_waitcnt vmcnt(0) lgkmcnt(0)
    s_branch Lf2y3
Lf2y:
    s_add_u32 m0, s70, 131072
    s_nop 0
    buffer_load_dwordx4 v4, s[52:55], s71 offen lds
    buffer_load_dwordx4 v5, s[52:55], s71 offen offset:1024 lds
    s_add_u32 s71, s71, 65536
    s_add_u32 m0, s70, 133120
    s_nop 0
    buffer_load_dwordx4 v21, s[52:55], s71 offen lds
    buffer_load_dwordx4 v22, s[52:55], s71 offen offset:1024 lds
    s_add_u32 s71, s71, 65536
    s_add_u32 m0, s70, 135168
    s_nop 0
    buffer_load_dwordx4 v4, s[52:55], s71 offen lds
    buffer_load_dwordx4 v5, s[52:55], s71 offen offset:1024 lds
    s_add_u32 s71, s71, 65536
    s_add_u32 m0, s70, 137216
    s_nop 0
    buffer_load_dwordx4 v21, s[52:55], s71 offen lds
    buffer_load_dwordx4 v22, s[52:55], s71 offen offset:1024 lds
    s_add_u32 s71, s71, 65536
    s_add_u32 m0, s70, 0
    s_nop 0
    buffer_load_dwordx4 v4, s[52:55], s71 offen lds
    buffer_load_dwordx4 v5, s[52:55], s71 offen offset:1024 lds
    s_add_u32 s71, s71, 65536
    s_add_u32 m0, s70, 2048
    s_nop 0
    buffer_load_dwordx4 v21, s[52:55], s71 offen lds
    buffer_load_dwordx4 v22, s[52:55], s71 offen offset:1024 lds
    s_add_u32 s71, s71, 65536
    s_add_u32 m0, s70, 4096
    s_nop 0
    buffer_load_dwordx4 v4, s[52:55], s71 offen lds
    buffer_load_dwordx4 v5, s[52:55], s71 offen offset:1024 lds
    s_add_u32 s71, s71, 65536
    s_add_u32 m0, s70, 6144
    s_nop 0
    buffer_load_dwordx4 v21, s[52:55], s71 offen lds
    buffer_load_dwordx4 v22, s[52:55], s71 offen offset:1024 lds
    s_add_u32 s71, s71, 65536
    s_add_u32 m0, s70, 32768
    s_nop 0
    buffer_load_dwordx4 v4, s[52:55], s71 offen lds
    buffer_load_dwordx4 v5, s[52:55], s71 offen offset:1024 lds
    s_add_u32 s71, s71, 65536
    s_add_u32 m0, s70, 34816
    s_nop 0
    buffer_load_dwordx4 v21, s[52:55], s71 offen lds
    buffer_load_dwordx4 v22, s[52:55], s71 offen offset:1024 lds
    s_add_u32 s71, s71, 65536
    s_add_u32 m0, s70, 36864
    s_nop 0
    buffer_load_dwordx4 v4, s[52:55], s71 offen lds
    buffer_load_dwordx4 v5, s[52:55], s71 offen offset:1024 lds
    s_add_u32 s71, s71, 65536
    s_add_u32 m0, s70, 38912
    s_nop 0
    buffer_load_dwordx4 v21, s[52:55], s71 offen lds
    buffer_load_dwordx4 v22, s[52:55], s71 offen offset:1024 lds
    s_add_u32 s71, s71, 65536
    s_add_u32 m0, s70, 65536
    s_nop 0
    buffer_load_dwordx4 v4, s[52:55], s71 offen lds
    buffer_load_dwordx4 v5, s[52:55], s71 offen offset:1024 lds
    s_add_u32 s71, s71, 65536
    s_add_u32 m0, s70, 67584
    s_nop 0
    buffer_load_dwordx4 v21, s[52:55], s71 offen lds
    buffer_load_dwordx4 v22, s[52:55], s71 offen offset:1024 lds
    s_add_u32 s71, s71, 65536
    s_add_u32 m0, s70, 69632
    s_nop 0
    buffer_load_dwordx4 v4, s[52:55], s71 offen lds
    buffer_load_dwordx4 v5, s[52:55], s71 offen offset:1024 lds
    s_add_u32 s71, s71, 65536
    s_add_u32 m0, s70, 71680
    s_nop 0
    buffer_load_dwordx4 v21, s[52:55], s71 offen lds
    buffer_load_dwordx4 v22, s[52:55], s71 offen offset:1024 lds
    s_add_u32 s71, s71, 65536
    s_add_u32 m0, s70, 98304
    s_nop 0
    buffer_load_dwordx4 v4, s[52:55], s71 offen lds
    buffer_load_dwordx4 v5, s[52:55], s71 offen offset:1024 lds
    s_add_u32 s71, s71, 65536
    s_add_u32 m0, s70, 100352
    s_nop 0
    buffer_load_dwordx4 v21, s[52:55], s71 offen lds
    buffer_load_dwordx4 v22, s[52:55], s71 offen offset:1024 lds
    s_add_u32 s71, s71, 65536
    s_add_u32 m0, s70, 102400
    s_nop 0
    buffer_load_dwordx4 v4, s[52:55], s71 offen lds
    buffer_load_dwordx4 v5, s[52:55], s71 offen offset:1024 lds
    s_add_u32 s71, s71, 65536
    s_add_u32 m0, s70, 104448
    s_nop 0
    buffer_load_dwordx4 v21, s[52:55], s71 offen lds
    buffer_load_dwordx4 v22, s[52:55], s71 offen offset:1024 lds
    s_add_u32 s71, s71, 65536
    v_lshrrev_b32 v10, 3, v0
    v_and_b32 v11, 7, v0
    s_lshl_b32 s31, s62, 16
    s_lshl_b32 s32, s63, 7
    s_add_u32 s31, s31, s32
    v_lshlrev_b32 v12, 10, v10
    v_lshl_add_u32 v12, v11, 4, v12
    v_lshrrev_b32 v13, 5, v10
    v_lshlrev_b32 v13, 15, v13
    v_and_b32 v14, 31, v10
    v_mul_u32_u24 v15, 144, v14
    v_add_u32 v15, v15, v13
    v_lshl_add_u32 v13, v14, 4, v13
    v_lshrrev_b32 v14, 1, v11
    v_lshl_add_u32 v13, v14, 10, v13
    v_and_b32 v14, 1, v11
    v_lshl_add_u32 v13, v14, 3, v13
    v_lshrrev_b32 v14, 2, v11
    v_lshl_add_u32 v15, v14, 16, v15
    v_and_b32 v14, 3, v11
    v_lshl_add_u32 v15, v14, 5, v15
    s_lshl_b32 s32, s62, 16
    s_lshl_b32 s33, s63, 12
    s_add_u32 s32, s32, s33
    s_add_u32 s32, s32, 3145728
    s_waitcnt vmcnt(0)
    s_barrier
    s_cmp_eq_u32 s24, 4
    s_cbranch_scc0 Lsy_139
    s_lshl_b32 s42, s72, 11
    s_lshl_b32 s43, s73, 7
    s_add_u32 s42, s42, s43
    s_add_u32 s42, s42, 15728640
    v_min_u32 v27, 13, v1
    v_lshlrev_b32 v27, 2, v27
    v_add_u32 v27, s42, v27
    s_mov_b32 s42, 800003
    s_mov_b32 s43, 0
Lpl_140:
    s_and_b32 s44, s42, 3
    s_cselect_b32 s44, 262144, 0
    buffer_load_dword v26, v27, s[12:15], s44 offen sc1
    s_waitcnt vmcnt(0)
    v_cmp_eq_u32 vcc, s64, v26
    s_nop 0
    s_or_b32 s43, s43, vcc_lo
    s_cmp_eq_u32 s43, -1
    s_cbranch_scc1 Lok_141
    s_sleep 3
    s_sub_u32 s42, s42, 1
    s_cbranch_scc0 Lpl_140
Lok_141:
Lsy_139:
    s_barrier
Lf2y3:
    s_barrier
    buffer_load_dwordx2 v[16:17], v13, s[12:15], s32 offen sc1
    buffer_load_dwordx2 v[18:19], v13, s[12:15], s32 offen offset:512 sc1
Ltfin:
    ds_bpermute_b32 v64, v30, v3 offset:0
    ds_bpermute_b32 v65, v30, v3 offset:4
    ds_bpermute_b32 v66, v30, v3 offset:8
    ds_bpermute_b32 v67, v30, v3 offset:12
    ds_bpermute_b32 v68, v30, v3 offset:16
    ds_bpermute_b32 v69, v30, v3 offset:20
    ds_bpermute_b32 v70, v30, v3 offset:24
    ds_bpermute_b32 v71, v30, v3 offset:28
    s_waitcnt vmcnt(0)
    v_lshlrev_b32 v100, 16, v16
    v_and_b32 v101, 0xffff0000, v16
    v_lshlrev_b32 v102, 16, v17
    v_and_b32 v103, 0xffff0000, v17
    v_lshlrev_b32 v104, 16, v18
    v_and_b32 v105, 0xffff0000, v18
    v_lshlrev_b32 v106, 16, v19
    v_and_b32 v107, 0xffff0000, v19
    s_waitcnt lgkmcnt(0)
    s_barrier
    ds_read_b128 v[32:35], v15 offset:0
    ds_read_b128 v[36:39], v15 offset:16
    ds_read_b128 v[40:43], v15 offset:8192
    ds_read_b128 v[44:47], v15 offset:8208
    ds_read_b128 v[48:51], v15 offset:16384
    ds_read_b128 v[52:55], v15 offset:16400
    ds_read_b128 v[56:59], v15 offset:24576
    ds_read_b128 v[60:63], v15 offset:24592
    s_waitcnt lgkmcnt(4)
    v_pk_add_f32 v[32:33], v[32:33], v[40:41]
    v_pk_add_f32 v[34:35], v[34:35], v[42:43]
    v_pk_add_f32 v[36:37], v[36:37], v[44:45]
    v_pk_add_f32 v[38:39], v[38:39], v[46:47]
    s_waitcnt lgkmcnt(2)
    v_pk_add_f32 v[32:33], v[32:33], v[48:49]
    v_pk_add_f32 v[34:35], v[34:35], v[50:51]
    v_pk_add_f32 v[36:37], v[36:37], v[52:53]
    v_pk_add_f32 v[38:39], v[38:39], v[54:55]
    s_waitcnt lgkmcnt(0)
    v_pk_add_f32 v[32:33], v[32:33], v[56:57]
    v_pk_add_f32 v[34:35], v[34:35], v[58:59]
    v_pk_add_f32 v[36:37], v[36:37], v[60:61]
    v_pk_add_f32 v[38:39], v[38:39], v[62:63]
    v_cvt_pk_bf16_f32 v44, v32, v33
    v_lshlrev_b32 v32, 16, v44
    v_and_b32 v33, 0xffff0000, v44
    v_cvt_pk_bf16_f32 v46, v34, v35
    v_lshlrev_b32 v34, 16, v46
    v_and_b32 v35, 0xffff0000, v46
    v_cvt_pk_bf16_f32 v48, v36, v37
    v_lshlrev_b32 v36, 16, v48
    v_and_b32 v37, 0xffff0000, v48
    v_cvt_pk_bf16_f32 v50, v38, v39
    v_lshlrev_b32 v38, 16, v50
    v_and_b32 v39, 0xffff0000, v50
    v_pk_mul_f32 v[32:33], v[32:33], v[64:65]
    v_pk_mul_f32 v[34:35], v[34:35], v[66:67]
    v_pk_mul_f32 v[36:37], v[36:37], v[68:69]
    v_pk_mul_f32 v[38:39], v[38:39], v[70:71]
    v_cvt_pk_bf16_f32 v44, v32, v33
    v_lshlrev_b32 v32, 16, v44
    v_and_b32 v33, 0xffff0000, v44
    v_cvt_pk_bf16_f32 v46, v34, v35
    v_lshlrev_b32 v34, 16, v46
    v_and_b32 v35, 0xffff0000, v46
    v_cvt_pk_bf16_f32 v48, v36, v37
    v_lshlrev_b32 v36, 16, v48
    v_and_b32 v37, 0xffff0000, v48
    v_cvt_pk_bf16_f32 v50, v38, v39
    v_lshlrev_b32 v38, 16, v50
    v_and_b32 v39, 0xffff0000, v50
    v_pk_add_f32 v[32:33], v[32:33], v[100:101]
    v_pk_add_f32 v[34:35], v[34:35], v[102:103]
    v_pk_add_f32 v[36:37], v[36:37], v[104:105]
    v_pk_add_f32 v[38:39], v[38:39], v[106:107]
    v_cvt_pk_bf16_f32 v40, v32, v33
    v_cvt_pk_bf16_f32 v41, v34, v35
    v_cvt_pk_bf16_f32 v42, v36, v37
    v_cvt_pk_bf16_f32 v43, v38, v39
    buffer_store_dwordx4 v[40:43], v12, s[56:59], s31 offen sc0 sc1
Ldone:
    s_endpgm
Llatesig:
    v_mov_b32 v12, s64
    v_mov_b32 v15, s66
    s_mov_b64 exec, 1
    buffer_store_dword v12, v15, s[12:15], 0 offen sc1
    s_mov_b64 exec, -1
    s_mov_b32 s39, 0
    s_branch Llatesig_bk
Lysvc18:
    s_cmp_ge_u32 s35, s37
    s_cbranch_scc1 Lysvc_ret
    s_add_u32 s35, s35, 1
    s_cmp_ge_u32 s35, s37
    s_cbranch_scc1 Lysvc_last18
    s_waitcnt vmcnt(18)
    s_branch Lysvc_go
Lysvc17:
    s_cmp_ge_u32 s35, s37
    s_cbranch_scc1 Lysvc_ret
    s_add_u32 s35, s35, 1
    s_cmp_ge_u32 s35, s37
    s_cbranch_scc1 Lysvc_last17
    s_waitcnt vmcnt(17)
    s_branch Lysvc_go
Lysvc13:
    s_cmp_ge_u32 s35, s37
    s_cbranch_scc1 Lysvc_ret
    s_add_u32 s35, s35, 1
    s_cmp_ge_u32 s35, s37
    s_cbranch_scc1 Lysvc_last13
    s_waitcnt vmcnt(13)
    s_branch Lysvc_go
Lysvc12:
    s_cmp_ge_u32 s35, s37
    s_cbranch_scc1 Lysvc_ret
    s_add_u32 s35, s35, 1
    s_cmp_ge_u32 s35, s37
    s_cbranch_scc1 Lysvc_last12
    s_waitcnt vmcnt(12)
    s_branch Lysvc_go
Lysvc11:
    s_cmp_ge_u32 s35, s37
    s_cbranch_scc1 Lysvc_ret
    s_add_u32 s35, s35, 1
    s_cmp_ge_u32 s35, s37
    s_cbranch_scc1 Lysvc_last11
    s_waitcnt vmcnt(11)
    s_branch Lysvc_go
Lysvc:
    s_cmp_ge_u32 s35, s37
    s_cbranch_scc1 Lysvc_ret
    s_add_u32 s35, s35, 1
    s_cmp_ge_u32 s35, s37
    s_cbranch_scc1 Lysvc_last9
    s_waitcnt vmcnt(9)
Lysvc_go:
    s_barrier
    s_and_b32 s42, s39, 0xfffffffb
    s_sub_u32 s42, s42, 1
    s_cmp_gt_u32 s42, 1
    s_cbranch_scc1 Lpc_142
    s_call_b64 s[40:41], Lpoll2
Lpc_142:
    s_add_u32 s39, s39, 1
    s_add_u32 m0, s31, s34
    s_nop 0
    buffer_load_dwordx4 v2, s[12:15], s32 offen offset:0 sc1 lds
    buffer_load_dwordx4 v2, s[12:15], s32 offen offset:1024 sc1 lds
    buffer_load_dwordx4 v2, s[12:15], s32 offen offset:2048 sc1 lds
    buffer_load_dwordx4 v2, s[12:15], s32 offen offset:3072 sc1 lds
    s_add_u32 m0, m0, 0x4000
    s_nop 0
    buffer_load_dwordx4 v2, s[12:15], s33 offen offset:0 sc1 lds
    buffer_load_dwordx4 v2, s[12:15], s33 offen offset:1024 sc1 lds
    buffer_load_dwordx4 v2, s[12:15], s33 offen offset:2048 sc1 lds
    buffer_load_dwordx4 v2, s[12:15], s33 offen offset:3072 sc1 lds
    s_add_u32 s32, s32, 0x4000
    s_add_u32 s33, s33, 0x4000
    s_add_u32 s31, s31, 0x8000
    s_cmp_eq_u32 s31, 163840
    s_cselect_b32 s31, 0, s31
    s_add_u32 m0, s31, s34
    s_nop 0
    buffer_load_dwordx4 v2, s[12:15], s32 offen offset:0 sc1 lds
    buffer_load_dwordx4 v2, s[12:15], s32 offen offset:1024 sc1 lds
    buffer_load_dwordx4 v2, s[12:15], s32 offen offset:2048 sc1 lds
    buffer_load_dwordx4 v2, s[12:15], s32 offen offset:3072 sc1 lds
    s_add_u32 m0, m0, 0x4000
    s_nop 0
    buffer_load_dwordx4 v2, s[12:15], s33 offen offset:0 sc1 lds
    buffer_load_dwordx4 v2, s[12:15], s33 offen offset:1024 sc1 lds
    buffer_load_dwordx4 v2, s[12:15], s33 offen offset:2048 sc1 lds
    buffer_load_dwordx4 v2, s[12:15], s33 offen offset:3072 sc1 lds
    s_add_u32 s32, s32, 0x4000
    s_add_u32 s33, s33, 0x4000
    s_add_u32 s31, s31, 0x8000
    s_cmp_eq_u32 s31, 163840
    s_cselect_b32 s31, 0, s31
    buffer_load_dword v7, v9, s[52:55], s61 offen
    s_add_u32 s61, s61, 4096
    s_min_u32 s61, s61, s62
    s_setpc_b64 s[58:59]
Lysvc_last18:
    s_waitcnt vmcnt(10)
    s_barrier
    s_setpc_b64 s[58:59]
Lysvc_last17:
    s_waitcnt vmcnt(9)
    s_barrier
    s_setpc_b64 s[58:59]
Lysvc_last13:
    s_waitcnt vmcnt(5)
    s_barrier
    s_setpc_b64 s[58:59]
Lysvc_last12:
    s_waitcnt vmcnt(4)
    s_barrier
    s_setpc_b64 s[58:59]
Lysvc_last11:
    s_waitcnt vmcnt(3)
    s_barrier
    s_setpc_b64 s[58:59]
Lysvc_last9:
    s_waitcnt vmcnt(1)
    s_barrier
Lysvc_ret:
    s_setpc_b64 s[58:59]
Lpoll2:
    s_cmp_eq_u32 s42, 0
    s_cbranch_scc0 Lpoll2c
    buffer_load_dword v12, v14, s[12:15], 0 offen sc1
    s_setpc_b64 s[40:41]
Lpoll2c:
    s_mov_b32 s42, 200000
Lpl_143:
    v_cmp_ne_u32 vcc, s64, v12
    s_nop 0
    s_cbranch_vccz Lok_144
    s_sub_u32 s42, s42, 1
    s_cbranch_scc1 Lok_144
    s_sleep 4
    buffer_load_dword v12, v14, s[12:15], 0 offen sc1
    s_waitcnt vmcnt(0)
    s_branch Lpl_143
Lok_144:
    v_add_u32 v14, 32, v14
    s_setpc_b64 s[40:41]
Lfb_36:
    s_call_b64 s[40:41], Lfallback1
    s_branch Lbk_37
Lfb_38:
    s_call_b64 s[40:41], Lfallback0
    s_branch Lbk_39
Lfb_40:
    s_call_b64 s[40:41], Lfallback1
    s_branch Lbk_41
Lfb_42:
    s_call_b64 s[40:41], Lfallback0
    s_branch Lbk_43
Lfb_44:
    s_call_b64 s[40:41], Lfallback1
    s_branch Lbk_45
Lfb_46:
    s_call_b64 s[40:41], Lfallback0
    s_branch Lbk_47
Lfb_48:
    s_call_b64 s[40:41], Lfallback1
    s_branch Lbk_49
Lfb_50:
    s_call_b64 s[40:41], Lfallback0
    s_branch Lbk_51
Lfb_52:
    s_call_b64 s[40:41], Lfallback1
    s_branch Lbk_53
Lfb_54:
    s_call_b64 s[40:41], Lfallback0
    s_branch Lbk_55
Lfb_56:
    s_call_b64 s[40:41], Lfallback1
    s_branch Lbk_57
Lfb_59:
    s_call_b64 s[40:41], Lfallback1
    s_branch Lbk_60
Lfb_61:
    s_call_b64 s[40:41], Lfallback0
    s_branch Lbk_62
Lfb_63:
    s_call_b64 s[40:41], Lfallback1
    s_branch Lbk_64
Lfb_66:
    s_call_b64 s[40:41], Lfallback0
    s_branch Lbk_67
Lfb_68:
    s_call_b64 s[40:41], Lfallback1
    s_branch Lbk_69
Lfb_70:
    s_call_b64 s[40:41], Lfallback0
    s_branch Lbk_71
Lfb_72:
    s_call_b64 s[40:41], Lfallback1
    s_branch Lbk_73
Lfb_75:
    s_call_b64 s[40:41], Lfallback0
    s_branch Lbk_76
Lfb_77:
    s_call_b64 s[40:41], Lfallback1
    s_branch Lbk_78
Lfb_79:
    s_call_b64 s[40:41], Lfallback0
    s_branch Lbk_80
Lfb_81:
    s_call_b64 s[40:41], Lfallback1
    s_branch Lbk_82
Lfb_83:
    s_call_b64 s[40:41], Lfallback0
    s_branch Lbk_84
Lfb_86:
    s_call_b64 s[40:41], Lfallback1
    s_branch Lbk_87
Lfb_89:
    s_call_b64 s[40:41], Lfallback0
    s_branch Lbk_90
Lfb_92:
    s_call_b64 s[40:41], Lfallback1
    s_branch Lbk_93
Lfb_95:
    s_call_b64 s[40:41], Lfallback0
    s_branch Lbk_96
Lfallback0:
    s_nop 15
    s_nop 7
    v_max3_f32 v80, v16, v17, v18
    v_max3_f32 v80, v80, v19, v20
    v_max3_f32 v80, v80, v21, v22
    v_max_f32 v80, v80, v23
    v_max3_f32 v81, v24, v25, v26
    v_max3_f32 v81, v81, v27, v28
    v_max3_f32 v81, v81, v29, v30
    v_max_f32 v81, v81, v31
    v_mov_b32 v82, v80
    v_mov_b32 v83, v81
    s_nop 0
    v_permlane16_swap_b32 v82, v80
    v_permlane16_swap_b32 v83, v81
    v_max_f32 v80, v80, v82
    v_max_f32 v81, v81, v83
    v_mov_b32 v82, v80
    v_mov_b32 v83, v81
    s_nop 0
    v_permlane32_swap_b32 v82, v80
    v_permlane32_swap_b32 v83, v81
    v_max_f32 v80, v80, v82
    v_max_f32 v81, v81, v83
    v_add_f32 v80, 0x42000000, v80
    v_add_f32 v81, 0x42000000, v81
    v_max_f32 v80, 0, v80
    v_max_f32 v81, 0, v81
    v_exp_f32 v82, -v80
    v_exp_f32 v83, -v81
    v_sub_f32 v48, v48, v80
    v_sub_f32 v49, v49, v80
    v_sub_f32 v50, v50, v80
    v_sub_f32 v51, v51, v80
    v_sub_f32 v52, v52, v81
    v_sub_f32 v53, v53, v81
    v_sub_f32 v54, v54, v81
    v_sub_f32 v55, v55, v81
    v_sub_f32 v16, v16, v80
    v_sub_f32 v32, v32, v80
    v_sub_f32 v17, v17, v80
    v_sub_f32 v33, v33, v80
    v_sub_f32 v18, v18, v80
    v_sub_f32 v34, v34, v80
    v_sub_f32 v19, v19, v80
    v_sub_f32 v35, v35, v80
    v_sub_f32 v20, v20, v80
    v_sub_f32 v36, v36, v80
    v_sub_f32 v21, v21, v80
    v_sub_f32 v37, v37, v80
    v_sub_f32 v22, v22, v80
    v_sub_f32 v38, v38, v80
    v_sub_f32 v23, v23, v80
    v_sub_f32 v39, v39, v80
    v_sub_f32 v24, v24, v81
    v_sub_f32 v40, v40, v81
    v_sub_f32 v25, v25, v81
    v_sub_f32 v41, v41, v81
    v_sub_f32 v26, v26, v81
    v_sub_f32 v42, v42, v81
    v_sub_f32 v27, v27, v81
    v_sub_f32 v43, v43, v81
    v_sub_f32 v28, v28, v81
    v_sub_f32 v44, v44, v81
    v_sub_f32 v29, v29, v81
    v_sub_f32 v45, v45, v81
    v_sub_f32 v30, v30, v81
    v_sub_f32 v46, v46, v81
    v_sub_f32 v31, v31, v81
    v_sub_f32 v47, v47, v81
    v_mul_f32 v56, v56, v82
    v_mul_f32 v57, v57, v82
    v_mul_f32 v58, v58, v82
    v_mul_f32 v59, v59, v82
    v_mul_f32 v60, v60, v83
    v_mul_f32 v61, v61, v83
    v_mul_f32 v62, v62, v83
    v_mul_f32 v63, v63, v83
    v_mul_f32 v128, v128, v82
    v_mul_f32 v129, v129, v82
    v_mul_f32 v130, v130, v82
    v_mul_f32 v131, v131, v82
    v_mul_f32 v132, v132, v82
    v_mul_f32 v133, v133, v82
    v_mul_f32 v134, v134, v82
    v_mul_f32 v135, v135, v82
    v_mul_f32 v136, v136, v83
    v_mul_f32 v137, v137, v83
    v_mul_f32 v138, v138, v83
    v_mul_f32 v139, v139, v83
    v_mul_f32 v140, v140, v83
    v_mul_f32 v141, v141, v83
    v_mul_f32 v142, v142, v83
    v_mul_f32 v143, v143, v83
    v_mul_f32 v144, v144, v82
    v_mul_f32 v145, v145, v82
    v_mul_f32 v146, v146, v82
    v_mul_f32 v147, v147, v82
    v_mul_f32 v148, v148, v82
    v_mul_f32 v149, v149, v82
    v_mul_f32 v150, v150, v82
    v_mul_f32 v151, v151, v82
    v_mul_f32 v152, v152, v83
    v_mul_f32 v153, v153, v83
    v_mul_f32 v154, v154, v83
    v_mul_f32 v155, v155, v83
    v_mul_f32 v156, v156, v83
    v_mul_f32 v157, v157, v83
    v_mul_f32 v158, v158, v83
    v_mul_f32 v159, v159, v83
    v_mul_f32 v160, v160, v82
    v_mul_f32 v161, v161, v82
    v_mul_f32 v162, v162, v82
    v_mul_f32 v163, v163, v82
    v_mul_f32 v164, v164, v82
    v_mul_f32 v165, v165, v82
    v_mul_f32 v166, v166, v82
    v_mul_f32 v167, v167, v82
    v_mul_f32 v168, v168, v83
    v_mul_f32 v169, v169, v83
    v_mul_f32 v170, v170, v83
    v_mul_f32 v171, v171, v83
    v_mul_f32 v172, v172, v83
    v_mul_f32 v173, v173, v83
    v_mul_f32 v174, v174, v83
    v_mul_f32 v175, v175, v83
    v_mul_f32 v176, v176, v82
    v_mul_f32 v177, v177, v82
    v_mul_f32 v178, v178, v82
    v_mul_f32 v179, v179, v82
    v_mul_f32 v180, v180, v82
    v_mul_f32 v181, v181, v82
    v_mul_f32 v182, v182, v82
    v_mul_f32 v183, v183, v82
    v_mul_f32 v184, v184, v83
    v_mul_f32 v185, v185, v83
    v_mul_f32 v186, v186, v83
    v_mul_f32 v187, v187, v83
    v_mul_f32 v188, v188, v83
    v_mul_f32 v189, v189, v83
    v_mul_f32 v190, v190, v83
    v_mul_f32 v191, v191, v83
    v_exp_f32 v80, v16
    v_exp_f32 v81, v17
    v_exp_f32 v82, v18
    v_cvt_pk_bf16_f32 v64, v80, v81
    v_exp_f32 v83, v19
    v_exp_f32 v84, v20
    v_cvt_pk_bf16_f32 v65, v82, v83
    v_exp_f32 v85, v21
    v_exp_f32 v86, v22
    v_cvt_pk_bf16_f32 v66, v84, v85
    v_or3_b32 v94, v64, v65, v66
    v_exp_f32 v87, v23
    v_exp_f32 v80, v24
    v_cvt_pk_bf16_f32 v67, v86, v87
    v_exp_f32 v81, v25
    v_exp_f32 v82, v26
    v_cvt_pk_bf16_f32 v68, v80, v81
    v_or3_b32 v94, v94, v67, v68
    v_exp_f32 v83, v27
    v_exp_f32 v84, v28
    v_cvt_pk_bf16_f32 v69, v82, v83
    v_exp_f32 v85, v29
    v_exp_f32 v86, v30
    v_cvt_pk_bf16_f32 v70, v84, v85
    v_or3_b32 v94, v94, v69, v70
    v_exp_f32 v87, v31
    s_nop 0
    v_cvt_pk_bf16_f32 v71, v86, v87
    v_bitop3_b32 v94, v94, v71, s38 bitop3:0xa8
    s_nop 3
    s_setpc_b64 s[40:41]
Lfallback1:
    s_nop 15
    s_nop 7
    v_max3_f32 v80, v32, v33, v34
    v_max3_f32 v80, v80, v35, v36
    v_max3_f32 v80, v80, v37, v38
    v_max_f32 v80, v80, v39
    v_max3_f32 v81, v40, v41, v42
    v_max3_f32 v81, v81, v43, v44
    v_max3_f32 v81, v81, v45, v46
    v_max_f32 v81, v81, v47
    v_mov_b32 v82, v80
    v_mov_b32 v83, v81
    s_nop 0
    v_permlane16_swap_b32 v82, v80
    v_permlane16_swap_b32 v83, v81
    v_max_f32 v80, v80, v82
    v_max_f32 v81, v81, v83
    v_mov_b32 v82, v80
    v_mov_b32 v83, v81
    s_nop 0
    v_permlane32_swap_b32 v82, v80
    s_nop 0
    v_permlane32_swap_b32 v83, v81
    v_max_f32 v80, v80, v82
    v_max_f32 v81, v81, v83
    v_add_f32 v80, 0x42000000, v80
    v_add_f32 v81, 0x42000000, v81
    v_max_f32 v80, 0, v80
    v_max_f32 v81, 0, v81
    v_exp_f32 v82, -v80
    v_exp_f32 v83, -v81
    v_sub_f32 v48, v48, v80
    v_sub_f32 v49, v49, v80
    v_sub_f32 v50, v50, v80
    v_sub_f32 v51, v51, v80
    v_sub_f32 v52, v52, v81
    v_sub_f32 v53, v53, v81
    v_sub_f32 v54, v54, v81
    v_sub_f32 v55, v55, v81
    v_sub_f32 v16, v16, v80
    v_sub_f32 v32, v32, v80
    v_sub_f32 v17, v17, v80
    v_sub_f32 v33, v33, v80
    v_sub_f32 v18, v18, v80
    v_sub_f32 v34, v34, v80
    v_sub_f32 v19, v19, v80
    v_sub_f32 v35, v35, v80
    v_sub_f32 v20, v20, v80
    v_sub_f32 v36, v36, v80
    v_sub_f32 v21, v21, v80
    v_sub_f32 v37, v37, v80
    v_sub_f32 v22, v22, v80
    v_sub_f32 v38, v38, v80
    v_sub_f32 v23, v23, v80
    v_sub_f32 v39, v39, v80
    v_sub_f32 v24, v24, v81
    v_sub_f32 v40, v40, v81
    v_sub_f32 v25, v25, v81
    v_sub_f32 v41, v41, v81
    v_sub_f32 v26, v26, v81
    v_sub_f32 v42, v42, v81
    v_sub_f32 v27, v27, v81
    v_sub_f32 v43, v43, v81
    v_sub_f32 v28, v28, v81
    v_sub_f32 v44, v44, v81
    v_sub_f32 v29, v29, v81
    v_sub_f32 v45, v45, v81
    v_sub_f32 v30, v30, v81
    v_sub_f32 v46, v46, v81
    v_sub_f32 v31, v31, v81
    v_sub_f32 v47, v47, v81
    v_mul_f32 v56, v56, v82
    v_mul_f32 v57, v57, v82
    v_mul_f32 v58, v58, v82
    v_mul_f32 v59, v59, v82
    v_mul_f32 v60, v60, v83
    v_mul_f32 v61, v61, v83
    v_mul_f32 v62, v62, v83
    v_mul_f32 v63, v63, v83
    v_mul_f32 v128, v128, v82
    v_mul_f32 v129, v129, v82
    v_mul_f32 v130, v130, v82
    v_mul_f32 v131, v131, v82
    v_mul_f32 v132, v132, v82
    v_mul_f32 v133, v133, v82
    v_mul_f32 v134, v134, v82
    v_mul_f32 v135, v135, v82
    v_mul_f32 v136, v136, v83
    v_mul_f32 v137, v137, v83
    v_mul_f32 v138, v138, v83
    v_mul_f32 v139, v139, v83
    v_mul_f32 v140, v140, v83
    v_mul_f32 v141, v141, v83
    v_mul_f32 v142, v142, v83
    v_mul_f32 v143, v143, v83
    v_mul_f32 v144, v144, v82
    v_mul_f32 v145, v145, v82
    v_mul_f32 v146, v146, v82
    v_mul_f32 v147, v147, v82
    v_mul_f32 v148, v148, v82
    v_mul_f32 v149, v149, v82
    v_mul_f32 v150, v150, v82
    v_mul_f32 v151, v151, v82
    v_mul_f32 v152, v152, v83
    v_mul_f32 v153, v153, v83
    v_mul_f32 v154, v154, v83
    v_mul_f32 v155, v155, v83
    v_mul_f32 v156, v156, v83
    v_mul_f32 v157, v157, v83
    v_mul_f32 v158, v158, v83
    v_mul_f32 v159, v159, v83
    v_mul_f32 v160, v160, v82
    v_mul_f32 v161, v161, v82
    v_mul_f32 v162, v162, v82
    v_mul_f32 v163, v163, v82
    v_mul_f32 v164, v164, v82
    v_mul_f32 v165, v165, v82
    v_mul_f32 v166, v166, v82
    v_mul_f32 v167, v167, v82
    v_mul_f32 v168, v168, v83
    v_mul_f32 v169, v169, v83
    v_mul_f32 v170, v170, v83
    v_mul_f32 v171, v171, v83
    v_mul_f32 v172, v172, v83
    v_mul_f32 v173, v173, v83
    v_mul_f32 v174, v174, v83
    v_mul_f32 v175, v175, v83
    v_mul_f32 v176, v176, v82
    v_mul_f32 v177, v177, v82
    v_mul_f32 v178, v178, v82
    v_mul_f32 v179, v179, v82
    v_mul_f32 v180, v180, v82
    v_mul_f32 v181, v181, v82
    v_mul_f32 v182, v182, v82
    v_mul_f32 v183, v183, v82
    v_mul_f32 v184, v184, v83
    v_mul_f32 v185, v185, v83
    v_mul_f32 v186, v186, v83
    v_mul_f32 v187, v187, v83
    v_mul_f32 v188, v188, v83
    v_mul_f32 v189, v189, v83
    v_mul_f32 v190, v190, v83
    v_mul_f32 v191, v191, v83
    v_exp_f32 v80, v32
    v_exp_f32 v81, v33
    v_exp_f32 v82, v34
    v_cvt_pk_bf16_f32 v72, v80, v81
    v_exp_f32 v83, v35
    v_exp_f32 v84, v36
    v_cvt_pk_bf16_f32 v73, v82, v83
    v_exp_f32 v85, v37
    v_exp_f32 v86, v38
    v_cvt_pk_bf16_f32 v74, v84, v85
    v_or3_b32 v94, v72, v73, v74
    v_exp_f32 v87, v39
    v_exp_f32 v80, v40
    v_cvt_pk_bf16_f32 v75, v86, v87
    v_exp_f32 v81, v41
    v_exp_f32 v82, v42
    v_cvt_pk_bf16_f32 v76, v80, v81
    v_or3_b32 v94, v94, v75, v76
    v_exp_f32 v83, v43
    v_exp_f32 v84, v44
    v_cvt_pk_bf16_f32 v77, v82, v83
    v_exp_f32 v85, v45
    v_exp_f32 v86, v46
    v_cvt_pk_bf16_f32 v78, v84, v85
    v_or3_b32 v94, v94, v77, v78
    v_exp_f32 v87, v47
    s_nop 0
    v_cvt_pk_bf16_f32 v79, v86, v87
    v_bitop3_b32 v94, v94, v79, s38 bitop3:0xa8
    s_nop 3
    s_setpc_b64 s[40:41]
CODE_END:
    s_endpgm
.section .rodata,"a"
.p2align 6
.amdhsa_kernel adaLN_cond__compressed_kv_cla__dense_activation_mish__prompt_kernel
  .amdhsa_next_free_vgpr 256
  .amdhsa_next_free_sgpr 102
  .amdhsa_accum_offset 256
  .amdhsa_group_segment_fixed_size 0
  .amdhsa_kernarg_size 120
  .amdhsa_user_sgpr_count 2
  .amdhsa_user_sgpr_kernarg_segment_ptr 1
  .amdhsa_system_sgpr_workgroup_id_x 1
.end_amdhsa_kernel
```
